```python
import torch

def _softmax(x, axis=-1):
    return torch.softmax(x, dim=axis)

def _gelu(x):
    return torch.nn.functional.gelu(x, approximate='tanh')

def _silu(x):
    return torch.nn.functional.silu(x)

def _sigmoid(x):
    return torch.sigmoid(x)

def _layernorm(x, axis=-1, eps=1e-05):
    m = x.mean(dim=axis, keepdim=True)
    v = x.var(dim=axis, keepdim=True, unbiased=False)
    return (x - m) / torch.sqrt(v + eps)

def _scatter_add(tgt, idx, src, axis=0):
    return tgt.clone().index_add_(axis, idx, src)

def _segment_sum(src, seg, n):
    out = torch.zeros((n,) + src.shape[1:], dtype=src.dtype)
    return out.index_add_(0, seg, src)

def _pad(x, pw):
    flat = tuple((v for pair in reversed(pw) for v in pair))
    return torch.nn.functional.pad(x, flat)
kernel_name = 'interleave_layers__memory_aug_recurrent_mem_tr__spectral_gfnet__prompt'

def setup_inputs():

    _w = lambda a: (lambda t: t.to(torch.bfloat16) if t.is_floating_point() else t)(torch.as_tensor(a))

    def _A_setup():
        B, S, Dm = (1, 2048, 512)
        H, Dh = (32, 128)
        M, seg = (8, 32)
        seg = min(seg, S)
        S = S // seg * seg
        return {'x': _w((lambda *s: torch.randn(*s, dtype=torch.bfloat16) * 0.05)(B, S, Dm)), 'mem0': _w((lambda *s: torch.randn(*s, dtype=torch.bfloat16) * 0.2)(B, M, Dm)), 'Wq': _w((lambda *s: torch.randn(*s, dtype=torch.bfloat16) * 1.6)(Dm, H, Dh) * Dm ** (-0.5)), 'Wk': _w((lambda *s: torch.randn(*s, dtype=torch.bfloat16) * 1.6)(Dm, H, Dh) * Dm ** (-0.5)), 'Wv': _w((lambda *s: torch.randn(*s, dtype=torch.bfloat16) * 0.2)(Dm, H, Dh) * Dm ** (-0.5)), 'Wo': _w((lambda *s: torch.randn(*s, dtype=torch.bfloat16) * 0.2)(H, Dh, Dm) * (H * Dh) ** (-0.5)), 'seg_len': seg}
    _A_in = _A_setup()

    def _B_setup():
        B, S, D = (1, 2048, 512)
        Df = D // 2 + 1
        return {'x': _w((lambda *s: torch.randn(*s, dtype=torch.bfloat16) * 0.05)(B, S, D)), 'w_r': _w((lambda *s: torch.randn(*s, dtype=torch.bfloat16) * 0.4)(S, Df) * 0.02), 'w_i': _w((lambda *s: torch.randn(*s, dtype=torch.bfloat16) * 0.4)(S, Df) * 0.02)}
    _B_in = _B_setup()
    return {'A_x': _A_in['x'], 'A_mem0': _A_in['mem0'], 'A_Wq': _A_in['Wq'], 'A_Wk': _A_in['Wk'], 'A_Wv': _A_in['Wv'], 'A_Wo': _A_in['Wo'], 'A_seg_len': _A_in['seg_len'], 'B_x': _B_in['x'], 'B_w_r': _B_in['w_r'], 'B_w_i': _B_in['w_i']}

def reference(A_x, A_mem0, A_Wq, A_Wk, A_Wv, A_Wo, A_seg_len, B_x, B_w_r, B_w_i):

    def _A_ref(x, mem0, Wq, Wk, Wv, Wo, seg_len):
        B, S, Dm = x.shape
        H, Dh = (Wq.shape[1], Wq.shape[2])
        M = mem0.shape[1]
        scale = Dh ** (-0.5)
        n_seg = S // seg_len
        L = M + seg_len
        idx = torch.arange(L)
        mask = (idx[:, None] < M) | (idx[:, None] >= idx[None, :])
        mem = mem0
        outs = []
        for s in range(n_seg):
            xs = x[:, s * seg_len:(s + 1) * seg_len, :].clone()
            h = torch.concatenate([mem, xs], axis=1)
            q = torch.einsum('btd,dhe->bhte', h, Wq)
            k = torch.einsum('btd,dhe->bhte', h, Wk)
            v = torch.einsum('btd,dhe->bhte', h, Wv)
            scores = torch.einsum('bhqe,bhke->bhqk', q, k) * scale
            scores = torch.where(mask[None, None], scores, -1000000000.0)
            p = _softmax(scores, axis=-1)
            o = torch.einsum('bhqk,bhke->bhqe', p, v)
            o = torch.einsum('bhte,hed->btd', o, Wo)
            mem = o[:, :M, :].clone()
            outs.append(o[:, M:, :])
        return torch.concatenate(outs, axis=1)

    def _B_ref(x, w_r, w_i):
        B, S, D = x.shape
        X = (lambda x, axes=(-2, -1): torch.fft.rfft2(x.float(), dim=axes))(x, axes=(-2, -1))
        W = w_r + 1j * w_i
        X = X * W
        y = (lambda x, s, axes=(-2, -1): torch.fft.irfft2(x, s=s, dim=axes).to(torch.bfloat16))(X, (S, D), axes=(-2, -1))
        return y
    x = A_x
    x = x + _A_ref(_layernorm(x, axis=-1), A_mem0, A_Wq, A_Wk, A_Wv, A_Wo, A_seg_len)
    x = x + _B_ref(_layernorm(x, axis=-1), B_w_r, B_w_i)
    x = x + _A_ref(_layernorm(x, axis=-1), A_mem0, A_Wq, A_Wk, A_Wv, A_Wo, A_seg_len)
    x = x + _B_ref(_layernorm(x, axis=-1), B_w_r, B_w_i)
    return x
```

```asm
; @launch grid=(256,1,1) block=(256,1,1) lds=163840
.amdgcn_target "amdgcn-amd-amdhsa--gfx950"
.macro QAA a:vararg
ds_read_b64_tr_b16 \a
.endm
.macro QAB a:vararg
v_mfma_f32_32x32x16_bf16 \a
.endm
.macro QAC a:vararg
v_smfmac_f32_16x16x64_bf16 \a
.endm
.macro QAD a:vararg
buffer_load_dwordx4 \a
.endm
.macro QAE a:vararg
v_cvt_pk_bf16_f32 \a
.endm
.macro QAF a:vararg
s_add_u32 \a
.endm
.macro QAG a:vararg
ds_read_b128 \a
.endm
.macro QAH a:vararg
s_waitcnt \a
.endm
.macro QAI a:vararg
v_lshlrev_b32 \a
.endm
.macro QAJ a:vararg
v_mfma_f32_16x16x32_bf16 \a
.endm
.macro QAK a:vararg
v_accvgpr_read_b32 \a
.endm
.macro QAL a:vararg
buffer_store_dwordx4 \a
.endm
.macro QAM a:vararg
v_and_b32 \a
.endm
.macro QAN a:vararg
v_pk_add_f32 \a
.endm
.macro QAP a:vararg
v_pk_fma_f32 \a
.endm
.macro QAQ a:vararg
v_mov_b32 \a
.endm
.macro QAR a:vararg
v_mov_b64 \a
.endm
.macro QAS a:vararg
s_lshl_b32 \a
.endm
.macro QAT a:vararg
s_mov_b32 \a
.endm
.macro QAU a:vararg
v_add_f32 \a
.endm
.macro QAV a:vararg
v_max3_u32 \a
.endm
.macro QAW a:vararg
v_mul_f32 \a
.endm
.macro QAX a:vararg
v_cndmask_b32 \a
.endm
.macro QAY a:vararg
ds_write_b128 \a
.endm
.macro QBA a:vararg
v_exp_f32 \a
.endm
.macro QBC a:vararg
v_lshl_add_u32 \a
.endm
.macro QBD a:vararg
v_mfma_f32_16x16x16_bf16 \a
.endm
.macro QBE a:vararg
v_readlane_b32 \a
.endm
.macro QBF a:vararg
v_add_u32 \a
.endm
.macro QBG a:vararg
v_bitop3_b32 \a
.endm
.macro QBH a:vararg
v_xor_b32 \a
.endm
.macro QBI a:vararg
v_pk_mul_f32 \a
.endm
.macro QBJ a:vararg
s_cmp_lg_u32 \a
.endm
.macro QBK a:vararg
s_cmp_ge_u32 \a
.endm
.macro QBL a:vararg
s_cselect_b32 \a
.endm
.macro QBN a:vararg
s_cmp_lt_u32 \a
.endm
.macro QBO a:vararg
s_and_b32 \a
.endm
.macro QBP a:vararg
v_cmp_eq_u32 \a
.endm
.macro QBQ a:vararg
v_max3_f32 \a
.endm
.macro QBR a:vararg
buffer_load_dword \a
.endm
.macro QBS a:vararg
s_cmp_eq_u32 \a
.endm
.macro QBT a:vararg
buffer_store_dwordx2 \a
.endm
.macro QBV a:vararg
v_sub_f32 \a
.endm
.macro QBW a:vararg
v_lshrrev_b32 \a
.endm
.macro QBY a:vararg
s_mov_b64 \a
.endm
.macro QBZ a:vararg
buffer_load_ushort \a
.endm
.macro QCA a:vararg
v_readfirstlane_b32 \a
.endm
.macro QCB a:vararg
s_lshr_b32 \a
.endm
.macro QCC a:vararg
v_bfe_u32 \a
.endm
.macro QCD a:vararg
buffer_store_dword \a
.endm
.macro QCE a:vararg
v_add_f32_dpp \a
.endm
.macro QCF a:vararg
v_mov_b32_dpp \a
.endm
.macro QCG a:vararg
ds_write_b64 \a
.endm
.macro QCH a:vararg
v_permlane32_swap_b32 \a
.endm
.text
.globl interleave_layers__memory_aug_recurrent_mem_tr__spectral_gfnet__prompt_kernel
.p2align 8
.type interleave_layers__memory_aug_recurrent_mem_tr__spectral_gfnet__prompt_kernel,@function
interleave_layers__memory_aug_recurrent_mem_tr__spectral_gfnet__prompt_kernel:
QBK s2,256
s_cbranch_scc1 lay_end
s_load_dwordx2 s[4:5],s[0:1],96
s_load_dwordx4 s[40:43],s[0:1],16
s_load_dwordx4 s[44:47],s[0:1],32
s_load_dwordx2 s[48:49],s[0:1],8
s_load_dwordx2 s[76:77],s[0:1],0
s_load_dwordx2 s[78:79],s[0:1],64
s_load_dwordx4 s[80:83],s[0:1],72
s_load_dwordx2 s[6:7],s[0:1],88
s_getreg_b32 s8,hwreg(HW_REG_XCC_ID)
QBW v1,6,v0
QAM v0,63,v0
QCA s9,v1
QBO s8,s8,15
QAI v1,4,v0
QAT s56,60817408
QAH lgkmcnt(0)
QAT s16,s4
QAT s17,s5
QAT s18,268435456
QAT s19,0x20000
QAT s92,s6
QAT s93,s7
QAT s94,256
QAT s95,0x20000
QAS s10,s8,2
QAF s10,s10,128
QBS s8,0
QBL s10,0,s10
QAQ v200,1
QAT s61,0
QCB s66,s2,2
QBS s8,0
s_cbranch_scc1 lay_tkx
s_bitcmp0_b32 s2,1
s_cbranch_scc1 lay_ln
lay_tkx:
QBJ s9,s61
s_cbranch_scc1 lay_tk0a
QBY exec,1
buffer_atomic_add v200,off,s[92:95],s10 sc0
QBY exec,-1
lay_tk0a:
s_branch lay_tk1
lay_ln:
QAS s61,s61,2
QAT s20,s76
QAT s21,s77
QAT s22,2097152
QAT s23,0x20000
QBW v2,5,v0
QAM v3,31,v0
QAI v4,10,v3
QBC v4,v2,4,v4
QAS s12,s66,15
QAS s13,s9,8
QAF s13,s13,s12
QAS s14,s9,13
QAF s14,s14,s12
QAF s26,s14,2097152
QAF s24,s26,4096
QAF s25,s14,4096
QAI v5,3,v3
QAD v[16:19],v4,s[20:23],s13 offen offset:0
QAD v[20:23],v4,s[20:23],s13 offen offset:32
QAD v[24:27],v4,s[20:23],s13 offen offset:64
QAD v[28:31],v4,s[20:23],s13 offen offset:96
QAD v[32:35],v4,s[20:23],s13 offen offset:128
QAD v[36:39],v4,s[20:23],s13 offen offset:160
QAD v[40:43],v4,s[20:23],s13 offen offset:192
QAD v[44:47],v4,s[20:23],s13 offen offset:224
QAH vmcnt(0)
QBJ s9,s61
s_cbranch_scc1 lay_tk0b
QBY exec,1
buffer_atomic_add v200,off,s[92:95],s10 sc0
QBY exec,-1
lay_tk0b:
QAI v64,16,v16
QAM v65,0xffff0000,v16
QAI v66,16,v17
QAM v67,0xffff0000,v17
QAI v68,16,v18
QAM v69,0xffff0000,v18
QAI v70,16,v19
QAM v71,0xffff0000,v19
QAI v72,16,v20
QAM v73,0xffff0000,v20
QAI v74,16,v21
QAM v75,0xffff0000,v21
QAI v76,16,v22
QAM v77,0xffff0000,v22
QAI v78,16,v23
QAM v79,0xffff0000,v23
QAI v80,16,v24
QAM v81,0xffff0000,v24
QAI v82,16,v25
QAM v83,0xffff0000,v25
QAI v84,16,v26
QAM v85,0xffff0000,v26
QAI v86,16,v27
QAM v87,0xffff0000,v27
QAI v88,16,v28
QAM v89,0xffff0000,v28
QAI v90,16,v29
QAM v91,0xffff0000,v29
QAI v92,16,v30
QAM v93,0xffff0000,v30
QAI v94,16,v31
QAM v95,0xffff0000,v31
QAI v96,16,v32
QAM v97,0xffff0000,v32
QAI v98,16,v33
QAM v99,0xffff0000,v33
QAI v100,16,v34
QAM v101,0xffff0000,v34
QAI v102,16,v35
QAM v103,0xffff0000,v35
QAI v104,16,v36
QAM v105,0xffff0000,v36
QAI v106,16,v37
QAM v107,0xffff0000,v37
QAI v108,16,v38
QAM v109,0xffff0000,v38
QAI v110,16,v39
QAM v111,0xffff0000,v39
QAI v112,16,v40
QAM v113,0xffff0000,v40
QAI v114,16,v41
QAM v115,0xffff0000,v41
QAI v116,16,v42
QAM v117,0xffff0000,v42
QAI v118,16,v43
QAM v119,0xffff0000,v43
QAI v120,16,v44
QAM v121,0xffff0000,v44
QAI v122,16,v45
QAM v123,0xffff0000,v45
QAI v124,16,v46
QAM v125,0xffff0000,v46
QAI v126,16,v47
QAM v127,0xffff0000,v47
QAN v[6:7],v[64:65],v[66:67]
QBI v[8:9],v[64:65],v[64:65]
QAP v[8:9],v[66:67],v[66:67],v[8:9]
QAN v[6:7],v[6:7],v[68:69]
QAP v[8:9],v[68:69],v[68:69],v[8:9]
QAN v[6:7],v[6:7],v[70:71]
QAP v[8:9],v[70:71],v[70:71],v[8:9]
QAN v[6:7],v[6:7],v[72:73]
QAP v[8:9],v[72:73],v[72:73],v[8:9]
QAN v[6:7],v[6:7],v[74:75]
QAP v[8:9],v[74:75],v[74:75],v[8:9]
QAN v[6:7],v[6:7],v[76:77]
QAP v[8:9],v[76:77],v[76:77],v[8:9]
QAN v[6:7],v[6:7],v[78:79]
QAP v[8:9],v[78:79],v[78:79],v[8:9]
QAN v[6:7],v[6:7],v[80:81]
QAP v[8:9],v[80:81],v[80:81],v[8:9]
QAN v[6:7],v[6:7],v[82:83]
QAP v[8:9],v[82:83],v[82:83],v[8:9]
QAN v[6:7],v[6:7],v[84:85]
QAP v[8:9],v[84:85],v[84:85],v[8:9]
QAN v[6:7],v[6:7],v[86:87]
QAP v[8:9],v[86:87],v[86:87],v[8:9]
QAN v[6:7],v[6:7],v[88:89]
QAP v[8:9],v[88:89],v[88:89],v[8:9]
QAN v[6:7],v[6:7],v[90:91]
QAP v[8:9],v[90:91],v[90:91],v[8:9]
QAN v[6:7],v[6:7],v[92:93]
QAP v[8:9],v[92:93],v[92:93],v[8:9]
QAN v[6:7],v[6:7],v[94:95]
QAP v[8:9],v[94:95],v[94:95],v[8:9]
QAN v[6:7],v[6:7],v[96:97]
QAP v[8:9],v[96:97],v[96:97],v[8:9]
QAN v[6:7],v[6:7],v[98:99]
QAP v[8:9],v[98:99],v[98:99],v[8:9]
QAN v[6:7],v[6:7],v[100:101]
QAP v[8:9],v[100:101],v[100:101],v[8:9]
QAN v[6:7],v[6:7],v[102:103]
QAP v[8:9],v[102:103],v[102:103],v[8:9]
QAN v[6:7],v[6:7],v[104:105]
QAP v[8:9],v[104:105],v[104:105],v[8:9]
QAN v[6:7],v[6:7],v[106:107]
QAP v[8:9],v[106:107],v[106:107],v[8:9]
QAN v[6:7],v[6:7],v[108:109]
QAP v[8:9],v[108:109],v[108:109],v[8:9]
QAN v[6:7],v[6:7],v[110:111]
QAP v[8:9],v[110:111],v[110:111],v[8:9]
QAN v[6:7],v[6:7],v[112:113]
QAP v[8:9],v[112:113],v[112:113],v[8:9]
QAN v[6:7],v[6:7],v[114:115]
QAP v[8:9],v[114:115],v[114:115],v[8:9]
QAN v[6:7],v[6:7],v[116:117]
QAP v[8:9],v[116:117],v[116:117],v[8:9]
QAN v[6:7],v[6:7],v[118:119]
QAP v[8:9],v[118:119],v[118:119],v[8:9]
QAN v[6:7],v[6:7],v[120:121]
QAP v[8:9],v[120:121],v[120:121],v[8:9]
QAN v[6:7],v[6:7],v[122:123]
QAP v[8:9],v[122:123],v[122:123],v[8:9]
QAN v[6:7],v[6:7],v[124:125]
QAP v[8:9],v[124:125],v[124:125],v[8:9]
QAN v[6:7],v[6:7],v[126:127]
QAP v[8:9],v[126:127],v[126:127],v[8:9]
QAU v6,v6,v7
QAU v7,v8,v9
QAQ v8,v6
QAQ v9,v7
QAS s13,s9,8
QBF v10,s13,v5
QCH v6,v8
QCH v7,v9
QAN v[6:7],v[6:7],v[8:9]
QCG v10,v[6:7] offset:0
QAH lgkmcnt(0)
s_barrier
ds_read_b64 v[6:7],v5 offset:0
ds_read_b64 v[8:9],v5 offset:256
ds_read_b64 v[10:11],v5 offset:512
ds_read_b64 v[12:13],v5 offset:768
QAH lgkmcnt(0)
QAN v[6:7],v[6:7],v[8:9]
QAN v[6:7],v[6:7],v[10:11]
QAN v[6:7],v[6:7],v[12:13]
QAW v6,0x3b000000,v6
QAW v7,0x3b000000,v7
v_fma_f32 v7,-v6,v6,v7
v_max_f32 v7,0,v7
QAE v8,v7,v6
QAM v6,0xffff0000,v8
QAI v7,16,v8
QAU v7,0x3727c5ac,v7
QAE v7,v7,v7
QAM v7,0xffff0000,v7
v_sqrt_f32 v7,v7
s_nop 0
QAE v7,v7,v7
QAM v7,0xffff0000,v7
v_rcp_f32 v8,v7
s_nop 0
QAW v10,-v6,v8
QAP v[12:13],v[64:65],v[8:9],v[10:11] op_sel_hi:[1,0,0]
s_nop 0
QAE v128,v12,v13
QAP v[14:15],v[66:67],v[8:9],v[10:11] op_sel_hi:[1,0,0]
s_nop 0
QAE v129,v14,v15
QAP v[12:13],v[68:69],v[8:9],v[10:11] op_sel_hi:[1,0,0]
s_nop 0
QAE v130,v12,v13
QAP v[14:15],v[70:71],v[8:9],v[10:11] op_sel_hi:[1,0,0]
s_nop 0
QAE v131,v14,v15
QAP v[12:13],v[72:73],v[8:9],v[10:11] op_sel_hi:[1,0,0]
s_nop 0
QAE v132,v12,v13
QAP v[14:15],v[74:75],v[8:9],v[10:11] op_sel_hi:[1,0,0]
s_nop 0
QAE v133,v14,v15
QAP v[12:13],v[76:77],v[8:9],v[10:11] op_sel_hi:[1,0,0]
s_nop 0
QAE v134,v12,v13
QAP v[14:15],v[78:79],v[8:9],v[10:11] op_sel_hi:[1,0,0]
s_nop 0
QAE v135,v14,v15
QAP v[12:13],v[80:81],v[8:9],v[10:11] op_sel_hi:[1,0,0]
s_nop 0
QAE v136,v12,v13
QAP v[14:15],v[82:83],v[8:9],v[10:11] op_sel_hi:[1,0,0]
s_nop 0
QAE v137,v14,v15
QAP v[12:13],v[84:85],v[8:9],v[10:11] op_sel_hi:[1,0,0]
s_nop 0
QAE v138,v12,v13
QAP v[14:15],v[86:87],v[8:9],v[10:11] op_sel_hi:[1,0,0]
s_nop 0
QAE v139,v14,v15
QAP v[12:13],v[88:89],v[8:9],v[10:11] op_sel_hi:[1,0,0]
s_nop 0
QAE v140,v12,v13
QAP v[14:15],v[90:91],v[8:9],v[10:11] op_sel_hi:[1,0,0]
s_nop 0
QAE v141,v14,v15
QAP v[12:13],v[92:93],v[8:9],v[10:11] op_sel_hi:[1,0,0]
s_nop 0
QAE v142,v12,v13
QAP v[14:15],v[94:95],v[8:9],v[10:11] op_sel_hi:[1,0,0]
s_nop 0
QAE v143,v14,v15
QAP v[12:13],v[96:97],v[8:9],v[10:11] op_sel_hi:[1,0,0]
s_nop 0
QAE v144,v12,v13
QAP v[14:15],v[98:99],v[8:9],v[10:11] op_sel_hi:[1,0,0]
s_nop 0
QAE v145,v14,v15
QAP v[12:13],v[100:101],v[8:9],v[10:11] op_sel_hi:[1,0,0]
s_nop 0
QAE v146,v12,v13
QAP v[14:15],v[102:103],v[8:9],v[10:11] op_sel_hi:[1,0,0]
s_nop 0
QAE v147,v14,v15
QAP v[12:13],v[104:105],v[8:9],v[10:11] op_sel_hi:[1,0,0]
s_nop 0
QAE v148,v12,v13
QAP v[14:15],v[106:107],v[8:9],v[10:11] op_sel_hi:[1,0,0]
s_nop 0
QAE v149,v14,v15
QAP v[12:13],v[108:109],v[8:9],v[10:11] op_sel_hi:[1,0,0]
s_nop 0
QAE v150,v12,v13
QAP v[14:15],v[110:111],v[8:9],v[10:11] op_sel_hi:[1,0,0]
s_nop 0
QAE v151,v14,v15
QAP v[12:13],v[112:113],v[8:9],v[10:11] op_sel_hi:[1,0,0]
s_nop 0
QAE v152,v12,v13
QAP v[14:15],v[114:115],v[8:9],v[10:11] op_sel_hi:[1,0,0]
s_nop 0
QAE v153,v14,v15
QAP v[12:13],v[116:117],v[8:9],v[10:11] op_sel_hi:[1,0,0]
s_nop 0
QAE v154,v12,v13
QAP v[14:15],v[118:119],v[8:9],v[10:11] op_sel_hi:[1,0,0]
s_nop 0
QAE v155,v14,v15
QAP v[12:13],v[120:121],v[8:9],v[10:11] op_sel_hi:[1,0,0]
s_nop 0
QAE v156,v12,v13
QAP v[14:15],v[122:123],v[8:9],v[10:11] op_sel_hi:[1,0,0]
s_nop 0
QAE v157,v14,v15
QAP v[12:13],v[124:125],v[8:9],v[10:11] op_sel_hi:[1,0,0]
s_nop 0
QAE v158,v12,v13
QAP v[14:15],v[126:127],v[8:9],v[10:11] op_sel_hi:[1,0,0]
s_nop 0
QAE v159,v14,v15
QAL v[128:131],v1,s[16:19],s14 offen offset:0 sc1
QAL v[132:135],v1,s[16:19],s14 offen offset:1024 sc1
QAL v[136:139],v1,s[16:19],s14 offen offset:2048 sc1
QAL v[140:143],v1,s[16:19],s14 offen offset:3072 sc1
QAL v[144:147],v1,s[16:19],s25 offen offset:0 sc1
QAL v[148:151],v1,s[16:19],s25 offen offset:1024 sc1
QAL v[152:155],v1,s[16:19],s25 offen offset:2048 sc1
QAL v[156:159],v1,s[16:19],s25 offen offset:3072 sc1
QAL v[16:19],v1,s[16:19],s26 offen offset:0 sc1
QAL v[20:23],v1,s[16:19],s26 offen offset:1024 sc1
QAL v[24:27],v1,s[16:19],s26 offen offset:2048 sc1
QAL v[28:31],v1,s[16:19],s26 offen offset:3072 sc1
QAL v[32:35],v1,s[16:19],s24 offen offset:0 sc1
QAL v[36:39],v1,s[16:19],s24 offen offset:1024 sc1
QAL v[40:43],v1,s[16:19],s24 offen offset:2048 sc1
QAL v[44:47],v1,s[16:19],s24 offen offset:3072 sc1
QCB s61,s61,2
QAH vmcnt(0)
s_barrier
QCB s13,s66,5
QAS s13,s13,2
QAS s14,1,s66
QAQ v2,s14
QBJ s9,0
s_cbranch_scc1 lay_noln1
QBY exec,1
buffer_atomic_or v2,off,s[92:95],s13 offset:32
QBY exec,-1
lay_noln1:
QBJ s61,0
s_cbranch_scc1 lay_layer
lay_tk1:
QAQ v2,2048
QBJ s9,0
s_cbranch_scc1 lay_tk2
QAH vmcnt(0)
QBY exec,1
ds_write_b32 v2,v200
QAH lgkmcnt(0)
QBY exec,-1
lay_tk2:
s_barrier
ds_read_b32 v3,v2
QAH lgkmcnt(0)
QCA s12,v3
s_barrier
s_getpc_b64 s[10:11]
lay_pc:
QBO s13,s12,31
QAS s13,s13,2
QAF s13,s13,s9
QAS s13,s13,11
QAI v2,7,v0
QBF v2,s13,v2
v_min_u32 v2,lay_end-lay_pc,v2
QAM v2,-4,v2
QBY exec,0xffff
global_load_dword v3,v2,s[10:11]
QBY exec,-1
QBK s12,32
s_cbranch_scc1 lay_slowrole
QBS s8,0
s_cbranch_scc1 lay_member
QBK s8,8
s_cbranch_scc1 lay_slowrole
s_sub_u32 s60,s8,1
QAS s60,s60,5
QAF s60,s60,s12
lay_bulk:
QAQ v2,0
s_nop 0
QCA s75,v2
QAT s57,s60
s_mul_i32 s13,s57,2341
QCB s13,s13,16
s_mul_i32 s14,s13,28
s_sub_u32 s14,s57,s14
QAS s60,s14,3
QAF s60,s60,s13
QBN s14,8
s_cbranch_scc1 lay_lr
s_sub_u32 s15,s14,8
QCB s60,s15,1
QAS s60,s60,4
QBO s15,s15,1
QAF s60,s60,s15
QAS s15,s13,1
QAF s60,s60,s15
QAF s60,s60,64
QBN s14,16
s_cbranch_scc1 lay_lr
s_sub_u32 s15,s14,16
QCB s60,s15,2
QAS s60,s60,5
QBO s15,s15,3
QAF s60,s60,s15
QAS s15,s13,2
QAF s60,s60,s15
QAF s60,s60,128
lay_lr:
s_movk_i32 s85,200
QBN s60,64
QBL s85,s60,s85
s_sub_u32 s13,s60,64
s_sub_u32 s14,s60,128
QBN s14,32
QBL s85,s13,s85
s_sub_u32 s13,s60,96
QBK s60,192
QBL s85,s13,s85
QBS s60,191
QBL s85,128,s85
QBN s85,128
s_cbranch_scc1 lay_layer
s_bitcmp1_b32 s61,0
s_cbranch_scc1 lay_vera
QBJ s9,0
s_cbranch_scc1 lay_rp1a_ok
QAT s15,0
lay_rp1a:
QBW v2,2,v1
QBR v3,v2,s[92:95],0 offen sc1
QAH vmcnt(0)
QBE s14,v3,0
QBE s13,v3,33
s_nop 1
QAF s14,s14,s13
QBE s13,v3,34
s_nop 1
QAF s14,s14,s13
QBE s13,v3,35
s_nop 1
QAF s14,s14,s13
QBE s13,v3,36
s_nop 1
QAF s14,s14,s13
QBE s13,v3,37
s_nop 1
QAF s14,s14,s13
QBE s13,v3,38
s_nop 1
QAF s14,s14,s13
QBE s13,v3,39
s_nop 1
QAF s14,s14,s13
QBE s13,v3,40
s_nop 1
QAF s14,s14,s13
QBE s13,v3,41
s_nop 1
QAF s14,s14,s13
QBE s13,v3,42
s_nop 1
QAF s14,s14,s13
QBE s13,v3,43
s_nop 1
QAF s14,s14,s13
QBE s13,v3,44
s_nop 1
QAF s14,s14,s13
QBE s13,v3,45
s_nop 1
QAF s14,s14,s13
QBE s13,v3,46
s_nop 1
QAF s14,s14,s13
QBE s13,v3,47
s_nop 1
QAF s14,s14,s13
QBK s14,256
s_cbranch_scc1 lay_rp1a_ok
s_sleep 10
QAF s15,s15,1
QBN s15,400000
s_cbranch_scc1 lay_rp1a
lay_rp1a_ok:
s_barrier
QBS s9,0
s_cbranch_scc1 lay_rp1a_w0
QBW v2,2,v1
QBR v3,v2,s[92:95],0 offen sc1
QAH vmcnt(0)
lay_rp1a_w0:
QBP vcc,32,v3
s_nop 1
QBO s13,vcc_hi,0xfe
QBO s14,vcc_lo,1
s_or_b32 s13,s13,s14
QBS s13,0xff
QBL s13,1,0
QBE s14,v3,0
QBS s13,0
s_cbranch_scc1 lay_irr
QAT s61,1
lay_vera:
s_sub_u32 s12,s60,160
QBK s12,32
s_cbranch_scc1 lay_noini
QBO s13,s12,15
QAS s13,s13,2
QAF s13,s13,s9
s_mul_i32 s14,s13,10240
QCB s13,s12,4
QAS s13,s13,20
QAF s15,s13,60817408
s_sub_u32 s13,s14,524288
QBN s13,32768
QBL s13,-1,0
QAQ v48,s13
QAQ v49,s13
QAQ v50,s13
QAQ v51,s13
QAF s13,s14,s15
QAL v[48:51],v1,s[16:19],s13 offen sc1
QAF s14,s14,1024
s_sub_u32 s13,s14,524288
QBN s13,32768
QBL s13,-1,0
QAQ v52,s13
QAQ v53,s13
QAQ v54,s13
QAQ v55,s13
QAF s13,s14,s15
QAL v[52:55],v1,s[16:19],s13 offen sc1
QAF s14,s14,1024
s_sub_u32 s13,s14,524288
QBN s13,32768
QBL s13,-1,0
QAQ v48,s13
QAQ v49,s13
QAQ v50,s13
QAQ v51,s13
QAF s13,s14,s15
QAL v[48:51],v1,s[16:19],s13 offen sc1
QAF s14,s14,1024
s_sub_u32 s13,s14,524288
QBN s13,32768
QBL s13,-1,0
QAQ v52,s13
QAQ v53,s13
QAQ v54,s13
QAQ v55,s13
QAF s13,s14,s15
QAL v[52:55],v1,s[16:19],s13 offen sc1
QAF s14,s14,1024
s_sub_u32 s13,s14,524288
QBN s13,32768
QBL s13,-1,0
QAQ v48,s13
QAQ v49,s13
QAQ v50,s13
QAQ v51,s13
QAF s13,s14,s15
QAL v[48:51],v1,s[16:19],s13 offen sc1
QAF s14,s14,1024
s_sub_u32 s13,s14,524288
QBN s13,32768
QBL s13,-1,0
QAQ v52,s13
QAQ v53,s13
QAQ v54,s13
QAQ v55,s13
QAF s13,s14,s15
QAL v[52:55],v1,s[16:19],s13 offen sc1
QAF s14,s14,1024
s_sub_u32 s13,s14,524288
QBN s13,32768
QBL s13,-1,0
QAQ v48,s13
QAQ v49,s13
QAQ v50,s13
QAQ v51,s13
QAF s13,s14,s15
QAL v[48:51],v1,s[16:19],s13 offen sc1
QAF s14,s14,1024
s_sub_u32 s13,s14,524288
QBN s13,32768
QBL s13,-1,0
QAQ v52,s13
QAQ v53,s13
QAQ v54,s13
QAQ v55,s13
QAF s13,s14,s15
QAL v[52:55],v1,s[16:19],s13 offen sc1
QAF s14,s14,1024
s_sub_u32 s13,s14,524288
QBN s13,32768
QBL s13,-1,0
QAQ v48,s13
QAQ v49,s13
QAQ v50,s13
QAQ v51,s13
QAF s13,s14,s15
QAL v[48:51],v1,s[16:19],s13 offen sc1
QAF s14,s14,1024
s_sub_u32 s13,s14,524288
QBN s13,32768
QBL s13,-1,0
QAQ v52,s13
QAQ v53,s13
QAQ v54,s13
QAQ v55,s13
QAF s13,s14,s15
QAL v[52:55],v1,s[16:19],s13 offen sc1
QAF s14,s14,1024
QAH vmcnt(0)
s_barrier
QAQ v48,1
QBJ s9,0
s_cbranch_scc1 lay_in1
QBY exec,1
buffer_atomic_add v48,off,s[92:95],0 offset:4
QBY exec,-1
lay_in1:
lay_noini:
QBJ s9,0
s_cbranch_scc1 lay_iwa_ok
QAT s15,0
lay_iwa:
QBR v2,off,s[92:95],0 offset:4 sc1
QAH vmcnt(0)
QCA s13,v2
s_nop 1
QBK s13,32
s_cbranch_scc1 lay_iwa_ok
s_sleep 10
QAF s15,s15,1
QBN s15,400000
s_cbranch_scc1 lay_iwa
lay_iwa_ok:
s_barrier
QAT s61,3
s_sub_u32 s66,s60,64
QBK s66,64
s_cbranch_scc1 lay_layer
QCB s13,s66,5
QAS s13,s13,2
QAQ v2,2048
QBJ s9,0
s_cbranch_scc1 lay_c1
QBR v3,off,s[92:95],s13 offset:32 sc1
QAH vmcnt(0)
ds_write_b32 v2,v3
QAH lgkmcnt(0)
lay_c1:
s_barrier
ds_read_b32 v3,v2
QAH lgkmcnt(0)
QCA s13,v3
s_barrier
s_nop 0
s_bitcmp0_b32 s13,s66
s_cbranch_scc1 lay_ln
lay_layer:
QBK s85,128
s_cbranch_scc1 lay_nofast
QAT s13,s85
QCB s67,s13,5
QAS s67,s67,3
QBO s14,s13,7
QAF s67,s67,s14
s_bfe_u32 s68,s13,0x10003
s_bfe_u32 s69,s13,0x10004
QBS s68,0
QBL s20,s42,s44
QBL s21,s43,s45
QAT s22,4194304
QAT s23,0x20000
QAS s29,s67,8
QAS s13,s9,20
QAF s29,s29,s13
QAS s30,s9,15
QAF s30,s30,32768
QBW v9,4,v0
QAM v10,15,v0
QAI v11,2,v9
QBH v10,v10,v11
QAI v10,4,v10
QBC v2,v9,13,v10
QAT s31,0
kvs_wl:
QAF m0,s30,0
QAF s13,s29,0
QAD v2,s[20:23],s13 offen lds
QAF m0,s30,1024
QAF s13,s29,32768
QAD v2,s[20:23],s13 offen lds
QAF m0,s30,2048
QAF s13,s29,65536
QAD v2,s[20:23],s13 offen lds
QAF m0,s30,3072
QAF s13,s29,98304
QAD v2,s[20:23],s13 offen lds
QAF s30,s30,4096
QAF s29,s29,131072
QAF s31,s31,1
QBN s31,8
s_cbranch_scc1 kvs_wl
QCC v9,v0,2,2
QBW v10,5,v0
QBC v10,v10,3,v9
QAI v10,8,v10
QCC v11,v0,4,1
QBC v10,v11,5,v10
QAM v11,3,v0
QBC v10,v11,3,v10
QBF v10,32768,v10
QBH v11,s9,v9
QBC v4,v11,6,v10
QBF v5,0x10000,v4
QAS s31,s67,6
QAF s31,s31,s69
QAS s31,s31,13
s_mul_i32 s13,s68,16777216
QAF s31,s31,s13
QAS s13,s9,11
QAF s31,s31,s13
QAF s31,s31,4194304
QAS s28,s69,15
QAS s30,s9,13
QAF s28,s28,s30
QAF s28,s28,0
QAH vmcnt(0)
s_barrier
QAA a[0:1],v4 offset:0
QAA a[2:3],v4 offset:1024
QAA a[4:5],v4 offset:4096
QAA a[6:7],v4 offset:5120
QAA a[8:9],v4 offset:8192
QAA a[10:11],v4 offset:9216
QAA a[12:13],v4 offset:12288
QAA a[14:15],v4 offset:13312
QAA a[16:17],v4 offset:16384
QAA a[18:19],v4 offset:17408
QAA a[20:21],v4 offset:20480
QAA a[22:23],v4 offset:21504
QAA a[24:25],v4 offset:24576
QAA a[26:27],v4 offset:25600
QAA a[28:29],v4 offset:28672
QAA a[30:31],v4 offset:29696
QAA a[32:33],v4 offset:32768
QAA a[34:35],v4 offset:33792
QAA a[36:37],v4 offset:36864
QAA a[38:39],v4 offset:37888
QAA a[40:41],v4 offset:40960
QAA a[42:43],v4 offset:41984
QAA a[44:45],v4 offset:45056
QAA a[46:47],v4 offset:46080
QAA a[48:49],v4 offset:49152
QAA a[50:51],v4 offset:50176
QAA a[52:53],v4 offset:53248
QAA a[54:55],v4 offset:54272
QAA a[56:57],v4 offset:57344
QAA a[58:59],v4 offset:58368
QAA a[60:61],v4 offset:61440
QAA a[62:63],v4 offset:62464
QAA a[64:65],v5 offset:0
QAA a[66:67],v5 offset:1024
QAA a[68:69],v5 offset:4096
QAA a[70:71],v5 offset:5120
QAA a[72:73],v5 offset:8192
QAA a[74:75],v5 offset:9216
QAA a[76:77],v5 offset:12288
QAA a[78:79],v5 offset:13312
QAA a[80:81],v5 offset:16384
QAA a[82:83],v5 offset:17408
QAA a[84:85],v5 offset:20480
QAA a[86:87],v5 offset:21504
QAA a[88:89],v5 offset:24576
QAA a[90:91],v5 offset:25600
QAA a[92:93],v5 offset:28672
QAA a[94:95],v5 offset:29696
QAA a[96:97],v5 offset:32768
QAA a[98:99],v5 offset:33792
QAA a[100:101],v5 offset:36864
QAA a[102:103],v5 offset:37888
QAA a[104:105],v5 offset:40960
QAA a[106:107],v5 offset:41984
QAA a[108:109],v5 offset:45056
QAA a[110:111],v5 offset:46080
QAA a[112:113],v5 offset:49152
QAA a[114:115],v5 offset:50176
QAA a[116:117],v5 offset:53248
QAA a[118:119],v5 offset:54272
QAA a[120:121],v5 offset:57344
QAA a[122:123],v5 offset:58368
QAA a[124:125],v5 offset:61440
QAA a[126:127],v5 offset:62464
QAT s66,0
QAT s34,0
QAQ v5,v1
QAH lgkmcnt(0)
s_bitcmp1_b32 s61,0
s_cbranch_scc1 lay_verb
QBJ s9,0
s_cbranch_scc1 lay_rp1b_ok
QAT s15,0
lay_rp1b:
QBW v2,2,v1
QBR v3,v2,s[92:95],0 offen sc1
QAH vmcnt(0)
QBE s14,v3,0
QBE s13,v3,33
s_nop 1
QAF s14,s14,s13
QBE s13,v3,34
s_nop 1
QAF s14,s14,s13
QBE s13,v3,35
s_nop 1
QAF s14,s14,s13
QBE s13,v3,36
s_nop 1
QAF s14,s14,s13
QBE s13,v3,37
s_nop 1
QAF s14,s14,s13
QBE s13,v3,38
s_nop 1
QAF s14,s14,s13
QBE s13,v3,39
s_nop 1
QAF s14,s14,s13
QBE s13,v3,40
s_nop 1
QAF s14,s14,s13
QBE s13,v3,41
s_nop 1
QAF s14,s14,s13
QBE s13,v3,42
s_nop 1
QAF s14,s14,s13
QBE s13,v3,43
s_nop 1
QAF s14,s14,s13
QBE s13,v3,44
s_nop 1
QAF s14,s14,s13
QBE s13,v3,45
s_nop 1
QAF s14,s14,s13
QBE s13,v3,46
s_nop 1
QAF s14,s14,s13
QBE s13,v3,47
s_nop 1
QAF s14,s14,s13
QBK s14,256
s_cbranch_scc1 lay_rp1b_ok
s_sleep 10
QAF s15,s15,1
QBN s15,400000
s_cbranch_scc1 lay_rp1b
lay_rp1b_ok:
s_barrier
QBS s9,0
s_cbranch_scc1 lay_rp1b_w0
QBW v2,2,v1
QBR v3,v2,s[92:95],0 offen sc1
QAH vmcnt(0)
lay_rp1b_w0:
QBP vcc,32,v3
s_nop 1
QBO s13,vcc_hi,0xfe
QBO s14,vcc_lo,1
s_or_b32 s13,s13,s14
QBS s13,0xff
QBL s13,1,0
QBE s14,v3,0
QBS s13,0
s_cbranch_scc1 lay_irr
QAT s61,1
lay_verb:
QAS s35,s66,8
QAF s35,s35,s56
QAF s35,s35,589824
QCB s13,s66,3
QAS s13,s13,2
QBS s75,0
QBL s35,s13,s35
QBJ s9,0
s_cbranch_scc1 lay_xf1_ok
QAT s15,0
lay_xf1:
QBJ s75,0
s_cbranch_scc1 lay_xa1
QBR v16,off,s[92:95],s35 offset:32 sc1
s_branch lay_xb1
lay_xa1:
QAD v[16:19],off,s[16:19],s35 sc1
lay_xb1:
QAH vmcnt(0)
QBJ s75,0
s_cbranch_scc1 lay_xa2
QCA s13,v16
QAS s14,s66,2
s_nop 0
QCB s13,s13,s14
QBO s13,s13,15
QBS s13,15
s_branch lay_xb2
lay_xa2:
QAM v16,v16,v17
QAM v18,v18,v19
QAM v16,v16,v18
s_nop 0
QCA s13,v16
s_nop 1
QBJ s13,0
lay_xb2:
s_cbranch_scc1 lay_xf1_ok
s_sleep 2
QAF s15,s15,1
QBN s15,400000
s_cbranch_scc1 lay_xf1
lay_xf1_ok:
s_barrier
QAF m0,s30,0
QAF s13,s28,0
QAD v1,s[16:19],s13 offen offset:0 sc1 lds
QAD v1,s[16:19],s13 offen offset:1024 sc1 lds
QAD v1,s[16:19],s13 offen offset:2048 sc1 lds
QAD v1,s[16:19],s13 offen offset:3072 sc1 lds
QAF m0,s30,4096
QAF s13,s28,4096
QAD v1,s[16:19],s13 offen offset:0 sc1 lds
QAD v1,s[16:19],s13 offen offset:1024 sc1 lds
QAD v1,s[16:19],s13 offen offset:2048 sc1 lds
QAD v1,s[16:19],s13 offen offset:3072 sc1 lds
QAF s30,s30,32768
QAF s28,s28,65536
QAH vmcnt(0)
kvs_pl:
s_barrier
QBJ s34,1
s_cbranch_scc1 kvs_nx
QAT s66,1
QAH lgkmcnt(0)
QAS s35,s66,8
QAF s35,s35,s56
QAF s35,s35,589824
QCB s13,s66,3
QAS s13,s13,2
QBS s75,0
QBL s35,s13,s35
QBJ s9,0
s_cbranch_scc1 lay_xf2_ok
QAT s15,0
lay_xf2:
QBJ s75,0
s_cbranch_scc1 lay_xa3
QBR v16,off,s[92:95],s35 offset:32 sc1
s_branch lay_xb3
lay_xa3:
QAD v[16:19],off,s[16:19],s35 sc1
lay_xb3:
QAH vmcnt(0)
QBJ s75,0
s_cbranch_scc1 lay_xa4
QCA s13,v16
QAS s14,s66,2
s_nop 0
QCB s13,s13,s14
QBO s13,s13,15
QBS s13,15
s_branch lay_xb4
lay_xa4:
QAM v16,v16,v17
QAM v18,v18,v19
QAM v16,v16,v18
s_nop 0
QCA s13,v16
s_nop 1
QBJ s13,0
lay_xb4:
s_cbranch_scc1 lay_xf2_ok
s_sleep 2
QAF s15,s15,1
QBN s15,400000
s_cbranch_scc1 lay_xf2
lay_xf2_ok:
s_barrier
kvs_nx:
QBS s34,3
s_cbranch_scc1 kvs_nd
QAF m0,s30,0
QAF s13,s28,0
QAD v1,s[16:19],s13 offen offset:0 sc1 lds
QAD v1,s[16:19],s13 offen offset:1024 sc1 lds
QAD v1,s[16:19],s13 offen offset:2048 sc1 lds
QAD v1,s[16:19],s13 offen offset:3072 sc1 lds
QAF m0,s30,4096
QAF s13,s28,4096
QAD v1,s[16:19],s13 offen offset:0 sc1 lds
QAD v1,s[16:19],s13 offen offset:1024 sc1 lds
QAD v1,s[16:19],s13 offen offset:2048 sc1 lds
QAD v1,s[16:19],s13 offen offset:3072 sc1 lds
QAF s30,s30,32768
QAF s28,s28,65536
kvs_nd:
QAG v[32:35],v5 offset:0
QAG v[36:39],v5 offset:1024
QAG v[40:43],v5 offset:2048
QAG v[44:47],v5 offset:3072
QAG v[48:51],v5 offset:4096
QAG v[52:55],v5 offset:5120
QAG v[56:59],v5 offset:6144
QAG v[60:63],v5 offset:7168
QAG v[64:67],v5 offset:8192
QAG v[68:71],v5 offset:9216
QAG v[72:75],v5 offset:10240
QAG v[76:79],v5 offset:11264
QBS s68,1
s_cbranch_scc1 kvs_v
QAH lgkmcnt(11)
QAB v[96:111],a[0:3],v[32:35],0
QAG v[80:83],v5 offset:12288
QAH lgkmcnt(11)
QAB v[96:111],a[4:7],v[36:39],v[96:111]
QAG v[84:87],v5 offset:13312
QAH lgkmcnt(11)
QAB v[96:111],a[8:11],v[40:43],v[96:111]
QAG v[88:91],v5 offset:14336
QAH lgkmcnt(11)
QAB v[96:111],a[12:15],v[44:47],v[96:111]
QAG v[92:95],v5 offset:15360
QAH lgkmcnt(11)
QAB v[96:111],a[16:19],v[48:51],v[96:111]
QAG v[32:35],v5 offset:16384
QAH lgkmcnt(11)
QAB v[96:111],a[20:23],v[52:55],v[96:111]
QAG v[36:39],v5 offset:17408
QAH lgkmcnt(11)
QAB v[96:111],a[24:27],v[56:59],v[96:111]
QAG v[40:43],v5 offset:18432
QAH lgkmcnt(11)
QAB v[96:111],a[28:31],v[60:63],v[96:111]
QAG v[44:47],v5 offset:19456
QAH lgkmcnt(11)
QAB v[96:111],a[32:35],v[64:67],v[96:111]
QAG v[48:51],v5 offset:20480
QAH lgkmcnt(11)
QAB v[96:111],a[36:39],v[68:71],v[96:111]
QAG v[52:55],v5 offset:21504
QAH lgkmcnt(11)
QAB v[96:111],a[40:43],v[72:75],v[96:111]
QAG v[56:59],v5 offset:22528
QAH lgkmcnt(11)
QAB v[96:111],a[44:47],v[76:79],v[96:111]
QAG v[60:63],v5 offset:23552
QAH lgkmcnt(11)
QAB v[96:111],a[48:51],v[80:83],v[96:111]
QAG v[64:67],v5 offset:24576
QAH lgkmcnt(11)
QAB v[96:111],a[52:55],v[84:87],v[96:111]
QAG v[68:71],v5 offset:25600
QAH lgkmcnt(11)
QAB v[96:111],a[56:59],v[88:91],v[96:111]
QAG v[72:75],v5 offset:26624
QAH lgkmcnt(11)
QAB v[96:111],a[60:63],v[92:95],v[96:111]
QAG v[76:79],v5 offset:27648
QAH lgkmcnt(11)
QAB v[96:111],a[64:67],v[32:35],v[96:111]
QAG v[80:83],v5 offset:28672
QAH lgkmcnt(11)
QAB v[96:111],a[68:71],v[36:39],v[96:111]
QAG v[84:87],v5 offset:29696
QAH lgkmcnt(11)
QAB v[96:111],a[72:75],v[40:43],v[96:111]
QAG v[88:91],v5 offset:30720
QAH lgkmcnt(11)
QAB v[96:111],a[76:79],v[44:47],v[96:111]
QAG v[92:95],v5 offset:31744
QAH lgkmcnt(11)
QAB v[96:111],a[80:83],v[48:51],v[96:111]
QAH lgkmcnt(10)
QAB v[96:111],a[84:87],v[52:55],v[96:111]
QAH lgkmcnt(9)
QAB v[96:111],a[88:91],v[56:59],v[96:111]
QAH lgkmcnt(8)
QAB v[96:111],a[92:95],v[60:63],v[96:111]
QAH lgkmcnt(7)
QAB v[96:111],a[96:99],v[64:67],v[96:111]
QAH lgkmcnt(6)
QAB v[96:111],a[100:103],v[68:71],v[96:111]
QAH lgkmcnt(5)
QAB v[96:111],a[104:107],v[72:75],v[96:111]
QAH lgkmcnt(4)
QAB v[96:111],a[108:111],v[76:79],v[96:111]
QAH lgkmcnt(3)
QAB v[96:111],a[112:115],v[80:83],v[96:111]
QAH lgkmcnt(2)
QAB v[96:111],a[116:119],v[84:87],v[96:111]
QAH lgkmcnt(1)
QAB v[96:111],a[120:123],v[88:91],v[96:111]
QAH lgkmcnt(0)
QAB v[96:111],a[124:127],v[92:95],v[96:111]
s_nop 11
QAE v112,v96,v97
QAE v113,v98,v99
QAE v114,v100,v101
QAE v115,v102,v103
QAE v116,v104,v105
QAE v117,v106,v107
QAE v118,v108,v109
QAE v119,v110,v111
s_branch kvs_st
kvs_v:
QAH lgkmcnt(11)
QAB v[96:111],v[32:35],a[0:3],0
QAG v[80:83],v5 offset:12288
QAH lgkmcnt(11)
QAB v[96:111],v[36:39],a[4:7],v[96:111]
QAG v[84:87],v5 offset:13312
QAH lgkmcnt(11)
QAB v[96:111],v[40:43],a[8:11],v[96:111]
QAG v[88:91],v5 offset:14336
QAH lgkmcnt(11)
QAB v[96:111],v[44:47],a[12:15],v[96:111]
QAG v[92:95],v5 offset:15360
QAH lgkmcnt(11)
QAB v[96:111],v[48:51],a[16:19],v[96:111]
QAG v[32:35],v5 offset:16384
QAH lgkmcnt(11)
QAB v[96:111],v[52:55],a[20:23],v[96:111]
QAG v[36:39],v5 offset:17408
QAH lgkmcnt(11)
QAB v[96:111],v[56:59],a[24:27],v[96:111]
QAG v[40:43],v5 offset:18432
QAH lgkmcnt(11)
QAB v[96:111],v[60:63],a[28:31],v[96:111]
QAG v[44:47],v5 offset:19456
QAH lgkmcnt(11)
QAB v[96:111],v[64:67],a[32:35],v[96:111]
QAG v[48:51],v5 offset:20480
QAH lgkmcnt(11)
QAB v[96:111],v[68:71],a[36:39],v[96:111]
QAG v[52:55],v5 offset:21504
QAH lgkmcnt(11)
QAB v[96:111],v[72:75],a[40:43],v[96:111]
QAG v[56:59],v5 offset:22528
QAH lgkmcnt(11)
QAB v[96:111],v[76:79],a[44:47],v[96:111]
QAG v[60:63],v5 offset:23552
QAH lgkmcnt(11)
QAB v[96:111],v[80:83],a[48:51],v[96:111]
QAG v[64:67],v5 offset:24576
QAH lgkmcnt(11)
QAB v[96:111],v[84:87],a[52:55],v[96:111]
QAG v[68:71],v5 offset:25600
QAH lgkmcnt(11)
QAB v[96:111],v[88:91],a[56:59],v[96:111]
QAG v[72:75],v5 offset:26624
QAH lgkmcnt(11)
QAB v[96:111],v[92:95],a[60:63],v[96:111]
QAG v[76:79],v5 offset:27648
QAH lgkmcnt(11)
QAB v[96:111],v[32:35],a[64:67],v[96:111]
QAG v[80:83],v5 offset:28672
QAH lgkmcnt(11)
QAB v[96:111],v[36:39],a[68:71],v[96:111]
QAG v[84:87],v5 offset:29696
QAH lgkmcnt(11)
QAB v[96:111],v[40:43],a[72:75],v[96:111]
QAG v[88:91],v5 offset:30720
QAH lgkmcnt(11)
QAB v[96:111],v[44:47],a[76:79],v[96:111]
QAG v[92:95],v5 offset:31744
QAH lgkmcnt(11)
QAB v[96:111],v[48:51],a[80:83],v[96:111]
QAH lgkmcnt(10)
QAB v[96:111],v[52:55],a[84:87],v[96:111]
QAH lgkmcnt(9)
QAB v[96:111],v[56:59],a[88:91],v[96:111]
QAH lgkmcnt(8)
QAB v[96:111],v[60:63],a[92:95],v[96:111]
QAH lgkmcnt(7)
QAB v[96:111],v[64:67],a[96:99],v[96:111]
QAH lgkmcnt(6)
QAB v[96:111],v[68:71],a[100:103],v[96:111]
QAH lgkmcnt(5)
QAB v[96:111],v[72:75],a[104:107],v[96:111]
QAH lgkmcnt(4)
QAB v[96:111],v[76:79],a[108:111],v[96:111]
QAH lgkmcnt(3)
QAB v[96:111],v[80:83],a[112:115],v[96:111]
QAH lgkmcnt(2)
QAB v[96:111],v[84:87],a[116:119],v[96:111]
QAH lgkmcnt(1)
QAB v[96:111],v[88:91],a[120:123],v[96:111]
QAH lgkmcnt(0)
QAB v[96:111],v[92:95],a[124:127],v[96:111]
s_nop 11
QAE v112,v96,v97
QAE v113,v98,v99
QAE v114,v104,v105
QAE v115,v106,v107
QAE v116,v100,v101
QAE v117,v102,v103
QAE v118,v108,v109
QAE v119,v110,v111
kvs_st:
QAL v[112:115],v1,s[16:19],s31 offen offset:0 sc1
QAL v[116:119],v1,s[16:19],s31 offen offset:1024 sc1
QAF s31,s31,16384
QBF v5,0x8000,v5
QBS s61,3
s_cbranch_scc1 lay_vdone
QBJ s9,0
s_cbranch_scc1 lay_iwb_ok
QAT s15,0
lay_iwb:
QBR v2,off,s[92:95],0 offset:4 sc1
QAH vmcnt(0)
QCA s13,v2
s_nop 1
QBK s13,32
s_cbranch_scc1 lay_iwb_ok
s_sleep 10
QAF s15,s15,1
QBN s15,400000
s_cbranch_scc1 lay_iwb
lay_iwb_ok:
s_barrier
QAT s61,3
lay_vdone:
QAH vmcnt(0)
s_barrier
QAS s13,s67,8
QAS s14,s34,2
QAF s13,s13,s14
QAF s13,s13,s56
QAF s13,s13,565248
QAQ v2,1
QBJ s9,0
s_cbranch_scc1 lay_af
QBY exec,1
buffer_atomic_add v2,off,s[16:19],s13
QBY exec,-1
lay_af:
QAF s34,s34,1
QBN s34,4
s_cbranch_scc1 kvs_pl
s_branch lay_nofast
lay_kvf:
QBS s68,0
QBL s20,s42,s44
QBL s21,s43,s45
QBS s68,2
QBL s20,s40,s20
QBL s21,s41,s21
QBL s33,96468992,0
QAT s22,4194304
QAT s23,0x20000
QAS s29,s67,8
QAS s13,s9,20
QAF s29,s29,s13
QAS s30,s9,15
QAF s30,s30,32768
QBW v9,4,v0
QAM v10,15,v0
QAI v11,2,v9
QBH v10,v10,v11
QAI v10,4,v10
QBC v2,v9,13,v10
QAT s31,0
kvf_wl:
QAF m0,s30,0
QAF s13,s29,0
QAD v2,s[20:23],s13 offen lds
QAF m0,s30,1024
QAF s13,s29,32768
QAD v2,s[20:23],s13 offen lds
QAF m0,s30,2048
QAF s13,s29,65536
QAD v2,s[20:23],s13 offen lds
QAF m0,s30,3072
QAF s13,s29,98304
QAD v2,s[20:23],s13 offen lds
QAF s30,s30,4096
QAF s29,s29,131072
QAF s31,s31,1
QBN s31,8
s_cbranch_scc1 kvf_wl
QCC v9,v0,2,2
QBW v10,5,v0
QBC v10,v10,3,v9
QAI v10,8,v10
QCC v11,v0,4,1
QBC v10,v11,5,v10
QAM v11,3,v0
QBC v10,v11,3,v10
QBF v10,32768,v10
QBH v11,0,v9
QBC v4,v11,6,v10
QBH v11,1,v9
QBC v5,v11,6,v10
QBH v11,2,v9
QBC v6,v11,6,v10
QBH v11,3,v9
QBC v7,v11,6,v10
QAS s28,s66,2
QAF s28,s28,s9
QAS s31,s67,6
QAF s31,s31,s28
QAS s31,s31,13
s_mul_i32 s13,s68,16777216
QAF s31,s31,s13
QAF s31,s31,s33
QAF s31,s31,4194304
QAS s28,s28,15
QAF s28,s28,0
QAH vmcnt(0)
s_barrier
QAA v[32:33],v4 offset:0
QAA v[34:35],v4 offset:1024
QAA v[36:37],v5 offset:0
QAA v[38:39],v5 offset:1024
QAA v[40:41],v6 offset:0
QAA v[42:43],v6 offset:1024
QAA v[44:45],v7 offset:0
QAA v[46:47],v7 offset:1024
QAH lgkmcnt(0)
QAS s35,s66,8
QAF s35,s35,s56
QAF s35,s35,589824
QCB s13,s66,3
QAS s13,s13,2
QBS s75,0
QBL s35,s13,s35
QBJ s9,0
s_cbranch_scc1 lay_xf3_ok
QAT s15,0
lay_xf3:
QBJ s75,0
s_cbranch_scc1 lay_xa5
QBR v16,off,s[92:95],s35 offset:32 sc1
s_branch lay_xb5
lay_xa5:
QAD v[16:19],off,s[16:19],s35 sc1
lay_xb5:
QAH vmcnt(0)
QBJ s75,0
s_cbranch_scc1 lay_xa6
QCA s13,v16
QAS s14,s66,2
s_nop 0
QCB s13,s13,s14
QBO s13,s13,15
QBS s13,15
s_branch lay_xb6
lay_xa6:
QAM v16,v16,v17
QAM v18,v18,v19
QAM v16,v16,v18
s_nop 0
QCA s13,v16
s_nop 1
QBJ s13,0
lay_xb6:
s_cbranch_scc1 lay_xf3_ok
s_sleep 2
QAF s15,s15,1
QBN s15,400000
s_cbranch_scc1 lay_xf3
lay_xf3_ok:
s_barrier
QAD v[128:131],v1,s[16:19],s28 offen offset:0 sc1
QAD v[132:135],v1,s[16:19],s28 offen offset:1024 sc1
QAD v[136:139],v1,s[16:19],s28 offen offset:2048 sc1
QAD v[140:143],v1,s[16:19],s28 offen offset:3072 sc1
QAF s28,s28,4096
QAD v[144:147],v1,s[16:19],s28 offen offset:0 sc1
QAD v[148:151],v1,s[16:19],s28 offen offset:1024 sc1
QAD v[152:155],v1,s[16:19],s28 offen offset:2048 sc1
QAD v[156:159],v1,s[16:19],s28 offen offset:3072 sc1
QAF s28,s28,4096
QAD v[160:163],v1,s[16:19],s28 offen offset:0 sc1
QAD v[164:167],v1,s[16:19],s28 offen offset:1024 sc1
QAD v[168:171],v1,s[16:19],s28 offen offset:2048 sc1
QAD v[172:175],v1,s[16:19],s28 offen offset:3072 sc1
QAF s28,s28,4096
QAD v[176:179],v1,s[16:19],s28 offen offset:0 sc1
QAD v[180:183],v1,s[16:19],s28 offen offset:1024 sc1
QAD v[184:187],v1,s[16:19],s28 offen offset:2048 sc1
QAD v[188:191],v1,s[16:19],s28 offen offset:3072 sc1
QAF s28,s28,4096
QAD v[192:195],v1,s[16:19],s28 offen offset:0 sc1
QAD v[196:199],v1,s[16:19],s28 offen offset:1024 sc1
QAD v[200:203],v1,s[16:19],s28 offen offset:2048 sc1
QAD v[204:207],v1,s[16:19],s28 offen offset:3072 sc1
QAF s28,s28,4096
QAD v[208:211],v1,s[16:19],s28 offen offset:0 sc1
QAD v[212:215],v1,s[16:19],s28 offen offset:1024 sc1
QAD v[216:219],v1,s[16:19],s28 offen offset:2048 sc1
QAD v[220:223],v1,s[16:19],s28 offen offset:3072 sc1
QAF s28,s28,4096
QAD v[224:227],v1,s[16:19],s28 offen offset:0 sc1
QAD v[228:231],v1,s[16:19],s28 offen offset:1024 sc1
QAD v[232:235],v1,s[16:19],s28 offen offset:2048 sc1
QAD v[236:239],v1,s[16:19],s28 offen offset:3072 sc1
QAF s28,s28,4096
QAD v[240:243],v1,s[16:19],s28 offen offset:0 sc1
QAD v[244:247],v1,s[16:19],s28 offen offset:1024 sc1
QAD v[248:251],v1,s[16:19],s28 offen offset:2048 sc1
QAD v[252:255],v1,s[16:19],s28 offen offset:3072 sc1
QBS s68,1
s_cbranch_scc1 kvf_v
QAH vmcnt(31) lgkmcnt(0)
QAB v[64:79],v[32:35],v[128:131],0
QAA v[48:49],v4 offset:4096
QAA v[50:51],v4 offset:5120
QAA v[52:53],v5 offset:4096
QAB v[80:95],v[36:39],v[128:131],0
QAA v[54:55],v5 offset:5120
QAA v[56:57],v6 offset:4096
QAA v[58:59],v6 offset:5120
QAB v[96:111],v[40:43],v[128:131],0
QAA v[60:61],v7 offset:4096
QAA v[62:63],v7 offset:5120
QAB v[112:127],v[44:47],v[128:131],0
QAH vmcnt(30) lgkmcnt(0)
QAB v[64:79],v[48:51],v[132:135],v[64:79]
QAA v[32:33],v4 offset:8192
QAA v[34:35],v4 offset:9216
QAA v[36:37],v5 offset:8192
QAB v[80:95],v[52:55],v[132:135],v[80:95]
QAA v[38:39],v5 offset:9216
QAA v[40:41],v6 offset:8192
QAA v[42:43],v6 offset:9216
QAB v[96:111],v[56:59],v[132:135],v[96:111]
QAA v[44:45],v7 offset:8192
QAA v[46:47],v7 offset:9216
QAB v[112:127],v[60:63],v[132:135],v[112:127]
QAH vmcnt(29) lgkmcnt(0)
QAB v[64:79],v[32:35],v[136:139],v[64:79]
QAA v[48:49],v4 offset:12288
QAA v[50:51],v4 offset:13312
QAA v[52:53],v5 offset:12288
QAB v[80:95],v[36:39],v[136:139],v[80:95]
QAA v[54:55],v5 offset:13312
QAA v[56:57],v6 offset:12288
QAA v[58:59],v6 offset:13312
QAB v[96:111],v[40:43],v[136:139],v[96:111]
QAA v[60:61],v7 offset:12288
QAA v[62:63],v7 offset:13312
QAB v[112:127],v[44:47],v[136:139],v[112:127]
QAH vmcnt(28) lgkmcnt(0)
QAB v[64:79],v[48:51],v[140:143],v[64:79]
QAA v[32:33],v4 offset:16384
QAA v[34:35],v4 offset:17408
QAA v[36:37],v5 offset:16384
QAB v[80:95],v[52:55],v[140:143],v[80:95]
QAA v[38:39],v5 offset:17408
QAA v[40:41],v6 offset:16384
QAA v[42:43],v6 offset:17408
QAB v[96:111],v[56:59],v[140:143],v[96:111]
QAA v[44:45],v7 offset:16384
QAA v[46:47],v7 offset:17408
QAB v[112:127],v[60:63],v[140:143],v[112:127]
QAH vmcnt(27) lgkmcnt(0)
QAB v[64:79],v[32:35],v[144:147],v[64:79]
QAA v[48:49],v4 offset:20480
QAA v[50:51],v4 offset:21504
QAA v[52:53],v5 offset:20480
QAB v[80:95],v[36:39],v[144:147],v[80:95]
QAA v[54:55],v5 offset:21504
QAA v[56:57],v6 offset:20480
QAA v[58:59],v6 offset:21504
QAB v[96:111],v[40:43],v[144:147],v[96:111]
QAA v[60:61],v7 offset:20480
QAA v[62:63],v7 offset:21504
QAB v[112:127],v[44:47],v[144:147],v[112:127]
QAH vmcnt(26) lgkmcnt(0)
QAB v[64:79],v[48:51],v[148:151],v[64:79]
QAA v[32:33],v4 offset:24576
QAA v[34:35],v4 offset:25600
QAA v[36:37],v5 offset:24576
QAB v[80:95],v[52:55],v[148:151],v[80:95]
QAA v[38:39],v5 offset:25600
QAA v[40:41],v6 offset:24576
QAA v[42:43],v6 offset:25600
QAB v[96:111],v[56:59],v[148:151],v[96:111]
QAA v[44:45],v7 offset:24576
QAA v[46:47],v7 offset:25600
QAB v[112:127],v[60:63],v[148:151],v[112:127]
QAH vmcnt(25) lgkmcnt(0)
QAB v[64:79],v[32:35],v[152:155],v[64:79]
QAA v[48:49],v4 offset:28672
QAA v[50:51],v4 offset:29696
QAA v[52:53],v5 offset:28672
QAB v[80:95],v[36:39],v[152:155],v[80:95]
QAA v[54:55],v5 offset:29696
QAA v[56:57],v6 offset:28672
QAA v[58:59],v6 offset:29696
QAB v[96:111],v[40:43],v[152:155],v[96:111]
QAA v[60:61],v7 offset:28672
QAA v[62:63],v7 offset:29696
QAB v[112:127],v[44:47],v[152:155],v[112:127]
QAH vmcnt(24) lgkmcnt(0)
QAB v[64:79],v[48:51],v[156:159],v[64:79]
QAA v[32:33],v4 offset:32768
QAA v[34:35],v4 offset:33792
QAA v[36:37],v5 offset:32768
QAB v[80:95],v[52:55],v[156:159],v[80:95]
QAA v[38:39],v5 offset:33792
QAA v[40:41],v6 offset:32768
QAA v[42:43],v6 offset:33792
QAB v[96:111],v[56:59],v[156:159],v[96:111]
QAA v[44:45],v7 offset:32768
QAA v[46:47],v7 offset:33792
QAB v[112:127],v[60:63],v[156:159],v[112:127]
QAH vmcnt(23) lgkmcnt(0)
QAB v[64:79],v[32:35],v[160:163],v[64:79]
QAA v[48:49],v4 offset:36864
QAA v[50:51],v4 offset:37888
QAA v[52:53],v5 offset:36864
QAB v[80:95],v[36:39],v[160:163],v[80:95]
QAA v[54:55],v5 offset:37888
QAA v[56:57],v6 offset:36864
QAA v[58:59],v6 offset:37888
QAB v[96:111],v[40:43],v[160:163],v[96:111]
QAA v[60:61],v7 offset:36864
QAA v[62:63],v7 offset:37888
QAB v[112:127],v[44:47],v[160:163],v[112:127]
QAH vmcnt(22) lgkmcnt(0)
QAB v[64:79],v[48:51],v[164:167],v[64:79]
QAA v[32:33],v4 offset:40960
QAA v[34:35],v4 offset:41984
QAA v[36:37],v5 offset:40960
QAB v[80:95],v[52:55],v[164:167],v[80:95]
QAA v[38:39],v5 offset:41984
QAA v[40:41],v6 offset:40960
QAA v[42:43],v6 offset:41984
QAB v[96:111],v[56:59],v[164:167],v[96:111]
QAA v[44:45],v7 offset:40960
QAA v[46:47],v7 offset:41984
QAB v[112:127],v[60:63],v[164:167],v[112:127]
QAH vmcnt(21) lgkmcnt(0)
QAB v[64:79],v[32:35],v[168:171],v[64:79]
QAA v[48:49],v4 offset:45056
QAA v[50:51],v4 offset:46080
QAA v[52:53],v5 offset:45056
QAB v[80:95],v[36:39],v[168:171],v[80:95]
QAA v[54:55],v5 offset:46080
QAA v[56:57],v6 offset:45056
QAA v[58:59],v6 offset:46080
QAB v[96:111],v[40:43],v[168:171],v[96:111]
QAA v[60:61],v7 offset:45056
QAA v[62:63],v7 offset:46080
QAB v[112:127],v[44:47],v[168:171],v[112:127]
QAH vmcnt(20) lgkmcnt(0)
QAB v[64:79],v[48:51],v[172:175],v[64:79]
QAA v[32:33],v4 offset:49152
QAA v[34:35],v4 offset:50176
QAA v[36:37],v5 offset:49152
QAB v[80:95],v[52:55],v[172:175],v[80:95]
QAA v[38:39],v5 offset:50176
QAA v[40:41],v6 offset:49152
QAA v[42:43],v6 offset:50176
QAB v[96:111],v[56:59],v[172:175],v[96:111]
QAA v[44:45],v7 offset:49152
QAA v[46:47],v7 offset:50176
QAB v[112:127],v[60:63],v[172:175],v[112:127]
QAH vmcnt(19) lgkmcnt(0)
QAB v[64:79],v[32:35],v[176:179],v[64:79]
QAA v[48:49],v4 offset:53248
QAA v[50:51],v4 offset:54272
QAA v[52:53],v5 offset:53248
QAB v[80:95],v[36:39],v[176:179],v[80:95]
QAA v[54:55],v5 offset:54272
QAA v[56:57],v6 offset:53248
QAA v[58:59],v6 offset:54272
QAB v[96:111],v[40:43],v[176:179],v[96:111]
QAA v[60:61],v7 offset:53248
QAA v[62:63],v7 offset:54272
QAB v[112:127],v[44:47],v[176:179],v[112:127]
QAH vmcnt(18) lgkmcnt(0)
QAB v[64:79],v[48:51],v[180:183],v[64:79]
QAA v[32:33],v4 offset:57344
QAA v[34:35],v4 offset:58368
QAA v[36:37],v5 offset:57344
QAB v[80:95],v[52:55],v[180:183],v[80:95]
QAA v[38:39],v5 offset:58368
QAA v[40:41],v6 offset:57344
QAA v[42:43],v6 offset:58368
QAB v[96:111],v[56:59],v[180:183],v[96:111]
QAA v[44:45],v7 offset:57344
QAA v[46:47],v7 offset:58368
QAB v[112:127],v[60:63],v[180:183],v[112:127]
QAH vmcnt(17) lgkmcnt(0)
QAB v[64:79],v[32:35],v[184:187],v[64:79]
QAA v[48:49],v4 offset:61440
QAA v[50:51],v4 offset:62464
QAA v[52:53],v5 offset:61440
QAB v[80:95],v[36:39],v[184:187],v[80:95]
QAA v[54:55],v5 offset:62464
QAA v[56:57],v6 offset:61440
QAA v[58:59],v6 offset:62464
QAB v[96:111],v[40:43],v[184:187],v[96:111]
QAA v[60:61],v7 offset:61440
QAA v[62:63],v7 offset:62464
QAB v[112:127],v[44:47],v[184:187],v[112:127]
QAH vmcnt(16) lgkmcnt(0)
QBF v4,0x10000,v4
QBF v5,0x10000,v5
QBF v6,0x10000,v6
QBF v7,0x10000,v7
QAB v[64:79],v[48:51],v[188:191],v[64:79]
QAA v[32:33],v4 offset:0
QAA v[34:35],v4 offset:1024
QAA v[36:37],v5 offset:0
QAB v[80:95],v[52:55],v[188:191],v[80:95]
QAA v[38:39],v5 offset:1024
QAA v[40:41],v6 offset:0
QAA v[42:43],v6 offset:1024
QAB v[96:111],v[56:59],v[188:191],v[96:111]
QAA v[44:45],v7 offset:0
QAA v[46:47],v7 offset:1024
QAB v[112:127],v[60:63],v[188:191],v[112:127]
QAH vmcnt(15) lgkmcnt(0)
QAB v[64:79],v[32:35],v[192:195],v[64:79]
QAA v[48:49],v4 offset:4096
QAA v[50:51],v4 offset:5120
QAA v[52:53],v5 offset:4096
QAB v[80:95],v[36:39],v[192:195],v[80:95]
QAA v[54:55],v5 offset:5120
QAA v[56:57],v6 offset:4096
QAA v[58:59],v6 offset:5120
QAB v[96:111],v[40:43],v[192:195],v[96:111]
QAA v[60:61],v7 offset:4096
QAA v[62:63],v7 offset:5120
QAB v[112:127],v[44:47],v[192:195],v[112:127]
QAH vmcnt(14) lgkmcnt(0)
QAB v[64:79],v[48:51],v[196:199],v[64:79]
QAA v[32:33],v4 offset:8192
QAA v[34:35],v4 offset:9216
QAA v[36:37],v5 offset:8192
QAB v[80:95],v[52:55],v[196:199],v[80:95]
QAA v[38:39],v5 offset:9216
QAA v[40:41],v6 offset:8192
QAA v[42:43],v6 offset:9216
QAB v[96:111],v[56:59],v[196:199],v[96:111]
QAA v[44:45],v7 offset:8192
QAA v[46:47],v7 offset:9216
QAB v[112:127],v[60:63],v[196:199],v[112:127]
QAH vmcnt(13) lgkmcnt(0)
QAB v[64:79],v[32:35],v[200:203],v[64:79]
QAA v[48:49],v4 offset:12288
QAA v[50:51],v4 offset:13312
QAA v[52:53],v5 offset:12288
QAB v[80:95],v[36:39],v[200:203],v[80:95]
QAA v[54:55],v5 offset:13312
QAA v[56:57],v6 offset:12288
QAA v[58:59],v6 offset:13312
QAB v[96:111],v[40:43],v[200:203],v[96:111]
QAA v[60:61],v7 offset:12288
QAA v[62:63],v7 offset:13312
QAB v[112:127],v[44:47],v[200:203],v[112:127]
QAH vmcnt(12) lgkmcnt(0)
QAB v[64:79],v[48:51],v[204:207],v[64:79]
QAA v[32:33],v4 offset:16384
QAA v[34:35],v4 offset:17408
QAA v[36:37],v5 offset:16384
QAB v[80:95],v[52:55],v[204:207],v[80:95]
QAA v[38:39],v5 offset:17408
QAA v[40:41],v6 offset:16384
QAA v[42:43],v6 offset:17408
QAB v[96:111],v[56:59],v[204:207],v[96:111]
QAA v[44:45],v7 offset:16384
QAA v[46:47],v7 offset:17408
QAB v[112:127],v[60:63],v[204:207],v[112:127]
QAH vmcnt(11) lgkmcnt(0)
QAB v[64:79],v[32:35],v[208:211],v[64:79]
QAA v[48:49],v4 offset:20480
QAA v[50:51],v4 offset:21504
QAA v[52:53],v5 offset:20480
QAB v[80:95],v[36:39],v[208:211],v[80:95]
QAA v[54:55],v5 offset:21504
QAA v[56:57],v6 offset:20480
QAA v[58:59],v6 offset:21504
QAB v[96:111],v[40:43],v[208:211],v[96:111]
QAA v[60:61],v7 offset:20480
QAA v[62:63],v7 offset:21504
QAB v[112:127],v[44:47],v[208:211],v[112:127]
QAH vmcnt(10) lgkmcnt(0)
QAB v[64:79],v[48:51],v[212:215],v[64:79]
QAA v[32:33],v4 offset:24576
QAA v[34:35],v4 offset:25600
QAA v[36:37],v5 offset:24576
QAB v[80:95],v[52:55],v[212:215],v[80:95]
QAA v[38:39],v5 offset:25600
QAA v[40:41],v6 offset:24576
QAA v[42:43],v6 offset:25600
QAB v[96:111],v[56:59],v[212:215],v[96:111]
QAA v[44:45],v7 offset:24576
QAA v[46:47],v7 offset:25600
QAB v[112:127],v[60:63],v[212:215],v[112:127]
QAH vmcnt(9) lgkmcnt(0)
QAB v[64:79],v[32:35],v[216:219],v[64:79]
QAA v[48:49],v4 offset:28672
QAA v[50:51],v4 offset:29696
QAA v[52:53],v5 offset:28672
QAB v[80:95],v[36:39],v[216:219],v[80:95]
QAA v[54:55],v5 offset:29696
QAA v[56:57],v6 offset:28672
QAA v[58:59],v6 offset:29696
QAB v[96:111],v[40:43],v[216:219],v[96:111]
QAA v[60:61],v7 offset:28672
QAA v[62:63],v7 offset:29696
QAB v[112:127],v[44:47],v[216:219],v[112:127]
QAH vmcnt(8) lgkmcnt(0)
QAB v[64:79],v[48:51],v[220:223],v[64:79]
QAA v[32:33],v4 offset:32768
QAA v[34:35],v4 offset:33792
QAA v[36:37],v5 offset:32768
QAB v[80:95],v[52:55],v[220:223],v[80:95]
QAA v[38:39],v5 offset:33792
QAA v[40:41],v6 offset:32768
QAA v[42:43],v6 offset:33792
QAB v[96:111],v[56:59],v[220:223],v[96:111]
QAA v[44:45],v7 offset:32768
QAA v[46:47],v7 offset:33792
QAB v[112:127],v[60:63],v[220:223],v[112:127]
QAH vmcnt(7) lgkmcnt(0)
QAB v[64:79],v[32:35],v[224:227],v[64:79]
QAA v[48:49],v4 offset:36864
QAA v[50:51],v4 offset:37888
QAA v[52:53],v5 offset:36864
QAB v[80:95],v[36:39],v[224:227],v[80:95]
QAA v[54:55],v5 offset:37888
QAA v[56:57],v6 offset:36864
QAA v[58:59],v6 offset:37888
QAB v[96:111],v[40:43],v[224:227],v[96:111]
QAA v[60:61],v7 offset:36864
QAA v[62:63],v7 offset:37888
QAB v[112:127],v[44:47],v[224:227],v[112:127]
QAH vmcnt(6) lgkmcnt(0)
QAB v[64:79],v[48:51],v[228:231],v[64:79]
QAA v[32:33],v4 offset:40960
QAA v[34:35],v4 offset:41984
QAA v[36:37],v5 offset:40960
QAB v[80:95],v[52:55],v[228:231],v[80:95]
QAA v[38:39],v5 offset:41984
QAA v[40:41],v6 offset:40960
QAA v[42:43],v6 offset:41984
QAB v[96:111],v[56:59],v[228:231],v[96:111]
QAA v[44:45],v7 offset:40960
QAA v[46:47],v7 offset:41984
QAB v[112:127],v[60:63],v[228:231],v[112:127]
QAH vmcnt(5) lgkmcnt(0)
QAB v[64:79],v[32:35],v[232:235],v[64:79]
QAA v[48:49],v4 offset:45056
QAA v[50:51],v4 offset:46080
QAA v[52:53],v5 offset:45056
QAB v[80:95],v[36:39],v[232:235],v[80:95]
QAA v[54:55],v5 offset:46080
QAA v[56:57],v6 offset:45056
QAA v[58:59],v6 offset:46080
QAB v[96:111],v[40:43],v[232:235],v[96:111]
QAA v[60:61],v7 offset:45056
QAA v[62:63],v7 offset:46080
QAB v[112:127],v[44:47],v[232:235],v[112:127]
QAH vmcnt(4) lgkmcnt(0)
QAB v[64:79],v[48:51],v[236:239],v[64:79]
QAA v[32:33],v4 offset:49152
QAA v[34:35],v4 offset:50176
QAA v[36:37],v5 offset:49152
QAB v[80:95],v[52:55],v[236:239],v[80:95]
QAA v[38:39],v5 offset:50176
QAA v[40:41],v6 offset:49152
QAA v[42:43],v6 offset:50176
QAB v[96:111],v[56:59],v[236:239],v[96:111]
QAA v[44:45],v7 offset:49152
QAA v[46:47],v7 offset:50176
QAB v[112:127],v[60:63],v[236:239],v[112:127]
QAH vmcnt(3) lgkmcnt(0)
QAB v[64:79],v[32:35],v[240:243],v[64:79]
QAA v[48:49],v4 offset:53248
QAA v[50:51],v4 offset:54272
QAA v[52:53],v5 offset:53248
QAB v[80:95],v[36:39],v[240:243],v[80:95]
QAA v[54:55],v5 offset:54272
QAA v[56:57],v6 offset:53248
QAA v[58:59],v6 offset:54272
QAB v[96:111],v[40:43],v[240:243],v[96:111]
QAA v[60:61],v7 offset:53248
QAA v[62:63],v7 offset:54272
QAB v[112:127],v[44:47],v[240:243],v[112:127]
QAH vmcnt(2) lgkmcnt(0)
QAB v[64:79],v[48:51],v[244:247],v[64:79]
QAA v[32:33],v4 offset:57344
QAA v[34:35],v4 offset:58368
QAA v[36:37],v5 offset:57344
QAB v[80:95],v[52:55],v[244:247],v[80:95]
QAA v[38:39],v5 offset:58368
QAA v[40:41],v6 offset:57344
QAA v[42:43],v6 offset:58368
QAB v[96:111],v[56:59],v[244:247],v[96:111]
QAA v[44:45],v7 offset:57344
QAA v[46:47],v7 offset:58368
QAB v[112:127],v[60:63],v[244:247],v[112:127]
QAH vmcnt(1) lgkmcnt(0)
QAB v[64:79],v[32:35],v[248:251],v[64:79]
QAA v[48:49],v4 offset:61440
QAA v[50:51],v4 offset:62464
QAA v[52:53],v5 offset:61440
QAB v[80:95],v[36:39],v[248:251],v[80:95]
QAA v[54:55],v5 offset:62464
QAA v[56:57],v6 offset:61440
QAA v[58:59],v6 offset:62464
QAB v[96:111],v[40:43],v[248:251],v[96:111]
QAA v[60:61],v7 offset:61440
QAA v[62:63],v7 offset:62464
QAB v[112:127],v[44:47],v[248:251],v[112:127]
QAH vmcnt(0) lgkmcnt(0)
QAB v[64:79],v[48:51],v[252:255],v[64:79]
QAB v[80:95],v[52:55],v[252:255],v[80:95]
QAB v[96:111],v[56:59],v[252:255],v[96:111]
QAB v[112:127],v[60:63],v[252:255],v[112:127]
QAE v32,v64,v65
QAE v33,v66,v67
QAE v34,v68,v69
QAE v35,v70,v71
QAE v36,v72,v73
QAE v37,v74,v75
QAE v38,v76,v77
QAE v39,v78,v79
QAL v[32:35],v1,s[16:19],s31 offen offset:0 sc1
QAL v[36:39],v1,s[16:19],s31 offen offset:1024 sc1
QAE v40,v80,v81
QAE v41,v82,v83
QAE v42,v84,v85
QAE v43,v86,v87
QAE v44,v88,v89
QAE v45,v90,v91
QAE v46,v92,v93
QAE v47,v94,v95
QAL v[40:43],v1,s[16:19],s31 offen offset:2048 sc1
QAL v[44:47],v1,s[16:19],s31 offen offset:3072 sc1
QAE v48,v96,v97
QAE v49,v98,v99
QAE v50,v100,v101
QAE v51,v102,v103
QAE v52,v104,v105
QAE v53,v106,v107
QAE v54,v108,v109
QAE v55,v110,v111
QAF s31,s31,4096
QAL v[48:51],v1,s[16:19],s31 offen offset:0 sc1
QAL v[52:55],v1,s[16:19],s31 offen offset:1024 sc1
QAE v56,v112,v113
QAE v57,v114,v115
QAE v58,v116,v117
QAE v59,v118,v119
QAE v60,v120,v121
QAE v61,v122,v123
QAE v62,v124,v125
QAE v63,v126,v127
QAL v[56:59],v1,s[16:19],s31 offen offset:2048 sc1
QAL v[60:63],v1,s[16:19],s31 offen offset:3072 sc1
s_branch kvf_fd
kvf_v:
QAH vmcnt(31) lgkmcnt(0)
QAB v[64:79],v[128:131],v[32:35],0
QAA v[48:49],v4 offset:4096
QAA v[50:51],v4 offset:5120
QAA v[52:53],v5 offset:4096
QAB v[80:95],v[128:131],v[36:39],0
QAA v[54:55],v5 offset:5120
QAA v[56:57],v6 offset:4096
QAA v[58:59],v6 offset:5120
QAB v[96:111],v[128:131],v[40:43],0
QAA v[60:61],v7 offset:4096
QAA v[62:63],v7 offset:5120
QAB v[112:127],v[128:131],v[44:47],0
QAH vmcnt(30) lgkmcnt(0)
QAB v[64:79],v[132:135],v[48:51],v[64:79]
QAA v[32:33],v4 offset:8192
QAA v[34:35],v4 offset:9216
QAA v[36:37],v5 offset:8192
QAB v[80:95],v[132:135],v[52:55],v[80:95]
QAA v[38:39],v5 offset:9216
QAA v[40:41],v6 offset:8192
QAA v[42:43],v6 offset:9216
QAB v[96:111],v[132:135],v[56:59],v[96:111]
QAA v[44:45],v7 offset:8192
QAA v[46:47],v7 offset:9216
QAB v[112:127],v[132:135],v[60:63],v[112:127]
QAH vmcnt(29) lgkmcnt(0)
QAB v[64:79],v[136:139],v[32:35],v[64:79]
QAA v[48:49],v4 offset:12288
QAA v[50:51],v4 offset:13312
QAA v[52:53],v5 offset:12288
QAB v[80:95],v[136:139],v[36:39],v[80:95]
QAA v[54:55],v5 offset:13312
QAA v[56:57],v6 offset:12288
QAA v[58:59],v6 offset:13312
QAB v[96:111],v[136:139],v[40:43],v[96:111]
QAA v[60:61],v7 offset:12288
QAA v[62:63],v7 offset:13312
QAB v[112:127],v[136:139],v[44:47],v[112:127]
QAH vmcnt(28) lgkmcnt(0)
QAB v[64:79],v[140:143],v[48:51],v[64:79]
QAA v[32:33],v4 offset:16384
QAA v[34:35],v4 offset:17408
QAA v[36:37],v5 offset:16384
QAB v[80:95],v[140:143],v[52:55],v[80:95]
QAA v[38:39],v5 offset:17408
QAA v[40:41],v6 offset:16384
QAA v[42:43],v6 offset:17408
QAB v[96:111],v[140:143],v[56:59],v[96:111]
QAA v[44:45],v7 offset:16384
QAA v[46:47],v7 offset:17408
QAB v[112:127],v[140:143],v[60:63],v[112:127]
QAH vmcnt(27) lgkmcnt(0)
QAB v[64:79],v[144:147],v[32:35],v[64:79]
QAA v[48:49],v4 offset:20480
QAA v[50:51],v4 offset:21504
QAA v[52:53],v5 offset:20480
QAB v[80:95],v[144:147],v[36:39],v[80:95]
QAA v[54:55],v5 offset:21504
QAA v[56:57],v6 offset:20480
QAA v[58:59],v6 offset:21504
QAB v[96:111],v[144:147],v[40:43],v[96:111]
QAA v[60:61],v7 offset:20480
QAA v[62:63],v7 offset:21504
QAB v[112:127],v[144:147],v[44:47],v[112:127]
QAH vmcnt(26) lgkmcnt(0)
QAB v[64:79],v[148:151],v[48:51],v[64:79]
QAA v[32:33],v4 offset:24576
QAA v[34:35],v4 offset:25600
QAA v[36:37],v5 offset:24576
QAB v[80:95],v[148:151],v[52:55],v[80:95]
QAA v[38:39],v5 offset:25600
QAA v[40:41],v6 offset:24576
QAA v[42:43],v6 offset:25600
QAB v[96:111],v[148:151],v[56:59],v[96:111]
QAA v[44:45],v7 offset:24576
QAA v[46:47],v7 offset:25600
QAB v[112:127],v[148:151],v[60:63],v[112:127]
QAH vmcnt(25) lgkmcnt(0)
QAB v[64:79],v[152:155],v[32:35],v[64:79]
QAA v[48:49],v4 offset:28672
QAA v[50:51],v4 offset:29696
QAA v[52:53],v5 offset:28672
QAB v[80:95],v[152:155],v[36:39],v[80:95]
QAA v[54:55],v5 offset:29696
QAA v[56:57],v6 offset:28672
QAA v[58:59],v6 offset:29696
QAB v[96:111],v[152:155],v[40:43],v[96:111]
QAA v[60:61],v7 offset:28672
QAA v[62:63],v7 offset:29696
QAB v[112:127],v[152:155],v[44:47],v[112:127]
QAH vmcnt(24) lgkmcnt(0)
QAB v[64:79],v[156:159],v[48:51],v[64:79]
QAA v[32:33],v4 offset:32768
QAA v[34:35],v4 offset:33792
QAA v[36:37],v5 offset:32768
QAB v[80:95],v[156:159],v[52:55],v[80:95]
QAA v[38:39],v5 offset:33792
QAA v[40:41],v6 offset:32768
QAA v[42:43],v6 offset:33792
QAB v[96:111],v[156:159],v[56:59],v[96:111]
QAA v[44:45],v7 offset:32768
QAA v[46:47],v7 offset:33792
QAB v[112:127],v[156:159],v[60:63],v[112:127]
QAH vmcnt(23) lgkmcnt(0)
QAB v[64:79],v[160:163],v[32:35],v[64:79]
QAA v[48:49],v4 offset:36864
QAA v[50:51],v4 offset:37888
QAA v[52:53],v5 offset:36864
QAB v[80:95],v[160:163],v[36:39],v[80:95]
QAA v[54:55],v5 offset:37888
QAA v[56:57],v6 offset:36864
QAA v[58:59],v6 offset:37888
QAB v[96:111],v[160:163],v[40:43],v[96:111]
QAA v[60:61],v7 offset:36864
QAA v[62:63],v7 offset:37888
QAB v[112:127],v[160:163],v[44:47],v[112:127]
QAH vmcnt(22) lgkmcnt(0)
QAB v[64:79],v[164:167],v[48:51],v[64:79]
QAA v[32:33],v4 offset:40960
QAA v[34:35],v4 offset:41984
QAA v[36:37],v5 offset:40960
QAB v[80:95],v[164:167],v[52:55],v[80:95]
QAA v[38:39],v5 offset:41984
QAA v[40:41],v6 offset:40960
QAA v[42:43],v6 offset:41984
QAB v[96:111],v[164:167],v[56:59],v[96:111]
QAA v[44:45],v7 offset:40960
QAA v[46:47],v7 offset:41984
QAB v[112:127],v[164:167],v[60:63],v[112:127]
QAH vmcnt(21) lgkmcnt(0)
QAB v[64:79],v[168:171],v[32:35],v[64:79]
QAA v[48:49],v4 offset:45056
QAA v[50:51],v4 offset:46080
QAA v[52:53],v5 offset:45056
QAB v[80:95],v[168:171],v[36:39],v[80:95]
QAA v[54:55],v5 offset:46080
QAA v[56:57],v6 offset:45056
QAA v[58:59],v6 offset:46080
QAB v[96:111],v[168:171],v[40:43],v[96:111]
QAA v[60:61],v7 offset:45056
QAA v[62:63],v7 offset:46080
QAB v[112:127],v[168:171],v[44:47],v[112:127]
QAH vmcnt(20) lgkmcnt(0)
QAB v[64:79],v[172:175],v[48:51],v[64:79]
QAA v[32:33],v4 offset:49152
QAA v[34:35],v4 offset:50176
QAA v[36:37],v5 offset:49152
QAB v[80:95],v[172:175],v[52:55],v[80:95]
QAA v[38:39],v5 offset:50176
QAA v[40:41],v6 offset:49152
QAA v[42:43],v6 offset:50176
QAB v[96:111],v[172:175],v[56:59],v[96:111]
QAA v[44:45],v7 offset:49152
QAA v[46:47],v7 offset:50176
QAB v[112:127],v[172:175],v[60:63],v[112:127]
QAH vmcnt(19) lgkmcnt(0)
QAB v[64:79],v[176:179],v[32:35],v[64:79]
QAA v[48:49],v4 offset:53248
QAA v[50:51],v4 offset:54272
QAA v[52:53],v5 offset:53248
QAB v[80:95],v[176:179],v[36:39],v[80:95]
QAA v[54:55],v5 offset:54272
QAA v[56:57],v6 offset:53248
QAA v[58:59],v6 offset:54272
QAB v[96:111],v[176:179],v[40:43],v[96:111]
QAA v[60:61],v7 offset:53248
QAA v[62:63],v7 offset:54272
QAB v[112:127],v[176:179],v[44:47],v[112:127]
QAH vmcnt(18) lgkmcnt(0)
QAB v[64:79],v[180:183],v[48:51],v[64:79]
QAA v[32:33],v4 offset:57344
QAA v[34:35],v4 offset:58368
QAA v[36:37],v5 offset:57344
QAB v[80:95],v[180:183],v[52:55],v[80:95]
QAA v[38:39],v5 offset:58368
QAA v[40:41],v6 offset:57344
QAA v[42:43],v6 offset:58368
QAB v[96:111],v[180:183],v[56:59],v[96:111]
QAA v[44:45],v7 offset:57344
QAA v[46:47],v7 offset:58368
QAB v[112:127],v[180:183],v[60:63],v[112:127]
QAH vmcnt(17) lgkmcnt(0)
QAB v[64:79],v[184:187],v[32:35],v[64:79]
QAA v[48:49],v4 offset:61440
QAA v[50:51],v4 offset:62464
QAA v[52:53],v5 offset:61440
QAB v[80:95],v[184:187],v[36:39],v[80:95]
QAA v[54:55],v5 offset:62464
QAA v[56:57],v6 offset:61440
QAA v[58:59],v6 offset:62464
QAB v[96:111],v[184:187],v[40:43],v[96:111]
QAA v[60:61],v7 offset:61440
QAA v[62:63],v7 offset:62464
QAB v[112:127],v[184:187],v[44:47],v[112:127]
QAH vmcnt(16) lgkmcnt(0)
QBF v4,0x10000,v4
QBF v5,0x10000,v5
QBF v6,0x10000,v6
QBF v7,0x10000,v7
QAB v[64:79],v[188:191],v[48:51],v[64:79]
QAA v[32:33],v4 offset:0
QAA v[34:35],v4 offset:1024
QAA v[36:37],v5 offset:0
QAB v[80:95],v[188:191],v[52:55],v[80:95]
QAA v[38:39],v5 offset:1024
QAA v[40:41],v6 offset:0
QAA v[42:43],v6 offset:1024
QAB v[96:111],v[188:191],v[56:59],v[96:111]
QAA v[44:45],v7 offset:0
QAA v[46:47],v7 offset:1024
QAB v[112:127],v[188:191],v[60:63],v[112:127]
QAH vmcnt(15) lgkmcnt(0)
QAB v[64:79],v[192:195],v[32:35],v[64:79]
QAA v[48:49],v4 offset:4096
QAA v[50:51],v4 offset:5120
QAA v[52:53],v5 offset:4096
QAB v[80:95],v[192:195],v[36:39],v[80:95]
QAA v[54:55],v5 offset:5120
QAA v[56:57],v6 offset:4096
QAA v[58:59],v6 offset:5120
QAB v[96:111],v[192:195],v[40:43],v[96:111]
QAA v[60:61],v7 offset:4096
QAA v[62:63],v7 offset:5120
QAB v[112:127],v[192:195],v[44:47],v[112:127]
QAH vmcnt(14) lgkmcnt(0)
QAB v[64:79],v[196:199],v[48:51],v[64:79]
QAA v[32:33],v4 offset:8192
QAA v[34:35],v4 offset:9216
QAA v[36:37],v5 offset:8192
QAB v[80:95],v[196:199],v[52:55],v[80:95]
QAA v[38:39],v5 offset:9216
QAA v[40:41],v6 offset:8192
QAA v[42:43],v6 offset:9216
QAB v[96:111],v[196:199],v[56:59],v[96:111]
QAA v[44:45],v7 offset:8192
QAA v[46:47],v7 offset:9216
QAB v[112:127],v[196:199],v[60:63],v[112:127]
QAH vmcnt(13) lgkmcnt(0)
QAB v[64:79],v[200:203],v[32:35],v[64:79]
QAA v[48:49],v4 offset:12288
QAA v[50:51],v4 offset:13312
QAA v[52:53],v5 offset:12288
QAB v[80:95],v[200:203],v[36:39],v[80:95]
QAA v[54:55],v5 offset:13312
QAA v[56:57],v6 offset:12288
QAA v[58:59],v6 offset:13312
QAB v[96:111],v[200:203],v[40:43],v[96:111]
QAA v[60:61],v7 offset:12288
QAA v[62:63],v7 offset:13312
QAB v[112:127],v[200:203],v[44:47],v[112:127]
QAH vmcnt(12) lgkmcnt(0)
QAB v[64:79],v[204:207],v[48:51],v[64:79]
QAA v[32:33],v4 offset:16384
QAA v[34:35],v4 offset:17408
QAA v[36:37],v5 offset:16384
QAB v[80:95],v[204:207],v[52:55],v[80:95]
QAA v[38:39],v5 offset:17408
QAA v[40:41],v6 offset:16384
QAA v[42:43],v6 offset:17408
QAB v[96:111],v[204:207],v[56:59],v[96:111]
QAA v[44:45],v7 offset:16384
QAA v[46:47],v7 offset:17408
QAB v[112:127],v[204:207],v[60:63],v[112:127]
QAH vmcnt(11) lgkmcnt(0)
QAB v[64:79],v[208:211],v[32:35],v[64:79]
QAA v[48:49],v4 offset:20480
QAA v[50:51],v4 offset:21504
QAA v[52:53],v5 offset:20480
QAB v[80:95],v[208:211],v[36:39],v[80:95]
QAA v[54:55],v5 offset:21504
QAA v[56:57],v6 offset:20480
QAA v[58:59],v6 offset:21504
QAB v[96:111],v[208:211],v[40:43],v[96:111]
QAA v[60:61],v7 offset:20480
QAA v[62:63],v7 offset:21504
QAB v[112:127],v[208:211],v[44:47],v[112:127]
QAH vmcnt(10) lgkmcnt(0)
QAB v[64:79],v[212:215],v[48:51],v[64:79]
QAA v[32:33],v4 offset:24576
QAA v[34:35],v4 offset:25600
QAA v[36:37],v5 offset:24576
QAB v[80:95],v[212:215],v[52:55],v[80:95]
QAA v[38:39],v5 offset:25600
QAA v[40:41],v6 offset:24576
QAA v[42:43],v6 offset:25600
QAB v[96:111],v[212:215],v[56:59],v[96:111]
QAA v[44:45],v7 offset:24576
QAA v[46:47],v7 offset:25600
QAB v[112:127],v[212:215],v[60:63],v[112:127]
QAH vmcnt(9) lgkmcnt(0)
QAB v[64:79],v[216:219],v[32:35],v[64:79]
QAA v[48:49],v4 offset:28672
QAA v[50:51],v4 offset:29696
QAA v[52:53],v5 offset:28672
QAB v[80:95],v[216:219],v[36:39],v[80:95]
QAA v[54:55],v5 offset:29696
QAA v[56:57],v6 offset:28672
QAA v[58:59],v6 offset:29696
QAB v[96:111],v[216:219],v[40:43],v[96:111]
QAA v[60:61],v7 offset:28672
QAA v[62:63],v7 offset:29696
QAB v[112:127],v[216:219],v[44:47],v[112:127]
QAH vmcnt(8) lgkmcnt(0)
QAB v[64:79],v[220:223],v[48:51],v[64:79]
QAA v[32:33],v4 offset:32768
QAA v[34:35],v4 offset:33792
QAA v[36:37],v5 offset:32768
QAB v[80:95],v[220:223],v[52:55],v[80:95]
QAA v[38:39],v5 offset:33792
QAA v[40:41],v6 offset:32768
QAA v[42:43],v6 offset:33792
QAB v[96:111],v[220:223],v[56:59],v[96:111]
QAA v[44:45],v7 offset:32768
QAA v[46:47],v7 offset:33792
QAB v[112:127],v[220:223],v[60:63],v[112:127]
QAH vmcnt(7) lgkmcnt(0)
QAB v[64:79],v[224:227],v[32:35],v[64:79]
QAA v[48:49],v4 offset:36864
QAA v[50:51],v4 offset:37888
QAA v[52:53],v5 offset:36864
QAB v[80:95],v[224:227],v[36:39],v[80:95]
QAA v[54:55],v5 offset:37888
QAA v[56:57],v6 offset:36864
QAA v[58:59],v6 offset:37888
QAB v[96:111],v[224:227],v[40:43],v[96:111]
QAA v[60:61],v7 offset:36864
QAA v[62:63],v7 offset:37888
QAB v[112:127],v[224:227],v[44:47],v[112:127]
QAH vmcnt(6) lgkmcnt(0)
QAB v[64:79],v[228:231],v[48:51],v[64:79]
QAA v[32:33],v4 offset:40960
QAA v[34:35],v4 offset:41984
QAA v[36:37],v5 offset:40960
QAB v[80:95],v[228:231],v[52:55],v[80:95]
QAA v[38:39],v5 offset:41984
QAA v[40:41],v6 offset:40960
QAA v[42:43],v6 offset:41984
QAB v[96:111],v[228:231],v[56:59],v[96:111]
QAA v[44:45],v7 offset:40960
QAA v[46:47],v7 offset:41984
QAB v[112:127],v[228:231],v[60:63],v[112:127]
QAH vmcnt(5) lgkmcnt(0)
QAB v[64:79],v[232:235],v[32:35],v[64:79]
QAA v[48:49],v4 offset:45056
QAA v[50:51],v4 offset:46080
QAA v[52:53],v5 offset:45056
QAB v[80:95],v[232:235],v[36:39],v[80:95]
QAA v[54:55],v5 offset:46080
QAA v[56:57],v6 offset:45056
QAA v[58:59],v6 offset:46080
QAB v[96:111],v[232:235],v[40:43],v[96:111]
QAA v[60:61],v7 offset:45056
QAA v[62:63],v7 offset:46080
QAB v[112:127],v[232:235],v[44:47],v[112:127]
QAH vmcnt(4) lgkmcnt(0)
QAB v[64:79],v[236:239],v[48:51],v[64:79]
QAA v[32:33],v4 offset:49152
QAA v[34:35],v4 offset:50176
QAA v[36:37],v5 offset:49152
QAB v[80:95],v[236:239],v[52:55],v[80:95]
QAA v[38:39],v5 offset:50176
QAA v[40:41],v6 offset:49152
QAA v[42:43],v6 offset:50176
QAB v[96:111],v[236:239],v[56:59],v[96:111]
QAA v[44:45],v7 offset:49152
QAA v[46:47],v7 offset:50176
QAB v[112:127],v[236:239],v[60:63],v[112:127]
QAH vmcnt(3) lgkmcnt(0)
QAB v[64:79],v[240:243],v[32:35],v[64:79]
QAA v[48:49],v4 offset:53248
QAA v[50:51],v4 offset:54272
QAA v[52:53],v5 offset:53248
QAB v[80:95],v[240:243],v[36:39],v[80:95]
QAA v[54:55],v5 offset:54272
QAA v[56:57],v6 offset:53248
QAA v[58:59],v6 offset:54272
QAB v[96:111],v[240:243],v[40:43],v[96:111]
QAA v[60:61],v7 offset:53248
QAA v[62:63],v7 offset:54272
QAB v[112:127],v[240:243],v[44:47],v[112:127]
QAH vmcnt(2) lgkmcnt(0)
QAB v[64:79],v[244:247],v[48:51],v[64:79]
QAA v[32:33],v4 offset:57344
QAA v[34:35],v4 offset:58368
QAA v[36:37],v5 offset:57344
QAB v[80:95],v[244:247],v[52:55],v[80:95]
QAA v[38:39],v5 offset:58368
QAA v[40:41],v6 offset:57344
QAA v[42:43],v6 offset:58368
QAB v[96:111],v[244:247],v[56:59],v[96:111]
QAA v[44:45],v7 offset:57344
QAA v[46:47],v7 offset:58368
QAB v[112:127],v[244:247],v[60:63],v[112:127]
QAH vmcnt(1) lgkmcnt(0)
QAB v[64:79],v[248:251],v[32:35],v[64:79]
QAA v[48:49],v4 offset:61440
QAA v[50:51],v4 offset:62464
QAA v[52:53],v5 offset:61440
QAB v[80:95],v[248:251],v[36:39],v[80:95]
QAA v[54:55],v5 offset:62464
QAA v[56:57],v6 offset:61440
QAA v[58:59],v6 offset:62464
QAB v[96:111],v[248:251],v[40:43],v[96:111]
QAA v[60:61],v7 offset:61440
QAA v[62:63],v7 offset:62464
QAB v[112:127],v[248:251],v[44:47],v[112:127]
QAH vmcnt(0) lgkmcnt(0)
QAB v[64:79],v[252:255],v[48:51],v[64:79]
QAB v[80:95],v[252:255],v[52:55],v[80:95]
QAB v[96:111],v[252:255],v[56:59],v[96:111]
QAB v[112:127],v[252:255],v[60:63],v[112:127]
QAE v32,v64,v65
QAE v33,v66,v67
QAE v34,v72,v73
QAE v35,v74,v75
QAE v36,v68,v69
QAE v37,v70,v71
QAE v38,v76,v77
QAE v39,v78,v79
QAL v[32:35],v1,s[16:19],s31 offen offset:0 sc1
QAL v[36:39],v1,s[16:19],s31 offen offset:1024 sc1
QAE v40,v80,v81
QAE v41,v82,v83
QAE v42,v88,v89
QAE v43,v90,v91
QAE v44,v84,v85
QAE v45,v86,v87
QAE v46,v92,v93
QAE v47,v94,v95
QAL v[40:43],v1,s[16:19],s31 offen offset:2048 sc1
QAL v[44:47],v1,s[16:19],s31 offen offset:3072 sc1
QAE v48,v96,v97
QAE v49,v98,v99
QAE v50,v104,v105
QAE v51,v106,v107
QAE v52,v100,v101
QAE v53,v102,v103
QAE v54,v108,v109
QAE v55,v110,v111
QAF s31,s31,4096
QAL v[48:51],v1,s[16:19],s31 offen offset:0 sc1
QAL v[52:55],v1,s[16:19],s31 offen offset:1024 sc1
QAE v56,v112,v113
QAE v57,v114,v115
QAE v58,v120,v121
QAE v59,v122,v123
QAE v60,v116,v117
QAE v61,v118,v119
QAE v62,v124,v125
QAE v63,v126,v127
QAL v[56:59],v1,s[16:19],s31 offen offset:2048 sc1
QAL v[60:63],v1,s[16:19],s31 offen offset:3072 sc1
kvf_fd:
QAH vmcnt(0)
s_barrier
QAS s13,s67,8
QAS s14,s66,2
QAF s13,s13,s14
QAF s13,s13,s56
QAF s13,s13,565256
QAQ v2,1
QBJ s9,0
s_cbranch_scc1 lay_aq
QBY exec,1
buffer_atomic_add v2,off,s[16:19],s13
QBY exec,-1
lay_aq:
s_branch lay_qret
lay_nofast:
QCB s62,s57,5
QBO s63,s57,31
QBN s62,4
QBL s64,5,4
s_movk_i32 s65,16384
QBL s65,13108,s65
lay_kvl:
s_mul_i32 s66,s63,s65
QCB s66,s66,16
s_mul_i32 s13,s66,s64
s_sub_u32 s13,s63,s13
s_mul_i32 s13,s13,7
QAF s67,s13,s62
QAF s66,s66,2
QAT s20,s42
QAT s21,s43
QAT s22,4194304
QAT s23,0x20000
QAT s24,s44
QAT s25,s45
QAT s26,4194304
QAT s27,0x20000
QAS s28,s66,17
QAS s13,s9,15
QAF s28,s28,s13
QAF s28,s28,0
QAS s29,s67,8
QAS s13,s9,17
QAF s29,s29,s13
QAS s30,s9,12
QBW v9,4,v0
QAM v10,15,v0
QAI v11,2,v9
QBH v10,v10,v11
QAI v10,4,v10
QBC v2,v9,13,v10
QAS s35,s66,8
QAF s35,s35,s56
QAF s35,s35,589824
QCB s13,s66,3
QAS s13,s13,2
QBS s75,0
QBL s35,s13,s35
QBJ s9,0
s_cbranch_scc1 lay_xw0
QBJ s75,0
s_cbranch_scc1 lay_xa7
QBR v16,off,s[92:95],s35 offset:32 sc1
s_branch lay_xb7
lay_xa7:
QAD v[16:19],off,s[16:19],s35 sc1
lay_xb7:
lay_xw0:
QAT s31,0
lkv_pl0:
QAF m0,s30,16384
QAF s13,s29,0
QAD v2,s[20:23],s13 offen lds
QAF m0,s30,17408
QAF s13,s29,32768
QAD v2,s[20:23],s13 offen lds
QAF m0,s30,18432
QAF s13,s29,65536
QAD v2,s[20:23],s13 offen lds
QAF m0,s30,19456
QAF s13,s29,98304
QAD v2,s[20:23],s13 offen lds
QAF m0,s30,32768
QAF s13,s29,0
QAD v2,s[24:27],s13 offen lds
QAF m0,s30,33792
QAF s13,s29,32768
QAD v2,s[24:27],s13 offen lds
QAF m0,s30,34816
QAF s13,s29,65536
QAD v2,s[24:27],s13 offen lds
QAF m0,s30,35840
QAF s13,s29,98304
QAD v2,s[24:27],s13 offen lds
QAF s29,s29,524288
QAF s30,s30,49152
QAF s31,s31,1
QBN s31,3
s_cbranch_scc1 lkv_pl0
QAS s30,s9,12
QBJ s9,0
s_cbranch_scc1 lay_xw_ok
QAH vmcnt(24)
QBJ s75,0
s_cbranch_scc1 lay_xa8
QCA s13,v16
QAS s14,s66,2
s_nop 0
QCB s13,s13,s14
QBO s13,s13,15
QBS s13,15
s_branch lay_xb8
lay_xa8:
QAM v16,v16,v17
QAM v18,v18,v19
QAM v16,v16,v18
s_nop 0
QCA s13,v16
s_nop 1
QBJ s13,0
lay_xb8:
s_cbranch_scc1 lay_xw_ok
QAT s15,0
lay_xw:
QBJ s75,0
s_cbranch_scc1 lay_xa9
QBR v16,off,s[92:95],s35 offset:32 sc1
s_branch lay_xb9
lay_xa9:
QAD v[16:19],off,s[16:19],s35 sc1
lay_xb9:
QAH vmcnt(0)
QBJ s75,0
s_cbranch_scc1 lay_xa10
QCA s13,v16
QAS s14,s66,2
s_nop 0
QCB s13,s13,s14
QBO s13,s13,15
QBS s13,15
s_branch lay_xb10
lay_xa10:
QAM v16,v16,v17
QAM v18,v18,v19
QAM v16,v16,v18
s_nop 0
QCA s13,v16
s_nop 1
QBJ s13,0
lay_xb10:
s_cbranch_scc1 lay_xw_ok
s_sleep 6
QAF s15,s15,1
QBN s15,400000
s_cbranch_scc1 lay_xw
lay_xw_ok:
s_barrier
QAT s31,0
lkv_pl1:
QAF m0,s30,0
QAF s13,s28,0
QAD v1,s[16:19],s13 offen sc1 lds
QAF m0,s30,1024
QAF s13,s28,1024
QAD v1,s[16:19],s13 offen sc1 lds
QAF m0,s30,2048
QAF s13,s28,2048
QAD v1,s[16:19],s13 offen sc1 lds
QAF m0,s30,3072
QAF s13,s28,3072
QAD v1,s[16:19],s13 offen sc1 lds
QAF s28,s28,4096
QAF s30,s30,49152
QAF s31,s31,1
QBN s31,3
s_cbranch_scc1 lkv_pl1
QAS s30,s9,12
QCC v9,v0,2,2
QBW v10,5,v0
QBC v10,v10,3,v9
QAI v10,8,v10
QCC v11,v0,4,1
QBC v10,v11,5,v10
QAM v11,3,v0
QBC v10,v11,3,v10
QCB s13,s9,1
QAS s13,s13,14
QAF s13,s13,16384
QBF v10,s13,v10
QBH v11,0,v9
QBC v4,v11,6,v10
QBH v11,1,v9
QBC v5,v11,6,v10
QBH v11,2,v9
QBC v6,v11,6,v10
QBH v11,3,v9
QBC v7,v11,6,v10
QBO s13,s9,1
QAS s13,s13,13
QBF v8,s13,v1
QAT s31,0
QAT s32,0
QAT s34,49152
QAH vmcnt(8)
s_barrier
QAG v[32:35],v8 offset:0
QAG v[36:39],v8 offset:4096
QAA v[40:41],v4 offset:0
QAA v[42:43],v4 offset:1024
QAA v[44:45],v5 offset:0
QAA v[46:47],v5 offset:1024
QAA v[48:49],v6 offset:0
QAA v[50:51],v6 offset:1024
QAA v[52:53],v7 offset:0
QAA v[54:55],v7 offset:1024
QBK s9,2
s_cbranch_scc1 lkv_vw
QAH lgkmcnt(0)
QAB v[128:143],v[40:43],v[32:35],0
QAG v[56:59],v8 offset:1024
QAG v[60:63],v8 offset:5120
QAA v[64:65],v4 offset:4096
QAB v[144:159],v[44:47],v[32:35],0
QAA v[66:67],v4 offset:5120
QAA v[68:69],v5 offset:4096
QAA v[70:71],v5 offset:5120
QAB v[160:175],v[48:51],v[32:35],0
QAA v[72:73],v6 offset:4096
QAA v[74:75],v6 offset:5120
QAB v[176:191],v[52:55],v[32:35],0
QAA v[76:77],v7 offset:4096
QAA v[78:79],v7 offset:5120
QAB v[192:207],v[40:43],v[36:39],0
QAB v[208:223],v[44:47],v[36:39],0
QAB v[224:239],v[48:51],v[36:39],0
QAB v[240:255],v[52:55],v[36:39],0
QAH lgkmcnt(0)
QAB v[128:143],v[64:67],v[56:59],v[128:143]
QAG v[32:35],v8 offset:2048
QAG v[36:39],v8 offset:6144
QAA v[40:41],v4 offset:8192
QAB v[144:159],v[68:71],v[56:59],v[144:159]
QAA v[42:43],v4 offset:9216
QAA v[44:45],v5 offset:8192
QAA v[46:47],v5 offset:9216
QAB v[160:175],v[72:75],v[56:59],v[160:175]
QAA v[48:49],v6 offset:8192
QAA v[50:51],v6 offset:9216
QAB v[176:191],v[76:79],v[56:59],v[176:191]
QAA v[52:53],v7 offset:8192
QAA v[54:55],v7 offset:9216
QAB v[192:207],v[64:67],v[60:63],v[192:207]
QAB v[208:223],v[68:71],v[60:63],v[208:223]
QAB v[224:239],v[72:75],v[60:63],v[224:239]
QAB v[240:255],v[76:79],v[60:63],v[240:255]
QAH lgkmcnt(0)
QAB v[128:143],v[40:43],v[32:35],v[128:143]
QAG v[56:59],v8 offset:3072
QAG v[60:63],v8 offset:7168
QAA v[64:65],v4 offset:12288
QAB v[144:159],v[44:47],v[32:35],v[144:159]
QAA v[66:67],v4 offset:13312
QAA v[68:69],v5 offset:12288
QAA v[70:71],v5 offset:13312
QAB v[160:175],v[48:51],v[32:35],v[160:175]
QAA v[72:73],v6 offset:12288
QAA v[74:75],v6 offset:13312
QAB v[176:191],v[52:55],v[32:35],v[176:191]
QAA v[76:77],v7 offset:12288
QAA v[78:79],v7 offset:13312
QAB v[192:207],v[40:43],v[36:39],v[192:207]
QAB v[208:223],v[44:47],v[36:39],v[208:223]
QAB v[224:239],v[48:51],v[36:39],v[224:239]
QAB v[240:255],v[52:55],v[36:39],v[240:255]
QAH vmcnt(4)
lkv_0_lp:
QAH vmcnt(12) lgkmcnt(0)
s_barrier
QAF s32,s32,1
QBS s32,3
QBL s33,0xfffe8000,s34
QBL s32,0,s32
QBK s31,5
QBL s28,0x7ff00000,s28
QBL s29,0x7ff00000,s29
QBF v4,s33,v4
QBF v5,s33,v5
QBF v6,s33,v6
QBF v7,s33,v7
QBF v8,s33,v8
QAB v[128:143],v[64:67],v[56:59],v[128:143]
QAG v[32:35],v8 offset:0
QAG v[36:39],v8 offset:4096
QAA v[40:41],v4 offset:0
QAB v[144:159],v[68:71],v[56:59],v[144:159]
QAA v[42:43],v4 offset:1024
QAA v[44:45],v5 offset:0
QAA v[46:47],v5 offset:1024
QAB v[160:175],v[72:75],v[56:59],v[160:175]
QAA v[48:49],v6 offset:0
QAA v[50:51],v6 offset:1024
QAB v[176:191],v[76:79],v[56:59],v[176:191]
QAA v[52:53],v7 offset:0
QAA v[54:55],v7 offset:1024
QAB v[192:207],v[64:67],v[60:63],v[192:207]
QAF m0,s30,0
QAF s13,s28,0
QAD v1,s[16:19],s13 offen sc1 lds
QAB v[208:223],v[68:71],v[60:63],v[208:223]
QAF m0,s30,1024
QAF s13,s28,1024
QAD v1,s[16:19],s13 offen sc1 lds
QAB v[224:239],v[72:75],v[60:63],v[224:239]
QAF m0,s30,2048
QAF s13,s28,2048
QAD v1,s[16:19],s13 offen sc1 lds
QAB v[240:255],v[76:79],v[60:63],v[240:255]
QBS s31,7
s_cbranch_scc1 lkv_0_ex
QAH lgkmcnt(0)
QAB v[128:143],v[40:43],v[32:35],v[128:143]
QAG v[56:59],v8 offset:1024
QAG v[60:63],v8 offset:5120
QAA v[64:65],v4 offset:4096
QAB v[144:159],v[44:47],v[32:35],v[144:159]
QAA v[66:67],v4 offset:5120
QAA v[68:69],v5 offset:4096
QAA v[70:71],v5 offset:5120
QAB v[160:175],v[48:51],v[32:35],v[160:175]
QAA v[72:73],v6 offset:4096
QAA v[74:75],v6 offset:5120
QAB v[176:191],v[52:55],v[32:35],v[176:191]
QAA v[76:77],v7 offset:4096
QAA v[78:79],v7 offset:5120
QAB v[192:207],v[40:43],v[36:39],v[192:207]
QAF m0,s30,3072
QAF s13,s28,3072
QAD v1,s[16:19],s13 offen sc1 lds
QAB v[208:223],v[44:47],v[36:39],v[208:223]
QAF m0,s30,16384
QAF s13,s29,0
QAD v2,s[20:23],s13 offen lds
QAB v[224:239],v[48:51],v[36:39],v[224:239]
QAF m0,s30,17408
QAF s13,s29,32768
QAD v2,s[20:23],s13 offen lds
QAB v[240:255],v[52:55],v[36:39],v[240:255]
QAH lgkmcnt(0)
QAB v[128:143],v[64:67],v[56:59],v[128:143]
QAG v[32:35],v8 offset:2048
QAG v[36:39],v8 offset:6144
QAA v[40:41],v4 offset:8192
QAB v[144:159],v[68:71],v[56:59],v[144:159]
QAA v[42:43],v4 offset:9216
QAA v[44:45],v5 offset:8192
QAA v[46:47],v5 offset:9216
QAB v[160:175],v[72:75],v[56:59],v[160:175]
QAA v[48:49],v6 offset:8192
QAA v[50:51],v6 offset:9216
QAB v[176:191],v[76:79],v[56:59],v[176:191]
QAA v[52:53],v7 offset:8192
QAA v[54:55],v7 offset:9216
QAB v[192:207],v[64:67],v[60:63],v[192:207]
QAF m0,s30,18432
QAF s13,s29,65536
QAD v2,s[20:23],s13 offen lds
QAB v[208:223],v[68:71],v[60:63],v[208:223]
QAF m0,s30,19456
QAF s13,s29,98304
QAD v2,s[20:23],s13 offen lds
QAB v[224:239],v[72:75],v[60:63],v[224:239]
QAF m0,s30,32768
QAF s13,s29,0
QAD v2,s[24:27],s13 offen lds
QAB v[240:255],v[76:79],v[60:63],v[240:255]
QAH lgkmcnt(0)
QAB v[128:143],v[40:43],v[32:35],v[128:143]
QAG v[56:59],v8 offset:3072
QAG v[60:63],v8 offset:7168
QAA v[64:65],v4 offset:12288
QAB v[144:159],v[44:47],v[32:35],v[144:159]
QAA v[66:67],v4 offset:13312
QAA v[68:69],v5 offset:12288
QAA v[70:71],v5 offset:13312
QAB v[160:175],v[48:51],v[32:35],v[160:175]
QAA v[72:73],v6 offset:12288
QAA v[74:75],v6 offset:13312
QAB v[176:191],v[52:55],v[32:35],v[176:191]
QAA v[76:77],v7 offset:12288
QAA v[78:79],v7 offset:13312
QAB v[192:207],v[40:43],v[36:39],v[192:207]
QAF m0,s30,33792
QAF s13,s29,32768
QAD v2,s[24:27],s13 offen lds
QAB v[208:223],v[44:47],v[36:39],v[208:223]
QAF m0,s30,34816
QAF s13,s29,65536
QAD v2,s[24:27],s13 offen lds
QAB v[224:239],v[48:51],v[36:39],v[224:239]
QAF m0,s30,35840
QAF s13,s29,98304
QAD v2,s[24:27],s13 offen lds
QAB v[240:255],v[52:55],v[36:39],v[240:255]
QAF s28,s28,4096
QAF s29,s29,524288
QAF s30,s30,s33
QAF s31,s31,1
s_branch lkv_0_lp
lkv_0_ex:
QAS s31,s67,6
QAS s13,s66,2
QAF s31,s31,s13
QBO s13,s9,1
QAS s13,s13,1
QAF s31,s31,s13
QAS s31,s31,13
QAF s31,s31,4194304
QAH lgkmcnt(0)
QAE v32,v128,v129
QAE v33,v130,v131
QAE v34,v132,v133
QAE v35,v134,v135
QAE v36,v136,v137
QAE v37,v138,v139
QAE v38,v140,v141
QAE v39,v142,v143
QAF s13,s31,0
QAL v[32:35],v1,s[16:19],s13 offen offset:0 sc1
QAL v[36:39],v1,s[16:19],s13 offen offset:1024 sc1
QAE v40,v144,v145
QAE v41,v146,v147
QAE v42,v148,v149
QAE v43,v150,v151
QAE v44,v152,v153
QAE v45,v154,v155
QAE v46,v156,v157
QAE v47,v158,v159
QAF s13,s31,2048
QAL v[40:43],v1,s[16:19],s13 offen offset:0 sc1
QAL v[44:47],v1,s[16:19],s13 offen offset:1024 sc1
QAE v48,v160,v161
QAE v49,v162,v163
QAE v50,v164,v165
QAE v51,v166,v167
QAE v52,v168,v169
QAE v53,v170,v171
QAE v54,v172,v173
QAE v55,v174,v175
QAF s13,s31,4096
QAL v[48:51],v1,s[16:19],s13 offen offset:0 sc1
QAL v[52:55],v1,s[16:19],s13 offen offset:1024 sc1
QAE v56,v176,v177
QAE v57,v178,v179
QAE v58,v180,v181
QAE v59,v182,v183
QAE v60,v184,v185
QAE v61,v186,v187
QAE v62,v188,v189
QAE v63,v190,v191
QAF s13,s31,6144
QAL v[56:59],v1,s[16:19],s13 offen offset:0 sc1
QAL v[60:63],v1,s[16:19],s13 offen offset:1024 sc1
QAE v32,v192,v193
QAE v33,v194,v195
QAE v34,v196,v197
QAE v35,v198,v199
QAE v36,v200,v201
QAE v37,v202,v203
QAE v38,v204,v205
QAE v39,v206,v207
QAF s13,s31,8192
QAL v[32:35],v1,s[16:19],s13 offen offset:0 sc1
QAL v[36:39],v1,s[16:19],s13 offen offset:1024 sc1
QAE v40,v208,v209
QAE v41,v210,v211
QAE v42,v212,v213
QAE v43,v214,v215
QAE v44,v216,v217
QAE v45,v218,v219
QAE v46,v220,v221
QAE v47,v222,v223
QAF s13,s31,10240
QAL v[40:43],v1,s[16:19],s13 offen offset:0 sc1
QAL v[44:47],v1,s[16:19],s13 offen offset:1024 sc1
QAE v48,v224,v225
QAE v49,v226,v227
QAE v50,v228,v229
QAE v51,v230,v231
QAE v52,v232,v233
QAE v53,v234,v235
QAE v54,v236,v237
QAE v55,v238,v239
QAF s13,s31,12288
QAL v[48:51],v1,s[16:19],s13 offen offset:0 sc1
QAL v[52:55],v1,s[16:19],s13 offen offset:1024 sc1
QAE v56,v240,v241
QAE v57,v242,v243
QAE v58,v244,v245
QAE v59,v246,v247
QAE v60,v248,v249
QAE v61,v250,v251
QAE v62,v252,v253
QAE v63,v254,v255
QAF s13,s31,14336
QAL v[56:59],v1,s[16:19],s13 offen offset:0 sc1
QAL v[60:63],v1,s[16:19],s13 offen offset:1024 sc1
s_branch lkv_kvdone
lkv_vw:
QAH lgkmcnt(0)
QAB v[128:143],v[32:35],v[40:43],0
QAG v[56:59],v8 offset:1024
QAG v[60:63],v8 offset:5120
QAA v[64:65],v4 offset:4096
QAB v[144:159],v[32:35],v[44:47],0
QAA v[66:67],v4 offset:5120
QAA v[68:69],v5 offset:4096
QAA v[70:71],v5 offset:5120
QAB v[160:175],v[32:35],v[48:51],0
QAA v[72:73],v6 offset:4096
QAA v[74:75],v6 offset:5120
QAB v[176:191],v[32:35],v[52:55],0
QAA v[76:77],v7 offset:4096
QAA v[78:79],v7 offset:5120
QAB v[192:207],v[36:39],v[40:43],0
QAB v[208:223],v[36:39],v[44:47],0
QAB v[224:239],v[36:39],v[48:51],0
QAB v[240:255],v[36:39],v[52:55],0
QAH lgkmcnt(0)
QAB v[128:143],v[56:59],v[64:67],v[128:143]
QAG v[32:35],v8 offset:2048
QAG v[36:39],v8 offset:6144
QAA v[40:41],v4 offset:8192
QAB v[144:159],v[56:59],v[68:71],v[144:159]
QAA v[42:43],v4 offset:9216
QAA v[44:45],v5 offset:8192
QAA v[46:47],v5 offset:9216
QAB v[160:175],v[56:59],v[72:75],v[160:175]
QAA v[48:49],v6 offset:8192
QAA v[50:51],v6 offset:9216
QAB v[176:191],v[56:59],v[76:79],v[176:191]
QAA v[52:53],v7 offset:8192
QAA v[54:55],v7 offset:9216
QAB v[192:207],v[60:63],v[64:67],v[192:207]
QAB v[208:223],v[60:63],v[68:71],v[208:223]
QAB v[224:239],v[60:63],v[72:75],v[224:239]
QAB v[240:255],v[60:63],v[76:79],v[240:255]
QAH lgkmcnt(0)
QAB v[128:143],v[32:35],v[40:43],v[128:143]
QAG v[56:59],v8 offset:3072
QAG v[60:63],v8 offset:7168
QAA v[64:65],v4 offset:12288
QAB v[144:159],v[32:35],v[44:47],v[144:159]
QAA v[66:67],v4 offset:13312
QAA v[68:69],v5 offset:12288
QAA v[70:71],v5 offset:13312
QAB v[160:175],v[32:35],v[48:51],v[160:175]
QAA v[72:73],v6 offset:12288
QAA v[74:75],v6 offset:13312
QAB v[176:191],v[32:35],v[52:55],v[176:191]
QAA v[76:77],v7 offset:12288
QAA v[78:79],v7 offset:13312
QAB v[192:207],v[36:39],v[40:43],v[192:207]
QAB v[208:223],v[36:39],v[44:47],v[208:223]
QAB v[224:239],v[36:39],v[48:51],v[224:239]
QAB v[240:255],v[36:39],v[52:55],v[240:255]
QAH vmcnt(4)
lkv_1_lp:
QAH vmcnt(12) lgkmcnt(0)
s_barrier
QAF s32,s32,1
QBS s32,3
QBL s33,0xfffe8000,s34
QBL s32,0,s32
QBK s31,5
QBL s28,0x7ff00000,s28
QBL s29,0x7ff00000,s29
QBF v4,s33,v4
QBF v5,s33,v5
QBF v6,s33,v6
QBF v7,s33,v7
QBF v8,s33,v8
QAB v[128:143],v[56:59],v[64:67],v[128:143]
QAG v[32:35],v8 offset:0
QAG v[36:39],v8 offset:4096
QAA v[40:41],v4 offset:0
QAB v[144:159],v[56:59],v[68:71],v[144:159]
QAA v[42:43],v4 offset:1024
QAA v[44:45],v5 offset:0
QAA v[46:47],v5 offset:1024
QAB v[160:175],v[56:59],v[72:75],v[160:175]
QAA v[48:49],v6 offset:0
QAA v[50:51],v6 offset:1024
QAB v[176:191],v[56:59],v[76:79],v[176:191]
QAA v[52:53],v7 offset:0
QAA v[54:55],v7 offset:1024
QAB v[192:207],v[60:63],v[64:67],v[192:207]
QAF m0,s30,0
QAF s13,s28,0
QAD v1,s[16:19],s13 offen sc1 lds
QAB v[208:223],v[60:63],v[68:71],v[208:223]
QAF m0,s30,1024
QAF s13,s28,1024
QAD v1,s[16:19],s13 offen sc1 lds
QAB v[224:239],v[60:63],v[72:75],v[224:239]
QAF m0,s30,2048
QAF s13,s28,2048
QAD v1,s[16:19],s13 offen sc1 lds
QAB v[240:255],v[60:63],v[76:79],v[240:255]
QBS s31,7
s_cbranch_scc1 lkv_1_ex
QAH lgkmcnt(0)
QAB v[128:143],v[32:35],v[40:43],v[128:143]
QAG v[56:59],v8 offset:1024
QAG v[60:63],v8 offset:5120
QAA v[64:65],v4 offset:4096
QAB v[144:159],v[32:35],v[44:47],v[144:159]
QAA v[66:67],v4 offset:5120
QAA v[68:69],v5 offset:4096
QAA v[70:71],v5 offset:5120
QAB v[160:175],v[32:35],v[48:51],v[160:175]
QAA v[72:73],v6 offset:4096
QAA v[74:75],v6 offset:5120
QAB v[176:191],v[32:35],v[52:55],v[176:191]
QAA v[76:77],v7 offset:4096
QAA v[78:79],v7 offset:5120
QAB v[192:207],v[36:39],v[40:43],v[192:207]
QAF m0,s30,3072
QAF s13,s28,3072
QAD v1,s[16:19],s13 offen sc1 lds
QAB v[208:223],v[36:39],v[44:47],v[208:223]
QAF m0,s30,16384
QAF s13,s29,0
QAD v2,s[20:23],s13 offen lds
QAB v[224:239],v[36:39],v[48:51],v[224:239]
QAF m0,s30,17408
QAF s13,s29,32768
QAD v2,s[20:23],s13 offen lds
QAB v[240:255],v[36:39],v[52:55],v[240:255]
QAH lgkmcnt(0)
QAB v[128:143],v[56:59],v[64:67],v[128:143]
QAG v[32:35],v8 offset:2048
QAG v[36:39],v8 offset:6144
QAA v[40:41],v4 offset:8192
QAB v[144:159],v[56:59],v[68:71],v[144:159]
QAA v[42:43],v4 offset:9216
QAA v[44:45],v5 offset:8192
QAA v[46:47],v5 offset:9216
QAB v[160:175],v[56:59],v[72:75],v[160:175]
QAA v[48:49],v6 offset:8192
QAA v[50:51],v6 offset:9216
QAB v[176:191],v[56:59],v[76:79],v[176:191]
QAA v[52:53],v7 offset:8192
QAA v[54:55],v7 offset:9216
QAB v[192:207],v[60:63],v[64:67],v[192:207]
QAF m0,s30,18432
QAF s13,s29,65536
QAD v2,s[20:23],s13 offen lds
QAB v[208:223],v[60:63],v[68:71],v[208:223]
QAF m0,s30,19456
QAF s13,s29,98304
QAD v2,s[20:23],s13 offen lds
QAB v[224:239],v[60:63],v[72:75],v[224:239]
QAF m0,s30,32768
QAF s13,s29,0
QAD v2,s[24:27],s13 offen lds
QAB v[240:255],v[60:63],v[76:79],v[240:255]
QAH lgkmcnt(0)
QAB v[128:143],v[32:35],v[40:43],v[128:143]
QAG v[56:59],v8 offset:3072
QAG v[60:63],v8 offset:7168
QAA v[64:65],v4 offset:12288
QAB v[144:159],v[32:35],v[44:47],v[144:159]
QAA v[66:67],v4 offset:13312
QAA v[68:69],v5 offset:12288
QAA v[70:71],v5 offset:13312
QAB v[160:175],v[32:35],v[48:51],v[160:175]
QAA v[72:73],v6 offset:12288
QAA v[74:75],v6 offset:13312
QAB v[176:191],v[32:35],v[52:55],v[176:191]
QAA v[76:77],v7 offset:12288
QAA v[78:79],v7 offset:13312
QAB v[192:207],v[36:39],v[40:43],v[192:207]
QAF m0,s30,33792
QAF s13,s29,32768
QAD v2,s[24:27],s13 offen lds
QAB v[208:223],v[36:39],v[44:47],v[208:223]
QAF m0,s30,34816
QAF s13,s29,65536
QAD v2,s[24:27],s13 offen lds
QAB v[224:239],v[36:39],v[48:51],v[224:239]
QAF m0,s30,35840
QAF s13,s29,98304
QAD v2,s[24:27],s13 offen lds
QAB v[240:255],v[36:39],v[52:55],v[240:255]
QAF s28,s28,4096
QAF s29,s29,524288
QAF s30,s30,s33
QAF s31,s31,1
s_branch lkv_1_lp
lkv_1_ex:
QAS s31,s67,6
QAS s13,s66,2
QAF s31,s31,s13
QBO s13,s9,1
QAS s13,s13,1
QAF s31,s31,s13
QAS s31,s31,13
QAF s31,s31,20971520
QAH lgkmcnt(0)
QAE v32,v128,v129
QAE v33,v130,v131
QAE v34,v136,v137
QAE v35,v138,v139
QAE v36,v132,v133
QAE v37,v134,v135
QAE v38,v140,v141
QAE v39,v142,v143
QAF s13,s31,0
QAL v[32:35],v1,s[16:19],s13 offen offset:0 sc1
QAL v[36:39],v1,s[16:19],s13 offen offset:1024 sc1
QAE v40,v144,v145
QAE v41,v146,v147
QAE v42,v152,v153
QAE v43,v154,v155
QAE v44,v148,v149
QAE v45,v150,v151
QAE v46,v156,v157
QAE v47,v158,v159
QAF s13,s31,2048
QAL v[40:43],v1,s[16:19],s13 offen offset:0 sc1
QAL v[44:47],v1,s[16:19],s13 offen offset:1024 sc1
QAE v48,v160,v161
QAE v49,v162,v163
QAE v50,v168,v169
QAE v51,v170,v171
QAE v52,v164,v165
QAE v53,v166,v167
QAE v54,v172,v173
QAE v55,v174,v175
QAF s13,s31,4096
QAL v[48:51],v1,s[16:19],s13 offen offset:0 sc1
QAL v[52:55],v1,s[16:19],s13 offen offset:1024 sc1
QAE v56,v176,v177
QAE v57,v178,v179
QAE v58,v184,v185
QAE v59,v186,v187
QAE v60,v180,v181
QAE v61,v182,v183
QAE v62,v188,v189
QAE v63,v190,v191
QAF s13,s31,6144
QAL v[56:59],v1,s[16:19],s13 offen offset:0 sc1
QAL v[60:63],v1,s[16:19],s13 offen offset:1024 sc1
QAE v32,v192,v193
QAE v33,v194,v195
QAE v34,v200,v201
QAE v35,v202,v203
QAE v36,v196,v197
QAE v37,v198,v199
QAE v38,v204,v205
QAE v39,v206,v207
QAF s13,s31,8192
QAL v[32:35],v1,s[16:19],s13 offen offset:0 sc1
QAL v[36:39],v1,s[16:19],s13 offen offset:1024 sc1
QAE v40,v208,v209
QAE v41,v210,v211
QAE v42,v216,v217
QAE v43,v218,v219
QAE v44,v212,v213
QAE v45,v214,v215
QAE v46,v220,v221
QAE v47,v222,v223
QAF s13,s31,10240
QAL v[40:43],v1,s[16:19],s13 offen offset:0 sc1
QAL v[44:47],v1,s[16:19],s13 offen offset:1024 sc1
QAE v48,v224,v225
QAE v49,v226,v227
QAE v50,v232,v233
QAE v51,v234,v235
QAE v52,v228,v229
QAE v53,v230,v231
QAE v54,v236,v237
QAE v55,v238,v239
QAF s13,s31,12288
QAL v[48:51],v1,s[16:19],s13 offen offset:0 sc1
QAL v[52:55],v1,s[16:19],s13 offen offset:1024 sc1
QAE v56,v240,v241
QAE v57,v242,v243
QAE v58,v248,v249
QAE v59,v250,v251
QAE v60,v244,v245
QAE v61,v246,v247
QAE v62,v252,v253
QAE v63,v254,v255
QAF s13,s31,14336
QAL v[56:59],v1,s[16:19],s13 offen offset:0 sc1
QAL v[60:63],v1,s[16:19],s13 offen offset:1024 sc1
lkv_kvdone:
QAH vmcnt(0)
s_barrier
QAS s13,s67,8
QAS s14,s66,2
QAF s13,s13,s14
QAF s13,s13,s56
QAF s13,s13,565256
QAQ v2,4
QBJ s9,0
s_cbranch_scc1 lay_a1
QBY exec,1
buffer_atomic_add v2,off,s[16:19],s13
QBY exec,-1
lay_a1:
QAF s63,s63,32
s_mul_i32 s13,s64,14
QBN s63,s13
s_cbranch_scc1 lay_kvl
QBJ s75,0
s_cbranch_scc1 lay_notab
QBW v2,5,v0
QAM v3,31,v0
QBK s60,128
s_cbranch_scc1 tab_wt
QBO s12,s60,63
QAS s12,s12,3
QAS s13,s9,1
QAF s12,s12,s13
QCB s14,s12,5
QBO s15,s12,31
QAS s24,s12,10
QAS s14,s14,5
QAS s15,s15,4
QBC v7,v2,3,s15
QAT s25,0
QBK s60,64
s_cbranch_scc1 tab_ti
QBF v4,s14,v3
QBW v5,1,v4
QAM v6,1,v4
QAI v6,7,v6
QBP vcc,1,v4
QAQ v9,256
s_nop 0
QAX v5,v5,v9,vcc
QAX v6,v6,0,vcc
v_mul_u32_u24 v8,v7,v5
QBF v8,v8,v6
QAF s24,s24,52428800
tab_tfl:
QAM v9,511,v8
v_cvt_f32_u32 v9,v9
QAW v9,0x3b000000,v9
v_cos_f32 v16,v9
QBF v8,v8,v5
QAM v9,511,v8
v_cvt_f32_u32 v9,v9
QAW v9,0x3b000000,v9
v_cos_f32 v17,v9
QBF v8,v8,v5
QAM v9,511,v8
v_cvt_f32_u32 v9,v9
QAW v9,0x3b000000,v9
v_cos_f32 v18,v9
QBF v8,v8,v5
QAM v9,511,v8
v_cvt_f32_u32 v9,v9
QAW v9,0x3b000000,v9
v_cos_f32 v19,v9
QBF v8,v8,v5
QAM v9,511,v8
v_cvt_f32_u32 v9,v9
QAW v9,0x3b000000,v9
v_cos_f32 v20,v9
QBF v8,v8,v5
QAM v9,511,v8
v_cvt_f32_u32 v9,v9
QAW v9,0x3b000000,v9
v_cos_f32 v21,v9
QBF v8,v8,v5
QAM v9,511,v8
v_cvt_f32_u32 v9,v9
QAW v9,0x3b000000,v9
v_cos_f32 v22,v9
QBF v8,v8,v5
QAM v9,511,v8
v_cvt_f32_u32 v9,v9
QAW v9,0x3b000000,v9
v_cos_f32 v23,v9
QBF v8,v8,v5
QAE v24,v16,v17
QAE v25,v18,v19
QAE v26,v20,v21
QAE v27,v22,v23
QBC v8,v5,3,v8
QAL v[24:27],v1,s[16:19],s24 offen sc1
QAF s24,s24,1024
QAF s25,s25,1
QBN s25,2
s_cbranch_scc1 tab_tfl
s_branch tab_tdone
tab_ti:
QAM v4,19,v3
QCC v5,v3,2,1
v_lshl_or_b32 v4,v5,3,v4
QCC v5,v3,3,1
v_lshl_or_b32 v4,v5,2,v4
QBF v4,s14,v4
QAF s24,s24,52953088
tab_til:
QBF v5,0,v7
QBW v6,1,v5
QBP vcc,1,v5
QAQ v9,256
s_nop 0
QAX v6,v6,v9,vcc
QAQ v9,0
QAX v9,v9,0,vcc
v_mad_u32_u24 v8,v6,v4,v9
QAM v8,511,v8
v_cvt_f32_u32 v8,v8
QAW v8,0x3b000000,v8
v_cos_f32 v8,v8
v_cmp_gt_u32 vcc,2,v5
QAU v9,v8,v8
s_nop 0
QAX v16,v9,v8,vcc
QBF v5,1,v7
QBW v6,1,v5
QBP vcc,1,v5
QAQ v9,256
s_nop 0
QAX v6,v6,v9,vcc
QAQ v9,128
QAX v9,v9,0,vcc
v_mad_u32_u24 v8,v6,v4,v9
QAM v8,511,v8
v_cvt_f32_u32 v8,v8
QAW v8,0x3b000000,v8
v_cos_f32 v8,v8
v_cmp_gt_u32 vcc,2,v5
QAU v9,v8,v8
s_nop 0
QAX v17,v9,v8,vcc
QBF v5,2,v7
QBW v6,1,v5
QBP vcc,1,v5
QAQ v9,256
s_nop 0
QAX v6,v6,v9,vcc
QAQ v9,0
QAX v9,v9,0,vcc
v_mad_u32_u24 v8,v6,v4,v9
QAM v8,511,v8
v_cvt_f32_u32 v8,v8
QAW v8,0x3b000000,v8
v_cos_f32 v8,v8
v_cmp_gt_u32 vcc,2,v5
QAU v9,v8,v8
s_nop 0
QAX v18,v9,v8,vcc
QBF v5,3,v7
QBW v6,1,v5
QBP vcc,1,v5
QAQ v9,256
s_nop 0
QAX v6,v6,v9,vcc
QAQ v9,128
QAX v9,v9,0,vcc
v_mad_u32_u24 v8,v6,v4,v9
QAM v8,511,v8
v_cvt_f32_u32 v8,v8
QAW v8,0x3b000000,v8
v_cos_f32 v8,v8
v_cmp_gt_u32 vcc,2,v5
QAU v9,v8,v8
s_nop 0
QAX v19,v9,v8,vcc
QBF v5,4,v7
QBW v6,1,v5
QBP vcc,1,v5
QAQ v9,256
s_nop 0
QAX v6,v6,v9,vcc
QAQ v9,0
QAX v9,v9,0,vcc
v_mad_u32_u24 v8,v6,v4,v9
QAM v8,511,v8
v_cvt_f32_u32 v8,v8
QAW v8,0x3b000000,v8
v_cos_f32 v8,v8
v_cmp_gt_u32 vcc,2,v5
QAU v9,v8,v8
s_nop 0
QAX v20,v9,v8,vcc
QBF v5,5,v7
QBW v6,1,v5
QBP vcc,1,v5
QAQ v9,256
s_nop 0
QAX v6,v6,v9,vcc
QAQ v9,128
QAX v9,v9,0,vcc
v_mad_u32_u24 v8,v6,v4,v9
QAM v8,511,v8
v_cvt_f32_u32 v8,v8
QAW v8,0x3b000000,v8
v_cos_f32 v8,v8
v_cmp_gt_u32 vcc,2,v5
QAU v9,v8,v8
s_nop 0
QAX v21,v9,v8,vcc
QBF v5,6,v7
QBW v6,1,v5
QBP vcc,1,v5
QAQ v9,256
s_nop 0
QAX v6,v6,v9,vcc
QAQ v9,0
QAX v9,v9,0,vcc
v_mad_u32_u24 v8,v6,v4,v9
QAM v8,511,v8
v_cvt_f32_u32 v8,v8
QAW v8,0x3b000000,v8
v_cos_f32 v8,v8
v_cmp_gt_u32 vcc,2,v5
QAU v9,v8,v8
s_nop 0
QAX v22,v9,v8,vcc
QBF v5,7,v7
QBW v6,1,v5
QBP vcc,1,v5
QAQ v9,256
s_nop 0
QAX v6,v6,v9,vcc
QAQ v9,128
QAX v9,v9,0,vcc
v_mad_u32_u24 v8,v6,v4,v9
QAM v8,511,v8
v_cvt_f32_u32 v8,v8
QAW v8,0x3b000000,v8
v_cos_f32 v8,v8
v_cmp_gt_u32 vcc,2,v5
QAU v9,v8,v8
s_nop 0
QAX v23,v9,v8,vcc
QAE v24,v16,v17
QAE v25,v18,v19
QAE v26,v20,v21
QAE v27,v22,v23
QBF v7,16,v7
QAL v[24:27],v1,s[16:19],s24 offen sc1
QAF s24,s24,1024
QAF s25,s25,1
QBN s25,2
s_cbranch_scc1 tab_til
s_branch tab_tdone
tab_wt:
s_sub_u32 s12,s60,128
QAS s12,s12,2
QAF s12,s12,s9
QBK s12,257
s_cbranch_scc1 tab_ct
QAT s20,s78
QAT s21,s79
QAT s22,1052672
QAT s23,0x20000
QAT s24,s80
QAT s25,s81
QAT s26,1052672
QAT s27,0x20000
QBC v4,v2,8,v3
v_mul_u32_u24 v4,514,v4
QAS s13,s12,1
QAS s28,s12,13
QAF s28,s28,57671680
QAT s29,0
QAT s30,0x35800000
tab_wtl:
QAF s14,s13,0
QBZ v32,v4,s[20:23],s14 offen
QBZ v48,v4,s[24:27],s14 offen
QAF s14,s13,32896
QBZ v33,v4,s[20:23],s14 offen
QBZ v49,v4,s[24:27],s14 offen
QAF s14,s13,65792
QBZ v34,v4,s[20:23],s14 offen
QBZ v50,v4,s[24:27],s14 offen
QAF s14,s13,98688
QBZ v35,v4,s[20:23],s14 offen
QBZ v51,v4,s[24:27],s14 offen
QAF s14,s13,263168
QBZ v36,v4,s[20:23],s14 offen
QBZ v52,v4,s[24:27],s14 offen
QAF s14,s13,296064
QBZ v37,v4,s[20:23],s14 offen
QBZ v53,v4,s[24:27],s14 offen
QAF s14,s13,328960
QBZ v38,v4,s[20:23],s14 offen
QBZ v54,v4,s[24:27],s14 offen
QAF s14,s13,361856
QBZ v39,v4,s[20:23],s14 offen
QBZ v55,v4,s[24:27],s14 offen
QAF s14,s13,526336
QBZ v40,v4,s[20:23],s14 offen
QBZ v56,v4,s[24:27],s14 offen
QAF s14,s13,559232
QBZ v41,v4,s[20:23],s14 offen
QBZ v57,v4,s[24:27],s14 offen
QAF s14,s13,592128
QBZ v42,v4,s[20:23],s14 offen
QBZ v58,v4,s[24:27],s14 offen
QAF s14,s13,625024
QBZ v43,v4,s[20:23],s14 offen
QBZ v59,v4,s[24:27],s14 offen
QAF s14,s13,789504
QBZ v44,v4,s[20:23],s14 offen
QBZ v60,v4,s[24:27],s14 offen
QAF s14,s13,822400
QBZ v45,v4,s[20:23],s14 offen
QBZ v61,v4,s[24:27],s14 offen
QAF s14,s13,855296
QBZ v46,v4,s[20:23],s14 offen
QBZ v62,v4,s[24:27],s14 offen
QAF s14,s13,888192
QBZ v47,v4,s[20:23],s14 offen
QBZ v63,v4,s[24:27],s14 offen
QAH vmcnt(0)
QAI v32,16,v32
QAI v48,16,v48
QAW v32,s30,v32
QAW v48,s30,v48
QAE v64,v32,v48
QAI v33,16,v33
QAI v49,16,v49
QAW v33,s30,v33
QAW v49,s30,v49
QAE v65,v33,v49
QAI v34,16,v34
QAI v50,16,v50
QAW v34,s30,v34
QAW v50,s30,v50
QAE v66,v34,v50
QAI v35,16,v35
QAI v51,16,v51
QAW v35,s30,v35
QAW v51,s30,v51
QAE v67,v35,v51
QAI v36,16,v36
QAI v52,16,v52
QAW v36,s30,v36
QAW v52,s30,v52
QAE v68,v36,v52
QAI v37,16,v37
QAI v53,16,v53
QAW v37,s30,v37
QAW v53,s30,v53
QAE v69,v37,v53
QAI v38,16,v38
QAI v54,16,v54
QAW v38,s30,v38
QAW v54,s30,v54
QAE v70,v38,v54
QAI v39,16,v39
QAI v55,16,v55
QAW v39,s30,v39
QAW v55,s30,v55
QAE v71,v39,v55
QAI v40,16,v40
QAI v56,16,v56
QAW v40,s30,v40
QAW v56,s30,v56
QAE v72,v40,v56
QAI v41,16,v41
QAI v57,16,v57
QAW v41,s30,v41
QAW v57,s30,v57
QAE v73,v41,v57
QAI v42,16,v42
QAI v58,16,v58
QAW v42,s30,v42
QAW v58,s30,v58
QAE v74,v42,v58
QAI v43,16,v43
QAI v59,16,v59
QAW v43,s30,v43
QAW v59,s30,v59
QAE v75,v43,v59
QAI v44,16,v44
QAI v60,16,v60
QAW v44,s30,v44
QAW v60,s30,v60
QAE v76,v44,v60
QAI v45,16,v45
QAI v61,16,v61
QAW v45,s30,v45
QAW v61,s30,v61
QAE v77,v45,v61
QAI v46,16,v46
QAI v62,16,v62
QAW v46,s30,v46
QAW v62,s30,v62
QAE v78,v46,v62
QAI v47,16,v47
QAI v63,16,v63
QAW v47,s30,v47
QAW v63,s30,v63
QAE v79,v47,v63
QAL v[64:67],v1,s[16:19],s28 offen offset:0 sc1
QAL v[68:71],v1,s[16:19],s28 offen offset:1024 sc1
QAL v[72:75],v1,s[16:19],s28 offen offset:2048 sc1
QAL v[76:79],v1,s[16:19],s28 offen offset:3072 sc1
QAF s28,s28,4096
QAF s13,s13,16448
QAF s29,s29,1
QBN s29,2
s_cbranch_scc1 tab_wtl
s_branch tab_tdone
tab_ct:
s_sub_u32 s12,s12,257
QBK s12,60
s_cbranch_scc1 tab_tdone
QAM v5,19,v3
QCC v6,v3,2,1
v_lshl_or_b32 v5,v6,3,v5
QCC v6,v3,3,1
v_lshl_or_b32 v5,v6,2,v5
QAT s25,0
QAT s28,0
QAT s29,0
QBK s12,28
s_cbranch_scc1 tab_c2
QBK s12,16
s_cbranch_scc1 tab_c1
QBO s24,s12,3
QAS s24,s24,4
QBO s25,s12,4
QAS s25,s25,3
QAT s26,5
QBK s12,8
QBL s27,1536,0
s_branch tab_cg
tab_c1:
s_sub_u32 s13,s12,16
QBK s13,6
QBL s28,1,0
QBL s14,6,0
s_sub_u32 s13,s13,s14
QBO s24,s13,1
QAS s24,s24,4
QAT s26,6
QCB s13,s13,1
QBS s13,1
QBL s27,1536,0
QBS s13,2
QBL s27,512,s27
s_branch tab_cg
tab_c2:
s_sub_u32 s13,s12,28
QCB s28,s13,4
QAT s29,1
QAT s26,0
QBO s14,s13,8
QBJ s14,0
QBL s27,1536,0
QBO s24,s13,3
QAS s24,s24,3
QBO s14,s13,4
QAS s14,s14,3
QBJ s28,0
QBL s15,s14,0
QBL s25,0,s14
QAF s24,s24,s15
tab_cg:
QBJ s28,0
s_cselect_b64 vcc,-1,0
QAX v8,v3,v5,vcc
QBF v8,s25,v8
QBC v6,v2,2,s24
QBF v7,0,v6
v_mul_u32_u24 v7,v7,v8
QAI v7,s26,v7
QBF v7,s27,v7
QAM v7,2047,v7
v_cvt_f32_u32 v7,v7
QAW v7,0x3a000000,v7
v_cos_f32 v32,v7
QBF v7,1,v6
v_mul_u32_u24 v7,v7,v8
QAI v7,s26,v7
QBF v7,s27,v7
QAM v7,2047,v7
v_cvt_f32_u32 v7,v7
QAW v7,0x3a000000,v7
v_cos_f32 v33,v7
QBF v7,2,v6
v_mul_u32_u24 v7,v7,v8
QAI v7,s26,v7
QBF v7,s27,v7
QAM v7,2047,v7
v_cvt_f32_u32 v7,v7
QAW v7,0x3a000000,v7
v_cos_f32 v34,v7
QBF v7,3,v6
v_mul_u32_u24 v7,v7,v8
QAI v7,s26,v7
QBF v7,s27,v7
QAM v7,2047,v7
v_cvt_f32_u32 v7,v7
QAW v7,0x3a000000,v7
v_cos_f32 v35,v7
QBF v7,8,v6
v_mul_u32_u24 v7,v7,v8
QAI v7,s26,v7
QBF v7,s27,v7
QAM v7,2047,v7
v_cvt_f32_u32 v7,v7
QAW v7,0x3a000000,v7
v_cos_f32 v36,v7
QBF v7,9,v6
v_mul_u32_u24 v7,v7,v8
QAI v7,s26,v7
QBF v7,s27,v7
QAM v7,2047,v7
v_cvt_f32_u32 v7,v7
QAW v7,0x3a000000,v7
v_cos_f32 v37,v7
QBF v7,10,v6
v_mul_u32_u24 v7,v7,v8
QAI v7,s26,v7
QBF v7,s27,v7
QAM v7,2047,v7
v_cvt_f32_u32 v7,v7
QAW v7,0x3a000000,v7
v_cos_f32 v38,v7
QBF v7,11,v6
v_mul_u32_u24 v7,v7,v8
QAI v7,s26,v7
QBF v7,s27,v7
QAM v7,2047,v7
v_cvt_f32_u32 v7,v7
QAW v7,0x3a000000,v7
v_cos_f32 v39,v7
QBJ s29,0
s_cbranch_scc1 tab_cs
QAE v32,v32,v33
QAE v33,v34,v35
QAE v34,v36,v37
QAE v35,v38,v39
tab_cs:
QAS s13,s12,10
QAF s13,s13,53477376
QAL v[32:35],v1,s[16:19],s13 offen sc1
tab_tdone:
QAH vmcnt(0)
s_barrier
QBO s13,s60,15
QAS s13,s13,8
QAF s13,s13,61423616
QAQ v2,1
QBJ s9,0
s_cbranch_scc1 lay_a2
QBY exec,1
buffer_atomic_add v2,off,s[16:19],s13
QBY exec,-1
lay_a2:
lay_notab:
QBN s60,192
s_cbranch_scc1 lay_noq
s_sub_u32 s67,s60,192
QAT s66,14
QAT s68,2
s_branch lay_kvf
lay_qret:
QAF s66,s66,1
QBS s66,15
s_cbranch_scc1 lay_kvf
s_branch lay_srv
lay_noq:
QCB s68,s60,6
s_min_u32 s68,s68,2
QAS s13,s68,6
s_sub_u32 s13,s60,s13
QAF s14,s68,3
QCB s66,s13,s14
QAS s15,s66,s14
s_sub_u32 s67,s13,s15
QBS s68,0
QBL s13,0,4
QAS s14,s68,2
QAF s13,s13,s14
QAF s66,s66,s13
lay_att:
QCB s69,4,s68
s_mul_i32 s70,s67,s69
QAS s71,1,s69
s_sub_u32 s71,s71,1
QAS s72,s70,8
QAF s72,s72,s56
QAT s20,s40
QAT s21,s41
QAT s22,4194304
QAT s23,0x20000
QAT s24,s46
QAT s25,s47
QAT s26,4194304
QAT s27,0x20000
QAT s15,0
lay_kw:
QAI v14,4,v1
QAS s13,s66,2
QAF s14,s13,8
QAS s13,s13,1
QBN s66,2
QBL s13,s13,s14
QBL s14,4,0
QAF s13,s13,s72
QAF s13,s13,565248
QAF s14,s14,s13
QBY exec,15
QBR v15,v14,s[16:19],s13 offen sc1
QBR v16,v14,s[16:19],s14 offen sc1
QBY exec,-1
QAH vmcnt(0)
v_min_u32 v15,v15,v16
v_cmp_le_u32 vcc,4,v15
s_nop 1
QBO s13,vcc_lo,s71
QBS s13,s71
s_cbranch_scc1 lay_kw_ok
s_sleep 8
QAF s15,s15,1
QBN s15,400000
s_cbranch_scc1 lay_kw
lay_kw_ok:
QAS s28,s66,2
QAF s28,s28,s9
QAS s13,s28,15
QAF s13,s13,0
QAD v[128:131],v1,s[16:19],s13 offen offset:0 sc1
QAD v[132:135],v1,s[16:19],s13 offen offset:1024 sc1
QAD v[136:139],v1,s[16:19],s13 offen offset:2048 sc1
QAD v[140:143],v1,s[16:19],s13 offen offset:3072 sc1
QAF s13,s13,4096
QAD v[144:147],v1,s[16:19],s13 offen offset:0 sc1
QAD v[148:151],v1,s[16:19],s13 offen offset:1024 sc1
QAD v[152:155],v1,s[16:19],s13 offen offset:2048 sc1
QAD v[156:159],v1,s[16:19],s13 offen offset:3072 sc1
QAF s13,s13,4096
QAD v[160:163],v1,s[16:19],s13 offen offset:0 sc1
QAD v[164:167],v1,s[16:19],s13 offen offset:1024 sc1
QAD v[168:171],v1,s[16:19],s13 offen offset:2048 sc1
QAD v[172:175],v1,s[16:19],s13 offen offset:3072 sc1
QAF s13,s13,4096
QAD v[176:179],v1,s[16:19],s13 offen offset:0 sc1
QAD v[180:183],v1,s[16:19],s13 offen offset:1024 sc1
QAD v[184:187],v1,s[16:19],s13 offen offset:2048 sc1
QAD v[188:191],v1,s[16:19],s13 offen offset:3072 sc1
QAF s13,s13,4096
QAD v[192:195],v1,s[16:19],s13 offen offset:0 sc1
QAD v[196:199],v1,s[16:19],s13 offen offset:1024 sc1
QAD v[200:203],v1,s[16:19],s13 offen offset:2048 sc1
QAD v[204:207],v1,s[16:19],s13 offen offset:3072 sc1
QAF s13,s13,4096
QAD v[208:211],v1,s[16:19],s13 offen offset:0 sc1
QAD v[212:215],v1,s[16:19],s13 offen offset:1024 sc1
QAD v[216:219],v1,s[16:19],s13 offen offset:2048 sc1
QAD v[220:223],v1,s[16:19],s13 offen offset:3072 sc1
QAF s13,s13,4096
QAD v[224:227],v1,s[16:19],s13 offen offset:0 sc1
QAD v[228:231],v1,s[16:19],s13 offen offset:1024 sc1
QAD v[232:235],v1,s[16:19],s13 offen offset:2048 sc1
QAD v[236:239],v1,s[16:19],s13 offen offset:3072 sc1
QAF s13,s13,4096
QAD v[240:243],v1,s[16:19],s13 offen offset:0 sc1
QAD v[244:247],v1,s[16:19],s13 offen offset:1024 sc1
QAD v[248:251],v1,s[16:19],s13 offen offset:2048 sc1
QAD v[252:255],v1,s[16:19],s13 offen offset:3072 sc1
QBW v14,4,v0
QAM v15,15,v0
QAI v16,2,v14
QBH v15,v15,v16
QAI v15,4,v15
QBC v2,v14,13,v15
QCC v14,v0,2,2
QBW v15,5,v0
QBC v16,v15,3,v14
QAI v16,8,v16
QCC v17,v0,4,1
QBC v16,v17,5,v16
QAM v18,3,v0
QBC v16,v18,3,v16
QBC v19,v15,2,v14
QAI v19,10,v19
QBC v19,v17,5,v19
QAM v18,1,v0
QBC v19,v18,4,v19
QCC v18,v0,1,1
QBC v19,v18,3,v19
QBH v18,0,v14
QBC v3,v18,6,v16
QBC v7,v18,6,v19
QBH v18,1,v14
QBC v4,v18,6,v16
QBC v8,v18,6,v19
QBH v18,2,v14
QBC v5,v18,6,v16
QBC v9,v18,6,v19
QBH v18,3,v14
QBC v6,v18,6,v16
QBC v10,v18,6,v19
s_mul_i32 s29,s9,20480
QAF s29,s29,65536
QBF v13,s29,v1
QCC v16,v0,1,2
QAI v16,2,v16
QAM v17,1,v0
QBF v16,v16,v17
QBC v16,v15,4,v16
QAI v16,4,v16
QAF s13,s29,16384
QBF v11,s13,v16
QAM v16,15,v0
v_or_b32 v16,2,v16
QBC v16,v15,5,v16
QAI v16,4,v16
QCC v17,v0,1,1
QBH v17,1,v17
QBC v16,v17,3,v16
QCC v17,v0,4,1
QBC v16,v17,2,v16
QBF v12,s13,v16
QAM v16,31,v0
QAI v15,2,v15
v_sub_u32 v0,v16,v15
QAS s30,s9,12
QAS s31,s70,8
QAS s13,s9,17
QAF s31,s31,s13
QAS s32,s70,17
QAF s32,s32,s30
QAS s33,s70,6
QAF s33,s33,s28
QAS s34,s33,12
QAF s34,s34,37748736
QAS s33,s33,13
QAF s33,s33,4194304
QAT s39,0x7ff00000
QAT s35,0x3e0293ee
QAF m0,s30,0
QAF s13,s31,0
QAD v2,s[20:23],s13 offen lds
QAF m0,s30,1024
QAF s13,s31,32768
QAD v2,s[20:23],s13 offen lds
QAF m0,s30,2048
QAF s13,s31,65536
QAD v2,s[20:23],s13 offen lds
QAF m0,s30,3072
QAF s13,s31,98304
QAD v2,s[20:23],s13 offen lds
QAF m0,s29,0
QAF s13,s33,0
QAD v1,s[16:19],s13 offen sc1 lds
QAF m0,s29,1024
QAF s13,s33,1024
QAD v1,s[16:19],s13 offen sc1 lds
QAF m0,s29,2048
QAF s13,s33,2048
QAD v1,s[16:19],s13 offen sc1 lds
QAF m0,s29,3072
QAF s13,s33,3072
QAD v1,s[16:19],s13 offen sc1 lds
QAF m0,s29,4096
QAF s13,s33,4096
QAD v1,s[16:19],s13 offen sc1 lds
QAF m0,s29,5120
QAF s13,s33,5120
QAD v1,s[16:19],s13 offen sc1 lds
QAF m0,s29,6144
QAF s13,s33,6144
QAD v1,s[16:19],s13 offen sc1 lds
QAF m0,s29,7168
QAF s13,s33,7168
QAD v1,s[16:19],s13 offen sc1 lds
QAF m0,s29,8192
QAF s13,s33,16777216
QAD v1,s[16:19],s13 offen sc1 lds
QAF m0,s29,9216
QAF s13,s33,16778240
QAD v1,s[16:19],s13 offen sc1 lds
QAF m0,s29,10240
QAF s13,s33,16779264
QAD v1,s[16:19],s13 offen sc1 lds
QAF m0,s29,11264
QAF s13,s33,16780288
QAD v1,s[16:19],s13 offen sc1 lds
QAF m0,s29,12288
QAF s13,s33,16781312
QAD v1,s[16:19],s13 offen sc1 lds
QAF m0,s29,13312
QAF s13,s33,16782336
QAD v1,s[16:19],s13 offen sc1 lds
QAF m0,s29,14336
QAF s13,s33,16783360
QAD v1,s[16:19],s13 offen sc1 lds
QAF m0,s29,15360
QAF s13,s33,16784384
QAD v1,s[16:19],s13 offen sc1 lds
QAF m0,s30,16384
QAF s13,s31,524288
QAD v2,s[20:23],s13 offen lds
QAF m0,s30,17408
QAF s13,s31,557056
QAD v2,s[20:23],s13 offen lds
QAF m0,s30,18432
QAF s13,s31,589824
QAD v2,s[20:23],s13 offen lds
QAF m0,s30,19456
QAF s13,s31,622592
QAD v2,s[20:23],s13 offen lds
QAF m0,s30,32768
QAF s13,s31,1048576
QAD v2,s[20:23],s13 offen lds
QAF m0,s30,33792
QAF s13,s31,1081344
QAD v2,s[20:23],s13 offen lds
QAF m0,s30,34816
QAF s13,s31,1114112
QAD v2,s[20:23],s13 offen lds
QAF m0,s30,35840
QAF s13,s31,1146880
QAD v2,s[20:23],s13 offen lds
QAH vmcnt(24)
s_barrier
QAA v[32:33],v3 offset:0
QAA v[34:35],v3 offset:1024
QAA v[36:37],v4 offset:0
QAA v[38:39],v4 offset:1024
QAA v[40:41],v5 offset:0
QAA v[42:43],v5 offset:1024
QAA v[44:45],v6 offset:0
QAA v[46:47],v6 offset:1024
QAT s36,0
lat_hl:
QAF s13,s36,1
QBN s13,s69
QBL s38,256,s39
QAF s38,s38,s31
QAH lgkmcnt(0)
QAB v[64:79],v[32:35],v[128:131],0
QAA v[48:49],v3 offset:4096
QAA v[50:51],v3 offset:5120
QAA v[52:53],v4 offset:4096
QAB v[80:95],v[36:39],v[128:131],0
QAA v[54:55],v4 offset:5120
QAA v[56:57],v5 offset:4096
QAA v[58:59],v5 offset:5120
QAB v[96:111],v[40:43],v[128:131],0
QAA v[60:61],v6 offset:4096
QAA v[62:63],v6 offset:5120
QAF m0,s30,49152
QAF s13,s31,1572864
QAD v2,s[20:23],s13 offen lds
QAB v[112:127],v[44:47],v[128:131],0
QAF m0,s30,50176
QAF s13,s31,1605632
QAD v2,s[20:23],s13 offen lds
QAH lgkmcnt(0)
QAB v[64:79],v[48:51],v[132:135],v[64:79]
QAA v[32:33],v3 offset:8192
QAA v[34:35],v3 offset:9216
QAA v[36:37],v4 offset:8192
QAB v[80:95],v[52:55],v[132:135],v[80:95]
QAA v[38:39],v4 offset:9216
QAA v[40:41],v5 offset:8192
QAA v[42:43],v5 offset:9216
QAB v[96:111],v[56:59],v[132:135],v[96:111]
QAA v[44:45],v6 offset:8192
QAA v[46:47],v6 offset:9216
QAF m0,s30,51200
QAF s13,s31,1638400
QAD v2,s[20:23],s13 offen lds
QAB v[112:127],v[60:63],v[132:135],v[112:127]
QAF m0,s30,52224
QAF s13,s31,1671168
QAD v2,s[20:23],s13 offen lds
QAH lgkmcnt(0)
QAB v[64:79],v[32:35],v[136:139],v[64:79]
QAA v[48:49],v3 offset:12288
QAA v[50:51],v3 offset:13312
QAA v[52:53],v4 offset:12288
QAB v[80:95],v[36:39],v[136:139],v[80:95]
QAA v[54:55],v4 offset:13312
QAA v[56:57],v5 offset:12288
QAA v[58:59],v5 offset:13312
QAB v[96:111],v[40:43],v[136:139],v[96:111]
QAA v[60:61],v6 offset:12288
QAA v[62:63],v6 offset:13312
QAB v[112:127],v[44:47],v[136:139],v[112:127]
QAH lgkmcnt(0)
QAH vmcnt(8)
s_barrier
QAB v[64:79],v[48:51],v[140:143],v[64:79]
QAA v[32:33],v3 offset:16384
QAA v[34:35],v3 offset:17408
QAA v[36:37],v4 offset:16384
QAB v[80:95],v[52:55],v[140:143],v[80:95]
QAA v[38:39],v4 offset:17408
QAA v[40:41],v5 offset:16384
QAA v[42:43],v5 offset:17408
QAB v[96:111],v[56:59],v[140:143],v[96:111]
QAA v[44:45],v6 offset:16384
QAA v[46:47],v6 offset:17408
QAB v[112:127],v[60:63],v[140:143],v[112:127]
QAH lgkmcnt(0)
QAB v[64:79],v[32:35],v[144:147],v[64:79]
QAA v[48:49],v3 offset:20480
QAA v[50:51],v3 offset:21504
QAA v[52:53],v4 offset:20480
QAB v[80:95],v[36:39],v[144:147],v[80:95]
QAA v[54:55],v4 offset:21504
QAA v[56:57],v5 offset:20480
QAA v[58:59],v5 offset:21504
QAB v[96:111],v[40:43],v[144:147],v[96:111]
QAA v[60:61],v6 offset:20480
QAA v[62:63],v6 offset:21504
QAF m0,s30,0
QAF s13,s31,2097152
QAD v2,s[20:23],s13 offen lds
QAB v[112:127],v[44:47],v[144:147],v[112:127]
QAF m0,s30,1024
QAF s13,s31,2129920
QAD v2,s[20:23],s13 offen lds
QAH lgkmcnt(0)
QAB v[64:79],v[48:51],v[148:151],v[64:79]
QAA v[32:33],v3 offset:24576
QAA v[34:35],v3 offset:25600
QAA v[36:37],v4 offset:24576
QAB v[80:95],v[52:55],v[148:151],v[80:95]
QAA v[38:39],v4 offset:25600
QAA v[40:41],v5 offset:24576
QAA v[42:43],v5 offset:25600
QAB v[96:111],v[56:59],v[148:151],v[96:111]
QAA v[44:45],v6 offset:24576
QAA v[46:47],v6 offset:25600
QAF m0,s30,2048
QAF s13,s31,2162688
QAD v2,s[20:23],s13 offen lds
QAB v[112:127],v[60:63],v[148:151],v[112:127]
QAF m0,s30,3072
QAF s13,s31,2195456
QAD v2,s[20:23],s13 offen lds
QAH lgkmcnt(0)
QAB v[64:79],v[32:35],v[152:155],v[64:79]
QAA v[48:49],v3 offset:28672
QAA v[50:51],v3 offset:29696
QAA v[52:53],v4 offset:28672
QAB v[80:95],v[36:39],v[152:155],v[80:95]
QAA v[54:55],v4 offset:29696
QAA v[56:57],v5 offset:28672
QAA v[58:59],v5 offset:29696
QAB v[96:111],v[40:43],v[152:155],v[96:111]
QAA v[60:61],v6 offset:28672
QAA v[62:63],v6 offset:29696
QAB v[112:127],v[44:47],v[152:155],v[112:127]
QAH lgkmcnt(0)
QAH vmcnt(8)
s_barrier
QAB v[64:79],v[48:51],v[156:159],v[64:79]
QAA v[32:33],v3 offset:32768
QAA v[34:35],v3 offset:33792
QAA v[36:37],v4 offset:32768
QAB v[80:95],v[52:55],v[156:159],v[80:95]
QAA v[38:39],v4 offset:33792
QAA v[40:41],v5 offset:32768
QAA v[42:43],v5 offset:33792
QAB v[96:111],v[56:59],v[156:159],v[96:111]
QAA v[44:45],v6 offset:32768
QAA v[46:47],v6 offset:33792
QAB v[112:127],v[60:63],v[156:159],v[112:127]
QAH lgkmcnt(0)
QAB v[64:79],v[32:35],v[160:163],v[64:79]
QAA v[48:49],v3 offset:36864
QAA v[50:51],v3 offset:37888
QAA v[52:53],v4 offset:36864
QAB v[80:95],v[36:39],v[160:163],v[80:95]
QAA v[54:55],v4 offset:37888
QAA v[56:57],v5 offset:36864
QAA v[58:59],v5 offset:37888
QAB v[96:111],v[40:43],v[160:163],v[96:111]
QAA v[60:61],v6 offset:36864
QAA v[62:63],v6 offset:37888
QAF m0,s30,16384
QAF s13,s31,2621440
QAD v2,s[20:23],s13 offen lds
QAB v[112:127],v[44:47],v[160:163],v[112:127]
QAF m0,s30,17408
QAF s13,s31,2654208
QAD v2,s[20:23],s13 offen lds
QAH lgkmcnt(0)
QAB v[64:79],v[48:51],v[164:167],v[64:79]
QAA v[32:33],v3 offset:40960
QAA v[34:35],v3 offset:41984
QAA v[36:37],v4 offset:40960
QAB v[80:95],v[52:55],v[164:167],v[80:95]
QAA v[38:39],v4 offset:41984
QAA v[40:41],v5 offset:40960
QAA v[42:43],v5 offset:41984
QAB v[96:111],v[56:59],v[164:167],v[96:111]
QAA v[44:45],v6 offset:40960
QAA v[46:47],v6 offset:41984
QAF m0,s30,18432
QAF s13,s31,2686976
QAD v2,s[20:23],s13 offen lds
QAB v[112:127],v[60:63],v[164:167],v[112:127]
QAF m0,s30,19456
QAF s13,s31,2719744
QAD v2,s[20:23],s13 offen lds
QAH lgkmcnt(0)
QAB v[64:79],v[32:35],v[168:171],v[64:79]
QAA v[48:49],v3 offset:45056
QAA v[50:51],v3 offset:46080
QAA v[52:53],v4 offset:45056
QAB v[80:95],v[36:39],v[168:171],v[80:95]
QAA v[54:55],v4 offset:46080
QAA v[56:57],v5 offset:45056
QAA v[58:59],v5 offset:46080
QAB v[96:111],v[40:43],v[168:171],v[96:111]
QAA v[60:61],v6 offset:45056
QAA v[62:63],v6 offset:46080
QAB v[112:127],v[44:47],v[168:171],v[112:127]
QAH lgkmcnt(0)
QAH vmcnt(8)
s_barrier
QAB v[64:79],v[48:51],v[172:175],v[64:79]
QAA v[32:33],v3 offset:49152
QAA v[34:35],v3 offset:50176
QAA v[36:37],v4 offset:49152
QAB v[80:95],v[52:55],v[172:175],v[80:95]
QAA v[38:39],v4 offset:50176
QAA v[40:41],v5 offset:49152
QAA v[42:43],v5 offset:50176
QAB v[96:111],v[56:59],v[172:175],v[96:111]
QAA v[44:45],v6 offset:49152
QAA v[46:47],v6 offset:50176
QAB v[112:127],v[60:63],v[172:175],v[112:127]
QAH lgkmcnt(0)
QAB v[64:79],v[32:35],v[176:179],v[64:79]
QAA v[48:49],v3 offset:53248
QAA v[50:51],v3 offset:54272
QAA v[52:53],v4 offset:53248
QAB v[80:95],v[36:39],v[176:179],v[80:95]
QAA v[54:55],v4 offset:54272
QAA v[56:57],v5 offset:53248
QAA v[58:59],v5 offset:54272
QAB v[96:111],v[40:43],v[176:179],v[96:111]
QAA v[60:61],v6 offset:53248
QAA v[62:63],v6 offset:54272
QAF m0,s30,32768
QAF s13,s31,3145728
QAD v2,s[20:23],s13 offen lds
QAB v[112:127],v[44:47],v[176:179],v[112:127]
QAF m0,s30,33792
QAF s13,s31,3178496
QAD v2,s[20:23],s13 offen lds
QAH lgkmcnt(0)
QAB v[64:79],v[48:51],v[180:183],v[64:79]
QAA v[32:33],v3 offset:57344
QAA v[34:35],v3 offset:58368
QAA v[36:37],v4 offset:57344
QAB v[80:95],v[52:55],v[180:183],v[80:95]
QAA v[38:39],v4 offset:58368
QAA v[40:41],v5 offset:57344
QAA v[42:43],v5 offset:58368
QAB v[96:111],v[56:59],v[180:183],v[96:111]
QAA v[44:45],v6 offset:57344
QAA v[46:47],v6 offset:58368
QAF m0,s30,34816
QAF s13,s31,3211264
QAD v2,s[20:23],s13 offen lds
QAB v[112:127],v[60:63],v[180:183],v[112:127]
QAF m0,s30,35840
QAF s13,s31,3244032
QAD v2,s[20:23],s13 offen lds
QAH lgkmcnt(0)
QAB v[64:79],v[32:35],v[184:187],v[64:79]
QAA v[48:49],v3 offset:61440
QAA v[50:51],v3 offset:62464
QAA v[52:53],v4 offset:61440
QAB v[80:95],v[36:39],v[184:187],v[80:95]
QAA v[54:55],v4 offset:62464
QAA v[56:57],v5 offset:61440
QAA v[58:59],v5 offset:62464
QAB v[96:111],v[40:43],v[184:187],v[96:111]
QAA v[60:61],v6 offset:61440
QAA v[62:63],v6 offset:62464
QAB v[112:127],v[44:47],v[184:187],v[112:127]
QAH lgkmcnt(0)
QAH vmcnt(8)
s_barrier
QAB v[64:79],v[48:51],v[188:191],v[64:79]
QAA v[32:33],v3 offset:0
QAA v[34:35],v3 offset:1024
QAA v[36:37],v4 offset:0
QAB v[80:95],v[52:55],v[188:191],v[80:95]
QAA v[38:39],v4 offset:1024
QAA v[40:41],v5 offset:0
QAA v[42:43],v5 offset:1024
QAB v[96:111],v[56:59],v[188:191],v[96:111]
QAA v[44:45],v6 offset:0
QAA v[46:47],v6 offset:1024
QAB v[112:127],v[60:63],v[188:191],v[112:127]
QAH lgkmcnt(0)
QAB v[64:79],v[32:35],v[192:195],v[64:79]
QAA v[48:49],v3 offset:4096
QAA v[50:51],v3 offset:5120
QAA v[52:53],v4 offset:4096
QAB v[80:95],v[36:39],v[192:195],v[80:95]
QAA v[54:55],v4 offset:5120
QAA v[56:57],v5 offset:4096
QAA v[58:59],v5 offset:5120
QAB v[96:111],v[40:43],v[192:195],v[96:111]
QAA v[60:61],v6 offset:4096
QAA v[62:63],v6 offset:5120
QAF m0,s30,49152
QAF s13,s31,3670016
QAD v2,s[20:23],s13 offen lds
QAB v[112:127],v[44:47],v[192:195],v[112:127]
QAF m0,s30,50176
QAF s13,s31,3702784
QAD v2,s[20:23],s13 offen lds
QAH lgkmcnt(0)
QAB v[64:79],v[48:51],v[196:199],v[64:79]
QAA v[32:33],v3 offset:8192
QAA v[34:35],v3 offset:9216
QAA v[36:37],v4 offset:8192
QAB v[80:95],v[52:55],v[196:199],v[80:95]
QAA v[38:39],v4 offset:9216
QAA v[40:41],v5 offset:8192
QAA v[42:43],v5 offset:9216
QAB v[96:111],v[56:59],v[196:199],v[96:111]
QAA v[44:45],v6 offset:8192
QAA v[46:47],v6 offset:9216
QAF m0,s30,51200
QAF s13,s31,3735552
QAD v2,s[20:23],s13 offen lds
QAB v[112:127],v[60:63],v[196:199],v[112:127]
QAF m0,s30,52224
QAF s13,s31,3768320
QAD v2,s[20:23],s13 offen lds
QAH lgkmcnt(0)
QAB v[64:79],v[32:35],v[200:203],v[64:79]
QAA v[48:49],v3 offset:12288
QAA v[50:51],v3 offset:13312
QAA v[52:53],v4 offset:12288
QAB v[80:95],v[36:39],v[200:203],v[80:95]
QAA v[54:55],v4 offset:13312
QAA v[56:57],v5 offset:12288
QAA v[58:59],v5 offset:13312
QAB v[96:111],v[40:43],v[200:203],v[96:111]
QAA v[60:61],v6 offset:12288
QAA v[62:63],v6 offset:13312
QAB v[112:127],v[44:47],v[200:203],v[112:127]
QAH lgkmcnt(0)
QAH vmcnt(8)
s_barrier
QAB v[64:79],v[48:51],v[204:207],v[64:79]
QAA v[32:33],v3 offset:16384
QAA v[34:35],v3 offset:17408
QAA v[36:37],v4 offset:16384
QAB v[80:95],v[52:55],v[204:207],v[80:95]
QAA v[38:39],v4 offset:17408
QAA v[40:41],v5 offset:16384
QAA v[42:43],v5 offset:17408
QAB v[96:111],v[56:59],v[204:207],v[96:111]
QAA v[44:45],v6 offset:16384
QAA v[46:47],v6 offset:17408
QAB v[112:127],v[60:63],v[204:207],v[112:127]
QAH lgkmcnt(0)
QAB v[64:79],v[32:35],v[208:211],v[64:79]
QAA v[48:49],v3 offset:20480
QAA v[50:51],v3 offset:21504
QAA v[52:53],v4 offset:20480
QAB v[80:95],v[36:39],v[208:211],v[80:95]
QAA v[54:55],v4 offset:21504
QAA v[56:57],v5 offset:20480
QAA v[58:59],v5 offset:21504
QAB v[96:111],v[40:43],v[208:211],v[96:111]
QAA v[60:61],v6 offset:20480
QAA v[62:63],v6 offset:21504
QAF m0,s30,0
QAF s13,s32,0
QBH v14,0,v1
QAD v14,s[24:27],s13 offen lds
QAB v[112:127],v[44:47],v[208:211],v[112:127]
QAF m0,s30,1024
QAF s13,s32,1024
QBH v14,64,v1
QAD v14,s[24:27],s13 offen lds
QAH lgkmcnt(0)
QAB v[64:79],v[48:51],v[212:215],v[64:79]
QAA v[32:33],v3 offset:24576
QAA v[34:35],v3 offset:25600
QAA v[36:37],v4 offset:24576
QAB v[80:95],v[52:55],v[212:215],v[80:95]
QAA v[38:39],v4 offset:25600
QAA v[40:41],v5 offset:24576
QAA v[42:43],v5 offset:25600
QAB v[96:111],v[56:59],v[212:215],v[96:111]
QAA v[44:45],v6 offset:24576
QAA v[46:47],v6 offset:25600
QAF m0,s30,2048
QAF s13,s32,2048
QBH v14,128,v1
QAD v14,s[24:27],s13 offen lds
QAB v[112:127],v[60:63],v[212:215],v[112:127]
QAF m0,s30,3072
QAF s13,s32,3072
QBH v14,192,v1
QAD v14,s[24:27],s13 offen lds
QAH lgkmcnt(0)
QAB v[64:79],v[32:35],v[216:219],v[64:79]
QAA v[48:49],v3 offset:28672
QAA v[50:51],v3 offset:29696
QAA v[52:53],v4 offset:28672
QAB v[80:95],v[36:39],v[216:219],v[80:95]
QAA v[54:55],v4 offset:29696
QAA v[56:57],v5 offset:28672
QAA v[58:59],v5 offset:29696
QAB v[96:111],v[40:43],v[216:219],v[96:111]
QAA v[60:61],v6 offset:28672
QAA v[62:63],v6 offset:29696
QAB v[112:127],v[44:47],v[216:219],v[112:127]
QAH lgkmcnt(0)
QAH vmcnt(8)
s_barrier
QAB v[64:79],v[48:51],v[220:223],v[64:79]
QAA v[32:33],v3 offset:32768
QAA v[34:35],v3 offset:33792
QAA v[36:37],v4 offset:32768
QAB v[80:95],v[52:55],v[220:223],v[80:95]
QAA v[38:39],v4 offset:33792
QAA v[40:41],v5 offset:32768
QAA v[42:43],v5 offset:33792
QAB v[96:111],v[56:59],v[220:223],v[96:111]
QAA v[44:45],v6 offset:32768
QAA v[46:47],v6 offset:33792
QAB v[112:127],v[60:63],v[220:223],v[112:127]
QAH lgkmcnt(0)
QAB v[64:79],v[32:35],v[224:227],v[64:79]
QAA v[48:49],v3 offset:36864
QAA v[50:51],v3 offset:37888
QAA v[52:53],v4 offset:36864
QAB v[80:95],v[36:39],v[224:227],v[80:95]
QAA v[54:55],v4 offset:37888
QAA v[56:57],v5 offset:36864
QAA v[58:59],v5 offset:37888
QAB v[96:111],v[40:43],v[224:227],v[96:111]
QAA v[60:61],v6 offset:36864
QAA v[62:63],v6 offset:37888
QAF m0,s30,16384
QAF s13,s32,16384
QBH v14,0,v1
QAD v14,s[24:27],s13 offen lds
QAB v[112:127],v[44:47],v[224:227],v[112:127]
QAF m0,s30,17408
QAF s13,s32,17408
QBH v14,64,v1
QAD v14,s[24:27],s13 offen lds
QAH lgkmcnt(0)
QAB v[64:79],v[48:51],v[228:231],v[64:79]
QAA v[32:33],v3 offset:40960
QAA v[34:35],v3 offset:41984
QAA v[36:37],v4 offset:40960
QAB v[80:95],v[52:55],v[228:231],v[80:95]
QAA v[38:39],v4 offset:41984
QAA v[40:41],v5 offset:40960
QAA v[42:43],v5 offset:41984
QAB v[96:111],v[56:59],v[228:231],v[96:111]
QAA v[44:45],v6 offset:40960
QAA v[46:47],v6 offset:41984
QAF m0,s30,18432
QAF s13,s32,18432
QBH v14,128,v1
QAD v14,s[24:27],s13 offen lds
QAB v[112:127],v[60:63],v[228:231],v[112:127]
QAF m0,s30,19456
QAF s13,s32,19456
QBH v14,192,v1
QAD v14,s[24:27],s13 offen lds
QAH lgkmcnt(0)
QAB v[64:79],v[32:35],v[232:235],v[64:79]
QAA v[48:49],v3 offset:45056
QAA v[50:51],v3 offset:46080
QAA v[52:53],v4 offset:45056
QAB v[80:95],v[36:39],v[232:235],v[80:95]
QAA v[54:55],v4 offset:46080
QAA v[56:57],v5 offset:45056
QAA v[58:59],v5 offset:46080
QAB v[96:111],v[40:43],v[232:235],v[96:111]
QAA v[60:61],v6 offset:45056
QAA v[62:63],v6 offset:46080
QAB v[112:127],v[44:47],v[232:235],v[112:127]
QAH lgkmcnt(0)
QAH vmcnt(8)
s_barrier
QAB v[64:79],v[48:51],v[236:239],v[64:79]
QAA v[32:33],v3 offset:49152
QAA v[34:35],v3 offset:50176
QAA v[36:37],v4 offset:49152
QAB v[80:95],v[52:55],v[236:239],v[80:95]
QAA v[38:39],v4 offset:50176
QAA v[40:41],v5 offset:49152
QAA v[42:43],v5 offset:50176
QAB v[96:111],v[56:59],v[236:239],v[96:111]
QAA v[44:45],v6 offset:49152
QAA v[46:47],v6 offset:50176
QAB v[112:127],v[60:63],v[236:239],v[112:127]
QAH lgkmcnt(0)
QAB v[64:79],v[32:35],v[240:243],v[64:79]
QAA v[48:49],v3 offset:53248
QAA v[50:51],v3 offset:54272
QAA v[52:53],v4 offset:53248
QAB v[80:95],v[36:39],v[240:243],v[80:95]
QAA v[54:55],v4 offset:54272
QAA v[56:57],v5 offset:53248
QAA v[58:59],v5 offset:54272
QAB v[96:111],v[40:43],v[240:243],v[96:111]
QAA v[60:61],v6 offset:53248
QAA v[62:63],v6 offset:54272
QAF m0,s30,32768
QAF s13,s32,32768
QBH v14,0,v1
QAD v14,s[24:27],s13 offen lds
QAB v[112:127],v[44:47],v[240:243],v[112:127]
QAF m0,s30,33792
QAF s13,s32,33792
QBH v14,64,v1
QAD v14,s[24:27],s13 offen lds
QAH lgkmcnt(0)
QAB v[64:79],v[48:51],v[244:247],v[64:79]
QAA v[32:33],v3 offset:57344
QAA v[34:35],v3 offset:58368
QAA v[36:37],v4 offset:57344
QAB v[80:95],v[52:55],v[244:247],v[80:95]
QAA v[38:39],v4 offset:58368
QAA v[40:41],v5 offset:57344
QAA v[42:43],v5 offset:58368
QAB v[96:111],v[56:59],v[244:247],v[96:111]
QAA v[44:45],v6 offset:57344
QAA v[46:47],v6 offset:58368
QAF m0,s30,34816
QAF s13,s32,34816
QBH v14,128,v1
QAD v14,s[24:27],s13 offen lds
QAB v[112:127],v[60:63],v[244:247],v[112:127]
QAF m0,s30,35840
QAF s13,s32,35840
QBH v14,192,v1
QAD v14,s[24:27],s13 offen lds
QAH lgkmcnt(0)
QAB v[64:79],v[32:35],v[248:251],v[64:79]
QAA v[48:49],v3 offset:61440
QAA v[50:51],v3 offset:62464
QAA v[52:53],v4 offset:61440
QAB v[80:95],v[36:39],v[248:251],v[80:95]
QAA v[54:55],v4 offset:62464
QAA v[56:57],v5 offset:61440
QAA v[58:59],v5 offset:62464
QAB v[96:111],v[40:43],v[248:251],v[96:111]
QAA v[60:61],v6 offset:61440
QAA v[62:63],v6 offset:62464
QAB v[112:127],v[44:47],v[248:251],v[112:127]
QAH lgkmcnt(0)
QAH vmcnt(8)
s_barrier
QAB v[64:79],v[48:51],v[252:255],v[64:79]
QAB v[80:95],v[52:55],v[252:255],v[80:95]
QAB v[96:111],v[56:59],v[252:255],v[96:111]
QAB v[112:127],v[60:63],v[252:255],v[112:127]
QBJ s36,0
s_cbranch_scc1 lat_nw
QBJ s9,0
s_cbranch_scc1 lay_pc1_ok
QAT s15,0
lay_pc1:
QAF s13,s56,557056
QBR v15,off,s[16:19],s13 sc1
QAH vmcnt(0)
QCA s13,v15
QAS s14,s66,2
QAF s14,s14,2
s_cmp_ge_i32 s13,s14
s_cbranch_scc1 lay_pc1_ok
s_sleep 40
QAF s15,s15,1
QBN s15,400000
s_cbranch_scc1 lay_pc1
lay_pc1_ok:
QBJ s9,0
s_cbranch_scc1 lay_pw_ok
QAT s15,0
lay_pw:
QAI v14,4,v1
QAF s13,s72,557056
QBY exec,15
QBR v15,v14,s[16:19],s13 offen sc1
QBY exec,-1
QAH vmcnt(0)
QAS s14,s66,2
QAF s14,s14,4
v_cmp_le_u32 vcc,s14,v15
s_nop 1
QBO s13,vcc_lo,s71
QBS s13,s71
s_cbranch_scc1 lay_pw_ok
s_sleep 6
QAF s15,s15,1
QBN s15,400000
s_cbranch_scc1 lay_pw
lay_pw_ok:
s_barrier
QAF m0,s29,16384
QAF s13,s34,0
QAD v1,s[16:19],s13 offen sc1 lds
QAF m0,s29,17408
QAF s13,s34,1024
QAD v1,s[16:19],s13 offen sc1 lds
QAF m0,s29,18432
QAF s13,s34,2048
QAD v1,s[16:19],s13 offen sc1 lds
QAF m0,s29,19456
QAF s13,s34,3072
QAD v1,s[16:19],s13 offen sc1 lds
QAH vmcnt(0)
lat_nw:
QAQ v15,0xf149f2ca
v_cmp_le_i32 vcc,0,v0
v_cmp_le_i32 s[10:11],1,v0
s_nop 0
QAX v16,v15,0,vcc
QAX v17,v15,0,s[10:11]
v_cmp_le_i32 vcc,2,v0
v_cmp_le_i32 s[10:11],3,v0
s_nop 0
QAX v18,v15,0,vcc
QAX v19,v15,0,s[10:11]
v_cmp_le_i32 vcc,8,v0
v_cmp_le_i32 s[10:11],9,v0
s_nop 0
QAX v20,v15,0,vcc
QAX v21,v15,0,s[10:11]
v_cmp_le_i32 vcc,10,v0
v_cmp_le_i32 s[10:11],11,v0
s_nop 0
QAX v22,v15,0,vcc
QAX v23,v15,0,s[10:11]
v_cmp_le_i32 vcc,16,v0
v_cmp_le_i32 s[10:11],17,v0
s_nop 0
QAX v24,v15,0,vcc
QAX v25,v15,0,s[10:11]
v_cmp_le_i32 vcc,18,v0
v_cmp_le_i32 s[10:11],19,v0
s_nop 0
QAX v26,v15,0,vcc
QAX v27,v15,0,s[10:11]
v_cmp_le_i32 vcc,24,v0
v_cmp_le_i32 s[10:11],25,v0
s_nop 0
QAX v28,v15,0,vcc
QAX v29,v15,0,s[10:11]
v_cmp_le_i32 vcc,26,v0
v_cmp_le_i32 s[10:11],27,v0
s_nop 0
QAX v30,v15,0,vcc
QAX v31,v15,0,s[10:11]
QAH vmcnt(63)
QAG v[32:35],v13 offset:0
QAG v[36:39],v13 offset:1024
QAG v[40:43],v13 offset:2048
QAG v[44:47],v13 offset:3072
QAG v[48:51],v13 offset:4096
QAG v[52:55],v13 offset:5120
QAG v[56:59],v13 offset:6144
QAG v[60:63],v13 offset:7168
QAE v64,v64,v65
QAE v65,v66,v67
QAE v66,v68,v69
QAE v67,v70,v71
QAE v68,v72,v73
QAE v69,v74,v75
QAE v70,v76,v77
QAE v71,v78,v79
QAE v72,v80,v81
QAE v73,v82,v83
QAE v74,v84,v85
QAE v75,v86,v87
QAE v76,v88,v89
QAE v77,v90,v91
QAE v78,v92,v93
QAE v79,v94,v95
QAE v80,v96,v97
QAE v81,v98,v99
QAE v82,v100,v101
QAE v83,v102,v103
QAE v84,v104,v105
QAE v85,v106,v107
QAE v86,v108,v109
QAE v87,v110,v111
QAE v88,v112,v113
QAE v89,v114,v115
QAE v90,v116,v117
QAE v91,v118,v119
QAE v92,v120,v121
QAE v93,v122,v123
QAE v94,v124,v125
QAE v95,v126,v127
QAH lgkmcnt(7)
QAB v[96:111],v[32:35],v[64:67],v[16:31]
QAG v[32:35],v11 offset:0
QAH lgkmcnt(7)
QAB v[96:111],v[36:39],v[68:71],v[96:111]
QAG v[36:39],v11 offset:512
QAH lgkmcnt(7)
QAB v[96:111],v[40:43],v[72:75],v[96:111]
QAG v[40:43],v11 offset:1024
QAH lgkmcnt(7)
QAB v[96:111],v[44:47],v[76:79],v[96:111]
QAG v[44:47],v11 offset:1536
QAH lgkmcnt(7)
QAB v[96:111],v[48:51],v[80:83],v[96:111]
QAG v[48:51],v11 offset:2048
QAH lgkmcnt(7)
QAB v[96:111],v[52:55],v[84:87],v[96:111]
QAG v[52:55],v11 offset:2560
QAH lgkmcnt(7)
QAB v[96:111],v[56:59],v[88:91],v[96:111]
QAG v[56:59],v11 offset:3072
QAH lgkmcnt(7)
QAB v[96:111],v[60:63],v[92:95],v[96:111]
QAG v[60:63],v11 offset:3584
QAH lgkmcnt(7)
QAB v[112:127],v[32:35],v[64:67],0
QAG v[32:35],v13 offset:8192
QAH lgkmcnt(7)
QAB v[112:127],v[36:39],v[68:71],v[112:127]
QAG v[36:39],v13 offset:9216
QAH lgkmcnt(7)
QAB v[112:127],v[40:43],v[72:75],v[112:127]
QAG v[40:43],v13 offset:10240
QAH lgkmcnt(7)
QAB v[112:127],v[44:47],v[76:79],v[112:127]
QAG v[44:47],v13 offset:11264
QAH lgkmcnt(7)
QAB v[112:127],v[48:51],v[80:83],v[112:127]
QAG v[48:51],v13 offset:12288
QAH lgkmcnt(7)
QAB v[112:127],v[52:55],v[84:87],v[112:127]
QAG v[52:55],v13 offset:13312
QAH lgkmcnt(7)
QAB v[112:127],v[56:59],v[88:91],v[112:127]
QAG v[56:59],v13 offset:14336
QAH lgkmcnt(7)
QAB v[112:127],v[60:63],v[92:95],v[112:127]
QAG v[60:63],v13 offset:15360
ds_read2_b32 v[16:17],v12 offset0:0 offset1:64
QBF v14,1024,v12
ds_read2_b32 v[18:19],v14 offset0:0 offset1:64
QBF v14,2048,v12
ds_read2_b32 v[20:21],v14 offset0:0 offset1:64
QBF v14,3072,v12
ds_read2_b32 v[22:23],v14 offset0:0 offset1:64
QAQ v24,0
QAQ v25,0
QAF s13,s36,1
QBN s13,s69
QBL s13,524288,s39
QAF s33,s33,s13
QCB s13,s13,1
QAF s34,s34,s13
QBQ v14,v96,v97,v98
QBQ v14,v14,v99,v100
QBQ v14,v14,v101,v102
QBQ v14,v14,v103,v104
QBQ v14,v14,v105,v106
QBQ v14,v14,v107,v108
QBQ v14,v14,v109,v110
QBQ v14,v14,v111,v112
QBQ v14,v14,v113,v114
v_max_f32 v14,v14,v115
QAQ v15,v14
s_nop 1
QCH v14,v15
v_max_f32 v14,v14,v15
QAW v14,s35,v14
v_fma_f32 v96,v96,s35,-v14
v_fma_f32 v97,v97,s35,-v14
v_fma_f32 v98,v98,s35,-v14
v_fma_f32 v99,v99,s35,-v14
v_fma_f32 v100,v100,s35,-v14
v_fma_f32 v101,v101,s35,-v14
v_fma_f32 v102,v102,s35,-v14
v_fma_f32 v103,v103,s35,-v14
v_fma_f32 v104,v104,s35,-v14
v_fma_f32 v105,v105,s35,-v14
v_fma_f32 v106,v106,s35,-v14
v_fma_f32 v107,v107,s35,-v14
v_fma_f32 v108,v108,s35,-v14
v_fma_f32 v109,v109,s35,-v14
v_fma_f32 v110,v110,s35,-v14
v_fma_f32 v111,v111,s35,-v14
v_fma_f32 v112,v112,s35,-v14
v_fma_f32 v113,v113,s35,-v14
v_fma_f32 v114,v114,s35,-v14
v_fma_f32 v115,v115,s35,-v14
QBA v96,v96
QBA v97,v97
QBA v98,v98
QBA v99,v99
QBA v100,v100
QBA v101,v101
QBA v102,v102
QBA v103,v103
QBA v104,v104
QBA v105,v105
QBA v106,v106
QBA v107,v107
QBA v108,v108
QBA v109,v109
QBA v110,v110
QBA v111,v111
QBA v112,v112
QBA v113,v113
QBA v114,v114
QBA v115,v115
QAU v14,v96,v97
QAU v15,v98,v99
QAU v14,v14,v100
QAU v15,v15,v101
QAU v14,v14,v102
QAU v15,v15,v103
QAU v14,v14,v104
QAU v15,v15,v105
QAU v14,v14,v106
QAU v15,v15,v107
QAU v14,v14,v108
QAU v15,v15,v109
QAU v14,v14,v110
QAU v15,v15,v111
QAU v14,v14,v112
QAU v15,v15,v113
QAU v14,v14,v114
QAU v15,v15,v115
QAU v14,v14,v15
QAQ v15,v14
s_nop 1
QCH v14,v15
QAU v14,v14,v15
v_rcp_f32 v14,v14
s_nop 0
QBI v[96:97],v[96:97],v[14:15] op_sel_hi:[1,0]
QBI v[98:99],v[98:99],v[14:15] op_sel_hi:[1,0]
QBI v[100:101],v[100:101],v[14:15] op_sel_hi:[1,0]
QBI v[102:103],v[102:103],v[14:15] op_sel_hi:[1,0]
QBI v[104:105],v[104:105],v[14:15] op_sel_hi:[1,0]
QBI v[106:107],v[106:107],v[14:15] op_sel_hi:[1,0]
QBI v[108:109],v[108:109],v[14:15] op_sel_hi:[1,0]
QBI v[110:111],v[110:111],v[14:15] op_sel_hi:[1,0]
QBI v[112:113],v[112:113],v[14:15] op_sel_hi:[1,0]
QBI v[114:115],v[114:115],v[14:15] op_sel_hi:[1,0]
QAE v116,v112,v113
QAE v117,v114,v115
QAQ v118,0
QAQ v119,0
QAE v120,v96,v97
QAE v121,v98,v99
QAE v122,v104,v105
QAE v123,v106,v107
QAE v124,v100,v101
QAE v125,v102,v103
QAE v126,v108,v109
QAE v127,v110,v111
QAH lgkmcnt(0)
QAB v[64:79],v[32:35],v[120:123],0
QAB v[64:79],v[36:39],v[124:127],v[64:79]
QAB v[64:79],v[16:19],v[116:119],v[64:79]
QAB v[80:95],v[40:43],v[120:123],0
QAB v[80:95],v[44:47],v[124:127],v[80:95]
QAB v[80:95],v[18:21],v[116:119],v[80:95]
QAB v[96:111],v[48:51],v[120:123],0
QAB v[96:111],v[52:55],v[124:127],v[96:111]
QAB v[96:111],v[20:23],v[116:119],v[96:111]
QAB v[32:47],v[56:59],v[120:123],0
QAB v[32:47],v[60:63],v[124:127],v[32:47]
QAB v[32:47],v[22:25],v[116:119],v[32:47]
QAE v64,v64,v65
QAE v65,v66,v67
QAE v66,v68,v69
QAE v67,v70,v71
QAE v68,v72,v73
QAE v69,v74,v75
QAE v70,v76,v77
QAE v71,v78,v79
QAE v72,v80,v81
QAE v73,v82,v83
QAE v74,v84,v85
QAE v75,v86,v87
QAE v76,v88,v89
QAE v77,v90,v91
QAE v78,v92,v93
QAE v79,v94,v95
QAE v80,v96,v97
QAE v81,v98,v99
QAE v82,v100,v101
QAE v83,v102,v103
QAE v84,v104,v105
QAE v85,v106,v107
QAE v86,v108,v109
QAE v87,v110,v111
QAE v88,v32,v33
QAE v89,v34,v35
QAE v90,v36,v37
QAE v91,v38,v39
QAE v92,v40,v41
QAE v93,v42,v43
QAE v94,v44,v45
QAE v95,v46,v47
QAA v[32:33],v7 offset:0
QAA v[34:35],v7 offset:8192
QAA v[36:37],v8 offset:0
QAA v[38:39],v8 offset:8192
QAA v[40:41],v9 offset:0
QAA v[42:43],v9 offset:8192
QAA v[44:45],v10 offset:0
QAA v[46:47],v10 offset:8192
QBJ s36,0
s_cbranch_scc1 lat_w1
QAH lgkmcnt(0)
QAB a[0:15],v[32:35],v[64:67],0
QAA v[48:49],v7 offset:256
QAA v[50:51],v7 offset:8448
QAA v[52:53],v8 offset:256
QAB a[16:31],v[36:39],v[64:67],0
QAA v[54:55],v8 offset:8448
QAA v[56:57],v9 offset:256
QAA v[58:59],v9 offset:8448
QAB a[32:47],v[40:43],v[64:67],0
QAA v[60:61],v10 offset:256
QAA v[62:63],v10 offset:8448
QAF m0,s30,49152
QAF s13,s32,49152
QBH v14,0,v1
QAD v14,s[24:27],s13 offen lds
QAB a[48:63],v[44:47],v[64:67],0
QAF m0,s30,50176
QAF s13,s32,50176
QBH v14,64,v1
QAD v14,s[24:27],s13 offen lds
QAH lgkmcnt(0)
QAB a[64:79],v[48:51],v[64:67],0
QAA v[32:33],v7 offset:512
QAA v[34:35],v7 offset:8704
QAA v[36:37],v8 offset:512
QAB a[80:95],v[52:55],v[64:67],0
QAA v[38:39],v8 offset:8704
QAA v[40:41],v9 offset:512
QAA v[42:43],v9 offset:8704
QAB a[96:111],v[56:59],v[64:67],0
QAA v[44:45],v10 offset:512
QAA v[46:47],v10 offset:8704
QAF m0,s30,51200
QAF s13,s32,51200
QBH v14,128,v1
QAD v14,s[24:27],s13 offen lds
QAB a[112:127],v[60:63],v[64:67],0
QAF m0,s30,52224
QAF s13,s32,52224
QBH v14,192,v1
QAD v14,s[24:27],s13 offen lds
QAH lgkmcnt(0)
QAB a[128:143],v[32:35],v[64:67],0
QAA v[48:49],v7 offset:768
QAA v[50:51],v7 offset:8960
QAA v[52:53],v8 offset:768
QAB a[144:159],v[36:39],v[64:67],0
QAA v[54:55],v8 offset:8960
QAA v[56:57],v9 offset:768
QAA v[58:59],v9 offset:8960
QAB a[160:175],v[40:43],v[64:67],0
QAA v[60:61],v10 offset:768
QAA v[62:63],v10 offset:8960
QAB a[176:191],v[44:47],v[64:67],0
QAH lgkmcnt(0)
QAH vmcnt(8)
s_barrier
QAB a[192:207],v[48:51],v[64:67],0
QAA v[32:33],v7 offset:16384
QAA v[34:35],v7 offset:24576
QAA v[36:37],v8 offset:16384
QAB a[208:223],v[52:55],v[64:67],0
QAA v[38:39],v8 offset:24576
QAA v[40:41],v9 offset:16384
QAA v[42:43],v9 offset:24576
QAB a[224:239],v[56:59],v[64:67],0
QAA v[44:45],v10 offset:16384
QAA v[46:47],v10 offset:24576
QAB a[240:255],v[60:63],v[64:67],0
s_branch lat_w2
lat_w1:
QAH lgkmcnt(0)
QAB a[0:15],v[32:35],v[64:67],a[0:15]
QAA v[48:49],v7 offset:256
QAA v[50:51],v7 offset:8448
QAA v[52:53],v8 offset:256
QAB a[16:31],v[36:39],v[64:67],a[16:31]
QAA v[54:55],v8 offset:8448
QAA v[56:57],v9 offset:256
QAA v[58:59],v9 offset:8448
QAB a[32:47],v[40:43],v[64:67],a[32:47]
QAA v[60:61],v10 offset:256
QAA v[62:63],v10 offset:8448
QAF m0,s30,49152
QAF s13,s32,49152
QBH v14,0,v1
QAD v14,s[24:27],s13 offen lds
QAB a[48:63],v[44:47],v[64:67],a[48:63]
QAF m0,s30,50176
QAF s13,s32,50176
QBH v14,64,v1
QAD v14,s[24:27],s13 offen lds
QAH lgkmcnt(0)
QAB a[64:79],v[48:51],v[64:67],a[64:79]
QAA v[32:33],v7 offset:512
QAA v[34:35],v7 offset:8704
QAA v[36:37],v8 offset:512
QAB a[80:95],v[52:55],v[64:67],a[80:95]
QAA v[38:39],v8 offset:8704
QAA v[40:41],v9 offset:512
QAA v[42:43],v9 offset:8704
QAB a[96:111],v[56:59],v[64:67],a[96:111]
QAA v[44:45],v10 offset:512
QAA v[46:47],v10 offset:8704
QAF m0,s30,51200
QAF s13,s32,51200
QBH v14,128,v1
QAD v14,s[24:27],s13 offen lds
QAB a[112:127],v[60:63],v[64:67],a[112:127]
QAF m0,s30,52224
QAF s13,s32,52224
QBH v14,192,v1
QAD v14,s[24:27],s13 offen lds
QAH lgkmcnt(0)
QAB a[128:143],v[32:35],v[64:67],a[128:143]
QAA v[48:49],v7 offset:768
QAA v[50:51],v7 offset:8960
QAA v[52:53],v8 offset:768
QAB a[144:159],v[36:39],v[64:67],a[144:159]
QAA v[54:55],v8 offset:8960
QAA v[56:57],v9 offset:768
QAA v[58:59],v9 offset:8960
QAB a[160:175],v[40:43],v[64:67],a[160:175]
QAA v[60:61],v10 offset:768
QAA v[62:63],v10 offset:8960
QAB a[176:191],v[44:47],v[64:67],a[176:191]
QAH lgkmcnt(0)
QAH vmcnt(8)
s_barrier
QAB a[192:207],v[48:51],v[64:67],a[192:207]
QAA v[32:33],v7 offset:16384
QAA v[34:35],v7 offset:24576
QAA v[36:37],v8 offset:16384
QAB a[208:223],v[52:55],v[64:67],a[208:223]
QAA v[38:39],v8 offset:24576
QAA v[40:41],v9 offset:16384
QAA v[42:43],v9 offset:24576
QAB a[224:239],v[56:59],v[64:67],a[224:239]
QAA v[44:45],v10 offset:16384
QAA v[46:47],v10 offset:24576
QAB a[240:255],v[60:63],v[64:67],a[240:255]
lat_w2:
QAH lgkmcnt(0)
QAB a[0:15],v[32:35],v[68:71],a[0:15]
QAA v[48:49],v7 offset:16640
QAA v[50:51],v7 offset:24832
QAA v[52:53],v8 offset:16640
QAB a[16:31],v[36:39],v[68:71],a[16:31]
QAA v[54:55],v8 offset:24832
QAA v[56:57],v9 offset:16640
QAA v[58:59],v9 offset:24832
QAB a[32:47],v[40:43],v[68:71],a[32:47]
QAA v[60:61],v10 offset:16640
QAA v[62:63],v10 offset:24832
QAF m0,s30,0
QAF s13,s32,65536
QBH v14,0,v1
QAD v14,s[24:27],s13 offen lds
QAB a[48:63],v[44:47],v[68:71],a[48:63]
QAF m0,s30,1024
QAF s13,s32,66560
QBH v14,64,v1
QAD v14,s[24:27],s13 offen lds
QAH lgkmcnt(0)
QAB a[64:79],v[48:51],v[68:71],a[64:79]
QAA v[32:33],v7 offset:16896
QAA v[34:35],v7 offset:25088
QAA v[36:37],v8 offset:16896
QAB a[80:95],v[52:55],v[68:71],a[80:95]
QAA v[38:39],v8 offset:25088
QAA v[40:41],v9 offset:16896
QAA v[42:43],v9 offset:25088
QAB a[96:111],v[56:59],v[68:71],a[96:111]
QAA v[44:45],v10 offset:16896
QAA v[46:47],v10 offset:25088
QAF m0,s30,2048
QAF s13,s32,67584
QBH v14,128,v1
QAD v14,s[24:27],s13 offen lds
QAB a[112:127],v[60:63],v[68:71],a[112:127]
QAF m0,s30,3072
QAF s13,s32,68608
QBH v14,192,v1
QAD v14,s[24:27],s13 offen lds
QAH lgkmcnt(0)
QAB a[128:143],v[32:35],v[68:71],a[128:143]
QAA v[48:49],v7 offset:17152
QAA v[50:51],v7 offset:25344
QAA v[52:53],v8 offset:17152
QAB a[144:159],v[36:39],v[68:71],a[144:159]
QAA v[54:55],v8 offset:25344
QAA v[56:57],v9 offset:17152
QAA v[58:59],v9 offset:25344
QAB a[160:175],v[40:43],v[68:71],a[160:175]
QAA v[60:61],v10 offset:17152
QAA v[62:63],v10 offset:25344
QAF m0,s29,0
QAF s13,s33,0
QAD v1,s[16:19],s13 offen sc1 lds
QAB a[176:191],v[44:47],v[68:71],a[176:191]
QAF m0,s29,1024
QAF s13,s33,1024
QAD v1,s[16:19],s13 offen sc1 lds
QAH lgkmcnt(0)
QAH vmcnt(10)
s_barrier
QAB a[192:207],v[48:51],v[68:71],a[192:207]
QAA v[32:33],v7 offset:32768
QAA v[34:35],v7 offset:40960
QAA v[36:37],v8 offset:32768
QAB a[208:223],v[52:55],v[68:71],a[208:223]
QAA v[38:39],v8 offset:40960
QAA v[40:41],v9 offset:32768
QAA v[42:43],v9 offset:40960
QAB a[224:239],v[56:59],v[68:71],a[224:239]
QAA v[44:45],v10 offset:32768
QAA v[46:47],v10 offset:40960
QAF m0,s29,2048
QAF s13,s33,2048
QAD v1,s[16:19],s13 offen sc1 lds
QAB a[240:255],v[60:63],v[68:71],a[240:255]
QAF m0,s29,3072
QAF s13,s33,3072
QAD v1,s[16:19],s13 offen sc1 lds
QAH lgkmcnt(0)
QAB a[0:15],v[32:35],v[72:75],a[0:15]
QAA v[48:49],v7 offset:33024
QAA v[50:51],v7 offset:41216
QAA v[52:53],v8 offset:33024
QAB a[16:31],v[36:39],v[72:75],a[16:31]
QAA v[54:55],v8 offset:41216
QAA v[56:57],v9 offset:33024
QAA v[58:59],v9 offset:41216
QAB a[32:47],v[40:43],v[72:75],a[32:47]
QAA v[60:61],v10 offset:33024
QAA v[62:63],v10 offset:41216
QAF m0,s30,16384
QAF s13,s32,81920
QBH v14,0,v1
QAD v14,s[24:27],s13 offen lds
QAB a[48:63],v[44:47],v[72:75],a[48:63]
QAF m0,s30,17408
QAF s13,s32,82944
QBH v14,64,v1
QAD v14,s[24:27],s13 offen lds
QAH lgkmcnt(0)
QAB a[64:79],v[48:51],v[72:75],a[64:79]
QAA v[32:33],v7 offset:33280
QAA v[34:35],v7 offset:41472
QAA v[36:37],v8 offset:33280
QAB a[80:95],v[52:55],v[72:75],a[80:95]
QAA v[38:39],v8 offset:41472
QAA v[40:41],v9 offset:33280
QAA v[42:43],v9 offset:41472
QAB a[96:111],v[56:59],v[72:75],a[96:111]
QAA v[44:45],v10 offset:33280
QAA v[46:47],v10 offset:41472
QAF m0,s30,18432
QAF s13,s32,83968
QBH v14,128,v1
QAD v14,s[24:27],s13 offen lds
QAB a[112:127],v[60:63],v[72:75],a[112:127]
QAF m0,s30,19456
QAF s13,s32,84992
QBH v14,192,v1
QAD v14,s[24:27],s13 offen lds
QAH lgkmcnt(0)
QAB a[128:143],v[32:35],v[72:75],a[128:143]
QAA v[48:49],v7 offset:33536
QAA v[50:51],v7 offset:41728
QAA v[52:53],v8 offset:33536
QAB a[144:159],v[36:39],v[72:75],a[144:159]
QAA v[54:55],v8 offset:41728
QAA v[56:57],v9 offset:33536
QAA v[58:59],v9 offset:41728
QAB a[160:175],v[40:43],v[72:75],a[160:175]
QAA v[60:61],v10 offset:33536
QAA v[62:63],v10 offset:41728
QAF m0,s29,4096
QAF s13,s33,4096
QAD v1,s[16:19],s13 offen sc1 lds
QAB a[176:191],v[44:47],v[72:75],a[176:191]
QAF m0,s29,5120
QAF s13,s33,5120
QAD v1,s[16:19],s13 offen sc1 lds
QAH lgkmcnt(0)
QAH vmcnt(14)
s_barrier
QAB a[192:207],v[48:51],v[72:75],a[192:207]
QAA v[32:33],v7 offset:49152
QAA v[34:35],v7 offset:57344
QAA v[36:37],v8 offset:49152
QAB a[208:223],v[52:55],v[72:75],a[208:223]
QAA v[38:39],v8 offset:57344
QAA v[40:41],v9 offset:49152
QAA v[42:43],v9 offset:57344
QAB a[224:239],v[56:59],v[72:75],a[224:239]
QAA v[44:45],v10 offset:49152
QAA v[46:47],v10 offset:57344
QAF m0,s29,6144
QAF s13,s33,6144
QAD v1,s[16:19],s13 offen sc1 lds
QAB a[240:255],v[60:63],v[72:75],a[240:255]
QAF m0,s29,7168
QAF s13,s33,7168
QAD v1,s[16:19],s13 offen sc1 lds
QAH lgkmcnt(0)
QAB a[0:15],v[32:35],v[76:79],a[0:15]
QAA v[48:49],v7 offset:49408
QAA v[50:51],v7 offset:57600
QAA v[52:53],v8 offset:49408
QAB a[16:31],v[36:39],v[76:79],a[16:31]
QAA v[54:55],v8 offset:57600
QAA v[56:57],v9 offset:49408
QAA v[58:59],v9 offset:57600
QAB a[32:47],v[40:43],v[76:79],a[32:47]
QAA v[60:61],v10 offset:49408
QAA v[62:63],v10 offset:57600
QAF m0,s30,32768
QAF s13,s32,98304
QBH v14,0,v1
QAD v14,s[24:27],s13 offen lds
QAB a[48:63],v[44:47],v[76:79],a[48:63]
QAF m0,s30,33792
QAF s13,s32,99328
QBH v14,64,v1
QAD v14,s[24:27],s13 offen lds
QAH lgkmcnt(0)
QAB a[64:79],v[48:51],v[76:79],a[64:79]
QAA v[32:33],v7 offset:49664
QAA v[34:35],v7 offset:57856
QAA v[36:37],v8 offset:49664
QAB a[80:95],v[52:55],v[76:79],a[80:95]
QAA v[38:39],v8 offset:57856
QAA v[40:41],v9 offset:49664
QAA v[42:43],v9 offset:57856
QAB a[96:111],v[56:59],v[76:79],a[96:111]
QAA v[44:45],v10 offset:49664
QAA v[46:47],v10 offset:57856
QAF m0,s30,34816
QAF s13,s32,100352
QBH v14,128,v1
QAD v14,s[24:27],s13 offen lds
QAB a[112:127],v[60:63],v[76:79],a[112:127]
QAF m0,s30,35840
QAF s13,s32,101376
QBH v14,192,v1
QAD v14,s[24:27],s13 offen lds
QAH lgkmcnt(0)
QAB a[128:143],v[32:35],v[76:79],a[128:143]
QAA v[48:49],v7 offset:49920
QAA v[50:51],v7 offset:58112
QAA v[52:53],v8 offset:49920
QAB a[144:159],v[36:39],v[76:79],a[144:159]
QAA v[54:55],v8 offset:58112
QAA v[56:57],v9 offset:49920
QAA v[58:59],v9 offset:58112
QAB a[160:175],v[40:43],v[76:79],a[160:175]
QAA v[60:61],v10 offset:49920
QAA v[62:63],v10 offset:58112
QAF m0,s29,8192
QAF s13,s33,16777216
QAD v1,s[16:19],s13 offen sc1 lds
QAB a[176:191],v[44:47],v[76:79],a[176:191]
QAF m0,s29,9216
QAF s13,s33,16778240
QAD v1,s[16:19],s13 offen sc1 lds
QAH lgkmcnt(0)
QAH vmcnt(18)
s_barrier
QAB a[192:207],v[48:51],v[76:79],a[192:207]
QAA v[32:33],v7 offset:0
QAA v[34:35],v7 offset:8192
QAA v[36:37],v8 offset:0
QAB a[208:223],v[52:55],v[76:79],a[208:223]
QAA v[38:39],v8 offset:8192
QAA v[40:41],v9 offset:0
QAA v[42:43],v9 offset:8192
QAB a[224:239],v[56:59],v[76:79],a[224:239]
QAA v[44:45],v10 offset:0
QAA v[46:47],v10 offset:8192
QAF m0,s29,10240
QAF s13,s33,16779264
QAD v1,s[16:19],s13 offen sc1 lds
QAB a[240:255],v[60:63],v[76:79],a[240:255]
QAF m0,s29,11264
QAF s13,s33,16780288
QAD v1,s[16:19],s13 offen sc1 lds
QAH lgkmcnt(0)
QAB a[0:15],v[32:35],v[80:83],a[0:15]
QAA v[48:49],v7 offset:256
QAA v[50:51],v7 offset:8448
QAA v[52:53],v8 offset:256
QAB a[16:31],v[36:39],v[80:83],a[16:31]
QAA v[54:55],v8 offset:8448
QAA v[56:57],v9 offset:256
QAA v[58:59],v9 offset:8448
QAB a[32:47],v[40:43],v[80:83],a[32:47]
QAA v[60:61],v10 offset:256
QAA v[62:63],v10 offset:8448
QAF m0,s30,49152
QAF s13,s32,114688
QBH v14,0,v1
QAD v14,s[24:27],s13 offen lds
QAB a[48:63],v[44:47],v[80:83],a[48:63]
QAF m0,s30,50176
QAF s13,s32,115712
QBH v14,64,v1
QAD v14,s[24:27],s13 offen lds
QAH lgkmcnt(0)
QAB a[64:79],v[48:51],v[80:83],a[64:79]
QAA v[32:33],v7 offset:512
QAA v[34:35],v7 offset:8704
QAA v[36:37],v8 offset:512
QAB a[80:95],v[52:55],v[80:83],a[80:95]
QAA v[38:39],v8 offset:8704
QAA v[40:41],v9 offset:512
QAA v[42:43],v9 offset:8704
QAB a[96:111],v[56:59],v[80:83],a[96:111]
QAA v[44:45],v10 offset:512
QAA v[46:47],v10 offset:8704
QAF m0,s30,51200
QAF s13,s32,116736
QBH v14,128,v1
QAD v14,s[24:27],s13 offen lds
QAB a[112:127],v[60:63],v[80:83],a[112:127]
QAF m0,s30,52224
QAF s13,s32,117760
QBH v14,192,v1
QAD v14,s[24:27],s13 offen lds
QAH lgkmcnt(0)
QAB a[128:143],v[32:35],v[80:83],a[128:143]
QAA v[48:49],v7 offset:768
QAA v[50:51],v7 offset:8960
QAA v[52:53],v8 offset:768
QAB a[144:159],v[36:39],v[80:83],a[144:159]
QAA v[54:55],v8 offset:8960
QAA v[56:57],v9 offset:768
QAA v[58:59],v9 offset:8960
QAB a[160:175],v[40:43],v[80:83],a[160:175]
QAA v[60:61],v10 offset:768
QAA v[62:63],v10 offset:8960
QAF m0,s29,12288
QAF s13,s33,16781312
QAD v1,s[16:19],s13 offen sc1 lds
QAB a[176:191],v[44:47],v[80:83],a[176:191]
QAF m0,s29,13312
QAF s13,s33,16782336
QAD v1,s[16:19],s13 offen sc1 lds
QAH lgkmcnt(0)
QAH vmcnt(18)
s_barrier
QAB a[192:207],v[48:51],v[80:83],a[192:207]
QAA v[32:33],v7 offset:16384
QAA v[34:35],v7 offset:24576
QAA v[36:37],v8 offset:16384
QAB a[208:223],v[52:55],v[80:83],a[208:223]
QAA v[38:39],v8 offset:24576
QAA v[40:41],v9 offset:16384
QAA v[42:43],v9 offset:24576
QAB a[224:239],v[56:59],v[80:83],a[224:239]
QAA v[44:45],v10 offset:16384
QAA v[46:47],v10 offset:24576
QAF m0,s29,14336
QAF s13,s33,16783360
QAD v1,s[16:19],s13 offen sc1 lds
QAB a[240:255],v[60:63],v[80:83],a[240:255]
QAF m0,s29,15360
QAF s13,s33,16784384
QAD v1,s[16:19],s13 offen sc1 lds
QAH lgkmcnt(0)
QAB a[0:15],v[32:35],v[84:87],a[0:15]
QAA v[48:49],v7 offset:16640
QAA v[50:51],v7 offset:24832
QAA v[52:53],v8 offset:16640
QAB a[16:31],v[36:39],v[84:87],a[16:31]
QAA v[54:55],v8 offset:24832
QAA v[56:57],v9 offset:16640
QAA v[58:59],v9 offset:24832
QAB a[32:47],v[40:43],v[84:87],a[32:47]
QAA v[60:61],v10 offset:16640
QAA v[62:63],v10 offset:24832
QAF m0,s30,0
QAF s13,s38,0
QAD v2,s[20:23],s13 offen lds
QAB a[48:63],v[44:47],v[84:87],a[48:63]
QAF m0,s30,1024
QAF s13,s38,32768
QAD v2,s[20:23],s13 offen lds
QAH lgkmcnt(0)
QAB a[64:79],v[48:51],v[84:87],a[64:79]
QAA v[32:33],v7 offset:16896
QAA v[34:35],v7 offset:25088
QAA v[36:37],v8 offset:16896
QAB a[80:95],v[52:55],v[84:87],a[80:95]
QAA v[38:39],v8 offset:25088
QAA v[40:41],v9 offset:16896
QAA v[42:43],v9 offset:25088
QAB a[96:111],v[56:59],v[84:87],a[96:111]
QAA v[44:45],v10 offset:16896
QAA v[46:47],v10 offset:25088
QAF m0,s30,2048
QAF s13,s38,65536
QAD v2,s[20:23],s13 offen lds
QAB a[112:127],v[60:63],v[84:87],a[112:127]
QAF m0,s30,3072
QAF s13,s38,98304
QAD v2,s[20:23],s13 offen lds
QAH lgkmcnt(0)
QAB a[128:143],v[32:35],v[84:87],a[128:143]
QAA v[48:49],v7 offset:17152
QAA v[50:51],v7 offset:25344
QAA v[52:53],v8 offset:17152
QAB a[144:159],v[36:39],v[84:87],a[144:159]
QAA v[54:55],v8 offset:25344
QAA v[56:57],v9 offset:17152
QAA v[58:59],v9 offset:25344
QAB a[160:175],v[40:43],v[84:87],a[160:175]
QAA v[60:61],v10 offset:17152
QAA v[62:63],v10 offset:25344
QAF m0,s29,16384
QAF s13,s34,0
QAD v1,s[16:19],s13 offen sc1 lds
QAB a[176:191],v[44:47],v[84:87],a[176:191]
QAF m0,s29,17408
QAF s13,s34,1024
QAD v1,s[16:19],s13 offen sc1 lds
QAH lgkmcnt(0)
QAH vmcnt(18)
s_barrier
QAB a[192:207],v[48:51],v[84:87],a[192:207]
QAA v[32:33],v7 offset:32768
QAA v[34:35],v7 offset:40960
QAA v[36:37],v8 offset:32768
QAB a[208:223],v[52:55],v[84:87],a[208:223]
QAA v[38:39],v8 offset:40960
QAA v[40:41],v9 offset:32768
QAA v[42:43],v9 offset:40960
QAB a[224:239],v[56:59],v[84:87],a[224:239]
QAA v[44:45],v10 offset:32768
QAA v[46:47],v10 offset:40960
QAF m0,s29,18432
QAF s13,s34,2048
QAD v1,s[16:19],s13 offen sc1 lds
QAB a[240:255],v[60:63],v[84:87],a[240:255]
QAF m0,s29,19456
QAF s13,s34,3072
QAD v1,s[16:19],s13 offen sc1 lds
QAH lgkmcnt(0)
QAB a[0:15],v[32:35],v[88:91],a[0:15]
QAA v[48:49],v7 offset:33024
QAA v[50:51],v7 offset:41216
QAA v[52:53],v8 offset:33024
QAB a[16:31],v[36:39],v[88:91],a[16:31]
QAA v[54:55],v8 offset:41216
QAA v[56:57],v9 offset:33024
QAA v[58:59],v9 offset:41216
QAB a[32:47],v[40:43],v[88:91],a[32:47]
QAA v[60:61],v10 offset:33024
QAA v[62:63],v10 offset:41216
QAF m0,s30,16384
QAF s13,s38,524288
QAD v2,s[20:23],s13 offen lds
QAB a[48:63],v[44:47],v[88:91],a[48:63]
QAF m0,s30,17408
QAF s13,s38,557056
QAD v2,s[20:23],s13 offen lds
QAH lgkmcnt(0)
QAB a[64:79],v[48:51],v[88:91],a[64:79]
QAA v[32:33],v7 offset:33280
QAA v[34:35],v7 offset:41472
QAA v[36:37],v8 offset:33280
QAB a[80:95],v[52:55],v[88:91],a[80:95]
QAA v[38:39],v8 offset:41472
QAA v[40:41],v9 offset:33280
QAA v[42:43],v9 offset:41472
QAB a[96:111],v[56:59],v[88:91],a[96:111]
QAA v[44:45],v10 offset:33280
QAA v[46:47],v10 offset:41472
QAF m0,s30,18432
QAF s13,s38,589824
QAD v2,s[20:23],s13 offen lds
QAB a[112:127],v[60:63],v[88:91],a[112:127]
QAF m0,s30,19456
QAF s13,s38,622592
QAD v2,s[20:23],s13 offen lds
QAH lgkmcnt(0)
QAB a[128:143],v[32:35],v[88:91],a[128:143]
QAA v[48:49],v7 offset:33536
QAA v[50:51],v7 offset:41728
QAA v[52:53],v8 offset:33536
QAB a[144:159],v[36:39],v[88:91],a[144:159]
QAA v[54:55],v8 offset:41728
QAA v[56:57],v9 offset:33536
QAA v[58:59],v9 offset:41728
QAB a[160:175],v[40:43],v[88:91],a[160:175]
QAA v[60:61],v10 offset:33536
QAA v[62:63],v10 offset:41728
QAB a[176:191],v[44:47],v[88:91],a[176:191]
QAH lgkmcnt(0)
QAH vmcnt(16)
s_barrier
QAB a[192:207],v[48:51],v[88:91],a[192:207]
QAA v[32:33],v7 offset:49152
QAA v[34:35],v7 offset:57344
QAA v[36:37],v8 offset:49152
QAB a[208:223],v[52:55],v[88:91],a[208:223]
QAA v[38:39],v8 offset:57344
QAA v[40:41],v9 offset:49152
QAA v[42:43],v9 offset:57344
QAB a[224:239],v[56:59],v[88:91],a[224:239]
QAA v[44:45],v10 offset:49152
QAA v[46:47],v10 offset:57344
QAB a[240:255],v[60:63],v[88:91],a[240:255]
QAH lgkmcnt(0)
QAB a[0:15],v[32:35],v[92:95],a[0:15]
QAA v[48:49],v7 offset:49408
QAA v[50:51],v7 offset:57600
QAA v[52:53],v8 offset:49408
QAB a[16:31],v[36:39],v[92:95],a[16:31]
QAA v[54:55],v8 offset:57600
QAA v[56:57],v9 offset:49408
QAA v[58:59],v9 offset:57600
QAB a[32:47],v[40:43],v[92:95],a[32:47]
QAA v[60:61],v10 offset:49408
QAA v[62:63],v10 offset:57600
QAF m0,s30,32768
QAF s13,s38,1048576
QAD v2,s[20:23],s13 offen lds
QAB a[48:63],v[44:47],v[92:95],a[48:63]
QAF m0,s30,33792
QAF s13,s38,1081344
QAD v2,s[20:23],s13 offen lds
QAH lgkmcnt(0)
QAB a[64:79],v[48:51],v[92:95],a[64:79]
QAA v[32:33],v7 offset:49664
QAA v[34:35],v7 offset:57856
QAA v[36:37],v8 offset:49664
QAB a[80:95],v[52:55],v[92:95],a[80:95]
QAA v[38:39],v8 offset:57856
QAA v[40:41],v9 offset:49664
QAA v[42:43],v9 offset:57856
QAB a[96:111],v[56:59],v[92:95],a[96:111]
QAA v[44:45],v10 offset:49664
QAA v[46:47],v10 offset:57856
QAF m0,s30,34816
QAF s13,s38,1114112
QAD v2,s[20:23],s13 offen lds
QAB a[112:127],v[60:63],v[92:95],a[112:127]
QAF m0,s30,35840
QAF s13,s38,1146880
QAD v2,s[20:23],s13 offen lds
QAH lgkmcnt(0)
QAB a[128:143],v[32:35],v[92:95],a[128:143]
QAA v[48:49],v7 offset:49920
QAA v[50:51],v7 offset:58112
QAA v[52:53],v8 offset:49920
QAB a[144:159],v[36:39],v[92:95],a[144:159]
QAA v[54:55],v8 offset:58112
QAA v[56:57],v9 offset:49920
QAA v[58:59],v9 offset:58112
QAB a[160:175],v[40:43],v[92:95],a[160:175]
QAA v[60:61],v10 offset:49920
QAA v[62:63],v10 offset:58112
QAB a[176:191],v[44:47],v[92:95],a[176:191]
QAH lgkmcnt(0)
QAH vmcnt(12)
s_barrier
QAB a[192:207],v[48:51],v[92:95],a[192:207]
QAA v[32:33],v3 offset:0
QAA v[34:35],v3 offset:1024
QAA v[36:37],v4 offset:0
QAB a[208:223],v[52:55],v[92:95],a[208:223]
QAA v[38:39],v4 offset:1024
QAA v[40:41],v5 offset:0
QAA v[42:43],v5 offset:1024
QAB a[224:239],v[56:59],v[92:95],a[224:239]
QAA v[44:45],v6 offset:0
QAA v[46:47],v6 offset:1024
QAB a[240:255],v[60:63],v[92:95],a[240:255]
QAF s31,s31,256
QAF s32,s32,131072
QAF s36,s36,1
QBN s36,s69
s_cbranch_scc1 lat_hl
QAH lgkmcnt(0)
QAS s13,s67,21
QAS s14,s28,15
QAF s13,s13,s14
QAF s13,s13,67108864
s_nop 7
QAK v32,a0
QAK v33,a1
QAK v34,a2
QAK v35,a3
QAK v36,a4
QAK v37,a5
QAK v38,a6
QAK v39,a7
QAK v40,a8
QAK v41,a9
QAK v42,a10
QAK v43,a11
QAK v44,a12
QAK v45,a13
QAK v46,a14
QAK v47,a15
QAE v64,v32,v33
QAE v65,v34,v35
QAE v66,v36,v37
QAE v67,v38,v39
QAE v68,v40,v41
QAE v69,v42,v43
QAE v70,v44,v45
QAE v71,v46,v47
QAL v[64:67],v1,s[16:19],s13 offen offset:0 sc1
QAL v[68:71],v1,s[16:19],s13 offen offset:1024 sc1
QAK v48,a16
QAK v49,a17
QAK v50,a18
QAK v51,a19
QAK v52,a20
QAK v53,a21
QAK v54,a22
QAK v55,a23
QAK v56,a24
QAK v57,a25
QAK v58,a26
QAK v59,a27
QAK v60,a28
QAK v61,a29
QAK v62,a30
QAK v63,a31
QAE v72,v48,v49
QAE v73,v50,v51
QAE v74,v52,v53
QAE v75,v54,v55
QAE v76,v56,v57
QAE v77,v58,v59
QAE v78,v60,v61
QAE v79,v62,v63
QAL v[72:75],v1,s[16:19],s13 offen offset:2048 sc1
QAL v[76:79],v1,s[16:19],s13 offen offset:3072 sc1
QAK v32,a32
QAK v33,a33
QAK v34,a34
QAK v35,a35
QAK v36,a36
QAK v37,a37
QAK v38,a38
QAK v39,a39
QAK v40,a40
QAK v41,a41
QAK v42,a42
QAK v43,a43
QAK v44,a44
QAK v45,a45
QAK v46,a46
QAK v47,a47
QAE v80,v32,v33
QAE v81,v34,v35
QAE v82,v36,v37
QAE v83,v38,v39
QAE v84,v40,v41
QAE v85,v42,v43
QAE v86,v44,v45
QAE v87,v46,v47
QAF s13,s13,4096
QAL v[80:83],v1,s[16:19],s13 offen offset:0 sc1
QAL v[84:87],v1,s[16:19],s13 offen offset:1024 sc1
QAK v48,a48
QAK v49,a49
QAK v50,a50
QAK v51,a51
QAK v52,a52
QAK v53,a53
QAK v54,a54
QAK v55,a55
QAK v56,a56
QAK v57,a57
QAK v58,a58
QAK v59,a59
QAK v60,a60
QAK v61,a61
QAK v62,a62
QAK v63,a63
QAE v88,v48,v49
QAE v89,v50,v51
QAE v90,v52,v53
QAE v91,v54,v55
QAE v92,v56,v57
QAE v93,v58,v59
QAE v94,v60,v61
QAE v95,v62,v63
QAL v[88:91],v1,s[16:19],s13 offen offset:2048 sc1
QAL v[92:95],v1,s[16:19],s13 offen offset:3072 sc1
QAK v32,a64
QAK v33,a65
QAK v34,a66
QAK v35,a67
QAK v36,a68
QAK v37,a69
QAK v38,a70
QAK v39,a71
QAK v40,a72
QAK v41,a73
QAK v42,a74
QAK v43,a75
QAK v44,a76
QAK v45,a77
QAK v46,a78
QAK v47,a79
QAE v64,v32,v33
QAE v65,v34,v35
QAE v66,v36,v37
QAE v67,v38,v39
QAE v68,v40,v41
QAE v69,v42,v43
QAE v70,v44,v45
QAE v71,v46,v47
QAF s13,s13,4096
QAL v[64:67],v1,s[16:19],s13 offen offset:0 sc1
QAL v[68:71],v1,s[16:19],s13 offen offset:1024 sc1
QAK v48,a80
QAK v49,a81
QAK v50,a82
QAK v51,a83
QAK v52,a84
QAK v53,a85
QAK v54,a86
QAK v55,a87
QAK v56,a88
QAK v57,a89
QAK v58,a90
QAK v59,a91
QAK v60,a92
QAK v61,a93
QAK v62,a94
QAK v63,a95
QAE v72,v48,v49
QAE v73,v50,v51
QAE v74,v52,v53
QAE v75,v54,v55
QAE v76,v56,v57
QAE v77,v58,v59
QAE v78,v60,v61
QAE v79,v62,v63
QAL v[72:75],v1,s[16:19],s13 offen offset:2048 sc1
QAL v[76:79],v1,s[16:19],s13 offen offset:3072 sc1
QAK v32,a96
QAK v33,a97
QAK v34,a98
QAK v35,a99
QAK v36,a100
QAK v37,a101
QAK v38,a102
QAK v39,a103
QAK v40,a104
QAK v41,a105
QAK v42,a106
QAK v43,a107
QAK v44,a108
QAK v45,a109
QAK v46,a110
QAK v47,a111
QAE v80,v32,v33
QAE v81,v34,v35
QAE v82,v36,v37
QAE v83,v38,v39
QAE v84,v40,v41
QAE v85,v42,v43
QAE v86,v44,v45
QAE v87,v46,v47
QAF s13,s13,4096
QAL v[80:83],v1,s[16:19],s13 offen offset:0 sc1
QAL v[84:87],v1,s[16:19],s13 offen offset:1024 sc1
QAK v48,a112
QAK v49,a113
QAK v50,a114
QAK v51,a115
QAK v52,a116
QAK v53,a117
QAK v54,a118
QAK v55,a119
QAK v56,a120
QAK v57,a121
QAK v58,a122
QAK v59,a123
QAK v60,a124
QAK v61,a125
QAK v62,a126
QAK v63,a127
QAE v88,v48,v49
QAE v89,v50,v51
QAE v90,v52,v53
QAE v91,v54,v55
QAE v92,v56,v57
QAE v93,v58,v59
QAE v94,v60,v61
QAE v95,v62,v63
QAL v[88:91],v1,s[16:19],s13 offen offset:2048 sc1
QAL v[92:95],v1,s[16:19],s13 offen offset:3072 sc1
QAK v32,a128
QAK v33,a129
QAK v34,a130
QAK v35,a131
QAK v36,a132
QAK v37,a133
QAK v38,a134
QAK v39,a135
QAK v40,a136
QAK v41,a137
QAK v42,a138
QAK v43,a139
QAK v44,a140
QAK v45,a141
QAK v46,a142
QAK v47,a143
QAE v64,v32,v33
QAE v65,v34,v35
QAE v66,v36,v37
QAE v67,v38,v39
QAE v68,v40,v41
QAE v69,v42,v43
QAE v70,v44,v45
QAE v71,v46,v47
QAF s13,s13,4096
QAL v[64:67],v1,s[16:19],s13 offen offset:0 sc1
QAL v[68:71],v1,s[16:19],s13 offen offset:1024 sc1
QAK v48,a144
QAK v49,a145
QAK v50,a146
QAK v51,a147
QAK v52,a148
QAK v53,a149
QAK v54,a150
QAK v55,a151
QAK v56,a152
QAK v57,a153
QAK v58,a154
QAK v59,a155
QAK v60,a156
QAK v61,a157
QAK v62,a158
QAK v63,a159
QAE v72,v48,v49
QAE v73,v50,v51
QAE v74,v52,v53
QAE v75,v54,v55
QAE v76,v56,v57
QAE v77,v58,v59
QAE v78,v60,v61
QAE v79,v62,v63
QAL v[72:75],v1,s[16:19],s13 offen offset:2048 sc1
QAL v[76:79],v1,s[16:19],s13 offen offset:3072 sc1
QAK v32,a160
QAK v33,a161
QAK v34,a162
QAK v35,a163
QAK v36,a164
QAK v37,a165
QAK v38,a166
QAK v39,a167
QAK v40,a168
QAK v41,a169
QAK v42,a170
QAK v43,a171
QAK v44,a172
QAK v45,a173
QAK v46,a174
QAK v47,a175
QAE v80,v32,v33
QAE v81,v34,v35
QAE v82,v36,v37
QAE v83,v38,v39
QAE v84,v40,v41
QAE v85,v42,v43
QAE v86,v44,v45
QAE v87,v46,v47
QAF s13,s13,4096
QAL v[80:83],v1,s[16:19],s13 offen offset:0 sc1
QAL v[84:87],v1,s[16:19],s13 offen offset:1024 sc1
QAK v48,a176
QAK v49,a177
QAK v50,a178
QAK v51,a179
QAK v52,a180
QAK v53,a181
QAK v54,a182
QAK v55,a183
QAK v56,a184
QAK v57,a185
QAK v58,a186
QAK v59,a187
QAK v60,a188
QAK v61,a189
QAK v62,a190
QAK v63,a191
QAE v88,v48,v49
QAE v89,v50,v51
QAE v90,v52,v53
QAE v91,v54,v55
QAE v92,v56,v57
QAE v93,v58,v59
QAE v94,v60,v61
QAE v95,v62,v63
QAL v[88:91],v1,s[16:19],s13 offen offset:2048 sc1
QAL v[92:95],v1,s[16:19],s13 offen offset:3072 sc1
QAK v32,a192
QAK v33,a193
QAK v34,a194
QAK v35,a195
QAK v36,a196
QAK v37,a197
QAK v38,a198
QAK v39,a199
QAK v40,a200
QAK v41,a201
QAK v42,a202
QAK v43,a203
QAK v44,a204
QAK v45,a205
QAK v46,a206
QAK v47,a207
QAE v64,v32,v33
QAE v65,v34,v35
QAE v66,v36,v37
QAE v67,v38,v39
QAE v68,v40,v41
QAE v69,v42,v43
QAE v70,v44,v45
QAE v71,v46,v47
QAF s13,s13,4096
QAL v[64:67],v1,s[16:19],s13 offen offset:0 sc1
QAL v[68:71],v1,s[16:19],s13 offen offset:1024 sc1
QAK v48,a208
QAK v49,a209
QAK v50,a210
QAK v51,a211
QAK v52,a212
QAK v53,a213
QAK v54,a214
QAK v55,a215
QAK v56,a216
QAK v57,a217
QAK v58,a218
QAK v59,a219
QAK v60,a220
QAK v61,a221
QAK v62,a222
QAK v63,a223
QAE v72,v48,v49
QAE v73,v50,v51
QAE v74,v52,v53
QAE v75,v54,v55
QAE v76,v56,v57
QAE v77,v58,v59
QAE v78,v60,v61
QAE v79,v62,v63
QAL v[72:75],v1,s[16:19],s13 offen offset:2048 sc1
QAL v[76:79],v1,s[16:19],s13 offen offset:3072 sc1
QAK v32,a224
QAK v33,a225
QAK v34,a226
QAK v35,a227
QAK v36,a228
QAK v37,a229
QAK v38,a230
QAK v39,a231
QAK v40,a232
QAK v41,a233
QAK v42,a234
QAK v43,a235
QAK v44,a236
QAK v45,a237
QAK v46,a238
QAK v47,a239
QAE v80,v32,v33
QAE v81,v34,v35
QAE v82,v36,v37
QAE v83,v38,v39
QAE v84,v40,v41
QAE v85,v42,v43
QAE v86,v44,v45
QAE v87,v46,v47
QAF s13,s13,4096
QAL v[80:83],v1,s[16:19],s13 offen offset:0 sc1
QAL v[84:87],v1,s[16:19],s13 offen offset:1024 sc1
QAK v48,a240
QAK v49,a241
QAK v50,a242
QAK v51,a243
QAK v52,a244
QAK v53,a245
QAK v54,a246
QAK v55,a247
QAK v56,a248
QAK v57,a249
QAK v58,a250
QAK v59,a251
QAK v60,a252
QAK v61,a253
QAK v62,a254
QAK v63,a255
QAE v88,v48,v49
QAE v89,v50,v51
QAE v90,v52,v53
QAE v91,v54,v55
QAE v92,v56,v57
QAE v93,v58,v59
QAE v94,v60,v61
QAE v95,v62,v63
QAL v[88:91],v1,s[16:19],s13 offen offset:2048 sc1
QAL v[92:95],v1,s[16:19],s13 offen offset:3072 sc1
QBW v0,4,v1
QAH vmcnt(0)
s_barrier
QAS s73,s66,8
QAF s73,s73,s56
QAF s13,s73,573440
QAQ v2,1
QBJ s9,0
s_cbranch_scc1 lay_a3
QBY exec,1
buffer_atomic_add v2,off,s[16:19],s13
QBY exec,-1
lay_a3:
QAT s74,60817408
QBJ s9,0
s_cbranch_scc1 lay_tw_ok
QAI v2,4,v1
QAQ v4,14
QAT s15,0
lay_tw:
QAF s13,s74,606208
QAT exec_hi,0
QAT exec_lo,0xffff
QBR v3,v2,s[16:19],s13 offen sc1
QBY exec,-1
QAH vmcnt(0)
v_cmp_ge_u32 vcc,v3,v4
s_nop 1
QBO s13,vcc_lo,0xffff
QBS s13,0xffff
s_cbranch_scc1 lay_tw_ok
s_sleep 4
QAF s15,s15,1
QBN s15,400000
s_cbranch_scc1 lay_tw
lay_tw_ok:
s_barrier
QBO s74,s67,3
QAS s29,s74,2
QAF s29,s29,s9
QAS s29,s29,15
QAF s29,s29,52428800
QAD a[0:3],v1,s[16:19],s29 offen offset:0 sc1
QAD a[4:7],v1,s[16:19],s29 offen offset:1024 sc1
QAD a[8:11],v1,s[16:19],s29 offen offset:2048 sc1
QAD a[12:15],v1,s[16:19],s29 offen offset:3072 sc1
QAF s29,s29,4096
QAD a[16:19],v1,s[16:19],s29 offen offset:0 sc1
QAD a[20:23],v1,s[16:19],s29 offen offset:1024 sc1
QAD a[24:27],v1,s[16:19],s29 offen offset:2048 sc1
QAD a[28:31],v1,s[16:19],s29 offen offset:3072 sc1
QAF s29,s29,4096
QAD a[32:35],v1,s[16:19],s29 offen offset:0 sc1
QAD a[36:39],v1,s[16:19],s29 offen offset:1024 sc1
QAD a[40:43],v1,s[16:19],s29 offen offset:2048 sc1
QAD a[44:47],v1,s[16:19],s29 offen offset:3072 sc1
QAF s29,s29,4096
QAD a[48:51],v1,s[16:19],s29 offen offset:0 sc1
QAD a[52:55],v1,s[16:19],s29 offen offset:1024 sc1
QAD a[56:59],v1,s[16:19],s29 offen offset:2048 sc1
QAD a[60:63],v1,s[16:19],s29 offen offset:3072 sc1
QAF s29,s29,4096
QAD a[64:67],v1,s[16:19],s29 offen offset:0 sc1
QAD a[68:71],v1,s[16:19],s29 offen offset:1024 sc1
QAD a[72:75],v1,s[16:19],s29 offen offset:2048 sc1
QAD a[76:79],v1,s[16:19],s29 offen offset:3072 sc1
QAF s29,s29,4096
QAD a[80:83],v1,s[16:19],s29 offen offset:0 sc1
QAD a[84:87],v1,s[16:19],s29 offen offset:1024 sc1
QAD a[88:91],v1,s[16:19],s29 offen offset:2048 sc1
QAD a[92:95],v1,s[16:19],s29 offen offset:3072 sc1
QAF s29,s29,4096
QAD a[96:99],v1,s[16:19],s29 offen offset:0 sc1
QAD a[100:103],v1,s[16:19],s29 offen offset:1024 sc1
QAD a[104:107],v1,s[16:19],s29 offen offset:2048 sc1
QAD a[108:111],v1,s[16:19],s29 offen offset:3072 sc1
QAF s29,s29,4096
QAD a[112:115],v1,s[16:19],s29 offen offset:0 sc1
QAD a[116:119],v1,s[16:19],s29 offen offset:1024 sc1
QAD a[120:123],v1,s[16:19],s29 offen offset:2048 sc1
QAD a[124:127],v1,s[16:19],s29 offen offset:3072 sc1
QBJ s9,0
s_cbranch_scc1 lay_cw_ok
QAT s15,0
lay_cw:
QAF s13,s73,573440
QBR v2,off,s[16:19],s13 sc1
QAH vmcnt(0)
QCA s13,v2
QAS s14,8,s68
s_nop 0
QBK s13,s14
s_cbranch_scc1 lay_cw_ok
s_sleep 2
QAF s15,s15,1
QBN s15,400000
s_cbranch_scc1 lay_cw
lay_cw_ok:
s_barrier
QAF s13,s68,3
QAS s14,s9,s13
QAF s14,s14,s67
QAS s14,s14,10
QAS s28,s66,17
QAF s28,s28,s14
QAS s29,4096,s13
QAS s30,1,s68
s_sub_u32 s30,s30,1
QAF s31,s28,67108864
QAT s32,s31
QAF s33,s28,2097152
QAD v[32:35],v1,s[16:19],s32 offen sc1
QAF s32,s32,2097152
QAD v[36:39],v1,s[16:19],s32 offen sc1
QAF s32,s32,2097152
QAD v[40:43],v1,s[16:19],s32 offen sc1
QAF s32,s32,2097152
QAD v[44:47],v1,s[16:19],s32 offen sc1
QAF s32,s32,2097152
QAD v[48:51],v1,s[16:19],s32 offen sc1
QAF s32,s32,2097152
QAD v[52:55],v1,s[16:19],s32 offen sc1
QAF s32,s32,2097152
QAD v[56:59],v1,s[16:19],s32 offen sc1
QAF s32,s32,2097152
QAD v[60:63],v1,s[16:19],s32 offen sc1
QAF s32,s32,2097152
QAD v[176:179],v1,s[16:19],s33 offen sc1
QBO s13,s30,1
QBS s13,0
QBL s13,s29,0
QAF s31,s31,s13
QAF s33,s33,s13
QBJ s13,0
QBL s32,s31,s32
QAD v[64:67],v1,s[16:19],s32 offen sc1
QAF s32,s32,2097152
QAD v[68:71],v1,s[16:19],s32 offen sc1
QAF s32,s32,2097152
QAD v[72:75],v1,s[16:19],s32 offen sc1
QAF s32,s32,2097152
QAD v[76:79],v1,s[16:19],s32 offen sc1
QAF s32,s32,2097152
QAD v[80:83],v1,s[16:19],s32 offen sc1
QAF s32,s32,2097152
QAD v[84:87],v1,s[16:19],s32 offen sc1
QAF s32,s32,2097152
QAD v[88:91],v1,s[16:19],s32 offen sc1
QAF s32,s32,2097152
QAD v[92:95],v1,s[16:19],s32 offen sc1
QAF s32,s32,2097152
QAD v[180:183],v1,s[16:19],s33 offen sc1
QBO s13,s30,2
QBS s13,0
QBL s13,s29,0
QAF s31,s31,s13
QAF s33,s33,s13
QBJ s13,0
QBL s32,s31,s32
QAD v[96:99],v1,s[16:19],s32 offen sc1
QAF s32,s32,2097152
QAD v[100:103],v1,s[16:19],s32 offen sc1
QAF s32,s32,2097152
QAD v[104:107],v1,s[16:19],s32 offen sc1
QAF s32,s32,2097152
QAD v[108:111],v1,s[16:19],s32 offen sc1
QAF s32,s32,2097152
QAD v[112:115],v1,s[16:19],s32 offen sc1
QAF s32,s32,2097152
QAD v[116:119],v1,s[16:19],s32 offen sc1
QAF s32,s32,2097152
QAD v[120:123],v1,s[16:19],s32 offen sc1
QAF s32,s32,2097152
QAD v[124:127],v1,s[16:19],s32 offen sc1
QAF s32,s32,2097152
QAD v[184:187],v1,s[16:19],s33 offen sc1
QBO s13,s30,3
QBS s13,0
QBL s13,s29,0
QAF s31,s31,s13
QAF s33,s33,s13
QBJ s13,0
QBL s32,s31,s32
QAD v[128:131],v1,s[16:19],s32 offen sc1
QAF s32,s32,2097152
QAD v[132:135],v1,s[16:19],s32 offen sc1
QAF s32,s32,2097152
QAD v[136:139],v1,s[16:19],s32 offen sc1
QAF s32,s32,2097152
QAD v[140:143],v1,s[16:19],s32 offen sc1
QAF s32,s32,2097152
QAD v[144:147],v1,s[16:19],s32 offen sc1
QAF s32,s32,2097152
QAD v[148:151],v1,s[16:19],s32 offen sc1
QAF s32,s32,2097152
QAD v[152:155],v1,s[16:19],s32 offen sc1
QAF s32,s32,2097152
QAD v[156:159],v1,s[16:19],s32 offen sc1
QAF s32,s32,2097152
QAD v[188:191],v1,s[16:19],s33 offen sc1
QAF s33,s28,46137344
QAR v[160:161],0
QAR v[162:163],0
QAR v[164:165],0
QAR v[166:167],0
QAH vmcnt(27)
QAI v168,16,v32
QAM v169,0xffff0000,v32
QAN v[160:161],v[160:161],v[168:169]
QAI v168,16,v33
QAM v169,0xffff0000,v33
QAN v[162:163],v[162:163],v[168:169]
QAI v168,16,v34
QAM v169,0xffff0000,v34
QAN v[164:165],v[164:165],v[168:169]
QAI v168,16,v35
QAM v169,0xffff0000,v35
QAN v[166:167],v[166:167],v[168:169]
QAI v168,16,v36
QAM v169,0xffff0000,v36
QAN v[160:161],v[160:161],v[168:169]
QAI v168,16,v37
QAM v169,0xffff0000,v37
QAN v[162:163],v[162:163],v[168:169]
QAI v168,16,v38
QAM v169,0xffff0000,v38
QAN v[164:165],v[164:165],v[168:169]
QAI v168,16,v39
QAM v169,0xffff0000,v39
QAN v[166:167],v[166:167],v[168:169]
QAI v168,16,v40
QAM v169,0xffff0000,v40
QAN v[160:161],v[160:161],v[168:169]
QAI v168,16,v41
QAM v169,0xffff0000,v41
QAN v[162:163],v[162:163],v[168:169]
QAI v168,16,v42
QAM v169,0xffff0000,v42
QAN v[164:165],v[164:165],v[168:169]
QAI v168,16,v43
QAM v169,0xffff0000,v43
QAN v[166:167],v[166:167],v[168:169]
QAI v168,16,v44
QAM v169,0xffff0000,v44
QAN v[160:161],v[160:161],v[168:169]
QAI v168,16,v45
QAM v169,0xffff0000,v45
QAN v[162:163],v[162:163],v[168:169]
QAI v168,16,v46
QAM v169,0xffff0000,v46
QAN v[164:165],v[164:165],v[168:169]
QAI v168,16,v47
QAM v169,0xffff0000,v47
QAN v[166:167],v[166:167],v[168:169]
QAI v168,16,v48
QAM v169,0xffff0000,v48
QAN v[160:161],v[160:161],v[168:169]
QAI v168,16,v49
QAM v169,0xffff0000,v49
QAN v[162:163],v[162:163],v[168:169]
QAI v168,16,v50
QAM v169,0xffff0000,v50
QAN v[164:165],v[164:165],v[168:169]
QAI v168,16,v51
QAM v169,0xffff0000,v51
QAN v[166:167],v[166:167],v[168:169]
QAI v168,16,v52
QAM v169,0xffff0000,v52
QAN v[160:161],v[160:161],v[168:169]
QAI v168,16,v53
QAM v169,0xffff0000,v53
QAN v[162:163],v[162:163],v[168:169]
QAI v168,16,v54
QAM v169,0xffff0000,v54
QAN v[164:165],v[164:165],v[168:169]
QAI v168,16,v55
QAM v169,0xffff0000,v55
QAN v[166:167],v[166:167],v[168:169]
QAI v168,16,v56
QAM v169,0xffff0000,v56
QAN v[160:161],v[160:161],v[168:169]
QAI v168,16,v57
QAM v169,0xffff0000,v57
QAN v[162:163],v[162:163],v[168:169]
QAI v168,16,v58
QAM v169,0xffff0000,v58
QAN v[164:165],v[164:165],v[168:169]
QAI v168,16,v59
QAM v169,0xffff0000,v59
QAN v[166:167],v[166:167],v[168:169]
QAI v168,16,v60
QAM v169,0xffff0000,v60
QAN v[160:161],v[160:161],v[168:169]
QAI v168,16,v61
QAM v169,0xffff0000,v61
QAN v[162:163],v[162:163],v[168:169]
QAI v168,16,v62
QAM v169,0xffff0000,v62
QAN v[164:165],v[164:165],v[168:169]
QAI v168,16,v63
QAM v169,0xffff0000,v63
QAN v[166:167],v[166:167],v[168:169]
QBO s13,s30,1
QBJ s13,0
s_cbranch_scc1 lay_r0
QAE v168,v160,v161
QAI v170,16,v168
QAM v171,0xffff0000,v168
QAI v172,16,v176
QAM v173,0xffff0000,v176
QAN v[170:171],v[170:171],v[172:173]
QAE v176,v170,v171
QAR v[160:161],0
QAE v168,v162,v163
QAI v170,16,v168
QAM v171,0xffff0000,v168
QAI v172,16,v177
QAM v173,0xffff0000,v177
QAN v[170:171],v[170:171],v[172:173]
QAE v177,v170,v171
QAR v[162:163],0
QAE v168,v164,v165
QAI v170,16,v168
QAM v171,0xffff0000,v168
QAI v172,16,v178
QAM v173,0xffff0000,v178
QAN v[170:171],v[170:171],v[172:173]
QAE v178,v170,v171
QAR v[164:165],0
QAE v168,v166,v167
QAI v170,16,v168
QAM v171,0xffff0000,v168
QAI v172,16,v179
QAM v173,0xffff0000,v179
QAN v[170:171],v[170:171],v[172:173]
QAE v179,v170,v171
QAR v[166:167],0
QAL v[176:179],v1,s[16:19],s33 offen sc1
QAF s33,s33,s29
lay_r0:
QAH vmcnt(18)
QAI v168,16,v64
QAM v169,0xffff0000,v64
QAN v[160:161],v[160:161],v[168:169]
QAI v168,16,v65
QAM v169,0xffff0000,v65
QAN v[162:163],v[162:163],v[168:169]
QAI v168,16,v66
QAM v169,0xffff0000,v66
QAN v[164:165],v[164:165],v[168:169]
QAI v168,16,v67
QAM v169,0xffff0000,v67
QAN v[166:167],v[166:167],v[168:169]
QAI v168,16,v68
QAM v169,0xffff0000,v68
QAN v[160:161],v[160:161],v[168:169]
QAI v168,16,v69
QAM v169,0xffff0000,v69
QAN v[162:163],v[162:163],v[168:169]
QAI v168,16,v70
QAM v169,0xffff0000,v70
QAN v[164:165],v[164:165],v[168:169]
QAI v168,16,v71
QAM v169,0xffff0000,v71
QAN v[166:167],v[166:167],v[168:169]
QAI v168,16,v72
QAM v169,0xffff0000,v72
QAN v[160:161],v[160:161],v[168:169]
QAI v168,16,v73
QAM v169,0xffff0000,v73
QAN v[162:163],v[162:163],v[168:169]
QAI v168,16,v74
QAM v169,0xffff0000,v74
QAN v[164:165],v[164:165],v[168:169]
QAI v168,16,v75
QAM v169,0xffff0000,v75
QAN v[166:167],v[166:167],v[168:169]
QAI v168,16,v76
QAM v169,0xffff0000,v76
QAN v[160:161],v[160:161],v[168:169]
QAI v168,16,v77
QAM v169,0xffff0000,v77
QAN v[162:163],v[162:163],v[168:169]
QAI v168,16,v78
QAM v169,0xffff0000,v78
QAN v[164:165],v[164:165],v[168:169]
QAI v168,16,v79
QAM v169,0xffff0000,v79
QAN v[166:167],v[166:167],v[168:169]
QAI v168,16,v80
QAM v169,0xffff0000,v80
QAN v[160:161],v[160:161],v[168:169]
QAI v168,16,v81
QAM v169,0xffff0000,v81
QAN v[162:163],v[162:163],v[168:169]
QAI v168,16,v82
QAM v169,0xffff0000,v82
QAN v[164:165],v[164:165],v[168:169]
QAI v168,16,v83
QAM v169,0xffff0000,v83
QAN v[166:167],v[166:167],v[168:169]
QAI v168,16,v84
QAM v169,0xffff0000,v84
QAN v[160:161],v[160:161],v[168:169]
QAI v168,16,v85
QAM v169,0xffff0000,v85
QAN v[162:163],v[162:163],v[168:169]
QAI v168,16,v86
QAM v169,0xffff0000,v86
QAN v[164:165],v[164:165],v[168:169]
QAI v168,16,v87
QAM v169,0xffff0000,v87
QAN v[166:167],v[166:167],v[168:169]
QAI v168,16,v88
QAM v169,0xffff0000,v88
QAN v[160:161],v[160:161],v[168:169]
QAI v168,16,v89
QAM v169,0xffff0000,v89
QAN v[162:163],v[162:163],v[168:169]
QAI v168,16,v90
QAM v169,0xffff0000,v90
QAN v[164:165],v[164:165],v[168:169]
QAI v168,16,v91
QAM v169,0xffff0000,v91
QAN v[166:167],v[166:167],v[168:169]
QAI v168,16,v92
QAM v169,0xffff0000,v92
QAN v[160:161],v[160:161],v[168:169]
QAI v168,16,v93
QAM v169,0xffff0000,v93
QAN v[162:163],v[162:163],v[168:169]
QAI v168,16,v94
QAM v169,0xffff0000,v94
QAN v[164:165],v[164:165],v[168:169]
QAI v168,16,v95
QAM v169,0xffff0000,v95
QAN v[166:167],v[166:167],v[168:169]
QBO s13,s30,2
QBJ s13,0
s_cbranch_scc1 lay_r1
QAE v168,v160,v161
QAI v170,16,v168
QAM v171,0xffff0000,v168
QAI v172,16,v180
QAM v173,0xffff0000,v180
QAN v[170:171],v[170:171],v[172:173]
QAE v180,v170,v171
QAR v[160:161],0
QAE v168,v162,v163
QAI v170,16,v168
QAM v171,0xffff0000,v168
QAI v172,16,v181
QAM v173,0xffff0000,v181
QAN v[170:171],v[170:171],v[172:173]
QAE v181,v170,v171
QAR v[162:163],0
QAE v168,v164,v165
QAI v170,16,v168
QAM v171,0xffff0000,v168
QAI v172,16,v182
QAM v173,0xffff0000,v182
QAN v[170:171],v[170:171],v[172:173]
QAE v182,v170,v171
QAR v[164:165],0
QAE v168,v166,v167
QAI v170,16,v168
QAM v171,0xffff0000,v168
QAI v172,16,v183
QAM v173,0xffff0000,v183
QAN v[170:171],v[170:171],v[172:173]
QAE v183,v170,v171
QAR v[166:167],0
QAL v[180:183],v1,s[16:19],s33 offen sc1
QAF s33,s33,s29
lay_r1:
QAH vmcnt(9)
QAI v168,16,v96
QAM v169,0xffff0000,v96
QAN v[160:161],v[160:161],v[168:169]
QAI v168,16,v97
QAM v169,0xffff0000,v97
QAN v[162:163],v[162:163],v[168:169]
QAI v168,16,v98
QAM v169,0xffff0000,v98
QAN v[164:165],v[164:165],v[168:169]
QAI v168,16,v99
QAM v169,0xffff0000,v99
QAN v[166:167],v[166:167],v[168:169]
QAI v168,16,v100
QAM v169,0xffff0000,v100
QAN v[160:161],v[160:161],v[168:169]
QAI v168,16,v101
QAM v169,0xffff0000,v101
QAN v[162:163],v[162:163],v[168:169]
QAI v168,16,v102
QAM v169,0xffff0000,v102
QAN v[164:165],v[164:165],v[168:169]
QAI v168,16,v103
QAM v169,0xffff0000,v103
QAN v[166:167],v[166:167],v[168:169]
QAI v168,16,v104
QAM v169,0xffff0000,v104
QAN v[160:161],v[160:161],v[168:169]
QAI v168,16,v105
QAM v169,0xffff0000,v105
QAN v[162:163],v[162:163],v[168:169]
QAI v168,16,v106
QAM v169,0xffff0000,v106
QAN v[164:165],v[164:165],v[168:169]
QAI v168,16,v107
QAM v169,0xffff0000,v107
QAN v[166:167],v[166:167],v[168:169]
QAI v168,16,v108
QAM v169,0xffff0000,v108
QAN v[160:161],v[160:161],v[168:169]
QAI v168,16,v109
QAM v169,0xffff0000,v109
QAN v[162:163],v[162:163],v[168:169]
QAI v168,16,v110
QAM v169,0xffff0000,v110
QAN v[164:165],v[164:165],v[168:169]
QAI v168,16,v111
QAM v169,0xffff0000,v111
QAN v[166:167],v[166:167],v[168:169]
QAI v168,16,v112
QAM v169,0xffff0000,v112
QAN v[160:161],v[160:161],v[168:169]
QAI v168,16,v113
QAM v169,0xffff0000,v113
QAN v[162:163],v[162:163],v[168:169]
QAI v168,16,v114
QAM v169,0xffff0000,v114
QAN v[164:165],v[164:165],v[168:169]
QAI v168,16,v115
QAM v169,0xffff0000,v115
QAN v[166:167],v[166:167],v[168:169]
QAI v168,16,v116
QAM v169,0xffff0000,v116
QAN v[160:161],v[160:161],v[168:169]
QAI v168,16,v117
QAM v169,0xffff0000,v117
QAN v[162:163],v[162:163],v[168:169]
QAI v168,16,v118
QAM v169,0xffff0000,v118
QAN v[164:165],v[164:165],v[168:169]
QAI v168,16,v119
QAM v169,0xffff0000,v119
QAN v[166:167],v[166:167],v[168:169]
QAI v168,16,v120
QAM v169,0xffff0000,v120
QAN v[160:161],v[160:161],v[168:169]
QAI v168,16,v121
QAM v169,0xffff0000,v121
QAN v[162:163],v[162:163],v[168:169]
QAI v168,16,v122
QAM v169,0xffff0000,v122
QAN v[164:165],v[164:165],v[168:169]
QAI v168,16,v123
QAM v169,0xffff0000,v123
QAN v[166:167],v[166:167],v[168:169]
QAI v168,16,v124
QAM v169,0xffff0000,v124
QAN v[160:161],v[160:161],v[168:169]
QAI v168,16,v125
QAM v169,0xffff0000,v125
QAN v[162:163],v[162:163],v[168:169]
QAI v168,16,v126
QAM v169,0xffff0000,v126
QAN v[164:165],v[164:165],v[168:169]
QAI v168,16,v127
QAM v169,0xffff0000,v127
QAN v[166:167],v[166:167],v[168:169]
QBO s13,s30,3
QBJ s13,0
s_cbranch_scc1 lay_r2
QAE v168,v160,v161
QAI v170,16,v168
QAM v171,0xffff0000,v168
QAI v172,16,v184
QAM v173,0xffff0000,v184
QAN v[170:171],v[170:171],v[172:173]
QAE v184,v170,v171
QAR v[160:161],0
QAE v168,v162,v163
QAI v170,16,v168
QAM v171,0xffff0000,v168
QAI v172,16,v185
QAM v173,0xffff0000,v185
QAN v[170:171],v[170:171],v[172:173]
QAE v185,v170,v171
QAR v[162:163],0
QAE v168,v164,v165
QAI v170,16,v168
QAM v171,0xffff0000,v168
QAI v172,16,v186
QAM v173,0xffff0000,v186
QAN v[170:171],v[170:171],v[172:173]
QAE v186,v170,v171
QAR v[164:165],0
QAE v168,v166,v167
QAI v170,16,v168
QAM v171,0xffff0000,v168
QAI v172,16,v187
QAM v173,0xffff0000,v187
QAN v[170:171],v[170:171],v[172:173]
QAE v187,v170,v171
QAR v[166:167],0
QAL v[184:187],v1,s[16:19],s33 offen sc1
QAF s33,s33,s29
lay_r2:
QAH vmcnt(0)
QAI v168,16,v128
QAM v169,0xffff0000,v128
QAN v[160:161],v[160:161],v[168:169]
QAI v168,16,v129
QAM v169,0xffff0000,v129
QAN v[162:163],v[162:163],v[168:169]
QAI v168,16,v130
QAM v169,0xffff0000,v130
QAN v[164:165],v[164:165],v[168:169]
QAI v168,16,v131
QAM v169,0xffff0000,v131
QAN v[166:167],v[166:167],v[168:169]
QAI v168,16,v132
QAM v169,0xffff0000,v132
QAN v[160:161],v[160:161],v[168:169]
QAI v168,16,v133
QAM v169,0xffff0000,v133
QAN v[162:163],v[162:163],v[168:169]
QAI v168,16,v134
QAM v169,0xffff0000,v134
QAN v[164:165],v[164:165],v[168:169]
QAI v168,16,v135
QAM v169,0xffff0000,v135
QAN v[166:167],v[166:167],v[168:169]
QAI v168,16,v136
QAM v169,0xffff0000,v136
QAN v[160:161],v[160:161],v[168:169]
QAI v168,16,v137
QAM v169,0xffff0000,v137
QAN v[162:163],v[162:163],v[168:169]
QAI v168,16,v138
QAM v169,0xffff0000,v138
QAN v[164:165],v[164:165],v[168:169]
QAI v168,16,v139
QAM v169,0xffff0000,v139
QAN v[166:167],v[166:167],v[168:169]
QAI v168,16,v140
QAM v169,0xffff0000,v140
QAN v[160:161],v[160:161],v[168:169]
QAI v168,16,v141
QAM v169,0xffff0000,v141
QAN v[162:163],v[162:163],v[168:169]
QAI v168,16,v142
QAM v169,0xffff0000,v142
QAN v[164:165],v[164:165],v[168:169]
QAI v168,16,v143
QAM v169,0xffff0000,v143
QAN v[166:167],v[166:167],v[168:169]
QAI v168,16,v144
QAM v169,0xffff0000,v144
QAN v[160:161],v[160:161],v[168:169]
QAI v168,16,v145
QAM v169,0xffff0000,v145
QAN v[162:163],v[162:163],v[168:169]
QAI v168,16,v146
QAM v169,0xffff0000,v146
QAN v[164:165],v[164:165],v[168:169]
QAI v168,16,v147
QAM v169,0xffff0000,v147
QAN v[166:167],v[166:167],v[168:169]
QAI v168,16,v148
QAM v169,0xffff0000,v148
QAN v[160:161],v[160:161],v[168:169]
QAI v168,16,v149
QAM v169,0xffff0000,v149
QAN v[162:163],v[162:163],v[168:169]
QAI v168,16,v150
QAM v169,0xffff0000,v150
QAN v[164:165],v[164:165],v[168:169]
QAI v168,16,v151
QAM v169,0xffff0000,v151
QAN v[166:167],v[166:167],v[168:169]
QAI v168,16,v152
QAM v169,0xffff0000,v152
QAN v[160:161],v[160:161],v[168:169]
QAI v168,16,v153
QAM v169,0xffff0000,v153
QAN v[162:163],v[162:163],v[168:169]
QAI v168,16,v154
QAM v169,0xffff0000,v154
QAN v[164:165],v[164:165],v[168:169]
QAI v168,16,v155
QAM v169,0xffff0000,v155
QAN v[166:167],v[166:167],v[168:169]
QAI v168,16,v156
QAM v169,0xffff0000,v156
QAN v[160:161],v[160:161],v[168:169]
QAI v168,16,v157
QAM v169,0xffff0000,v157
QAN v[162:163],v[162:163],v[168:169]
QAI v168,16,v158
QAM v169,0xffff0000,v158
QAN v[164:165],v[164:165],v[168:169]
QAI v168,16,v159
QAM v169,0xffff0000,v159
QAN v[166:167],v[166:167],v[168:169]
QBO s13,s30,4
QBJ s13,0
s_cbranch_scc1 lay_r3
QAE v168,v160,v161
QAI v170,16,v168
QAM v171,0xffff0000,v168
QAI v172,16,v188
QAM v173,0xffff0000,v188
QAN v[170:171],v[170:171],v[172:173]
QAE v188,v170,v171
QAR v[160:161],0
QAE v168,v162,v163
QAI v170,16,v168
QAM v171,0xffff0000,v168
QAI v172,16,v189
QAM v173,0xffff0000,v189
QAN v[170:171],v[170:171],v[172:173]
QAE v189,v170,v171
QAR v[162:163],0
QAE v168,v164,v165
QAI v170,16,v168
QAM v171,0xffff0000,v168
QAI v172,16,v190
QAM v173,0xffff0000,v190
QAN v[170:171],v[170:171],v[172:173]
QAE v190,v170,v171
QAR v[164:165],0
QAE v168,v166,v167
QAI v170,16,v168
QAM v171,0xffff0000,v168
QAI v172,16,v191
QAM v173,0xffff0000,v191
QAN v[170:171],v[170:171],v[172:173]
QAE v191,v170,v171
QAR v[166:167],0
QAL v[188:191],v1,s[16:19],s33 offen sc1
QAF s33,s33,s29
lay_r3:
QAH vmcnt(0)
s_barrier
QAF s13,s73,593920
QAQ v2,1
QBJ s9,0
s_cbranch_scc1 lay_a4
QBY exec,1
buffer_atomic_add v2,off,s[16:19],s13
QBY exec,-1
lay_a4:
QBK s67,16
s_cbranch_scc1 lay_nor2
QBJ s9,0
s_cbranch_scc1 lay_x1_ok
QAT s15,0
lay_x1:
QAF s13,s73,593920
QBR v2,off,s[16:19],s13 sc1
QAH vmcnt(0)
QCA s13,v2
QAS s14,8,s68
s_nop 0
QBK s13,s14
s_cbranch_scc1 lay_x1_ok
s_sleep 2
QAF s15,s15,1
QBN s15,400000
s_cbranch_scc1 lay_x1
lay_x1_ok:
s_barrier
lay_r2l:
QCB s84,s67,2
QAS s13,s66,2
QAF s84,s84,s13
lay_r2go:
QAS s24,s84,15
QAS s14,s9,13
QAF s24,s24,s14
QAF s25,s24,46137344
QAF s26,s25,4096
QAD v[48:51],v1,s[16:19],s25 offen offset:0 sc1
QAD v[52:55],v1,s[16:19],s25 offen offset:1024 sc1
QAD v[56:59],v1,s[16:19],s25 offen offset:2048 sc1
QAD v[60:63],v1,s[16:19],s25 offen offset:3072 sc1
QAD v[64:67],v1,s[16:19],s26 offen offset:0 sc1
QAD v[68:71],v1,s[16:19],s26 offen offset:1024 sc1
QAD v[72:75],v1,s[16:19],s26 offen offset:2048 sc1
QAD v[76:79],v1,s[16:19],s26 offen offset:3072 sc1
QAM v3,31,v0
QAI v5,3,v3
QBF v2,s14,v1
QAM v4,19,v3
QCC v6,v3,2,1
v_lshl_or_b32 v4,v6,3,v4
QCC v6,v3,3,1
v_lshl_or_b32 v4,v6,2,v4
QBW v6,5,v0
QBC v4,v6,5,v4
QAI v4,4,v4
QAS s15,s74,2
QAF s15,s15,s9
QAS s15,s15,6
QAF s15,s15,s84
QAS s15,s15,11
QAF s15,s15,48234496
QAH vmcnt(0)
QAI v112,16,v48
QAM v113,0xffff0000,v48
QAI v114,16,v49
QAM v115,0xffff0000,v49
QAI v116,16,v50
QAM v117,0xffff0000,v50
QAI v118,16,v51
QAM v119,0xffff0000,v51
QAI v120,16,v52
QAM v121,0xffff0000,v52
QAI v122,16,v53
QAM v123,0xffff0000,v53
QAI v124,16,v54
QAM v125,0xffff0000,v54
QAI v126,16,v55
QAM v127,0xffff0000,v55
QAI v128,16,v56
QAM v129,0xffff0000,v56
QAI v130,16,v57
QAM v131,0xffff0000,v57
QAI v132,16,v58
QAM v133,0xffff0000,v58
QAI v134,16,v59
QAM v135,0xffff0000,v59
QAI v136,16,v60
QAM v137,0xffff0000,v60
QAI v138,16,v61
QAM v139,0xffff0000,v61
QAI v140,16,v62
QAM v141,0xffff0000,v62
QAI v142,16,v63
QAM v143,0xffff0000,v63
QAI v144,16,v64
QAM v145,0xffff0000,v64
QAI v146,16,v65
QAM v147,0xffff0000,v65
QAI v148,16,v66
QAM v149,0xffff0000,v66
QAI v150,16,v67
QAM v151,0xffff0000,v67
QAI v152,16,v68
QAM v153,0xffff0000,v68
QAI v154,16,v69
QAM v155,0xffff0000,v69
QAI v156,16,v70
QAM v157,0xffff0000,v70
QAI v158,16,v71
QAM v159,0xffff0000,v71
QAI v160,16,v72
QAM v161,0xffff0000,v72
QAI v162,16,v73
QAM v163,0xffff0000,v73
QAI v164,16,v74
QAM v165,0xffff0000,v74
QAI v166,16,v75
QAM v167,0xffff0000,v75
QAI v168,16,v76
QAM v169,0xffff0000,v76
QAI v170,16,v77
QAM v171,0xffff0000,v77
QAI v172,16,v78
QAM v173,0xffff0000,v78
QAI v174,16,v79
QAM v175,0xffff0000,v79
QAN v[16:17],v[112:113],v[114:115]
QBI v[18:19],v[112:113],v[112:113]
QAP v[18:19],v[114:115],v[114:115],v[18:19]
QAN v[16:17],v[16:17],v[116:117]
QAP v[18:19],v[116:117],v[116:117],v[18:19]
QAN v[16:17],v[16:17],v[118:119]
QAP v[18:19],v[118:119],v[118:119],v[18:19]
QAN v[16:17],v[16:17],v[120:121]
QAP v[18:19],v[120:121],v[120:121],v[18:19]
QAN v[16:17],v[16:17],v[122:123]
QAP v[18:19],v[122:123],v[122:123],v[18:19]
QAN v[16:17],v[16:17],v[124:125]
QAP v[18:19],v[124:125],v[124:125],v[18:19]
QAN v[16:17],v[16:17],v[126:127]
QAP v[18:19],v[126:127],v[126:127],v[18:19]
QAN v[16:17],v[16:17],v[128:129]
QAP v[18:19],v[128:129],v[128:129],v[18:19]
QAN v[16:17],v[16:17],v[130:131]
QAP v[18:19],v[130:131],v[130:131],v[18:19]
QAN v[16:17],v[16:17],v[132:133]
QAP v[18:19],v[132:133],v[132:133],v[18:19]
QAN v[16:17],v[16:17],v[134:135]
QAP v[18:19],v[134:135],v[134:135],v[18:19]
QAN v[16:17],v[16:17],v[136:137]
QAP v[18:19],v[136:137],v[136:137],v[18:19]
QAN v[16:17],v[16:17],v[138:139]
QAP v[18:19],v[138:139],v[138:139],v[18:19]
QAN v[16:17],v[16:17],v[140:141]
QAP v[18:19],v[140:141],v[140:141],v[18:19]
QAN v[16:17],v[16:17],v[142:143]
QAP v[18:19],v[142:143],v[142:143],v[18:19]
QAN v[16:17],v[16:17],v[144:145]
QAP v[18:19],v[144:145],v[144:145],v[18:19]
QAN v[16:17],v[16:17],v[146:147]
QAP v[18:19],v[146:147],v[146:147],v[18:19]
QAN v[16:17],v[16:17],v[148:149]
QAP v[18:19],v[148:149],v[148:149],v[18:19]
QAN v[16:17],v[16:17],v[150:151]
QAP v[18:19],v[150:151],v[150:151],v[18:19]
QAN v[16:17],v[16:17],v[152:153]
QAP v[18:19],v[152:153],v[152:153],v[18:19]
QAN v[16:17],v[16:17],v[154:155]
QAP v[18:19],v[154:155],v[154:155],v[18:19]
QAN v[16:17],v[16:17],v[156:157]
QAP v[18:19],v[156:157],v[156:157],v[18:19]
QAN v[16:17],v[16:17],v[158:159]
QAP v[18:19],v[158:159],v[158:159],v[18:19]
QAN v[16:17],v[16:17],v[160:161]
QAP v[18:19],v[160:161],v[160:161],v[18:19]
QAN v[16:17],v[16:17],v[162:163]
QAP v[18:19],v[162:163],v[162:163],v[18:19]
QAN v[16:17],v[16:17],v[164:165]
QAP v[18:19],v[164:165],v[164:165],v[18:19]
QAN v[16:17],v[16:17],v[166:167]
QAP v[18:19],v[166:167],v[166:167],v[18:19]
QAN v[16:17],v[16:17],v[168:169]
QAP v[18:19],v[168:169],v[168:169],v[18:19]
QAN v[16:17],v[16:17],v[170:171]
QAP v[18:19],v[170:171],v[170:171],v[18:19]
QAN v[16:17],v[16:17],v[172:173]
QAP v[18:19],v[172:173],v[172:173],v[18:19]
QAN v[16:17],v[16:17],v[174:175]
QAP v[18:19],v[174:175],v[174:175],v[18:19]
QAU v16,v16,v17
QAU v17,v18,v19
QAQ v18,v16
QAQ v19,v17
QAS s13,s9,8
QBF v20,s13,v5
QCH v16,v18
QCH v17,v19
QAN v[16:17],v[16:17],v[18:19]
QCG v20,v[16:17] offset:32768
QAH lgkmcnt(0)
s_barrier
ds_read_b64 v[16:17],v5 offset:32768
ds_read_b64 v[18:19],v5 offset:33024
ds_read_b64 v[20:21],v5 offset:33280
ds_read_b64 v[22:23],v5 offset:33536
QAH lgkmcnt(0)
QAN v[16:17],v[16:17],v[18:19]
QAN v[16:17],v[16:17],v[20:21]
QAN v[16:17],v[16:17],v[22:23]
QAW v16,0x3b000000,v16
QAW v17,0x3b000000,v17
v_fma_f32 v17,-v16,v16,v17
v_max_f32 v17,0,v17
QAE v18,v17,v16
QAM v16,0xffff0000,v18
QAI v17,16,v18
QAU v17,0x3727c5ac,v17
QAE v17,v17,v17
QAM v17,0xffff0000,v17
v_sqrt_f32 v17,v17
s_nop 0
QAE v17,v17,v17
QAM v17,0xffff0000,v17
v_rcp_f32 v18,v17
s_nop 0
QAW v20,-v16,v18
QAP v[22:23],v[112:113],v[18:19],v[20:21] op_sel_hi:[1,0,0]
s_nop 0
QAE v80,v22,v23
QAP v[24:25],v[114:115],v[18:19],v[20:21] op_sel_hi:[1,0,0]
s_nop 0
QAE v81,v24,v25
QAP v[22:23],v[116:117],v[18:19],v[20:21] op_sel_hi:[1,0,0]
s_nop 0
QAE v82,v22,v23
QAP v[24:25],v[118:119],v[18:19],v[20:21] op_sel_hi:[1,0,0]
s_nop 0
QAE v83,v24,v25
QAP v[22:23],v[120:121],v[18:19],v[20:21] op_sel_hi:[1,0,0]
s_nop 0
QAE v84,v22,v23
QAP v[24:25],v[122:123],v[18:19],v[20:21] op_sel_hi:[1,0,0]
s_nop 0
QAE v85,v24,v25
QAP v[22:23],v[124:125],v[18:19],v[20:21] op_sel_hi:[1,0,0]
s_nop 0
QAE v86,v22,v23
QAP v[24:25],v[126:127],v[18:19],v[20:21] op_sel_hi:[1,0,0]
s_nop 0
QAE v87,v24,v25
QAP v[22:23],v[128:129],v[18:19],v[20:21] op_sel_hi:[1,0,0]
s_nop 0
QAE v88,v22,v23
QAP v[24:25],v[130:131],v[18:19],v[20:21] op_sel_hi:[1,0,0]
s_nop 0
QAE v89,v24,v25
QAP v[22:23],v[132:133],v[18:19],v[20:21] op_sel_hi:[1,0,0]
s_nop 0
QAE v90,v22,v23
QAP v[24:25],v[134:135],v[18:19],v[20:21] op_sel_hi:[1,0,0]
s_nop 0
QAE v91,v24,v25
QAP v[22:23],v[136:137],v[18:19],v[20:21] op_sel_hi:[1,0,0]
s_nop 0
QAE v92,v22,v23
QAP v[24:25],v[138:139],v[18:19],v[20:21] op_sel_hi:[1,0,0]
s_nop 0
QAE v93,v24,v25
QAP v[22:23],v[140:141],v[18:19],v[20:21] op_sel_hi:[1,0,0]
s_nop 0
QAE v94,v22,v23
QAP v[24:25],v[142:143],v[18:19],v[20:21] op_sel_hi:[1,0,0]
s_nop 0
QAE v95,v24,v25
QAP v[22:23],v[144:145],v[18:19],v[20:21] op_sel_hi:[1,0,0]
s_nop 0
QAE v96,v22,v23
QAP v[24:25],v[146:147],v[18:19],v[20:21] op_sel_hi:[1,0,0]
s_nop 0
QAE v97,v24,v25
QAP v[22:23],v[148:149],v[18:19],v[20:21] op_sel_hi:[1,0,0]
s_nop 0
QAE v98,v22,v23
QAP v[24:25],v[150:151],v[18:19],v[20:21] op_sel_hi:[1,0,0]
s_nop 0
QAE v99,v24,v25
QAP v[22:23],v[152:153],v[18:19],v[20:21] op_sel_hi:[1,0,0]
s_nop 0
QAE v100,v22,v23
QAP v[24:25],v[154:155],v[18:19],v[20:21] op_sel_hi:[1,0,0]
s_nop 0
QAE v101,v24,v25
QAP v[22:23],v[156:157],v[18:19],v[20:21] op_sel_hi:[1,0,0]
s_nop 0
QAE v102,v22,v23
QAP v[24:25],v[158:159],v[18:19],v[20:21] op_sel_hi:[1,0,0]
s_nop 0
QAE v103,v24,v25
QAP v[22:23],v[160:161],v[18:19],v[20:21] op_sel_hi:[1,0,0]
s_nop 0
QAE v104,v22,v23
QAP v[24:25],v[162:163],v[18:19],v[20:21] op_sel_hi:[1,0,0]
s_nop 0
QAE v105,v24,v25
QAP v[22:23],v[164:165],v[18:19],v[20:21] op_sel_hi:[1,0,0]
s_nop 0
QAE v106,v22,v23
QAP v[24:25],v[166:167],v[18:19],v[20:21] op_sel_hi:[1,0,0]
s_nop 0
QAE v107,v24,v25
QAP v[22:23],v[168:169],v[18:19],v[20:21] op_sel_hi:[1,0,0]
s_nop 0
QAE v108,v22,v23
QAP v[24:25],v[170:171],v[18:19],v[20:21] op_sel_hi:[1,0,0]
s_nop 0
QAE v109,v24,v25
QAP v[22:23],v[172:173],v[18:19],v[20:21] op_sel_hi:[1,0,0]
s_nop 0
QAE v110,v22,v23
QAP v[24:25],v[174:175],v[18:19],v[20:21] op_sel_hi:[1,0,0]
s_nop 0
QAE v111,v24,v25
QAY v2,v[80:83] offset:0
QAY v2,v[84:87] offset:1024
QAY v2,v[88:91] offset:2048
QAY v2,v[92:95] offset:3072
QAY v2,v[96:99] offset:4096
QAY v2,v[100:103] offset:5120
QAY v2,v[104:107] offset:6144
QAY v2,v[108:111] offset:7168
QAH lgkmcnt(0)
s_barrier
QAG v[112:115],v4 offset:0
QAG v[116:119],v4 offset:1024
QAG v[120:123],v4 offset:2048
QAG v[124:127],v4 offset:3072
QAG v[128:131],v4 offset:4096
QAG v[132:135],v4 offset:5120
QAG v[136:139],v4 offset:6144
QAG v[140:143],v4 offset:7168
QAG v[144:147],v4 offset:8192
QAG v[148:151],v4 offset:9216
QAG v[152:155],v4 offset:10240
QAG v[156:159],v4 offset:11264
QAH lgkmcnt(11)
QAB v[16:31],v[112:115],a[0:3],0
QAG v[160:163],v4 offset:12288
QAH lgkmcnt(11)
QAB v[16:31],v[116:119],a[4:7],v[16:31]
QAG v[164:167],v4 offset:13312
QAH lgkmcnt(11)
QAB v[16:31],v[120:123],a[8:11],v[16:31]
QAG v[168:171],v4 offset:14336
QAH lgkmcnt(11)
QAB v[16:31],v[124:127],a[12:15],v[16:31]
QAG v[172:175],v4 offset:15360
QAH lgkmcnt(11)
QAB v[16:31],v[128:131],a[16:19],v[16:31]
QAG v[112:115],v4 offset:16384
QAH lgkmcnt(11)
QAB v[16:31],v[132:135],a[20:23],v[16:31]
QAG v[116:119],v4 offset:17408
QAH lgkmcnt(11)
QAB v[16:31],v[136:139],a[24:27],v[16:31]
QAG v[120:123],v4 offset:18432
QAH lgkmcnt(11)
QAB v[16:31],v[140:143],a[28:31],v[16:31]
QAG v[124:127],v4 offset:19456
QAH lgkmcnt(11)
QAB v[16:31],v[144:147],a[32:35],v[16:31]
QAG v[128:131],v4 offset:20480
QAH lgkmcnt(11)
QAB v[16:31],v[148:151],a[36:39],v[16:31]
QAG v[132:135],v4 offset:21504
QAH lgkmcnt(11)
QAB v[16:31],v[152:155],a[40:43],v[16:31]
QAG v[136:139],v4 offset:22528
QAH lgkmcnt(11)
QAB v[16:31],v[156:159],a[44:47],v[16:31]
QAG v[140:143],v4 offset:23552
QAH lgkmcnt(11)
QAB v[16:31],v[160:163],a[48:51],v[16:31]
QAG v[144:147],v4 offset:24576
QAH lgkmcnt(11)
QAB v[16:31],v[164:167],a[52:55],v[16:31]
QAG v[148:151],v4 offset:25600
QAH lgkmcnt(11)
QAB v[16:31],v[168:171],a[56:59],v[16:31]
QAG v[152:155],v4 offset:26624
QAH lgkmcnt(11)
QAB v[16:31],v[172:175],a[60:63],v[16:31]
QAG v[156:159],v4 offset:27648
QAH lgkmcnt(11)
QAB v[16:31],v[112:115],a[64:67],v[16:31]
QAG v[160:163],v4 offset:28672
QAH lgkmcnt(11)
QAB v[16:31],v[116:119],a[68:71],v[16:31]
QAG v[164:167],v4 offset:29696
QAH lgkmcnt(11)
QAB v[16:31],v[120:123],a[72:75],v[16:31]
QAG v[168:171],v4 offset:30720
QAH lgkmcnt(11)
QAB v[16:31],v[124:127],a[76:79],v[16:31]
QAG v[172:175],v4 offset:31744
QAH lgkmcnt(11)
QAB v[16:31],v[128:131],a[80:83],v[16:31]
QAH lgkmcnt(10)
QAB v[16:31],v[132:135],a[84:87],v[16:31]
QAH lgkmcnt(9)
QAB v[16:31],v[136:139],a[88:91],v[16:31]
QAH lgkmcnt(8)
QAB v[16:31],v[140:143],a[92:95],v[16:31]
QAH lgkmcnt(7)
QAB v[16:31],v[144:147],a[96:99],v[16:31]
QAH lgkmcnt(6)
QAB v[16:31],v[148:151],a[100:103],v[16:31]
QAH lgkmcnt(5)
QAB v[16:31],v[152:155],a[104:107],v[16:31]
QAH lgkmcnt(4)
QAB v[16:31],v[156:159],a[108:111],v[16:31]
QAH lgkmcnt(3)
QAB v[16:31],v[160:163],a[112:115],v[16:31]
QAH lgkmcnt(2)
QAB v[16:31],v[164:167],a[116:119],v[16:31]
QAH lgkmcnt(1)
QAB v[16:31],v[168:171],a[120:123],v[16:31]
QAH lgkmcnt(0)
QAB v[16:31],v[172:175],a[124:127],v[16:31]
QAS s13,s9,11
QAF s13,s13,36864
QCC v7,v3,1,2
QBH v7,v7,v6
QAI v7,4,v7
QBC v7,v3,6,v7
QBF v7,s13,v7
QBH v8,32,v7
QCC v9,v0,3,2
QAI v9,4,v9
QBH v9,v9,v1
QBF v9,s13,v9
QAE v32,v16,v17
QAE v33,v18,v19
QAE v34,v20,v21
QAE v35,v22,v23
QAE v36,v24,v25
QAE v37,v26,v27
QAE v38,v28,v29
QAE v39,v30,v31
QAY v7,v[32:35]
QAY v8,v[36:39]
QAH lgkmcnt(0)
QAG v[40:43],v9
QAG v[44:47],v9 offset:1024
QAH lgkmcnt(1)
QAL v[40:43],v1,s[16:19],s15 offen offset:0 sc1
QAH lgkmcnt(0)
QAL v[44:47],v1,s[16:19],s15 offen offset:1024 sc1
QAH vmcnt(0)
s_barrier
QCB s13,s84,2
s_sub_u32 s14,s84,42
QBK s84,56
QBL s13,s14,s13
QAS s13,s13,7
QAF s13,s13,s56
QAF s13,s13,598016
QAQ v2,1
QBJ s9,0
s_cbranch_scc1 lay_a5
QBY exec,1
buffer_atomic_add v2,off,s[16:19],s13
QBY exec,-1
lay_a5:
QAS s13,8,s68
QAF s67,s67,s13
QBN s67,16
s_cbranch_scc1 lay_r2l
lay_nor2:
QBK s60,192
s_cbranch_scc1 lay_colp
QBK s60,128
s_cbranch_scc1 lay_col
QBK s60,64
s_cbranch_scc1 lay_inv
QCB s84,s60,4
QAS s73,s84,8
QAF s73,s73,s56
QAF s84,s84,56
QBO s69,s60,7
s_bfe_u32 s70,s60,0x10003
QAS s72,s69,10
QAF s72,s72,s56
QAT s24,s46
QAT s25,s47
QAT s26,4194304
QAT s27,0x20000
QAS s29,s9,15
QAF s29,s29,32768
QAS s32,s69,19
QAS s13,s70,9
QAF s32,s32,s13
QAS s13,s9,7
QAF s32,s32,s13
QBW v5,3,v0
QAM v6,7,v0
QCC v7,v0,4,1
QAI v7,2,v7
QBH v6,v6,v7
QAI v6,4,v6
QBC v2,v5,10,v6
QCC v5,v0,2,2
QBW v15,5,v0
QBC v6,v15,2,v5
QAI v6,7,v6
QCC v7,v0,4,1
QBC v6,v7,5,v6
QAM v7,1,v0
QBC v6,v7,4,v6
QCC v7,v0,1,1
QBC v6,v7,3,v6
QBF v6,s29,v6
QBW v5,1,v5
QBC v3,v5,6,v6
QBH v5,1,v5
QBC v4,v5,6,v6
QAT s31,0
QAT s30,s29
tl_wl0:
QAF m0,s30,0
QAF s13,s32,0
QAD v2,s[24:27],s13 offen lds
QAF m0,s30,1024
QAF s13,s32,8192
QAD v2,s[24:27],s13 offen lds
QAF m0,s30,2048
QAF s13,s32,16384
QAD v2,s[24:27],s13 offen lds
QAF m0,s30,3072
QAF s13,s32,24576
QAD v2,s[24:27],s13 offen lds
QAF s30,s30,4096
QAF s32,s32,32768
QAF s31,s31,1
QBN s31,8
s_cbranch_scc1 tl_wl0
QAH vmcnt(0)
QAA a[0:1],v3 offset:0
QAA a[2:3],v3 offset:1024
QAA a[4:5],v4 offset:0
QAA a[6:7],v4 offset:1024
QAA a[8:9],v3 offset:2048
QAA a[10:11],v3 offset:3072
QAA a[12:13],v4 offset:2048
QAA a[14:15],v4 offset:3072
QAA a[16:17],v3 offset:4096
QAA a[18:19],v3 offset:5120
QAA a[20:21],v4 offset:4096
QAA a[22:23],v4 offset:5120
QAA a[24:25],v3 offset:6144
QAA a[26:27],v3 offset:7168
QAA a[28:29],v4 offset:6144
QAA a[30:31],v4 offset:7168
QAA a[32:33],v3 offset:8192
QAA a[34:35],v3 offset:9216
QAA a[36:37],v4 offset:8192
QAA a[38:39],v4 offset:9216
QAA a[40:41],v3 offset:10240
QAA a[42:43],v3 offset:11264
QAA a[44:45],v4 offset:10240
QAA a[46:47],v4 offset:11264
QAA a[48:49],v3 offset:12288
QAA a[50:51],v3 offset:13312
QAA a[52:53],v4 offset:12288
QAA a[54:55],v4 offset:13312
QAA a[56:57],v3 offset:14336
QAA a[58:59],v3 offset:15360
QAA a[60:61],v4 offset:14336
QAA a[62:63],v4 offset:15360
QAA a[64:65],v3 offset:16384
QAA a[66:67],v3 offset:17408
QAA a[68:69],v4 offset:16384
QAA a[70:71],v4 offset:17408
QAA a[72:73],v3 offset:18432
QAA a[74:75],v3 offset:19456
QAA a[76:77],v4 offset:18432
QAA a[78:79],v4 offset:19456
QAA a[80:81],v3 offset:20480
QAA a[82:83],v3 offset:21504
QAA a[84:85],v4 offset:20480
QAA a[86:87],v4 offset:21504
QAA a[88:89],v3 offset:22528
QAA a[90:91],v3 offset:23552
QAA a[92:93],v4 offset:22528
QAA a[94:95],v4 offset:23552
QAA a[96:97],v3 offset:24576
QAA a[98:99],v3 offset:25600
QAA a[100:101],v4 offset:24576
QAA a[102:103],v4 offset:25600
QAA a[104:105],v3 offset:26624
QAA a[106:107],v3 offset:27648
QAA a[108:109],v4 offset:26624
QAA a[110:111],v4 offset:27648
QAA a[112:113],v3 offset:28672
QAA a[114:115],v3 offset:29696
QAA a[116:117],v4 offset:28672
QAA a[118:119],v4 offset:29696
QAA a[120:121],v3 offset:30720
QAA a[122:123],v3 offset:31744
QAA a[124:125],v4 offset:30720
QAA a[126:127],v4 offset:31744
QAH lgkmcnt(0)
QAT s31,0
QAT s30,s29
tl_wl1:
QAF m0,s30,0
QAF s13,s32,0
QAD v2,s[24:27],s13 offen lds
QAF m0,s30,1024
QAF s13,s32,8192
QAD v2,s[24:27],s13 offen lds
QAF m0,s30,2048
QAF s13,s32,16384
QAD v2,s[24:27],s13 offen lds
QAF m0,s30,3072
QAF s13,s32,24576
QAD v2,s[24:27],s13 offen lds
QAF s30,s30,4096
QAF s32,s32,32768
QAF s31,s31,1
QBN s31,8
s_cbranch_scc1 tl_wl1
QAH vmcnt(0)
QAA a[128:129],v3 offset:0
QAA a[130:131],v3 offset:1024
QAA a[132:133],v4 offset:0
QAA a[134:135],v4 offset:1024
QAA a[136:137],v3 offset:2048
QAA a[138:139],v3 offset:3072
QAA a[140:141],v4 offset:2048
QAA a[142:143],v4 offset:3072
QAA a[144:145],v3 offset:4096
QAA a[146:147],v3 offset:5120
QAA a[148:149],v4 offset:4096
QAA a[150:151],v4 offset:5120
QAA a[152:153],v3 offset:6144
QAA a[154:155],v3 offset:7168
QAA a[156:157],v4 offset:6144
QAA a[158:159],v4 offset:7168
QAA a[160:161],v3 offset:8192
QAA a[162:163],v3 offset:9216
QAA a[164:165],v4 offset:8192
QAA a[166:167],v4 offset:9216
QAA a[168:169],v3 offset:10240
QAA a[170:171],v3 offset:11264
QAA a[172:173],v4 offset:10240
QAA a[174:175],v4 offset:11264
QAA a[176:177],v3 offset:12288
QAA a[178:179],v3 offset:13312
QAA a[180:181],v4 offset:12288
QAA a[182:183],v4 offset:13312
QAA a[184:185],v3 offset:14336
QAA a[186:187],v3 offset:15360
QAA a[188:189],v4 offset:14336
QAA a[190:191],v4 offset:15360
QAA a[192:193],v3 offset:16384
QAA a[194:195],v3 offset:17408
QAA a[196:197],v4 offset:16384
QAA a[198:199],v4 offset:17408
QAA a[200:201],v3 offset:18432
QAA a[202:203],v3 offset:19456
QAA a[204:205],v4 offset:18432
QAA a[206:207],v4 offset:19456
QAA a[208:209],v3 offset:20480
QAA a[210:211],v3 offset:21504
QAA a[212:213],v4 offset:20480
QAA a[214:215],v4 offset:21504
QAA a[216:217],v3 offset:22528
QAA a[218:219],v3 offset:23552
QAA a[220:221],v4 offset:22528
QAA a[222:223],v4 offset:23552
QAA a[224:225],v3 offset:24576
QAA a[226:227],v3 offset:25600
QAA a[228:229],v4 offset:24576
QAA a[230:231],v4 offset:25600
QAA a[232:233],v3 offset:26624
QAA a[234:235],v3 offset:27648
QAA a[236:237],v4 offset:26624
QAA a[238:239],v4 offset:27648
QAA a[240:241],v3 offset:28672
QAA a[242:243],v3 offset:29696
QAA a[244:245],v4 offset:28672
QAA a[246:247],v4 offset:29696
QAA a[248:249],v3 offset:30720
QAA a[250:251],v3 offset:31744
QAA a[252:253],v4 offset:30720
QAA a[254:255],v4 offset:31744
QAH lgkmcnt(0)
QBF v13,s29,v1
QCC v16,v0,1,2
QAI v16,2,v16
QAM v17,1,v0
QBF v16,v16,v17
QBC v16,v15,4,v16
QAI v16,4,v16
QAF s13,s29,16384
QBF v11,s13,v16
QAM v16,15,v0
v_or_b32 v16,2,v16
QBC v16,v15,5,v16
QAI v16,4,v16
QCC v17,v0,1,1
QBH v17,1,v17
QBC v16,v17,3,v16
QCC v17,v0,4,1
QBC v16,v17,2,v16
QBF v12,s13,v16
QAM v16,31,v0
QAI v15,2,v15
v_sub_u32 v0,v16,v15
QAS s36,s69,2
QAF s36,s36,s9
QAS s36,s36,6
QAF s33,s36,s84
QAS s33,s33,13
QAF s33,s33,4194304
s_sub_u32 s37,119,s84
QAF s37,s37,s36
QAS s37,s37,13
QAF s37,s37,4194304
QAT s35,0x3e0293ee
QBJ s9,0
s_cbranch_scc1 lay_tk_ok
QAT s15,0
lay_tk:
QAI v14,4,v1
QAF s13,s72,565312
QBY exec,15
buffer_load_dwordx2 v[16:17],v14,s[16:19],s13 offen sc1
QBY exec,-1
QAH vmcnt(0)
v_min_u32 v15,v16,v17
v_cmp_le_u32 vcc,5,v15
s_nop 1
QBO s13,vcc_lo,15
QBS s13,15
s_cbranch_scc1 lay_tk_ok
s_sleep 8
QAF s15,s15,1
QBN s15,400000
s_cbranch_scc1 lay_tk
lay_tk_ok:
s_barrier
QAF s13,s33,0
QAD v[32:35],v1,s[16:19],s13 offen offset:0 sc1
QAD v[36:39],v1,s[16:19],s13 offen offset:1024 sc1
QAD v[40:43],v1,s[16:19],s13 offen offset:2048 sc1
QAD v[44:47],v1,s[16:19],s13 offen offset:3072 sc1
QAF s13,s33,4096
QAD v[48:51],v1,s[16:19],s13 offen offset:0 sc1
QAD v[52:55],v1,s[16:19],s13 offen offset:1024 sc1
QAD v[56:59],v1,s[16:19],s13 offen offset:2048 sc1
QAD v[60:63],v1,s[16:19],s13 offen offset:3072 sc1
QAF s13,s33,130023424
QAD v[64:67],v1,s[16:19],s13 offen offset:0 sc1
QAD v[68:71],v1,s[16:19],s13 offen offset:1024 sc1
QAD v[72:75],v1,s[16:19],s13 offen offset:2048 sc1
QAD v[76:79],v1,s[16:19],s13 offen offset:3072 sc1
QAF s13,s33,130027520
QAD v[80:83],v1,s[16:19],s13 offen offset:0 sc1
QAD v[84:87],v1,s[16:19],s13 offen offset:1024 sc1
QAD v[88:91],v1,s[16:19],s13 offen offset:2048 sc1
QAD v[92:95],v1,s[16:19],s13 offen offset:3072 sc1
QAF s13,s33,16777216
QAD v[128:131],v1,s[16:19],s13 offen offset:0 sc1
QAD v[132:135],v1,s[16:19],s13 offen offset:1024 sc1
QAD v[136:139],v1,s[16:19],s13 offen offset:2048 sc1
QAD v[140:143],v1,s[16:19],s13 offen offset:3072 sc1
QAF s13,s33,16781312
QAD v[144:147],v1,s[16:19],s13 offen offset:0 sc1
QAD v[148:151],v1,s[16:19],s13 offen offset:1024 sc1
QAD v[152:155],v1,s[16:19],s13 offen offset:2048 sc1
QAD v[156:159],v1,s[16:19],s13 offen offset:3072 sc1
QAF m0,s29,0
QAF s13,s37,0
QAD v1,s[16:19],s13 offen offset:0 sc1 lds
QAD v1,s[16:19],s13 offen offset:1024 sc1 lds
QAD v1,s[16:19],s13 offen offset:2048 sc1 lds
QAD v1,s[16:19],s13 offen offset:3072 sc1 lds
QAF m0,s29,4096
QAF s13,s37,4096
QAD v1,s[16:19],s13 offen offset:0 sc1 lds
QAD v1,s[16:19],s13 offen offset:1024 sc1 lds
QAD v1,s[16:19],s13 offen offset:2048 sc1 lds
QAD v1,s[16:19],s13 offen offset:3072 sc1 lds
QAF m0,s29,8192
QAF s13,s37,130023424
QAD v1,s[16:19],s13 offen offset:0 sc1 lds
QAD v1,s[16:19],s13 offen offset:1024 sc1 lds
QAD v1,s[16:19],s13 offen offset:2048 sc1 lds
QAD v1,s[16:19],s13 offen offset:3072 sc1 lds
QAF m0,s29,12288
QAF s13,s37,130027520
QAD v1,s[16:19],s13 offen offset:0 sc1 lds
QAD v1,s[16:19],s13 offen offset:1024 sc1 lds
QAD v1,s[16:19],s13 offen offset:2048 sc1 lds
QAD v1,s[16:19],s13 offen offset:3072 sc1 lds
QAF m0,s29,20480
QAF s13,s37,16777216
QAD v1,s[16:19],s13 offen offset:0 sc1 lds
QAD v1,s[16:19],s13 offen offset:1024 sc1 lds
QAD v1,s[16:19],s13 offen offset:2048 sc1 lds
QAD v1,s[16:19],s13 offen offset:3072 sc1 lds
QAF m0,s29,24576
QAF s13,s37,16781312
QAD v1,s[16:19],s13 offen offset:0 sc1 lds
QAD v1,s[16:19],s13 offen offset:1024 sc1 lds
QAD v1,s[16:19],s13 offen offset:2048 sc1 lds
QAD v1,s[16:19],s13 offen offset:3072 sc1 lds
s_branch tl_go
tl_again:
QAG v[32:35],v13 offset:0
QAG v[36:39],v13 offset:1024
QAG v[40:43],v13 offset:2048
QAG v[44:47],v13 offset:3072
QAG v[48:51],v13 offset:4096
QAG v[52:55],v13 offset:5120
QAG v[56:59],v13 offset:6144
QAG v[60:63],v13 offset:7168
QAG v[64:67],v13 offset:8192
QAG v[68:71],v13 offset:9216
QAG v[72:75],v13 offset:10240
QAG v[76:79],v13 offset:11264
QAG v[80:83],v13 offset:12288
QAG v[84:87],v13 offset:13312
QAG v[88:91],v13 offset:14336
QAG v[92:95],v13 offset:15360
QAG v[128:131],v13 offset:20480
QAG v[132:135],v13 offset:21504
QAG v[136:139],v13 offset:22528
QAG v[140:143],v13 offset:23552
QAG v[144:147],v13 offset:24576
QAG v[148:151],v13 offset:25600
QAG v[152:155],v13 offset:26624
QAG v[156:159],v13 offset:27648
tl_go:
QAF s34,s36,s84
QAS s34,s34,12
QAF s34,s34,37748736
QAQ v15,0xf149f2ca
v_cmp_le_i32 vcc,0,v0
v_cmp_le_i32 s[10:11],1,v0
s_nop 0
QAX v16,v15,0,vcc
QAX v17,v15,0,s[10:11]
v_cmp_le_i32 vcc,2,v0
v_cmp_le_i32 s[10:11],3,v0
s_nop 0
QAX v18,v15,0,vcc
QAX v19,v15,0,s[10:11]
v_cmp_le_i32 vcc,8,v0
v_cmp_le_i32 s[10:11],9,v0
s_nop 0
QAX v20,v15,0,vcc
QAX v21,v15,0,s[10:11]
v_cmp_le_i32 vcc,10,v0
v_cmp_le_i32 s[10:11],11,v0
s_nop 0
QAX v22,v15,0,vcc
QAX v23,v15,0,s[10:11]
v_cmp_le_i32 vcc,16,v0
v_cmp_le_i32 s[10:11],17,v0
s_nop 0
QAX v24,v15,0,vcc
QAX v25,v15,0,s[10:11]
v_cmp_le_i32 vcc,18,v0
v_cmp_le_i32 s[10:11],19,v0
s_nop 0
QAX v26,v15,0,vcc
QAX v27,v15,0,s[10:11]
v_cmp_le_i32 vcc,24,v0
v_cmp_le_i32 s[10:11],25,v0
s_nop 0
QAX v28,v15,0,vcc
QAX v29,v15,0,s[10:11]
v_cmp_le_i32 vcc,26,v0
v_cmp_le_i32 s[10:11],27,v0
s_nop 0
QAX v30,v15,0,vcc
QAX v31,v15,0,s[10:11]
QAH vmcnt(0) lgkmcnt(0)
s_nop 0
QAB v[96:111],v[32:35],v[64:67],v[16:31]
QAB v[96:111],v[36:39],v[68:71],v[96:111]
QAB v[96:111],v[40:43],v[72:75],v[96:111]
QAB v[96:111],v[44:47],v[76:79],v[96:111]
QAB v[96:111],v[48:51],v[80:83],v[96:111]
QAB v[96:111],v[52:55],v[84:87],v[96:111]
QAB v[96:111],v[56:59],v[88:91],v[96:111]
QAB v[96:111],v[60:63],v[92:95],v[96:111]
QAS s28,s69,21
QAS s13,s84,15
QAF s28,s28,s13
QAS s13,s70,14
QAF s28,s28,s13
QAS s13,s9,12
QAF s28,s28,s13
QAF s28,s28,67108864
QAS s13,s9,13
QBF v5,s13,v1
QBF v6,1024,v12
QBF v7,2048,v12
QBF v8,3072,v12
QBJ s9,0
s_cbranch_scc1 lay_pc2_ok
QAT s15,0
lay_pc2:
QAF s13,s56,557056
QBR v15,off,s[16:19],s13 sc1
QAH vmcnt(0)
QCA s13,v15
s_sub_u32 s14,s84,2
s_nop 0
s_cmp_ge_i32 s13,s14
s_cbranch_scc1 lay_pc2_ok
s_sleep 40
QAF s15,s15,1
QBN s15,400000
s_cbranch_scc1 lay_pc2
lay_pc2_ok:
QBJ s9,0
s_cbranch_scc1 lay_tp_ok
QAT s15,0
lay_tp:
QAI v14,4,v1
QAF s13,s72,557056
QBY exec,15
QBR v15,v14,s[16:19],s13 offen sc1
QBY exec,-1
QAH vmcnt(0)
v_cmp_lt_u32 vcc,s84,v15
s_nop 1
QBO s13,vcc_lo,15
QBS s13,15
s_cbranch_scc1 lay_tp_ok
s_sleep 2
QAF s15,s15,1
QBN s15,400000
s_cbranch_scc1 lay_tp
lay_tp_ok:
s_barrier
QAF m0,s29,16384
QAF s13,s34,0
QAD v1,s[16:19],s13 offen sc1 lds
QAF m0,s29,17408
QAF s13,s34,1024
QAD v1,s[16:19],s13 offen sc1 lds
QAF m0,s29,18432
QAF s13,s34,2048
QAD v1,s[16:19],s13 offen sc1 lds
QAF m0,s29,19456
QAF s13,s34,3072
QAD v1,s[16:19],s13 offen sc1 lds
QAQ v24,0
QAQ v25,0
QAH vmcnt(0)
QAG v[32:35],v11 offset:0
QAG v[36:39],v11 offset:512
QAG v[40:43],v11 offset:1024
QAG v[44:47],v11 offset:1536
QAG v[48:51],v11 offset:2048
QAG v[52:55],v11 offset:2560
QAG v[56:59],v11 offset:3072
QAG v[60:63],v11 offset:3584
ds_read2_b32 v[16:17],v12 offset0:0 offset1:64
ds_read2_b32 v[18:19],v6 offset0:0 offset1:64
ds_read2_b32 v[20:21],v7 offset0:0 offset1:64
ds_read2_b32 v[22:23],v8 offset0:0 offset1:64
QAH lgkmcnt(11)
QAB v[112:127],v[32:35],v[64:67],0
QAH lgkmcnt(10)
QAB v[112:127],v[36:39],v[68:71],v[112:127]
QAH lgkmcnt(9)
QAB v[112:127],v[40:43],v[72:75],v[112:127]
QAH lgkmcnt(8)
QAB v[112:127],v[44:47],v[76:79],v[112:127]
QAH lgkmcnt(7)
QAB v[112:127],v[48:51],v[80:83],v[112:127]
QAH lgkmcnt(6)
QAB v[112:127],v[52:55],v[84:87],v[112:127]
QAH lgkmcnt(5)
QAB v[112:127],v[56:59],v[88:91],v[112:127]
QAH lgkmcnt(4)
QAB v[112:127],v[60:63],v[92:95],v[112:127]
QBQ v14,v96,v97,v98
QBQ v14,v14,v99,v100
QBQ v14,v14,v101,v102
QBQ v14,v14,v103,v104
QBQ v14,v14,v105,v106
QBQ v14,v14,v107,v108
QBQ v14,v14,v109,v110
s_nop 4
QBQ v14,v14,v111,v112
QBQ v14,v14,v113,v114
v_max_f32 v14,v14,v115
QAQ v15,v14
s_nop 1
QCH v14,v15
v_max_f32 v14,v14,v15
QAW v14,s35,v14
v_fma_f32 v96,v96,s35,-v14
v_fma_f32 v97,v97,s35,-v14
v_fma_f32 v98,v98,s35,-v14
v_fma_f32 v99,v99,s35,-v14
v_fma_f32 v100,v100,s35,-v14
v_fma_f32 v101,v101,s35,-v14
v_fma_f32 v102,v102,s35,-v14
v_fma_f32 v103,v103,s35,-v14
v_fma_f32 v104,v104,s35,-v14
v_fma_f32 v105,v105,s35,-v14
v_fma_f32 v106,v106,s35,-v14
v_fma_f32 v107,v107,s35,-v14
v_fma_f32 v108,v108,s35,-v14
v_fma_f32 v109,v109,s35,-v14
v_fma_f32 v110,v110,s35,-v14
v_fma_f32 v111,v111,s35,-v14
v_fma_f32 v112,v112,s35,-v14
v_fma_f32 v113,v113,s35,-v14
v_fma_f32 v114,v114,s35,-v14
v_fma_f32 v115,v115,s35,-v14
QBA v96,v96
QBA v97,v97
QBA v98,v98
QBA v99,v99
QBA v100,v100
QBA v101,v101
QBA v102,v102
QBA v103,v103
QBA v104,v104
QBA v105,v105
QBA v106,v106
QBA v107,v107
QBA v108,v108
QBA v109,v109
QBA v110,v110
QBA v111,v111
QBA v112,v112
QBA v113,v113
QBA v114,v114
QBA v115,v115
QAU v14,v96,v97
QAU v15,v98,v99
QAU v14,v14,v100
QAU v15,v15,v101
QAU v14,v14,v102
QAU v15,v15,v103
QAU v14,v14,v104
QAU v15,v15,v105
QAU v14,v14,v106
QAU v15,v15,v107
QAU v14,v14,v108
QAU v15,v15,v109
QAU v14,v14,v110
QAU v15,v15,v111
QAU v14,v14,v112
QAU v15,v15,v113
QAU v14,v14,v114
QAU v15,v15,v115
QAU v14,v14,v15
QAQ v15,v14
s_nop 1
QCH v14,v15
QAU v14,v14,v15
v_rcp_f32 v14,v14
s_nop 0
QBI v[96:97],v[96:97],v[14:15] op_sel_hi:[1,0]
QBI v[98:99],v[98:99],v[14:15] op_sel_hi:[1,0]
QBI v[100:101],v[100:101],v[14:15] op_sel_hi:[1,0]
QBI v[102:103],v[102:103],v[14:15] op_sel_hi:[1,0]
QBI v[104:105],v[104:105],v[14:15] op_sel_hi:[1,0]
QBI v[106:107],v[106:107],v[14:15] op_sel_hi:[1,0]
QBI v[108:109],v[108:109],v[14:15] op_sel_hi:[1,0]
QBI v[110:111],v[110:111],v[14:15] op_sel_hi:[1,0]
QBI v[112:113],v[112:113],v[14:15] op_sel_hi:[1,0]
QBI v[114:115],v[114:115],v[14:15] op_sel_hi:[1,0]
QAE v116,v112,v113
QAE v117,v114,v115
QAQ v118,0
QAQ v119,0
QAE v120,v96,v97
QAE v121,v98,v99
QAE v122,v104,v105
QAE v123,v106,v107
QAE v124,v100,v101
QAE v125,v102,v103
QAE v126,v108,v109
QAE v127,v110,v111
QAH lgkmcnt(0)
QAB v[64:79],v[128:131],v[120:123],0
QAB v[64:79],v[132:135],v[124:127],v[64:79]
QAB v[64:79],v[16:19],v[116:119],v[64:79]
QAB v[80:95],v[136:139],v[120:123],0
QAB v[80:95],v[140:143],v[124:127],v[80:95]
QAB v[80:95],v[18:21],v[116:119],v[80:95]
QAB v[96:111],v[144:147],v[120:123],0
QAB v[96:111],v[148:151],v[124:127],v[96:111]
QAB v[96:111],v[20:23],v[116:119],v[96:111]
QAB v[32:47],v[152:155],v[120:123],0
QAB v[32:47],v[156:159],v[124:127],v[32:47]
QAB v[32:47],v[22:25],v[116:119],v[32:47]
QAE v128,v64,v65
QAE v129,v66,v67
QAE v130,v68,v69
QAE v131,v70,v71
QAE v132,v72,v73
QAE v133,v74,v75
QAE v134,v76,v77
QAE v135,v78,v79
QAY v5,v[128:131] offset:0
QAY v5,v[132:135] offset:1024
QAE v136,v80,v81
QAE v137,v82,v83
QAE v138,v84,v85
QAE v139,v86,v87
QAE v140,v88,v89
QAE v141,v90,v91
QAE v142,v92,v93
QAE v143,v94,v95
QAY v5,v[136:139] offset:2048
QAY v5,v[140:143] offset:3072
QAE v144,v96,v97
QAE v145,v98,v99
QAE v146,v100,v101
QAE v147,v102,v103
QAE v148,v104,v105
QAE v149,v106,v107
QAE v150,v108,v109
QAE v151,v110,v111
QAY v5,v[144:147] offset:4096
QAY v5,v[148:151] offset:5120
QAE v152,v32,v33
QAE v153,v34,v35
QAE v154,v36,v37
QAE v155,v38,v39
QAE v156,v40,v41
QAE v157,v42,v43
QAE v158,v44,v45
QAE v159,v46,v47
QAY v5,v[152:155] offset:6144
QAY v5,v[156:159] offset:7168
QAH lgkmcnt(0)
s_barrier
QAG v[32:35],v1 offset:0
QAG v[36:39],v1 offset:1024
QAG v[40:43],v1 offset:2048
QAG v[44:47],v1 offset:3072
QAG v[48:51],v1 offset:4096
QAG v[52:55],v1 offset:5120
QAG v[56:59],v1 offset:6144
QAG v[60:63],v1 offset:7168
QAG v[64:67],v1 offset:8192
QAG v[68:71],v1 offset:9216
QAG v[72:75],v1 offset:10240
QAG v[76:79],v1 offset:11264
QAH lgkmcnt(11)
QAB v[160:175],a[0:3],v[32:35],0
QAB v[176:191],a[4:7],v[32:35],0
QAG v[80:83],v1 offset:12288
QAH lgkmcnt(11)
QAB v[160:175],a[8:11],v[36:39],v[160:175]
QAB v[176:191],a[12:15],v[36:39],v[176:191]
QAG v[84:87],v1 offset:13312
QAH lgkmcnt(11)
QAB v[160:175],a[16:19],v[40:43],v[160:175]
QAB v[176:191],a[20:23],v[40:43],v[176:191]
QAG v[88:91],v1 offset:14336
QAH lgkmcnt(11)
QAB v[160:175],a[24:27],v[44:47],v[160:175]
QAB v[176:191],a[28:31],v[44:47],v[176:191]
QAG v[92:95],v1 offset:15360
QAH lgkmcnt(11)
QAB v[160:175],a[32:35],v[48:51],v[160:175]
QAB v[176:191],a[36:39],v[48:51],v[176:191]
QAG v[32:35],v1 offset:16384
QAH lgkmcnt(11)
QAB v[160:175],a[40:43],v[52:55],v[160:175]
QAB v[176:191],a[44:47],v[52:55],v[176:191]
QAG v[36:39],v1 offset:17408
QAH lgkmcnt(11)
QAB v[160:175],a[48:51],v[56:59],v[160:175]
QAB v[176:191],a[52:55],v[56:59],v[176:191]
QAG v[40:43],v1 offset:18432
QAH lgkmcnt(11)
QAB v[160:175],a[56:59],v[60:63],v[160:175]
QAB v[176:191],a[60:63],v[60:63],v[176:191]
QAG v[44:47],v1 offset:19456
QAH lgkmcnt(11)
QAB v[160:175],a[64:67],v[64:67],v[160:175]
QAB v[176:191],a[68:71],v[64:67],v[176:191]
QAG v[48:51],v1 offset:20480
QAH lgkmcnt(11)
QAB v[160:175],a[72:75],v[68:71],v[160:175]
QAB v[176:191],a[76:79],v[68:71],v[176:191]
QAG v[52:55],v1 offset:21504
QAH lgkmcnt(11)
QAB v[160:175],a[80:83],v[72:75],v[160:175]
QAB v[176:191],a[84:87],v[72:75],v[176:191]
QAG v[56:59],v1 offset:22528
QAH lgkmcnt(11)
QAB v[160:175],a[88:91],v[76:79],v[160:175]
QAB v[176:191],a[92:95],v[76:79],v[176:191]
QAG v[60:63],v1 offset:23552
QAH lgkmcnt(11)
QAB v[160:175],a[96:99],v[80:83],v[160:175]
QAB v[176:191],a[100:103],v[80:83],v[176:191]
QAG v[64:67],v1 offset:24576
QAH lgkmcnt(11)
QAB v[160:175],a[104:107],v[84:87],v[160:175]
QAB v[176:191],a[108:111],v[84:87],v[176:191]
QAG v[68:71],v1 offset:25600
QAH lgkmcnt(11)
QAB v[160:175],a[112:115],v[88:91],v[160:175]
QAB v[176:191],a[116:119],v[88:91],v[176:191]
QAG v[72:75],v1 offset:26624
QAH lgkmcnt(11)
QAB v[160:175],a[120:123],v[92:95],v[160:175]
QAB v[176:191],a[124:127],v[92:95],v[176:191]
QAG v[76:79],v1 offset:27648
QAH lgkmcnt(11)
QAB v[160:175],a[128:131],v[32:35],v[160:175]
QAB v[176:191],a[132:135],v[32:35],v[176:191]
QAG v[80:83],v1 offset:28672
QAH lgkmcnt(11)
QAB v[160:175],a[136:139],v[36:39],v[160:175]
QAB v[176:191],a[140:143],v[36:39],v[176:191]
QAG v[84:87],v1 offset:29696
QAH lgkmcnt(11)
QAB v[160:175],a[144:147],v[40:43],v[160:175]
QAB v[176:191],a[148:151],v[40:43],v[176:191]
QAG v[88:91],v1 offset:30720
QAH lgkmcnt(11)
QAB v[160:175],a[152:155],v[44:47],v[160:175]
QAB v[176:191],a[156:159],v[44:47],v[176:191]
QAG v[92:95],v1 offset:31744
QAH lgkmcnt(11)
QAB v[160:175],a[160:163],v[48:51],v[160:175]
QAB v[176:191],a[164:167],v[48:51],v[176:191]
QAH lgkmcnt(10)
QAB v[160:175],a[168:171],v[52:55],v[160:175]
QAB v[176:191],a[172:175],v[52:55],v[176:191]
QAH lgkmcnt(9)
QAB v[160:175],a[176:179],v[56:59],v[160:175]
QAB v[176:191],a[180:183],v[56:59],v[176:191]
QAH lgkmcnt(8)
QAB v[160:175],a[184:187],v[60:63],v[160:175]
QAB v[176:191],a[188:191],v[60:63],v[176:191]
QAH lgkmcnt(7)
QAB v[160:175],a[192:195],v[64:67],v[160:175]
QAB v[176:191],a[196:199],v[64:67],v[176:191]
QAH lgkmcnt(6)
QAB v[160:175],a[200:203],v[68:71],v[160:175]
QAB v[176:191],a[204:207],v[68:71],v[176:191]
QAH lgkmcnt(5)
QAB v[160:175],a[208:211],v[72:75],v[160:175]
QAB v[176:191],a[212:215],v[72:75],v[176:191]
QAH lgkmcnt(4)
QAB v[160:175],a[216:219],v[76:79],v[160:175]
QAB v[176:191],a[220:223],v[76:79],v[176:191]
QAH lgkmcnt(3)
QAB v[160:175],a[224:227],v[80:83],v[160:175]
QAB v[176:191],a[228:231],v[80:83],v[176:191]
QAH lgkmcnt(2)
QAB v[160:175],a[232:235],v[84:87],v[160:175]
QAB v[176:191],a[236:239],v[84:87],v[176:191]
QAH lgkmcnt(1)
QAB v[160:175],a[240:243],v[88:91],v[160:175]
QAB v[176:191],a[244:247],v[88:91],v[176:191]
QAH lgkmcnt(0)
QAB v[160:175],a[248:251],v[92:95],v[160:175]
QAB v[176:191],a[252:255],v[92:95],v[176:191]
s_nop 3
QAE v128,v160,v161
QAE v129,v162,v163
QAE v130,v164,v165
QAE v131,v166,v167
QAE v132,v168,v169
QAE v133,v170,v171
QAE v134,v172,v173
QAE v135,v174,v175
QAL v[128:131],v1,s[16:19],s28 offen offset:0 sc1
QAL v[132:135],v1,s[16:19],s28 offen offset:1024 sc1
QAE v136,v176,v177
QAE v137,v178,v179
QAE v138,v180,v181
QAE v139,v182,v183
QAE v140,v184,v185
QAE v141,v186,v187
QAE v142,v188,v189
QAE v143,v190,v191
QAL v[136:139],v1,s[16:19],s28 offen offset:2048 sc1
QAL v[140:143],v1,s[16:19],s28 offen offset:3072 sc1
QAH vmcnt(0)
s_barrier
QAF s13,s73,577536
QAQ v2,1
QBJ s9,0
s_cbranch_scc1 lay_a8
QBY exec,1
buffer_atomic_add v2,off,s[16:19],s13
QBY exec,-1
lay_a8:
QBK s84,60
s_cbranch_scc1 lay_tend
s_sub_u32 s84,119,s84
s_sub_u32 s73,s84,56
QAS s73,s73,8
QAF s73,s73,s56
s_branch tl_again
lay_tend:
QBW v0,4,v1
s_branch lay_col
lay_srv:
QAT s74,60817408
QBJ s9,0
s_cbranch_scc1 lay_tw2_ok
QAI v2,4,v1
QAQ v4,14
QAT s15,0
lay_tw2:
QAF s13,s74,606208
QAT exec_hi,0
QAT exec_lo,0xffff
QBR v3,v2,s[16:19],s13 offen sc1
QBY exec,-1
QAH vmcnt(0)
v_cmp_ge_u32 vcc,v3,v4
s_nop 1
QBO s13,vcc_lo,0xffff
QBS s13,0xffff
s_cbranch_scc1 lay_tw2_ok
s_sleep 4
QAF s15,s15,1
QBN s15,400000
s_cbranch_scc1 lay_tw2
lay_tw2_ok:
s_barrier
QAS s84,s85,1
QCB s13,s9,1
QAF s84,s84,s13
QBO s29,s9,1
QAS s30,s29,12
QAF s30,s30,53477376
QAS s31,s29,11
s_xor_b32 s13,s31,0
QAF s13,s13,s30
QAF s13,s13,0
QAD a[128:131],v1,s[16:19],s13 offen sc1
s_xor_b32 s13,s31,1024
QAF s13,s13,s30
QAF s13,s13,0
QAD a[132:135],v1,s[16:19],s13 offen sc1
s_xor_b32 s13,s31,2048
QAF s13,s13,s30
QAF s13,s13,0
QAD a[136:139],v1,s[16:19],s13 offen sc1
s_xor_b32 s13,s31,3072
QAF s13,s13,s30
QAF s13,s13,0
QAD a[140:143],v1,s[16:19],s13 offen sc1
s_xor_b32 s13,s31,0
QAF s13,s13,s30
QAF s13,s13,8192
QAD a[144:147],v1,s[16:19],s13 offen sc1
s_xor_b32 s13,s31,1024
QAF s13,s13,s30
QAF s13,s13,8192
QAD a[148:151],v1,s[16:19],s13 offen sc1
s_xor_b32 s13,s31,2048
QAF s13,s13,s30
QAF s13,s13,8192
QAD a[152:155],v1,s[16:19],s13 offen sc1
s_xor_b32 s13,s31,3072
QAF s13,s13,s30
QAF s13,s13,8192
QAD a[156:159],v1,s[16:19],s13 offen sc1
QAT s13,53493760
QAD a[160:163],v1,s[16:19],s13 offen sc1
QAT s13,53494784
QAD a[164:167],v1,s[16:19],s13 offen sc1
QAT s13,53495808
QAD a[168:171],v1,s[16:19],s13 offen sc1
QAT s13,53496832
QAD a[172:175],v1,s[16:19],s13 offen sc1
QAT s13,53497856
QAD a[176:179],v1,s[16:19],s13 offen sc1
QAT s13,53498880
QAD a[180:183],v1,s[16:19],s13 offen sc1
QAT s13,53499904
QAD a[184:187],v1,s[16:19],s13 offen sc1
QAT s13,53500928
QAD a[188:191],v1,s[16:19],s13 offen sc1
QAT s13,53501952
QAD a[192:195],v1,s[16:19],s13 offen sc1
QAT s13,53502976
QAD a[196:199],v1,s[16:19],s13 offen sc1
QAT s13,53504000
QAD a[200:203],v1,s[16:19],s13 offen sc1
QAT s13,53505024
QAD a[204:207],v1,s[16:19],s13 offen sc1
QAF s13,s30,28672
QAD v[176:179],v1,s[16:19],s13 offen offset:0 sc1
QAD v[180:183],v1,s[16:19],s13 offen offset:1024 sc1
QAD v[184:187],v1,s[16:19],s13 offen offset:2048 sc1
QAD v[188:191],v1,s[16:19],s13 offen offset:3072 sc1
QAF s13,s30,36864
QAD v[192:195],v1,s[16:19],s13 offen offset:0 sc1
QAD v[196:199],v1,s[16:19],s13 offen offset:1024 sc1
QAD v[200:203],v1,s[16:19],s13 offen offset:2048 sc1
QAD v[204:207],v1,s[16:19],s13 offen offset:3072 sc1
QAF s13,s30,45056
QAD v[208:211],v1,s[16:19],s13 offen offset:0 sc1
QAD v[212:215],v1,s[16:19],s13 offen offset:1024 sc1
QAD v[216:219],v1,s[16:19],s13 offen offset:2048 sc1
QAD v[220:223],v1,s[16:19],s13 offen offset:3072 sc1
QAF s13,s30,53248
QAD v[224:227],v1,s[16:19],s13 offen offset:0 sc1
QAD v[228:231],v1,s[16:19],s13 offen offset:1024 sc1
QAD v[232:235],v1,s[16:19],s13 offen offset:2048 sc1
QAD v[236:239],v1,s[16:19],s13 offen offset:3072 sc1
s_min_u32 s13,s84,256
QAS s13,s13,13
QAS s14,s29,12
QAF s13,s13,s14
QAF s13,s13,57671680
QAD v[240:243],v1,s[16:19],s13 offen offset:0 sc1
QAD v[244:247],v1,s[16:19],s13 offen offset:1024 sc1
QAD v[248:251],v1,s[16:19],s13 offen offset:2048 sc1
QAD v[252:255],v1,s[16:19],s13 offen offset:3072 sc1
QBO s74,s60,3
s_sub_u32 s84,s60,192
QCB s84,s84,2
QAS s73,s84,8
QAF s73,s73,s56
QAF s84,s84,56
QAH vmcnt(20)
QAS s29,s74,2
QAF s29,s29,s9
QAS s29,s29,15
QAF s29,s29,52428800
QAD a[0:3],v1,s[16:19],s29 offen offset:0 sc1
QAD a[4:7],v1,s[16:19],s29 offen offset:1024 sc1
QAD a[8:11],v1,s[16:19],s29 offen offset:2048 sc1
QAD a[12:15],v1,s[16:19],s29 offen offset:3072 sc1
QAF s29,s29,4096
QAD a[16:19],v1,s[16:19],s29 offen offset:0 sc1
QAD a[20:23],v1,s[16:19],s29 offen offset:1024 sc1
QAD a[24:27],v1,s[16:19],s29 offen offset:2048 sc1
QAD a[28:31],v1,s[16:19],s29 offen offset:3072 sc1
QAF s29,s29,4096
QAD a[32:35],v1,s[16:19],s29 offen offset:0 sc1
QAD a[36:39],v1,s[16:19],s29 offen offset:1024 sc1
QAD a[40:43],v1,s[16:19],s29 offen offset:2048 sc1
QAD a[44:47],v1,s[16:19],s29 offen offset:3072 sc1
QAF s29,s29,4096
QAD a[48:51],v1,s[16:19],s29 offen offset:0 sc1
QAD a[52:55],v1,s[16:19],s29 offen offset:1024 sc1
QAD a[56:59],v1,s[16:19],s29 offen offset:2048 sc1
QAD a[60:63],v1,s[16:19],s29 offen offset:3072 sc1
QAF s29,s29,4096
QAD a[64:67],v1,s[16:19],s29 offen offset:0 sc1
QAD a[68:71],v1,s[16:19],s29 offen offset:1024 sc1
QAD a[72:75],v1,s[16:19],s29 offen offset:2048 sc1
QAD a[76:79],v1,s[16:19],s29 offen offset:3072 sc1
QAF s29,s29,4096
QAD a[80:83],v1,s[16:19],s29 offen offset:0 sc1
QAD a[84:87],v1,s[16:19],s29 offen offset:1024 sc1
QAD a[88:91],v1,s[16:19],s29 offen offset:2048 sc1
QAD a[92:95],v1,s[16:19],s29 offen offset:3072 sc1
QAF s29,s29,4096
QAD a[96:99],v1,s[16:19],s29 offen offset:0 sc1
QAD a[100:103],v1,s[16:19],s29 offen offset:1024 sc1
QAD a[104:107],v1,s[16:19],s29 offen offset:2048 sc1
QAD a[108:111],v1,s[16:19],s29 offen offset:3072 sc1
QAF s29,s29,4096
QAD a[112:115],v1,s[16:19],s29 offen offset:0 sc1
QAD a[116:119],v1,s[16:19],s29 offen offset:1024 sc1
QAD a[120:123],v1,s[16:19],s29 offen offset:2048 sc1
QAD a[124:127],v1,s[16:19],s29 offen offset:3072 sc1
QAS s28,s74,2
QAF s28,s28,s9
QAS s28,s28,11
QAS s13,s84,15
QAF s28,s28,s13
QAF s28,s28,2097152
QAD v[96:99],v1,s[16:19],s28 offen offset:0 sc1
QAD v[100:103],v1,s[16:19],s28 offen offset:1024 sc1
QBJ s9,0
s_cbranch_scc1 lay_pc3_ok
QAT s15,0
lay_pc3:
QAF s13,s56,557056
QBR v2,off,s[16:19],s13 sc1
QAH vmcnt(0)
QCA s13,v2
s_sub_u32 s14,s84,1
s_nop 0
s_cmp_ge_i32 s13,s14
s_cbranch_scc1 lay_pc3_ok
s_sleep 40
QAF s15,s15,1
QBN s15,400000
s_cbranch_scc1 lay_pc3
lay_pc3_ok:
QBJ s9,0
s_cbranch_scc1 lay_t1_ok
QAT s15,0
lay_t1:
QAF s13,s73,577536
QBR v2,off,s[16:19],s13 sc1
QAH vmcnt(0)
QCA s13,v2
s_nop 1
QBK s13,16
s_cbranch_scc1 lay_t1_ok
s_sleep 1
QAF s15,s15,1
QBN s15,400000
s_cbranch_scc1 lay_t1
lay_t1_ok:
s_barrier
QAS s28,s74,2
QAF s28,s28,s9
QAS s28,s28,11
QAS s13,s84,15
QAF s28,s28,s13
QAF s32,s28,67108864
QAF s33,s28,46137344
QAD v[32:35],v1,s[16:19],s32 offen offset:0 sc1
QAD v[64:67],v1,s[16:19],s32 offen offset:1024 sc1
QAF s32,s32,2097152
QAD v[36:39],v1,s[16:19],s32 offen offset:0 sc1
QAD v[68:71],v1,s[16:19],s32 offen offset:1024 sc1
QAF s32,s32,2097152
QAD v[40:43],v1,s[16:19],s32 offen offset:0 sc1
QAD v[72:75],v1,s[16:19],s32 offen offset:1024 sc1
QAF s32,s32,2097152
QAD v[44:47],v1,s[16:19],s32 offen offset:0 sc1
QAD v[76:79],v1,s[16:19],s32 offen offset:1024 sc1
QAF s32,s32,2097152
QAD v[48:51],v1,s[16:19],s32 offen offset:0 sc1
QAD v[80:83],v1,s[16:19],s32 offen offset:1024 sc1
QAF s32,s32,2097152
QAD v[52:55],v1,s[16:19],s32 offen offset:0 sc1
QAD v[84:87],v1,s[16:19],s32 offen offset:1024 sc1
QAF s32,s32,2097152
QAD v[56:59],v1,s[16:19],s32 offen offset:0 sc1
QAD v[88:91],v1,s[16:19],s32 offen offset:1024 sc1
QAF s32,s32,2097152
QAD v[60:63],v1,s[16:19],s32 offen offset:0 sc1
QAD v[92:95],v1,s[16:19],s32 offen offset:1024 sc1
QAF s32,s32,2097152
QAH vmcnt(14)
QAI v144,16,v32
QAM v145,0xffff0000,v32
QAI v146,16,v33
QAM v147,0xffff0000,v33
QAI v148,16,v34
QAM v149,0xffff0000,v34
QAI v150,16,v35
QAM v151,0xffff0000,v35
QAH vmcnt(12)
QAI v152,16,v36
QAM v153,0xffff0000,v36
QAN v[144:145],v[144:145],v[152:153]
QAI v152,16,v37
QAM v153,0xffff0000,v37
QAN v[146:147],v[146:147],v[152:153]
QAI v152,16,v38
QAM v153,0xffff0000,v38
QAN v[148:149],v[148:149],v[152:153]
QAI v152,16,v39
QAM v153,0xffff0000,v39
QAN v[150:151],v[150:151],v[152:153]
QAH vmcnt(10)
QAI v152,16,v40
QAM v153,0xffff0000,v40
QAN v[144:145],v[144:145],v[152:153]
QAI v152,16,v41
QAM v153,0xffff0000,v41
QAN v[146:147],v[146:147],v[152:153]
QAI v152,16,v42
QAM v153,0xffff0000,v42
QAN v[148:149],v[148:149],v[152:153]
QAI v152,16,v43
QAM v153,0xffff0000,v43
QAN v[150:151],v[150:151],v[152:153]
QAH vmcnt(8)
QAI v152,16,v44
QAM v153,0xffff0000,v44
QAN v[144:145],v[144:145],v[152:153]
QAI v152,16,v45
QAM v153,0xffff0000,v45
QAN v[146:147],v[146:147],v[152:153]
QAI v152,16,v46
QAM v153,0xffff0000,v46
QAN v[148:149],v[148:149],v[152:153]
QAI v152,16,v47
QAM v153,0xffff0000,v47
QAN v[150:151],v[150:151],v[152:153]
QAH vmcnt(6)
QAI v152,16,v48
QAM v153,0xffff0000,v48
QAN v[144:145],v[144:145],v[152:153]
QAI v152,16,v49
QAM v153,0xffff0000,v49
QAN v[146:147],v[146:147],v[152:153]
QAI v152,16,v50
QAM v153,0xffff0000,v50
QAN v[148:149],v[148:149],v[152:153]
QAI v152,16,v51
QAM v153,0xffff0000,v51
QAN v[150:151],v[150:151],v[152:153]
QAH vmcnt(4)
QAI v152,16,v52
QAM v153,0xffff0000,v52
QAN v[144:145],v[144:145],v[152:153]
QAI v152,16,v53
QAM v153,0xffff0000,v53
QAN v[146:147],v[146:147],v[152:153]
QAI v152,16,v54
QAM v153,0xffff0000,v54
QAN v[148:149],v[148:149],v[152:153]
QAI v152,16,v55
QAM v153,0xffff0000,v55
QAN v[150:151],v[150:151],v[152:153]
QAH vmcnt(2)
QAI v152,16,v56
QAM v153,0xffff0000,v56
QAN v[144:145],v[144:145],v[152:153]
QAI v152,16,v57
QAM v153,0xffff0000,v57
QAN v[146:147],v[146:147],v[152:153]
QAI v152,16,v58
QAM v153,0xffff0000,v58
QAN v[148:149],v[148:149],v[152:153]
QAI v152,16,v59
QAM v153,0xffff0000,v59
QAN v[150:151],v[150:151],v[152:153]
QAH vmcnt(0)
QAI v152,16,v60
QAM v153,0xffff0000,v60
QAN v[144:145],v[144:145],v[152:153]
QAI v152,16,v61
QAM v153,0xffff0000,v61
QAN v[146:147],v[146:147],v[152:153]
QAI v152,16,v62
QAM v153,0xffff0000,v62
QAN v[148:149],v[148:149],v[152:153]
QAI v152,16,v63
QAM v153,0xffff0000,v63
QAN v[150:151],v[150:151],v[152:153]
QAE v152,v144,v145
QAI v156,16,v96
QAM v157,0xffff0000,v96
QAI v154,16,v152
QAM v155,0xffff0000,v152
QAN v[154:155],v[154:155],v[156:157]
QAE v96,v154,v155
QAE v152,v146,v147
QAI v156,16,v97
QAM v157,0xffff0000,v97
QAI v154,16,v152
QAM v155,0xffff0000,v152
QAN v[154:155],v[154:155],v[156:157]
QAE v97,v154,v155
QAE v152,v148,v149
QAI v156,16,v98
QAM v157,0xffff0000,v98
QAI v154,16,v152
QAM v155,0xffff0000,v152
QAN v[154:155],v[154:155],v[156:157]
QAE v98,v154,v155
QAE v152,v150,v151
QAI v156,16,v99
QAM v157,0xffff0000,v99
QAI v154,16,v152
QAM v155,0xffff0000,v152
QAN v[154:155],v[154:155],v[156:157]
QAE v99,v154,v155
QAL v[96:99],v1,s[16:19],s33 offen offset:0 sc1
QAI v144,16,v64
QAM v145,0xffff0000,v64
QAI v146,16,v65
QAM v147,0xffff0000,v65
QAI v148,16,v66
QAM v149,0xffff0000,v66
QAI v150,16,v67
QAM v151,0xffff0000,v67
QAI v152,16,v68
QAM v153,0xffff0000,v68
QAN v[144:145],v[144:145],v[152:153]
QAI v152,16,v69
QAM v153,0xffff0000,v69
QAN v[146:147],v[146:147],v[152:153]
QAI v152,16,v70
QAM v153,0xffff0000,v70
QAN v[148:149],v[148:149],v[152:153]
QAI v152,16,v71
QAM v153,0xffff0000,v71
QAN v[150:151],v[150:151],v[152:153]
QAI v152,16,v72
QAM v153,0xffff0000,v72
QAN v[144:145],v[144:145],v[152:153]
QAI v152,16,v73
QAM v153,0xffff0000,v73
QAN v[146:147],v[146:147],v[152:153]
QAI v152,16,v74
QAM v153,0xffff0000,v74
QAN v[148:149],v[148:149],v[152:153]
QAI v152,16,v75
QAM v153,0xffff0000,v75
QAN v[150:151],v[150:151],v[152:153]
QAI v152,16,v76
QAM v153,0xffff0000,v76
QAN v[144:145],v[144:145],v[152:153]
QAI v152,16,v77
QAM v153,0xffff0000,v77
QAN v[146:147],v[146:147],v[152:153]
QAI v152,16,v78
QAM v153,0xffff0000,v78
QAN v[148:149],v[148:149],v[152:153]
QAI v152,16,v79
QAM v153,0xffff0000,v79
QAN v[150:151],v[150:151],v[152:153]
QAI v152,16,v80
QAM v153,0xffff0000,v80
QAN v[144:145],v[144:145],v[152:153]
QAI v152,16,v81
QAM v153,0xffff0000,v81
QAN v[146:147],v[146:147],v[152:153]
QAI v152,16,v82
QAM v153,0xffff0000,v82
QAN v[148:149],v[148:149],v[152:153]
QAI v152,16,v83
QAM v153,0xffff0000,v83
QAN v[150:151],v[150:151],v[152:153]
QAI v152,16,v84
QAM v153,0xffff0000,v84
QAN v[144:145],v[144:145],v[152:153]
QAI v152,16,v85
QAM v153,0xffff0000,v85
QAN v[146:147],v[146:147],v[152:153]
QAI v152,16,v86
QAM v153,0xffff0000,v86
QAN v[148:149],v[148:149],v[152:153]
QAI v152,16,v87
QAM v153,0xffff0000,v87
QAN v[150:151],v[150:151],v[152:153]
QAI v152,16,v88
QAM v153,0xffff0000,v88
QAN v[144:145],v[144:145],v[152:153]
QAI v152,16,v89
QAM v153,0xffff0000,v89
QAN v[146:147],v[146:147],v[152:153]
QAI v152,16,v90
QAM v153,0xffff0000,v90
QAN v[148:149],v[148:149],v[152:153]
QAI v152,16,v91
QAM v153,0xffff0000,v91
QAN v[150:151],v[150:151],v[152:153]
QAI v152,16,v92
QAM v153,0xffff0000,v92
QAN v[144:145],v[144:145],v[152:153]
QAI v152,16,v93
QAM v153,0xffff0000,v93
QAN v[146:147],v[146:147],v[152:153]
QAI v152,16,v94
QAM v153,0xffff0000,v94
QAN v[148:149],v[148:149],v[152:153]
QAI v152,16,v95
QAM v153,0xffff0000,v95
QAN v[150:151],v[150:151],v[152:153]
QAE v152,v144,v145
QAI v156,16,v100
QAM v157,0xffff0000,v100
QAI v154,16,v152
QAM v155,0xffff0000,v152
QAN v[154:155],v[154:155],v[156:157]
QAE v100,v154,v155
QAE v152,v146,v147
QAI v156,16,v101
QAM v157,0xffff0000,v101
QAI v154,16,v152
QAM v155,0xffff0000,v152
QAN v[154:155],v[154:155],v[156:157]
QAE v101,v154,v155
QAE v152,v148,v149
QAI v156,16,v102
QAM v157,0xffff0000,v102
QAI v154,16,v152
QAM v155,0xffff0000,v152
QAN v[154:155],v[154:155],v[156:157]
QAE v102,v154,v155
QAE v152,v150,v151
QAI v156,16,v103
QAM v157,0xffff0000,v103
QAI v154,16,v152
QAM v155,0xffff0000,v152
QAN v[154:155],v[154:155],v[156:157]
QAE v103,v154,v155
QAL v[100:103],v1,s[16:19],s33 offen offset:1024 sc1
QAH vmcnt(0)
s_barrier
QAF s13,s73,579584
QAQ v2,1
QBJ s9,0
s_cbranch_scc1 lay_a9
QBY exec,1
buffer_atomic_add v2,off,s[16:19],s13
QBY exec,-1
lay_a9:
QBJ s9,0
s_cbranch_scc1 lay_t2_ok
QAT s15,0
lay_t2:
QAF s13,s73,579584
QBR v2,off,s[16:19],s13 sc1
QAH vmcnt(0)
QCA s13,v2
s_nop 1
QBK s13,4
s_cbranch_scc1 lay_t2_ok
s_sleep 1
QAF s15,s15,1
QBN s15,400000
s_cbranch_scc1 lay_t2
lay_t2_ok:
s_barrier
s_movk_i32 s67,100
QAT s68,2
QCB s73,s84,2
QAS s73,s73,8
QAF s73,s73,s56
s_branch lay_r2go
lay_inv:
s_sub_u32 s84,s60,64
QAS s24,s9,17
QAF s24,s24,52953088
QAS s14,s9,15
QAF s14,s14,32768
QBF v4,s14,v1
QAF s13,s24,0
QAD a[0:3],v1,s[16:19],s13 offen sc1
QAF s13,s24,32768
QAD a[4:7],v1,s[16:19],s13 offen sc1
QAF s13,s24,65536
QAD a[8:11],v1,s[16:19],s13 offen sc1
QAF s13,s24,98304
QAD a[12:15],v1,s[16:19],s13 offen sc1
QAF s13,s24,1024
QAD a[16:19],v1,s[16:19],s13 offen sc1
QAF s13,s24,33792
QAD a[20:23],v1,s[16:19],s13 offen sc1
QAF s13,s24,66560
QAD a[24:27],v1,s[16:19],s13 offen sc1
QAF s13,s24,99328
QAD a[28:31],v1,s[16:19],s13 offen sc1
QAF s13,s24,2048
QAD a[32:35],v1,s[16:19],s13 offen sc1
QAF s13,s24,34816
QAD a[36:39],v1,s[16:19],s13 offen sc1
QAF s13,s24,67584
QAD a[40:43],v1,s[16:19],s13 offen sc1
QAF s13,s24,100352
QAD a[44:47],v1,s[16:19],s13 offen sc1
QAF s13,s24,3072
QAD a[48:51],v1,s[16:19],s13 offen sc1
QAF s13,s24,35840
QAD a[52:55],v1,s[16:19],s13 offen sc1
QAF s13,s24,68608
QAD a[56:59],v1,s[16:19],s13 offen sc1
QAF s13,s24,101376
QAD a[60:63],v1,s[16:19],s13 offen sc1
QAF s13,s24,4096
QAD a[64:67],v1,s[16:19],s13 offen sc1
QAF s13,s24,36864
QAD a[68:71],v1,s[16:19],s13 offen sc1
QAF s13,s24,69632
QAD a[72:75],v1,s[16:19],s13 offen sc1
QAF s13,s24,102400
QAD a[76:79],v1,s[16:19],s13 offen sc1
QAF s13,s24,5120
QAD a[80:83],v1,s[16:19],s13 offen sc1
QAF s13,s24,37888
QAD a[84:87],v1,s[16:19],s13 offen sc1
QAF s13,s24,70656
QAD a[88:91],v1,s[16:19],s13 offen sc1
QAF s13,s24,103424
QAD a[92:95],v1,s[16:19],s13 offen sc1
QAF s13,s24,6144
QAD a[96:99],v1,s[16:19],s13 offen sc1
QAF s13,s24,38912
QAD a[100:103],v1,s[16:19],s13 offen sc1
QAF s13,s24,71680
QAD a[104:107],v1,s[16:19],s13 offen sc1
QAF s13,s24,104448
QAD a[108:111],v1,s[16:19],s13 offen sc1
QAF s13,s24,7168
QAD a[112:115],v1,s[16:19],s13 offen sc1
QAF s13,s24,39936
QAD a[116:119],v1,s[16:19],s13 offen sc1
QAF s13,s24,72704
QAD a[120:123],v1,s[16:19],s13 offen sc1
QAF s13,s24,105472
QAD a[124:127],v1,s[16:19],s13 offen sc1
QAF s13,s24,8192
QAD a[128:131],v1,s[16:19],s13 offen sc1
QAF s13,s24,40960
QAD a[132:135],v1,s[16:19],s13 offen sc1
QAF s13,s24,73728
QAD a[136:139],v1,s[16:19],s13 offen sc1
QAF s13,s24,106496
QAD a[140:143],v1,s[16:19],s13 offen sc1
QAF s13,s24,9216
QAD a[144:147],v1,s[16:19],s13 offen sc1
QAF s13,s24,41984
QAD a[148:151],v1,s[16:19],s13 offen sc1
QAF s13,s24,74752
QAD a[152:155],v1,s[16:19],s13 offen sc1
QAF s13,s24,107520
QAD a[156:159],v1,s[16:19],s13 offen sc1
QAF s13,s24,10240
QAD a[160:163],v1,s[16:19],s13 offen sc1
QAF s13,s24,43008
QAD a[164:167],v1,s[16:19],s13 offen sc1
QAF s13,s24,75776
QAD a[168:171],v1,s[16:19],s13 offen sc1
QAF s13,s24,108544
QAD a[172:175],v1,s[16:19],s13 offen sc1
QAF s13,s24,11264
QAD a[176:179],v1,s[16:19],s13 offen sc1
QAF s13,s24,44032
QAD a[180:183],v1,s[16:19],s13 offen sc1
QAF s13,s24,76800
QAD a[184:187],v1,s[16:19],s13 offen sc1
QAF s13,s24,109568
QAD a[188:191],v1,s[16:19],s13 offen sc1
QAH vmcnt(14)
QAF s13,s24,12288
QAD a[192:195],v1,s[16:19],s13 offen sc1
QAF s13,s24,45056
QAD a[196:199],v1,s[16:19],s13 offen sc1
QAF s13,s24,77824
QAD a[200:203],v1,s[16:19],s13 offen sc1
QAF s13,s24,110592
QAD a[204:207],v1,s[16:19],s13 offen sc1
QAF s13,s24,13312
QAD a[208:211],v1,s[16:19],s13 offen sc1
QAF s13,s24,46080
QAD a[212:215],v1,s[16:19],s13 offen sc1
QAF s13,s24,78848
QAD a[216:219],v1,s[16:19],s13 offen sc1
QAF s13,s24,111616
QAD a[220:223],v1,s[16:19],s13 offen sc1
QAF s13,s24,14336
QAD a[224:227],v1,s[16:19],s13 offen sc1
QAF s13,s24,47104
QAD a[228:231],v1,s[16:19],s13 offen sc1
QAF s13,s24,79872
QAD a[232:235],v1,s[16:19],s13 offen sc1
QAF s13,s24,112640
QAD a[236:239],v1,s[16:19],s13 offen sc1
QAF s13,s24,15360
QAD a[240:243],v1,s[16:19],s13 offen sc1
QAF s13,s24,48128
QAD a[244:247],v1,s[16:19],s13 offen sc1
QAF s13,s24,80896
QAD a[248:251],v1,s[16:19],s13 offen sc1
QAF s13,s24,113664
QAD a[252:255],v1,s[16:19],s13 offen sc1
QAF s13,s24,16384
QAD v[128:131],v1,s[16:19],s13 offen sc1
QAF s13,s24,49152
QAD v[132:135],v1,s[16:19],s13 offen sc1
QAF s13,s24,81920
QAD v[136:139],v1,s[16:19],s13 offen sc1
QAF s13,s24,114688
QAD v[140:143],v1,s[16:19],s13 offen sc1
QAF s13,s24,17408
QAD v[144:147],v1,s[16:19],s13 offen sc1
QAF s13,s24,50176
QAD v[148:151],v1,s[16:19],s13 offen sc1
QAF s13,s24,82944
QAD v[152:155],v1,s[16:19],s13 offen sc1
QAF s13,s24,115712
QAD v[156:159],v1,s[16:19],s13 offen sc1
QAF s13,s24,18432
QAD v[160:163],v1,s[16:19],s13 offen sc1
QAF s13,s24,51200
QAD v[164:167],v1,s[16:19],s13 offen sc1
QAF s13,s24,83968
QAD v[168:171],v1,s[16:19],s13 offen sc1
QAF s13,s24,116736
QAD v[172:175],v1,s[16:19],s13 offen sc1
QAF s13,s24,19456
QAD v[176:179],v1,s[16:19],s13 offen sc1
QAF s13,s24,52224
QAD v[180:183],v1,s[16:19],s13 offen sc1
QAF s13,s24,84992
QAD v[184:187],v1,s[16:19],s13 offen sc1
QAF s13,s24,117760
QAD v[188:191],v1,s[16:19],s13 offen sc1
QAF s13,s24,20480
QAD v[192:195],v1,s[16:19],s13 offen sc1
QAF s13,s24,53248
QAD v[196:199],v1,s[16:19],s13 offen sc1
QAF s13,s24,86016
QAD v[200:203],v1,s[16:19],s13 offen sc1
QAF s13,s24,118784
QAD v[204:207],v1,s[16:19],s13 offen sc1
QAF s13,s24,21504
QAD v[208:211],v1,s[16:19],s13 offen sc1
QAF s13,s24,54272
QAD v[212:215],v1,s[16:19],s13 offen sc1
QAF s13,s24,87040
QAD v[216:219],v1,s[16:19],s13 offen sc1
QAF s13,s24,119808
QAD v[220:223],v1,s[16:19],s13 offen sc1
QAF s13,s24,22528
QAD v[224:227],v1,s[16:19],s13 offen sc1
QAF s13,s24,55296
QAD v[228:231],v1,s[16:19],s13 offen sc1
QAF s13,s24,88064
QAD v[232:235],v1,s[16:19],s13 offen sc1
QAF s13,s24,120832
QAD v[236:239],v1,s[16:19],s13 offen sc1
QAF s13,s24,23552
QAD v[240:243],v1,s[16:19],s13 offen sc1
QAF s13,s24,56320
QAD v[244:247],v1,s[16:19],s13 offen sc1
QAF s13,s24,89088
QAD v[248:251],v1,s[16:19],s13 offen sc1
QAF s13,s24,121856
QAD v[252:255],v1,s[16:19],s13 offen sc1
QAH vmcnt(14)
QAF s13,s24,24576
QAF m0,s14,0
s_nop 0
QAD v1,s[16:19],s13 offen sc1 lds
QAF s13,s24,57344
QAF m0,s14,1024
s_nop 0
QAD v1,s[16:19],s13 offen sc1 lds
QAF s13,s24,90112
QAF m0,s14,2048
s_nop 0
QAD v1,s[16:19],s13 offen sc1 lds
QAF s13,s24,122880
QAF m0,s14,3072
s_nop 0
QAD v1,s[16:19],s13 offen sc1 lds
QAF s13,s24,25600
QAF m0,s14,4096
s_nop 0
QAD v1,s[16:19],s13 offen sc1 lds
QAF s13,s24,58368
QAF m0,s14,5120
s_nop 0
QAD v1,s[16:19],s13 offen sc1 lds
QAF s13,s24,91136
QAF m0,s14,6144
s_nop 0
QAD v1,s[16:19],s13 offen sc1 lds
QAF s13,s24,123904
QAF m0,s14,7168
s_nop 0
QAD v1,s[16:19],s13 offen sc1 lds
QAF s13,s24,26624
QAF m0,s14,8192
s_nop 0
QAD v1,s[16:19],s13 offen sc1 lds
QAF s13,s24,59392
QAF m0,s14,9216
s_nop 0
QAD v1,s[16:19],s13 offen sc1 lds
QAF s13,s24,92160
QAF m0,s14,10240
s_nop 0
QAD v1,s[16:19],s13 offen sc1 lds
QAF s13,s24,124928
QAF m0,s14,11264
s_nop 0
QAD v1,s[16:19],s13 offen sc1 lds
QAF s13,s24,27648
QAF m0,s14,12288
s_nop 0
QAD v1,s[16:19],s13 offen sc1 lds
QAF s13,s24,60416
QAF m0,s14,13312
s_nop 0
QAD v1,s[16:19],s13 offen sc1 lds
QAF s13,s24,93184
QAF m0,s14,14336
s_nop 0
QAD v1,s[16:19],s13 offen sc1 lds
QAF s13,s24,125952
QAF m0,s14,15360
s_nop 0
QAD v1,s[16:19],s13 offen sc1 lds
QAF s13,s24,28672
QAF m0,s14,16384
s_nop 0
QAD v1,s[16:19],s13 offen sc1 lds
QAF s13,s24,61440
QAF m0,s14,17408
s_nop 0
QAD v1,s[16:19],s13 offen sc1 lds
QAF s13,s24,94208
QAF m0,s14,18432
s_nop 0
QAD v1,s[16:19],s13 offen sc1 lds
QAF s13,s24,126976
QAF m0,s14,19456
s_nop 0
QAD v1,s[16:19],s13 offen sc1 lds
QAF s13,s24,29696
QAF m0,s14,20480
s_nop 0
QAD v1,s[16:19],s13 offen sc1 lds
QAF s13,s24,62464
QAF m0,s14,21504
s_nop 0
QAD v1,s[16:19],s13 offen sc1 lds
QAF s13,s24,95232
QAF m0,s14,22528
s_nop 0
QAD v1,s[16:19],s13 offen sc1 lds
QAF s13,s24,128000
QAF m0,s14,23552
s_nop 0
QAD v1,s[16:19],s13 offen sc1 lds
QAF s13,s24,30720
QAF m0,s14,24576
s_nop 0
QAD v1,s[16:19],s13 offen sc1 lds
QAF s13,s24,63488
QAF m0,s14,25600
s_nop 0
QAD v1,s[16:19],s13 offen sc1 lds
QAF s13,s24,96256
QAF m0,s14,26624
s_nop 0
QAD v1,s[16:19],s13 offen sc1 lds
QAF s13,s24,129024
QAF m0,s14,27648
s_nop 0
QAD v1,s[16:19],s13 offen sc1 lds
QAF s13,s24,31744
QAF m0,s14,28672
s_nop 0
QAD v1,s[16:19],s13 offen sc1 lds
QAF s13,s24,64512
QAF m0,s14,29696
s_nop 0
QAD v1,s[16:19],s13 offen sc1 lds
QAF s13,s24,97280
QAF m0,s14,30720
s_nop 0
QAD v1,s[16:19],s13 offen sc1 lds
QAF s13,s24,130048
QAF m0,s14,31744
s_nop 0
QAD v1,s[16:19],s13 offen sc1 lds
QAS s12,s84,11
QAS s13,s9,19
QAF s12,s12,s13
QAF s12,s12,50331648
QAS s14,s9,13
QAS s25,s84,15
QAF s25,s25,s14
QAF s26,s25,46137344
QAF s27,s26,4096
QCC v5,v0,2,2
QBW v6,5,v0
QBC v7,v6,3,v5
QAI v7,6,v7
QCC v8,v0,4,1
QBC v7,v8,5,v7
QAM v8,3,v0
QBC v7,v8,3,v7
QAM v3,31,v0
QAI v5,3,v3
QBJ s9,0
s_cbranch_scc1 lay_pc4_ok
QAT s15,0
lay_pc4:
QAF s13,s56,557056
QBR v8,off,s[16:19],s13 sc1
QAH vmcnt(0)
QCA s13,v8
QAT s14,64
s_nop 0
s_cmp_ge_i32 s13,s14
s_cbranch_scc1 lay_pc4_ok
s_sleep 40
QAF s15,s15,1
QBN s15,400000
s_cbranch_scc1 lay_pc4
lay_pc4_ok:
QAS s14,s9,13
QBJ s9,0
s_cbranch_scc1 lay_gw_ok
QAI v8,3,v1
QAQ v10,4
v_writelane_b32 v10,5,0
QAT s15,0
lay_gw:
QAF s13,s56,602112
QAT exec_hi,0
QAT exec_lo,0xffffffff
QBR v9,v8,s[16:19],s13 offen sc1
QBY exec,-1
QAH vmcnt(0)
v_cmp_ge_u32 vcc,v9,v10
s_nop 1
QBO s13,vcc_lo,0xffffffff
QBS s13,0xffffffff
s_cbranch_scc1 lay_gw_ok
s_sleep 2
QAF s15,s15,1
QBN s15,400000
s_cbranch_scc1 lay_gw
lay_gw_ok:
s_barrier
QAD v[16:19],v1,s[16:19],s26 offen offset:0 sc1
QAD v[20:23],v1,s[16:19],s26 offen offset:1024 sc1
QAD v[24:27],v1,s[16:19],s26 offen offset:2048 sc1
QAD v[28:31],v1,s[16:19],s26 offen offset:3072 sc1
QAD v[32:35],v1,s[16:19],s27 offen offset:0 sc1
QAD v[36:39],v1,s[16:19],s27 offen offset:1024 sc1
QAD v[40:43],v1,s[16:19],s27 offen offset:2048 sc1
QAD v[44:47],v1,s[16:19],s27 offen offset:3072 sc1
QAF m0,s14,0
QAF s13,s12,0
QAD v1,s[16:19],s13 offen sc1 lds
QAF m0,s14,1024
QAF s13,s12,1024
QAD v1,s[16:19],s13 offen sc1 lds
QAF m0,s14,2048
QAF s13,s12,131072
QAD v1,s[16:19],s13 offen sc1 lds
QAF m0,s14,3072
QAF s13,s12,132096
QAD v1,s[16:19],s13 offen sc1 lds
QAF m0,s14,4096
QAF s13,s12,262144
QAD v1,s[16:19],s13 offen sc1 lds
QAF m0,s14,5120
QAF s13,s12,263168
QAD v1,s[16:19],s13 offen sc1 lds
QAF m0,s14,6144
QAF s13,s12,393216
QAD v1,s[16:19],s13 offen sc1 lds
QAF m0,s14,7168
QAF s13,s12,394240
QAD v1,s[16:19],s13 offen sc1 lds
QAH vmcnt(8)
QAI v64,16,v16
QAM v65,0xffff0000,v16
QAI v66,16,v17
QAM v67,0xffff0000,v17
QAI v68,16,v18
QAM v69,0xffff0000,v18
QAI v70,16,v19
QAM v71,0xffff0000,v19
QAI v72,16,v20
QAM v73,0xffff0000,v20
QAI v74,16,v21
QAM v75,0xffff0000,v21
QAI v76,16,v22
QAM v77,0xffff0000,v22
QAI v78,16,v23
QAM v79,0xffff0000,v23
QAI v80,16,v24
QAM v81,0xffff0000,v24
QAI v82,16,v25
QAM v83,0xffff0000,v25
QAI v84,16,v26
QAM v85,0xffff0000,v26
QAI v86,16,v27
QAM v87,0xffff0000,v27
QAI v88,16,v28
QAM v89,0xffff0000,v28
QAI v90,16,v29
QAM v91,0xffff0000,v29
QAI v92,16,v30
QAM v93,0xffff0000,v30
QAI v94,16,v31
QAM v95,0xffff0000,v31
QAI v96,16,v32
QAM v97,0xffff0000,v32
QAI v98,16,v33
QAM v99,0xffff0000,v33
QAI v100,16,v34
QAM v101,0xffff0000,v34
QAI v102,16,v35
QAM v103,0xffff0000,v35
QAI v104,16,v36
QAM v105,0xffff0000,v36
QAI v106,16,v37
QAM v107,0xffff0000,v37
QAI v108,16,v38
QAM v109,0xffff0000,v38
QAI v110,16,v39
QAM v111,0xffff0000,v39
QAI v112,16,v40
QAM v113,0xffff0000,v40
QAI v114,16,v41
QAM v115,0xffff0000,v41
QAI v116,16,v42
QAM v117,0xffff0000,v42
QAI v118,16,v43
QAM v119,0xffff0000,v43
QAI v120,16,v44
QAM v121,0xffff0000,v44
QAI v122,16,v45
QAM v123,0xffff0000,v45
QAI v124,16,v46
QAM v125,0xffff0000,v46
QAI v126,16,v47
QAM v127,0xffff0000,v47
QAH vmcnt(0)
s_barrier
QAA v[48:49],v7 offset:0
QAA v[50:51],v7 offset:256
QAA v[52:53],v7 offset:1024
QAA v[54:55],v7 offset:1280
QAA v[56:57],v7 offset:2048
QAA v[58:59],v7 offset:2304
QAH lgkmcnt(4)
QAB v[64:79],a[0:3],v[48:51],v[64:79]
QAA v[60:61],v7 offset:3072
QAA v[62:63],v7 offset:3328
QAB v[80:95],a[4:7],v[48:51],v[80:95]
QAB v[96:111],a[8:11],v[48:51],v[96:111]
QAB v[112:127],a[12:15],v[48:51],v[112:127]
QAH lgkmcnt(4)
QAB v[64:79],a[16:19],v[52:55],v[64:79]
QAA v[48:49],v7 offset:4096
QAA v[50:51],v7 offset:4352
QAG a[0:3],v4 offset:0
QAB v[80:95],a[20:23],v[52:55],v[80:95]
QAG a[4:7],v4 offset:1024
QAB v[96:111],a[24:27],v[52:55],v[96:111]
QAG a[8:11],v4 offset:2048
QAB v[112:127],a[28:31],v[52:55],v[112:127]
QAG a[12:15],v4 offset:3072
QAH lgkmcnt(8)
QAB v[64:79],a[32:35],v[56:59],v[64:79]
QAA v[52:53],v7 offset:5120
QAA v[54:55],v7 offset:5376
QAG a[16:19],v4 offset:4096
QAB v[80:95],a[36:39],v[56:59],v[80:95]
QAG a[20:23],v4 offset:5120
QAB v[96:111],a[40:43],v[56:59],v[96:111]
QAG a[24:27],v4 offset:6144
QAB v[112:127],a[44:47],v[56:59],v[112:127]
QAG a[28:31],v4 offset:7168
QAH lgkmcnt(12)
QAB v[64:79],a[48:51],v[60:63],v[64:79]
QAA v[56:57],v7 offset:6144
QAA v[58:59],v7 offset:6400
QAG a[32:35],v4 offset:8192
QAB v[80:95],a[52:55],v[60:63],v[80:95]
QAG a[36:39],v4 offset:9216
QAB v[96:111],a[56:59],v[60:63],v[96:111]
QAG a[40:43],v4 offset:10240
QAB v[112:127],a[60:63],v[60:63],v[112:127]
QAG a[44:47],v4 offset:11264
QAH lgkmcnt(15)
QAB v[64:79],a[64:67],v[48:51],v[64:79]
QAA v[60:61],v7 offset:7168
QAA v[62:63],v7 offset:7424
QAG a[48:51],v4 offset:12288
QAB v[80:95],a[68:71],v[48:51],v[80:95]
QAG a[52:55],v4 offset:13312
QAB v[96:111],a[72:75],v[48:51],v[96:111]
QAG a[56:59],v4 offset:14336
QAB v[112:127],a[76:79],v[48:51],v[112:127]
QAG a[60:63],v4 offset:15360
QAH lgkmcnt(15)
QAB v[64:79],a[80:83],v[52:55],v[64:79]
QAA v[48:49],v7 offset:8192
QAA v[50:51],v7 offset:8448
QAG a[64:67],v4 offset:16384
QAB v[80:95],a[84:87],v[52:55],v[80:95]
QAG a[68:71],v4 offset:17408
QAB v[96:111],a[88:91],v[52:55],v[96:111]
QAG a[72:75],v4 offset:18432
QAB v[112:127],a[92:95],v[52:55],v[112:127]
QAG a[76:79],v4 offset:19456
QAH lgkmcnt(15)
QAB v[64:79],a[96:99],v[56:59],v[64:79]
QAA v[52:53],v7 offset:9216
QAA v[54:55],v7 offset:9472
QAG a[80:83],v4 offset:20480
QAB v[80:95],a[100:103],v[56:59],v[80:95]
QAG a[84:87],v4 offset:21504
QAB v[96:111],a[104:107],v[56:59],v[96:111]
QAG a[88:91],v4 offset:22528
QAB v[112:127],a[108:111],v[56:59],v[112:127]
QAG a[92:95],v4 offset:23552
QAH lgkmcnt(15)
QAB v[64:79],a[112:115],v[60:63],v[64:79]
QAA v[56:57],v7 offset:10240
QAA v[58:59],v7 offset:10496
QAG a[96:99],v4 offset:24576
QAB v[80:95],a[116:119],v[60:63],v[80:95]
QAG a[100:103],v4 offset:25600
QAB v[96:111],a[120:123],v[60:63],v[96:111]
QAG a[104:107],v4 offset:26624
QAB v[112:127],a[124:127],v[60:63],v[112:127]
QAG a[108:111],v4 offset:27648
QAH lgkmcnt(15)
QAB v[64:79],a[128:131],v[48:51],v[64:79]
QAA v[60:61],v7 offset:11264
QAA v[62:63],v7 offset:11520
QAG a[112:115],v4 offset:28672
QAB v[80:95],a[132:135],v[48:51],v[80:95]
QAG a[116:119],v4 offset:29696
QAB v[96:111],a[136:139],v[48:51],v[96:111]
QAG a[120:123],v4 offset:30720
QAB v[112:127],a[140:143],v[48:51],v[112:127]
QAG a[124:127],v4 offset:31744
QAH lgkmcnt(15)
QAB v[64:79],a[144:147],v[52:55],v[64:79]
QAA v[48:49],v7 offset:12288
QAA v[50:51],v7 offset:12544
QAB v[80:95],a[148:151],v[52:55],v[80:95]
QAB v[96:111],a[152:155],v[52:55],v[96:111]
QAB v[112:127],a[156:159],v[52:55],v[112:127]
QAH lgkmcnt(12)
QAB v[64:79],a[160:163],v[56:59],v[64:79]
QAA v[52:53],v7 offset:13312
QAA v[54:55],v7 offset:13568
QAB v[80:95],a[164:167],v[56:59],v[80:95]
QAB v[96:111],a[168:171],v[56:59],v[96:111]
QAB v[112:127],a[172:175],v[56:59],v[112:127]
QAH lgkmcnt(8)
QAB v[64:79],a[176:179],v[60:63],v[64:79]
QAA v[56:57],v7 offset:14336
QAA v[58:59],v7 offset:14592
QAB v[80:95],a[180:183],v[60:63],v[80:95]
QAB v[96:111],a[184:187],v[60:63],v[96:111]
QAB v[112:127],a[188:191],v[60:63],v[112:127]
QAH lgkmcnt(4)
QAB v[64:79],a[192:195],v[48:51],v[64:79]
QAA v[60:61],v7 offset:15360
QAA v[62:63],v7 offset:15616
QAB v[80:95],a[196:199],v[48:51],v[80:95]
QAB v[96:111],a[200:203],v[48:51],v[96:111]
QAB v[112:127],a[204:207],v[48:51],v[112:127]
QAH lgkmcnt(4)
QAB v[64:79],a[208:211],v[52:55],v[64:79]
QAA v[48:49],v7 offset:16384
QAA v[50:51],v7 offset:16640
QAB v[80:95],a[212:215],v[52:55],v[80:95]
QAB v[96:111],a[216:219],v[52:55],v[96:111]
QAB v[112:127],a[220:223],v[52:55],v[112:127]
QAH lgkmcnt(4)
QAB v[64:79],a[224:227],v[56:59],v[64:79]
QAA v[52:53],v7 offset:17408
QAA v[54:55],v7 offset:17664
QAB v[80:95],a[228:231],v[56:59],v[80:95]
QAB v[96:111],a[232:235],v[56:59],v[96:111]
QAB v[112:127],a[236:239],v[56:59],v[112:127]
QAH lgkmcnt(4)
QAB v[64:79],a[240:243],v[60:63],v[64:79]
QAA v[56:57],v7 offset:18432
QAA v[58:59],v7 offset:18688
QAB v[80:95],a[244:247],v[60:63],v[80:95]
QAB v[96:111],a[248:251],v[60:63],v[96:111]
QAB v[112:127],a[252:255],v[60:63],v[112:127]
QAH lgkmcnt(4)
QAB v[64:79],v[128:131],v[48:51],v[64:79]
QAA v[60:61],v7 offset:19456
QAA v[62:63],v7 offset:19712
QAB v[80:95],v[132:135],v[48:51],v[80:95]
QAB v[96:111],v[136:139],v[48:51],v[96:111]
QAB v[112:127],v[140:143],v[48:51],v[112:127]
QAH lgkmcnt(4)
QAB v[64:79],v[144:147],v[52:55],v[64:79]
QAA v[48:49],v7 offset:20480
QAA v[50:51],v7 offset:20736
QAB v[80:95],v[148:151],v[52:55],v[80:95]
QAB v[96:111],v[152:155],v[52:55],v[96:111]
QAB v[112:127],v[156:159],v[52:55],v[112:127]
QAH lgkmcnt(4)
QAB v[64:79],v[160:163],v[56:59],v[64:79]
QAA v[52:53],v7 offset:21504
QAA v[54:55],v7 offset:21760
QAB v[80:95],v[164:167],v[56:59],v[80:95]
QAB v[96:111],v[168:171],v[56:59],v[96:111]
QAB v[112:127],v[172:175],v[56:59],v[112:127]
QAH lgkmcnt(4)
QAB v[64:79],v[176:179],v[60:63],v[64:79]
QAA v[56:57],v7 offset:22528
QAA v[58:59],v7 offset:22784
QAB v[80:95],v[180:183],v[60:63],v[80:95]
QAB v[96:111],v[184:187],v[60:63],v[96:111]
QAB v[112:127],v[188:191],v[60:63],v[112:127]
QAH lgkmcnt(4)
QAB v[64:79],v[192:195],v[48:51],v[64:79]
QAA v[60:61],v7 offset:23552
QAA v[62:63],v7 offset:23808
QAB v[80:95],v[196:199],v[48:51],v[80:95]
QAB v[96:111],v[200:203],v[48:51],v[96:111]
QAB v[112:127],v[204:207],v[48:51],v[112:127]
QAH lgkmcnt(4)
QAB v[64:79],v[208:211],v[52:55],v[64:79]
QAA v[48:49],v7 offset:24576
QAA v[50:51],v7 offset:24832
QAB v[80:95],v[212:215],v[52:55],v[80:95]
QAB v[96:111],v[216:219],v[52:55],v[96:111]
QAB v[112:127],v[220:223],v[52:55],v[112:127]
QAH lgkmcnt(4)
QAB v[64:79],v[224:227],v[56:59],v[64:79]
QAA v[52:53],v7 offset:25600
QAA v[54:55],v7 offset:25856
QAB v[80:95],v[228:231],v[56:59],v[80:95]
QAB v[96:111],v[232:235],v[56:59],v[96:111]
QAB v[112:127],v[236:239],v[56:59],v[112:127]
QAH lgkmcnt(4)
QAB v[64:79],v[240:243],v[60:63],v[64:79]
QAA v[56:57],v7 offset:26624
QAA v[58:59],v7 offset:26880
QAB v[80:95],v[244:247],v[60:63],v[80:95]
QAB v[96:111],v[248:251],v[60:63],v[96:111]
QAB v[112:127],v[252:255],v[60:63],v[112:127]
QAH lgkmcnt(4)
QAB v[64:79],a[0:3],v[48:51],v[64:79]
QAA v[60:61],v7 offset:27648
QAA v[62:63],v7 offset:27904
QAB v[80:95],a[4:7],v[48:51],v[80:95]
QAB v[96:111],a[8:11],v[48:51],v[96:111]
QAB v[112:127],a[12:15],v[48:51],v[112:127]
QAH lgkmcnt(4)
QAB v[64:79],a[16:19],v[52:55],v[64:79]
QAA v[48:49],v7 offset:28672
QAA v[50:51],v7 offset:28928
QAB v[80:95],a[20:23],v[52:55],v[80:95]
QAB v[96:111],a[24:27],v[52:55],v[96:111]
QAB v[112:127],a[28:31],v[52:55],v[112:127]
QAH lgkmcnt(4)
QAB v[64:79],a[32:35],v[56:59],v[64:79]
QAA v[52:53],v7 offset:29696
QAA v[54:55],v7 offset:29952
QAB v[80:95],a[36:39],v[56:59],v[80:95]
QAB v[96:111],a[40:43],v[56:59],v[96:111]
QAB v[112:127],a[44:47],v[56:59],v[112:127]
QAH lgkmcnt(4)
QAB v[64:79],a[48:51],v[60:63],v[64:79]
QAA v[56:57],v7 offset:30720
QAA v[58:59],v7 offset:30976
QAB v[80:95],a[52:55],v[60:63],v[80:95]
QAB v[96:111],a[56:59],v[60:63],v[96:111]
QAB v[112:127],a[60:63],v[60:63],v[112:127]
QAH lgkmcnt(4)
QAB v[64:79],a[64:67],v[48:51],v[64:79]
QAA v[60:61],v7 offset:31744
QAA v[62:63],v7 offset:32000
QAB v[80:95],a[68:71],v[48:51],v[80:95]
QAB v[96:111],a[72:75],v[48:51],v[96:111]
QAB v[112:127],a[76:79],v[48:51],v[112:127]
QAH lgkmcnt(4)
QAB v[64:79],a[80:83],v[52:55],v[64:79]
QAB v[80:95],a[84:87],v[52:55],v[80:95]
QAB v[96:111],a[88:91],v[52:55],v[96:111]
QAB v[112:127],a[92:95],v[52:55],v[112:127]
QAH lgkmcnt(2)
QAB v[64:79],a[96:99],v[56:59],v[64:79]
QAB v[80:95],a[100:103],v[56:59],v[80:95]
QAB v[96:111],a[104:107],v[56:59],v[96:111]
QAB v[112:127],a[108:111],v[56:59],v[112:127]
QAH lgkmcnt(0)
QAB v[64:79],a[112:115],v[60:63],v[64:79]
QAB v[80:95],a[116:119],v[60:63],v[80:95]
QAB v[96:111],a[120:123],v[60:63],v[96:111]
QAB v[112:127],a[124:127],v[60:63],v[112:127]
QAE v128,v64,v65
QAE v129,v66,v67
QAE v130,v68,v69
QAE v131,v70,v71
QAE v132,v72,v73
QAE v133,v74,v75
QAE v134,v76,v77
QAE v135,v78,v79
QAE v136,v80,v81
QAE v137,v82,v83
QAE v138,v84,v85
QAE v139,v86,v87
QAE v140,v88,v89
QAE v141,v90,v91
QAE v142,v92,v93
QAE v143,v94,v95
QAE v144,v96,v97
QAE v145,v98,v99
QAE v146,v100,v101
QAE v147,v102,v103
QAE v148,v104,v105
QAE v149,v106,v107
QAE v150,v108,v109
QAE v151,v110,v111
QAE v152,v112,v113
QAE v153,v114,v115
QAE v154,v116,v117
QAE v155,v118,v119
QAE v156,v120,v121
QAE v157,v122,v123
QAE v158,v124,v125
QAE v159,v126,v127
QBS s75,0
s_cbranch_scc1 inv_mid
QAT s20,s82
QAT s21,s83
QAT s22,2097152
QAT s23,0x20000
QAS s15,s9,15
QAF s15,s15,32768
QAM v8,15,v3
QBH v8,v8,v6
QAI v8,4,v8
QBC v8,v3,8,v8
QBF v8,s15,v8
QBW v9,4,v0
QAM v10,15,v0
QAI v4,4,v10
QBC v4,v9,10,v4
QBH v10,v10,v9
QAI v10,4,v10
QBC v10,v9,8,v10
QBF v10,s15,v10
QAS s13,s84,15
QAS s15,s9,8
QAF s13,s13,s15
QBH v9,0,v8
QAY v9,v[128:131]
QBH v9,32,v8
QAY v9,v[132:135]
QBH v9,64,v8
QAY v9,v[136:139]
QBH v9,96,v8
QAY v9,v[140:143]
QBH v9,128,v8
QAY v9,v[144:147]
QBH v9,160,v8
QAY v9,v[148:151]
QBH v9,192,v8
QAY v9,v[152:155]
QBH v9,224,v8
QAY v9,v[156:159]
QAH lgkmcnt(0)
QBH v9,0,v10
QAG v[16:19],v9 offset:0
QBH v9,64,v10
QAG v[20:23],v9 offset:1024
QBH v9,128,v10
QAG v[24:27],v9 offset:2048
QBH v9,192,v10
QAG v[28:31],v9 offset:3072
QBH v9,0,v10
QAG v[32:35],v9 offset:4096
QBH v9,64,v10
QAG v[36:39],v9 offset:5120
QBH v9,128,v10
QAG v[40:43],v9 offset:6144
QBH v9,192,v10
QAG v[44:47],v9 offset:7168
QAH lgkmcnt(7)
QAL v[16:19],v4,s[20:23],s13 offen
QAF s13,s13,4096
QAH lgkmcnt(6)
QAL v[20:23],v4,s[20:23],s13 offen
QAF s13,s13,4096
QAH lgkmcnt(5)
QAL v[24:27],v4,s[20:23],s13 offen
QAF s13,s13,4096
QAH lgkmcnt(4)
QAL v[28:31],v4,s[20:23],s13 offen
QAF s13,s13,4096
QAH lgkmcnt(3)
QAL v[32:35],v4,s[20:23],s13 offen
QAF s13,s13,4096
QAH lgkmcnt(2)
QAL v[36:39],v4,s[20:23],s13 offen
QAF s13,s13,4096
QAH lgkmcnt(1)
QAL v[40:43],v4,s[20:23],s13 offen
QAF s13,s13,4096
QAH lgkmcnt(0)
QAL v[44:47],v4,s[20:23],s13 offen
QAF s13,s13,4096
s_branch inv_iend
inv_mid:
QAF s26,s25,2097152
QAF s27,s26,4096
QAF s28,s25,4096
QAL v[128:131],v1,s[16:19],s26 offen offset:0 sc1
QAL v[132:135],v1,s[16:19],s26 offen offset:1024 sc1
QAL v[136:139],v1,s[16:19],s26 offen offset:2048 sc1
QAL v[140:143],v1,s[16:19],s26 offen offset:3072 sc1
QAL v[144:147],v1,s[16:19],s27 offen offset:0 sc1
QAL v[148:151],v1,s[16:19],s27 offen offset:1024 sc1
QAL v[152:155],v1,s[16:19],s27 offen offset:2048 sc1
QAL v[156:159],v1,s[16:19],s27 offen offset:3072 sc1
s_barrier
QAN v[48:49],v[64:65],v[66:67]
QBI v[50:51],v[64:65],v[64:65]
QAP v[50:51],v[66:67],v[66:67],v[50:51]
QAN v[48:49],v[48:49],v[68:69]
QAP v[50:51],v[68:69],v[68:69],v[50:51]
QAN v[48:49],v[48:49],v[70:71]
QAP v[50:51],v[70:71],v[70:71],v[50:51]
QAN v[48:49],v[48:49],v[72:73]
QAP v[50:51],v[72:73],v[72:73],v[50:51]
QAN v[48:49],v[48:49],v[74:75]
QAP v[50:51],v[74:75],v[74:75],v[50:51]
QAN v[48:49],v[48:49],v[76:77]
QAP v[50:51],v[76:77],v[76:77],v[50:51]
QAN v[48:49],v[48:49],v[78:79]
QAP v[50:51],v[78:79],v[78:79],v[50:51]
QAN v[48:49],v[48:49],v[80:81]
QAP v[50:51],v[80:81],v[80:81],v[50:51]
QAN v[48:49],v[48:49],v[82:83]
QAP v[50:51],v[82:83],v[82:83],v[50:51]
QAN v[48:49],v[48:49],v[84:85]
QAP v[50:51],v[84:85],v[84:85],v[50:51]
QAN v[48:49],v[48:49],v[86:87]
QAP v[50:51],v[86:87],v[86:87],v[50:51]
QAN v[48:49],v[48:49],v[88:89]
QAP v[50:51],v[88:89],v[88:89],v[50:51]
QAN v[48:49],v[48:49],v[90:91]
QAP v[50:51],v[90:91],v[90:91],v[50:51]
QAN v[48:49],v[48:49],v[92:93]
QAP v[50:51],v[92:93],v[92:93],v[50:51]
QAN v[48:49],v[48:49],v[94:95]
QAP v[50:51],v[94:95],v[94:95],v[50:51]
QAN v[48:49],v[48:49],v[96:97]
QAP v[50:51],v[96:97],v[96:97],v[50:51]
QAN v[48:49],v[48:49],v[98:99]
QAP v[50:51],v[98:99],v[98:99],v[50:51]
QAN v[48:49],v[48:49],v[100:101]
QAP v[50:51],v[100:101],v[100:101],v[50:51]
QAN v[48:49],v[48:49],v[102:103]
QAP v[50:51],v[102:103],v[102:103],v[50:51]
QAN v[48:49],v[48:49],v[104:105]
QAP v[50:51],v[104:105],v[104:105],v[50:51]
QAN v[48:49],v[48:49],v[106:107]
QAP v[50:51],v[106:107],v[106:107],v[50:51]
QAN v[48:49],v[48:49],v[108:109]
QAP v[50:51],v[108:109],v[108:109],v[50:51]
QAN v[48:49],v[48:49],v[110:111]
QAP v[50:51],v[110:111],v[110:111],v[50:51]
QAN v[48:49],v[48:49],v[112:113]
QAP v[50:51],v[112:113],v[112:113],v[50:51]
QAN v[48:49],v[48:49],v[114:115]
QAP v[50:51],v[114:115],v[114:115],v[50:51]
QAN v[48:49],v[48:49],v[116:117]
QAP v[50:51],v[116:117],v[116:117],v[50:51]
QAN v[48:49],v[48:49],v[118:119]
QAP v[50:51],v[118:119],v[118:119],v[50:51]
QAN v[48:49],v[48:49],v[120:121]
QAP v[50:51],v[120:121],v[120:121],v[50:51]
QAN v[48:49],v[48:49],v[122:123]
QAP v[50:51],v[122:123],v[122:123],v[50:51]
QAN v[48:49],v[48:49],v[124:125]
QAP v[50:51],v[124:125],v[124:125],v[50:51]
QAN v[48:49],v[48:49],v[126:127]
QAP v[50:51],v[126:127],v[126:127],v[50:51]
QAU v48,v48,v49
QAU v49,v50,v51
QAQ v50,v48
QAQ v51,v49
QAS s13,s9,8
QBF v52,s13,v5
QCH v48,v50
QCH v49,v51
QAN v[48:49],v[48:49],v[50:51]
QCG v52,v[48:49] offset:32768
QAH lgkmcnt(0)
s_barrier
ds_read_b64 v[48:49],v5 offset:32768
ds_read_b64 v[50:51],v5 offset:33024
ds_read_b64 v[52:53],v5 offset:33280
ds_read_b64 v[54:55],v5 offset:33536
QAH lgkmcnt(0)
QAN v[48:49],v[48:49],v[50:51]
QAN v[48:49],v[48:49],v[52:53]
QAN v[48:49],v[48:49],v[54:55]
QAW v48,0x3b000000,v48
QAW v49,0x3b000000,v49
v_fma_f32 v49,-v48,v48,v49
v_max_f32 v49,0,v49
QAE v50,v49,v48
QAM v48,0xffff0000,v50
QAI v49,16,v50
QAU v49,0x3727c5ac,v49
QAE v49,v49,v49
QAM v49,0xffff0000,v49
v_sqrt_f32 v49,v49
s_nop 0
QAE v49,v49,v49
QAM v49,0xffff0000,v49
v_rcp_f32 v50,v49
s_nop 0
QAW v52,-v48,v50
QAP v[54:55],v[64:65],v[50:51],v[52:53] op_sel_hi:[1,0,0]
s_nop 0
QAE v16,v54,v55
QAP v[56:57],v[66:67],v[50:51],v[52:53] op_sel_hi:[1,0,0]
s_nop 0
QAE v17,v56,v57
QAP v[54:55],v[68:69],v[50:51],v[52:53] op_sel_hi:[1,0,0]
s_nop 0
QAE v18,v54,v55
QAP v[56:57],v[70:71],v[50:51],v[52:53] op_sel_hi:[1,0,0]
s_nop 0
QAE v19,v56,v57
QAP v[54:55],v[72:73],v[50:51],v[52:53] op_sel_hi:[1,0,0]
s_nop 0
QAE v20,v54,v55
QAP v[56:57],v[74:75],v[50:51],v[52:53] op_sel_hi:[1,0,0]
s_nop 0
QAE v21,v56,v57
QAP v[54:55],v[76:77],v[50:51],v[52:53] op_sel_hi:[1,0,0]
s_nop 0
QAE v22,v54,v55
QAP v[56:57],v[78:79],v[50:51],v[52:53] op_sel_hi:[1,0,0]
s_nop 0
QAE v23,v56,v57
QAP v[54:55],v[80:81],v[50:51],v[52:53] op_sel_hi:[1,0,0]
s_nop 0
QAE v24,v54,v55
QAP v[56:57],v[82:83],v[50:51],v[52:53] op_sel_hi:[1,0,0]
s_nop 0
QAE v25,v56,v57
QAP v[54:55],v[84:85],v[50:51],v[52:53] op_sel_hi:[1,0,0]
s_nop 0
QAE v26,v54,v55
QAP v[56:57],v[86:87],v[50:51],v[52:53] op_sel_hi:[1,0,0]
s_nop 0
QAE v27,v56,v57
QAP v[54:55],v[88:89],v[50:51],v[52:53] op_sel_hi:[1,0,0]
s_nop 0
QAE v28,v54,v55
QAP v[56:57],v[90:91],v[50:51],v[52:53] op_sel_hi:[1,0,0]
s_nop 0
QAE v29,v56,v57
QAP v[54:55],v[92:93],v[50:51],v[52:53] op_sel_hi:[1,0,0]
s_nop 0
QAE v30,v54,v55
QAP v[56:57],v[94:95],v[50:51],v[52:53] op_sel_hi:[1,0,0]
s_nop 0
QAE v31,v56,v57
QAP v[54:55],v[96:97],v[50:51],v[52:53] op_sel_hi:[1,0,0]
s_nop 0
QAE v32,v54,v55
QAP v[56:57],v[98:99],v[50:51],v[52:53] op_sel_hi:[1,0,0]
s_nop 0
QAE v33,v56,v57
QAP v[54:55],v[100:101],v[50:51],v[52:53] op_sel_hi:[1,0,0]
s_nop 0
QAE v34,v54,v55
QAP v[56:57],v[102:103],v[50:51],v[52:53] op_sel_hi:[1,0,0]
s_nop 0
QAE v35,v56,v57
QAP v[54:55],v[104:105],v[50:51],v[52:53] op_sel_hi:[1,0,0]
s_nop 0
QAE v36,v54,v55
QAP v[56:57],v[106:107],v[50:51],v[52:53] op_sel_hi:[1,0,0]
s_nop 0
QAE v37,v56,v57
QAP v[54:55],v[108:109],v[50:51],v[52:53] op_sel_hi:[1,0,0]
s_nop 0
QAE v38,v54,v55
QAP v[56:57],v[110:111],v[50:51],v[52:53] op_sel_hi:[1,0,0]
s_nop 0
QAE v39,v56,v57
QAP v[54:55],v[112:113],v[50:51],v[52:53] op_sel_hi:[1,0,0]
s_nop 0
QAE v40,v54,v55
QAP v[56:57],v[114:115],v[50:51],v[52:53] op_sel_hi:[1,0,0]
s_nop 0
QAE v41,v56,v57
QAP v[54:55],v[116:117],v[50:51],v[52:53] op_sel_hi:[1,0,0]
s_nop 0
QAE v42,v54,v55
QAP v[56:57],v[118:119],v[50:51],v[52:53] op_sel_hi:[1,0,0]
s_nop 0
QAE v43,v56,v57
QAP v[54:55],v[120:121],v[50:51],v[52:53] op_sel_hi:[1,0,0]
s_nop 0
QAE v44,v54,v55
QAP v[56:57],v[122:123],v[50:51],v[52:53] op_sel_hi:[1,0,0]
s_nop 0
QAE v45,v56,v57
QAP v[54:55],v[124:125],v[50:51],v[52:53] op_sel_hi:[1,0,0]
s_nop 0
QAE v46,v54,v55
QAP v[56:57],v[126:127],v[50:51],v[52:53] op_sel_hi:[1,0,0]
s_nop 0
QAE v47,v56,v57
QAL v[16:19],v1,s[16:19],s25 offen offset:0 sc1
QAL v[20:23],v1,s[16:19],s25 offen offset:1024 sc1
QAL v[24:27],v1,s[16:19],s25 offen offset:2048 sc1
QAL v[28:31],v1,s[16:19],s25 offen offset:3072 sc1
QAL v[32:35],v1,s[16:19],s28 offen offset:0 sc1
QAL v[36:39],v1,s[16:19],s28 offen offset:1024 sc1
QAL v[40:43],v1,s[16:19],s28 offen offset:2048 sc1
QAL v[44:47],v1,s[16:19],s28 offen offset:3072 sc1
inv_iend:
QBJ s75,0
s_cbranch_scc1 lay_end
QAH vmcnt(0)
s_barrier
QCB s13,s84,2
QAS s13,s13,8
QBO s14,s84,3
QAS s14,s14,2
QAF s13,s13,s14
QAF s13,s13,s56
QAF s13,s13,1638400
QAQ v2,1
QBJ s9,0
s_cbranch_scc1 lay_a6
QBY exec,1
QCD v2,off,s[16:19],s13 sc1
QBY exec,-1
lay_a6:
s_branch lay_next
lay_col:
QBK s85,129
s_cbranch_scc1 lay_next
QAS s84,s85,1
QCB s13,s9,1
QAF s84,s84,s13
QBO s29,s9,1
QAS s30,s29,12
QAF s30,s30,53477376
QAS s31,s29,11
s_xor_b32 s13,s31,0
QAF s13,s13,s30
QAF s13,s13,0
QAD a[128:131],v1,s[16:19],s13 offen sc1
s_xor_b32 s13,s31,1024
QAF s13,s13,s30
QAF s13,s13,0
QAD a[132:135],v1,s[16:19],s13 offen sc1
s_xor_b32 s13,s31,2048
QAF s13,s13,s30
QAF s13,s13,0
QAD a[136:139],v1,s[16:19],s13 offen sc1
s_xor_b32 s13,s31,3072
QAF s13,s13,s30
QAF s13,s13,0
QAD a[140:143],v1,s[16:19],s13 offen sc1
s_xor_b32 s13,s31,0
QAF s13,s13,s30
QAF s13,s13,8192
QAD a[144:147],v1,s[16:19],s13 offen sc1
s_xor_b32 s13,s31,1024
QAF s13,s13,s30
QAF s13,s13,8192
QAD a[148:151],v1,s[16:19],s13 offen sc1
s_xor_b32 s13,s31,2048
QAF s13,s13,s30
QAF s13,s13,8192
QAD a[152:155],v1,s[16:19],s13 offen sc1
s_xor_b32 s13,s31,3072
QAF s13,s13,s30
QAF s13,s13,8192
QAD a[156:159],v1,s[16:19],s13 offen sc1
QAT s13,53493760
QAD a[160:163],v1,s[16:19],s13 offen sc1
QAT s13,53494784
QAD a[164:167],v1,s[16:19],s13 offen sc1
QAT s13,53495808
QAD a[168:171],v1,s[16:19],s13 offen sc1
QAT s13,53496832
QAD a[172:175],v1,s[16:19],s13 offen sc1
QAT s13,53497856
QAD a[176:179],v1,s[16:19],s13 offen sc1
QAT s13,53498880
QAD a[180:183],v1,s[16:19],s13 offen sc1
QAT s13,53499904
QAD a[184:187],v1,s[16:19],s13 offen sc1
QAT s13,53500928
QAD a[188:191],v1,s[16:19],s13 offen sc1
QAT s13,53501952
QAD a[192:195],v1,s[16:19],s13 offen sc1
QAT s13,53502976
QAD a[196:199],v1,s[16:19],s13 offen sc1
QAT s13,53504000
QAD a[200:203],v1,s[16:19],s13 offen sc1
QAT s13,53505024
QAD a[204:207],v1,s[16:19],s13 offen sc1
QAF s13,s30,28672
QAD v[176:179],v1,s[16:19],s13 offen offset:0 sc1
QAD v[180:183],v1,s[16:19],s13 offen offset:1024 sc1
QAD v[184:187],v1,s[16:19],s13 offen offset:2048 sc1
QAD v[188:191],v1,s[16:19],s13 offen offset:3072 sc1
QAF s13,s30,36864
QAD v[192:195],v1,s[16:19],s13 offen offset:0 sc1
QAD v[196:199],v1,s[16:19],s13 offen offset:1024 sc1
QAD v[200:203],v1,s[16:19],s13 offen offset:2048 sc1
QAD v[204:207],v1,s[16:19],s13 offen offset:3072 sc1
QAF s13,s30,45056
QAD v[208:211],v1,s[16:19],s13 offen offset:0 sc1
QAD v[212:215],v1,s[16:19],s13 offen offset:1024 sc1
QAD v[216:219],v1,s[16:19],s13 offen offset:2048 sc1
QAD v[220:223],v1,s[16:19],s13 offen offset:3072 sc1
QAF s13,s30,53248
QAD v[224:227],v1,s[16:19],s13 offen offset:0 sc1
QAD v[228:231],v1,s[16:19],s13 offen offset:1024 sc1
QAD v[232:235],v1,s[16:19],s13 offen offset:2048 sc1
QAD v[236:239],v1,s[16:19],s13 offen offset:3072 sc1
s_min_u32 s13,s84,256
QAS s13,s13,13
QAS s14,s29,12
QAF s13,s13,s14
QAF s13,s13,57671680
QAD v[240:243],v1,s[16:19],s13 offen offset:0 sc1
QAD v[244:247],v1,s[16:19],s13 offen offset:1024 sc1
QAD v[248:251],v1,s[16:19],s13 offen offset:2048 sc1
QAD v[252:255],v1,s[16:19],s13 offen offset:3072 sc1
lay_colp:
QAS s84,s85,1
QCB s13,s9,1
QAF s84,s84,s13
QBO s29,s9,1
QBO s12,s84,255
QCB s13,s12,4
QAS s13,s13,17
QBO s14,s12,15
QAS s14,s14,7
QAF s24,s13,s14
QAS s13,s29,16
QAF s24,s24,s13
QAF s25,s24,48234496
QAF s26,s24,50331648
QCB s28,s9,1
QAS s28,s28,13
QAS s27,s9,12
QBW v2,3,v0
QAM v3,7,v0
QCC v4,v0,4,1
QAI v4,2,v4
QBH v4,v3,v4
QAI v4,4,v4
QBC v4,v2,11,v4
QCC v5,v0,2,2
QBW v6,5,v0
QBC v7,v6,2,v5
QAI v7,7,v7
QCC v8,v0,4,1
QBC v7,v8,5,v7
QAM v8,3,v0
QBC v7,v8,3,v7
QBF v7,s28,v7
QBW v8,1,v5
QBC v9,v8,6,v7
QBH v8,1,v8
QBC v10,v8,6,v7
QBS s84,256
s_cselect_b64 vcc,-1,0
QBL s15,64,0
QAX v9,v9,v10,vcc
QAS s13,s29,12
v_subrev_u32 v11,s13,v9
v_subrev_u32 v12,s13,v10
QBF v9,s13,v9
QBF v10,s13,v10
QAF s13,s27,16384
QBF v13,s13,v1
QBH v14,4096,v13
QAM v15,31,v0
QAM v8,7,v0
QBH v8,v8,v6
QAI v8,4,v8
QBC v15,v15,7,v8
QAF s13,s27,32768
QBF v15,s13,v15
QBH v8,v3,v2
QAI v8,4,v8
QBC v8,v2,7,v8
QBF v5,s13,v8
QAI v7,4,v3
QBC v7,v2,11,v7
QBF v7,s15,v7
QBS s12,0
QBL s13,4,8
QAQ v8,0x80000000
v_cmp_gt_u32 vcc,s13,v3
s_nop 1
QAX v7,v8,v7,vcc
QBJ s9,0
s_cbranch_scc1 lay_pc5_ok
QAT s15,0
lay_pc5:
QAF s13,s56,557056
QBR v16,off,s[16:19],s13 sc1
QAH vmcnt(0)
QCA s13,v16
QAT s14,64
s_nop 0
s_cmp_ge_i32 s13,s14
s_cbranch_scc1 lay_pc5_ok
s_sleep 40
QAF s15,s15,1
QBN s15,400000
s_cbranch_scc1 lay_pc5
lay_pc5_ok:
QBJ s9,0
s_cbranch_scc1 lay_fw_ok
QAI v16,3,v1
QAQ v18,16
QAQ v17,4
v_cmp_le_u32 vcc,224,v1
s_nop 1
QAX v18,v18,v17,vcc
QAT s15,0
lay_fw:
QAF s13,s56,598016
QAT exec_hi,0
QAT exec_lo,0x3fffff
QBR v17,v16,s[16:19],s13 offen sc1
QBY exec,-1
QAH vmcnt(0)
v_cmp_ge_u32 vcc,v17,v18
s_nop 1
QBO s13,vcc_lo,0x3fffff
QBS s13,0x3fffff
s_cbranch_scc1 lay_fw_ok
s_sleep 2
QAF s15,s15,1
QBN s15,400000
s_cbranch_scc1 lay_fw
lay_fw_ok:
s_barrier
QBK s84,257
s_cbranch_scc1 col_idle
QAF m0,s27,0
QAF s13,s25,0
QAD v4,s[16:19],s13 offen sc1 lds
QAF m0,s27,1024
QAF s13,s25,16384
QAD v4,s[16:19],s13 offen sc1 lds
QAF m0,s27,2048
QAF s13,s25,32768
QAD v4,s[16:19],s13 offen sc1 lds
QAF m0,s27,3072
QAF s13,s25,49152
QAD v4,s[16:19],s13 offen sc1 lds
QAH vmcnt(0)
s_barrier
QAA v[16:17],v9 offset:0
QAA v[32:33],v10 offset:0
QAA v[18:19],v9 offset:1024
QAA v[34:35],v10 offset:1024
QAA v[20:21],v9 offset:2048
QAA v[36:37],v10 offset:2048
QAA v[22:23],v9 offset:3072
QAA v[38:39],v10 offset:3072
QAA v[24:25],v11 offset:4096
QAA v[40:41],v12 offset:4096
QAA v[26:27],v11 offset:5120
QAA v[42:43],v12 offset:5120
QAA v[28:29],v11 offset:6144
QAA v[44:45],v12 offset:6144
QAA v[30:31],v11 offset:7168
QAA v[46:47],v12 offset:7168
QAH lgkmcnt(0)
QBJ s12,0
s_cbranch_scc1 col_cplx
QAR v[32:33],0
QAR v[34:35],0
QAR v[36:37],0
QAR v[38:39],0
QAR v[40:41],0
QAR v[42:43],0
QAR v[44:45],0
QAR v[46:47],0
col_cplx:
QAB v[64:79],v[16:19],a[128:131],0
QBH v48,0x80008000,v16
QBH v49,0x80008000,v17
QAB v[80:95],v[32:35],a[128:131],0
QBH v50,0x80008000,v18
QBH v51,0x80008000,v19
QAB v[64:79],v[20:23],a[132:135],v[64:79]
QBH v52,0x80008000,v20
QBH v53,0x80008000,v21
QAB v[80:95],v[36:39],a[132:135],v[80:95]
QBH v54,0x80008000,v22
QBH v55,0x80008000,v23
QAB v[64:79],v[24:27],a[136:139],v[64:79]
QBH v56,0x80008000,v24
QBH v57,0x80008000,v25
QAB v[80:95],v[40:43],a[136:139],v[80:95]
QBH v58,0x80008000,v26
QBH v59,0x80008000,v27
QAB v[64:79],v[28:31],a[140:143],v[64:79]
QBH v60,0x80008000,v28
QBH v61,0x80008000,v29
QAB v[80:95],v[44:47],a[140:143],v[80:95]
QBH v62,0x80008000,v30
QBH v63,0x80008000,v31
QAB v[64:79],v[32:35],a[144:147],v[64:79]
QAB v[80:95],v[48:51],a[144:147],v[80:95]
QAB v[64:79],v[36:39],a[148:151],v[64:79]
QAB v[80:95],v[52:55],a[148:151],v[80:95]
QAB v[64:79],v[40:43],a[152:155],v[64:79]
QAB v[80:95],v[56:59],a[152:155],v[80:95]
QAB v[64:79],v[44:47],a[156:159],v[64:79]
QAB v[80:95],v[60:63],a[156:159],v[80:95]
QAM v120,0xffff0000,v240
QAI v104,16,v240
QAM v121,0xffff0000,v241
QAI v105,16,v241
QAM v122,0xffff0000,v242
QAI v106,16,v242
QAM v123,0xffff0000,v243
QAI v107,16,v243
QAM v124,0xffff0000,v244
QAI v108,16,v244
QAM v125,0xffff0000,v245
QAI v109,16,v245
QAM v126,0xffff0000,v246
QAI v110,16,v246
QAM v127,0xffff0000,v247
QAI v111,16,v247
QAM v128,0xffff0000,v248
QAI v112,16,v248
QAM v129,0xffff0000,v249
QAI v113,16,v249
QAM v130,0xffff0000,v250
QAI v114,16,v250
QAM v131,0xffff0000,v251
QAI v115,16,v251
QAM v132,0xffff0000,v252
QAI v116,16,v252
QAM v133,0xffff0000,v253
QAI v117,16,v253
QAM v134,0xffff0000,v254
QAI v118,16,v254
QAM v135,0xffff0000,v255
QAI v119,16,v255
QBI v[96:97],v[64:65],v[176:177]
QBI v[98:99],v[80:81],v[176:177]
QAP v[96:97],v[80:81],v[192:193],v[96:97]
QAP v[98:99],v[64:65],v[192:193],v[98:99] neg_lo:[1,0,0] neg_hi:[1,0,0]
QAE v16,v96,v97
QAE v32,v98,v99
QBI v[100:101],v[66:67],v[178:179]
QBI v[102:103],v[82:83],v[178:179]
QAP v[100:101],v[82:83],v[194:195],v[100:101]
QAP v[102:103],v[66:67],v[194:195],v[102:103] neg_lo:[1,0,0] neg_hi:[1,0,0]
QAE v17,v100,v101
QAE v33,v102,v103
QBI v[96:97],v[68:69],v[180:181]
QBI v[98:99],v[84:85],v[180:181]
QAP v[96:97],v[84:85],v[196:197],v[96:97]
QAP v[98:99],v[68:69],v[196:197],v[98:99] neg_lo:[1,0,0] neg_hi:[1,0,0]
QAE v18,v96,v97
QAE v34,v98,v99
QBI v[100:101],v[70:71],v[182:183]
QBI v[102:103],v[86:87],v[182:183]
QAP v[100:101],v[86:87],v[198:199],v[100:101]
QAP v[102:103],v[70:71],v[198:199],v[102:103] neg_lo:[1,0,0] neg_hi:[1,0,0]
QAE v19,v100,v101
QAE v35,v102,v103
QBI v[96:97],v[72:73],v[184:185]
QBI v[98:99],v[88:89],v[184:185]
QAP v[96:97],v[88:89],v[200:201],v[96:97]
QAP v[98:99],v[72:73],v[200:201],v[98:99] neg_lo:[1,0,0] neg_hi:[1,0,0]
QAE v20,v96,v97
QAE v36,v98,v99
QBI v[100:101],v[74:75],v[186:187]
QBI v[102:103],v[90:91],v[186:187]
QAP v[100:101],v[90:91],v[202:203],v[100:101]
QAP v[102:103],v[74:75],v[202:203],v[102:103] neg_lo:[1,0,0] neg_hi:[1,0,0]
QAE v21,v100,v101
QAE v37,v102,v103
QBI v[96:97],v[76:77],v[188:189]
QBI v[98:99],v[92:93],v[188:189]
QAP v[96:97],v[92:93],v[204:205],v[96:97]
QAP v[98:99],v[76:77],v[204:205],v[98:99] neg_lo:[1,0,0] neg_hi:[1,0,0]
QAE v22,v96,v97
QAE v38,v98,v99
QBI v[100:101],v[78:79],v[190:191]
QBI v[102:103],v[94:95],v[190:191]
QAP v[100:101],v[94:95],v[206:207],v[100:101]
QAP v[102:103],v[78:79],v[206:207],v[102:103] neg_lo:[1,0,0] neg_hi:[1,0,0]
QAE v23,v100,v101
QAE v39,v102,v103
QAB v[64:79],a[160:163],v[16:19],0
QAB v[80:95],a[160:163],v[32:35],0
QAB v[64:79],a[164:167],v[20:23],v[64:79]
QAB v[80:95],a[164:167],v[36:39],v[80:95]
QAB v[64:79],a[168:171],v[32:35],v[64:79]
QAB v[80:95],a[176:179],v[16:19],v[80:95]
QAB v[64:79],a[172:175],v[36:39],v[64:79]
QAB v[80:95],a[180:183],v[20:23],v[80:95]
s_nop 3
QBI v[96:97],v[64:65],v[104:105]
s_nop 6
QBI v[98:99],v[80:81],v[104:105]
QAP v[96:97],v[80:81],v[120:121],v[96:97] neg_lo:[1,0,0] neg_hi:[1,0,0]
QAP v[98:99],v[64:65],v[120:121],v[98:99]
QAE v16,v96,v97
QAE v32,v98,v99
QBI v[100:101],v[66:67],v[106:107]
QBI v[102:103],v[82:83],v[106:107]
QAP v[100:101],v[82:83],v[122:123],v[100:101] neg_lo:[1,0,0] neg_hi:[1,0,0]
QAP v[102:103],v[66:67],v[122:123],v[102:103]
QAE v17,v100,v101
QAE v33,v102,v103
QBI v[96:97],v[68:69],v[108:109]
QBI v[98:99],v[84:85],v[108:109]
QAP v[96:97],v[84:85],v[124:125],v[96:97] neg_lo:[1,0,0] neg_hi:[1,0,0]
QAP v[98:99],v[68:69],v[124:125],v[98:99]
QAE v18,v96,v97
QAE v34,v98,v99
QBI v[100:101],v[70:71],v[110:111]
QBI v[102:103],v[86:87],v[110:111]
QAP v[100:101],v[86:87],v[126:127],v[100:101] neg_lo:[1,0,0] neg_hi:[1,0,0]
QAP v[102:103],v[70:71],v[126:127],v[102:103]
QAE v19,v100,v101
QAE v35,v102,v103
QBI v[96:97],v[72:73],v[112:113]
QBI v[98:99],v[88:89],v[112:113]
QAP v[96:97],v[88:89],v[128:129],v[96:97] neg_lo:[1,0,0] neg_hi:[1,0,0]
QAP v[98:99],v[72:73],v[128:129],v[98:99]
QAE v20,v96,v97
QAE v36,v98,v99
QBI v[100:101],v[74:75],v[114:115]
QBI v[102:103],v[90:91],v[114:115]
QAP v[100:101],v[90:91],v[130:131],v[100:101] neg_lo:[1,0,0] neg_hi:[1,0,0]
QAP v[102:103],v[74:75],v[130:131],v[102:103]
QAE v21,v100,v101
QAE v37,v102,v103
QBI v[96:97],v[76:77],v[116:117]
QBI v[98:99],v[92:93],v[116:117]
QAP v[96:97],v[92:93],v[132:133],v[96:97] neg_lo:[1,0,0] neg_hi:[1,0,0]
QAP v[98:99],v[76:77],v[132:133],v[98:99]
QAE v22,v96,v97
QAE v38,v98,v99
QBI v[100:101],v[78:79],v[118:119]
QBI v[102:103],v[94:95],v[118:119]
QAP v[100:101],v[94:95],v[134:135],v[100:101] neg_lo:[1,0,0] neg_hi:[1,0,0]
QAP v[102:103],v[78:79],v[134:135],v[102:103]
QAE v23,v100,v101
QAE v39,v102,v103
QAB v[64:79],v[16:19],a[184:187],0
QAB v[80:95],v[32:35],a[184:187],0
QAB v[64:79],v[20:23],a[188:191],v[64:79]
QAB v[80:95],v[36:39],a[188:191],v[80:95]
QAB v[64:79],v[32:35],a[200:203],v[64:79]
QAB v[80:95],v[16:19],a[192:195],v[80:95]
QAB v[64:79],v[36:39],a[204:207],v[64:79]
QAB v[80:95],v[20:23],a[196:199],v[80:95]
s_nop 3
QBI v[96:97],v[64:65],v[208:209]
s_nop 6
QBI v[98:99],v[80:81],v[208:209]
QAP v[96:97],v[80:81],v[224:225],v[96:97] neg_lo:[1,0,0] neg_hi:[1,0,0]
QAP v[98:99],v[64:65],v[224:225],v[98:99]
QAE v16,v96,v97
QAE v32,v98,v99
QBI v[100:101],v[66:67],v[210:211]
QBI v[102:103],v[82:83],v[210:211]
QAP v[100:101],v[82:83],v[226:227],v[100:101] neg_lo:[1,0,0] neg_hi:[1,0,0]
QAP v[102:103],v[66:67],v[226:227],v[102:103]
QAE v17,v100,v101
QAE v33,v102,v103
QBI v[96:97],v[68:69],v[212:213]
QBI v[98:99],v[84:85],v[212:213]
QAP v[96:97],v[84:85],v[228:229],v[96:97] neg_lo:[1,0,0] neg_hi:[1,0,0]
QAP v[98:99],v[68:69],v[228:229],v[98:99]
QAE v18,v96,v97
QAE v34,v98,v99
QBI v[100:101],v[70:71],v[214:215]
QBI v[102:103],v[86:87],v[214:215]
QAP v[100:101],v[86:87],v[230:231],v[100:101] neg_lo:[1,0,0] neg_hi:[1,0,0]
QAP v[102:103],v[70:71],v[230:231],v[102:103]
QAE v19,v100,v101
QAE v35,v102,v103
QBI v[96:97],v[72:73],v[216:217]
QBI v[98:99],v[88:89],v[216:217]
QAP v[96:97],v[88:89],v[232:233],v[96:97] neg_lo:[1,0,0] neg_hi:[1,0,0]
QAP v[98:99],v[72:73],v[232:233],v[98:99]
QAE v20,v96,v97
QAE v36,v98,v99
QBI v[100:101],v[74:75],v[218:219]
QBI v[102:103],v[90:91],v[218:219]
QAP v[100:101],v[90:91],v[234:235],v[100:101] neg_lo:[1,0,0] neg_hi:[1,0,0]
QAP v[102:103],v[74:75],v[234:235],v[102:103]
QAE v21,v100,v101
QAE v37,v102,v103
QBI v[96:97],v[76:77],v[220:221]
QBI v[98:99],v[92:93],v[220:221]
QAP v[96:97],v[92:93],v[236:237],v[96:97] neg_lo:[1,0,0] neg_hi:[1,0,0]
QAP v[98:99],v[76:77],v[236:237],v[98:99]
QAE v22,v96,v97
QAE v38,v98,v99
QBI v[100:101],v[78:79],v[222:223]
QBI v[102:103],v[94:95],v[222:223]
QAP v[100:101],v[94:95],v[238:239],v[100:101] neg_lo:[1,0,0] neg_hi:[1,0,0]
QAP v[102:103],v[78:79],v[238:239],v[102:103]
QAE v23,v100,v101
QAE v39,v102,v103
QAY v13,v[16:19] offset:0
QAY v13,v[32:35] offset:2048
QAY v13,v[20:23] offset:1024
QAY v13,v[36:39] offset:3072
QBH v48,0x80008000,v32
QBH v49,0x80008000,v33
QBH v50,0x80008000,v34
QBH v51,0x80008000,v35
QBH v52,0x80008000,v36
QBH v53,0x80008000,v37
QBH v54,0x80008000,v38
QBH v55,0x80008000,v39
QAH lgkmcnt(0)
s_barrier
QAG v[24:27],v14 offset:0
QAG v[40:43],v14 offset:2048
QAG v[28:31],v14 offset:1024
QAG v[44:47],v14 offset:3072
QAB v[64:79],v[16:19],a[128:131],0
QAB v[80:95],v[32:35],a[128:131],0
QAB v[64:79],v[48:51],a[144:147],v[64:79]
QAB v[80:95],v[16:19],a[144:147],v[80:95]
QAB v[64:79],v[20:23],a[132:135],v[64:79]
QAB v[80:95],v[36:39],a[132:135],v[80:95]
QAB v[64:79],v[52:55],a[148:151],v[64:79]
QAB v[80:95],v[20:23],a[148:151],v[80:95]
QAH lgkmcnt(0)
QAB v[64:79],v[24:27],a[136:139],v[64:79]
QBH v56,0x80008000,v40
QBH v57,0x80008000,v41
QBH v58,0x80008000,v42
QBH v59,0x80008000,v43
QAB v[80:95],v[40:43],a[136:139],v[80:95]
QAB v[80:95],v[24:27],a[152:155],v[80:95]
QAB v[64:79],v[56:59],a[152:155],v[64:79]
QAB v[64:79],v[28:31],a[140:143],v[64:79]
QBH v60,0x80008000,v44
QBH v61,0x80008000,v45
QBH v62,0x80008000,v46
QBH v63,0x80008000,v47
QAB v[80:95],v[44:47],a[140:143],v[80:95]
QAB v[80:95],v[28:31],a[156:159],v[80:95]
QAB v[64:79],v[60:63],a[156:159],v[64:79]
s_nop 11
QAE v176,v64,v65
QAE v177,v66,v67
QAE v178,v68,v69
QAE v179,v70,v71
QAY v15,v[176:179]
QAE v180,v72,v73
QAE v181,v74,v75
QAE v182,v76,v77
QAE v183,v78,v79
QBH v8,32,v15
QAY v8,v[180:183]
QAE v184,v80,v81
QAE v185,v82,v83
QAE v186,v84,v85
QAE v187,v86,v87
QBH v8,64,v15
QAY v8,v[184:187]
QAE v188,v88,v89
QAE v189,v90,v91
QAE v190,v92,v93
QAE v191,v94,v95
QBH v8,96,v15
QAY v8,v[188:191]
QAH lgkmcnt(0)
QAG v[16:19],v5 offset:0
QAG v[20:23],v5 offset:1024
QAG v[24:27],v5 offset:2048
QAG v[28:31],v5 offset:3072
QAF s13,s26,0
QAH lgkmcnt(3)
QAL v[16:19],v7,s[16:19],s13 offen sc1
QAF s13,s26,16384
QAH lgkmcnt(2)
QAL v[20:23],v7,s[16:19],s13 offen sc1
QAF s13,s26,32768
QAH lgkmcnt(1)
QAL v[24:27],v7,s[16:19],s13 offen sc1
QAF s13,s26,49152
QAH lgkmcnt(0)
QAL v[28:31],v7,s[16:19],s13 offen sc1
s_branch col_fin
col_idle:
s_barrier
s_barrier
col_fin:
QAH vmcnt(0)
s_barrier
QBO s13,s85,31
QAS s13,s13,7
QAF s13,s13,s56
QAF s13,s13,602112
QAQ v2,1
QBJ s9,0
s_cbranch_scc1 lay_a7
QBY exec,1
buffer_atomic_add v2,off,s[16:19],s13
QBY exec,-1
lay_a7:
lay_next:
QBJ s75,0
s_cbranch_scc1 lay_done
QAT s75,1
QAF s56,s56,1048576
s_branch lay_layer
lay_slowrole:
QBJ s9,0
s_cbranch_scc1 lay_rp2_ok
QAT s15,0
lay_rp2:
QBW v2,2,v1
QBR v3,v2,s[92:95],0 offen sc1
QAH vmcnt(0)
QBE s14,v3,0
QBE s13,v3,33
s_nop 1
QAF s14,s14,s13
QBE s13,v3,34
s_nop 1
QAF s14,s14,s13
QBE s13,v3,35
s_nop 1
QAF s14,s14,s13
QBE s13,v3,36
s_nop 1
QAF s14,s14,s13
QBE s13,v3,37
s_nop 1
QAF s14,s14,s13
QBE s13,v3,38
s_nop 1
QAF s14,s14,s13
QBE s13,v3,39
s_nop 1
QAF s14,s14,s13
QBE s13,v3,40
s_nop 1
QAF s14,s14,s13
QBE s13,v3,41
s_nop 1
QAF s14,s14,s13
QBE s13,v3,42
s_nop 1
QAF s14,s14,s13
QBE s13,v3,43
s_nop 1
QAF s14,s14,s13
QBE s13,v3,44
s_nop 1
QAF s14,s14,s13
QBE s13,v3,45
s_nop 1
QAF s14,s14,s13
QBE s13,v3,46
s_nop 1
QAF s14,s14,s13
QBE s13,v3,47
s_nop 1
QAF s14,s14,s13
QBK s14,256
s_cbranch_scc1 lay_rp2_ok
s_sleep 10
QAF s15,s15,1
QBN s15,400000
s_cbranch_scc1 lay_rp2
lay_rp2_ok:
s_barrier
QBS s9,0
s_cbranch_scc1 lay_rp2_w0
QBW v2,2,v1
QBR v3,v2,s[92:95],0 offen sc1
QAH vmcnt(0)
lay_rp2_w0:
QBP vcc,32,v3
s_nop 1
QBO s13,vcc_hi,0xfe
QBO s14,vcc_lo,1
s_or_b32 s13,s13,s14
QBS s13,0xff
QBL s13,1,0
QBE s14,v3,0
lay_irr:
s_nop 1
s_min_u32 s74,s14,32
s_sub_u32 s74,32,s74
s_movk_i32 s10,192
s_barrier
QAQ v2,0
QAQ v3,1
QBJ s9,0
s_cbranch_scc1 lay_g_a
QBY exec,1
buffer_atomic_add v3,off,s[92:95],s10 sc0
QAH vmcnt(0)
ds_write_b32 v2,v3
QAH lgkmcnt(0)
QBY exec,-1
lay_g_a:
s_barrier
ds_read_b32 v3,v2
QAH lgkmcnt(0)
QCA s60,v3
s_barrier
QAT s61,1
QBK s60,s74
s_cbranch_scc0 lay_adopt
s_sub_u32 s60,s60,s74
QBK s60,224
s_cbranch_scc1 lay_done
s_branch lay_bulk
lay_adopt:
s_sub_u32 s12,31,s60
lay_member:
QAT s3,1
QBW v44,4,v0
QAM v45,1,v44
QAI v45,1,v45
QAM v46,15,v0
QBH v45,v45,v46
QAI v44,13,v44
QBH v46,0,v45
QBC v32,v46,4,v44
QBH v46,4,v45
QBC v33,v46,4,v44
QBH v46,8,v45
QBC v34,v46,4,v44
QBH v46,12,v45
QBC v35,v46,4,v44
QAS s50,s12,8
QAS s13,s9,18
QAF s50,s50,s13
QAS s51,s12,17
QAS s13,s9,13
QAF s51,s51,s13
QAS s52,s9,13
QCB s13,s9,1
QAS s13,s13,3
QBH v45,s13,v0
QAI v36,4,v45
QBH v45,4,v45
QAI v37,4,v45
QAT s20,s42
QAT s21,s43
QAT s22,4194304
QAT s23,0x20000
QAF m0,s52,131072
QAF s13,s50,0
QAD v32,s[20:23],s13 offen nt lds
QAF m0,s52,132096
QAF s13,s50,32768
QAD v33,s[20:23],s13 offen nt lds
QAF m0,s52,133120
QAF s13,s50,65536
QAD v34,s[20:23],s13 offen nt lds
QAF m0,s52,134144
QAF s13,s50,98304
QAD v35,s[20:23],s13 offen nt lds
QAF m0,s52,135168
QAF s13,s50,131072
QAD v32,s[20:23],s13 offen nt lds
QAF m0,s52,136192
QAF s13,s50,163840
QAD v33,s[20:23],s13 offen nt lds
QAF m0,s52,137216
QAF s13,s50,196608
QAD v34,s[20:23],s13 offen nt lds
QAF m0,s52,138240
QAF s13,s50,229376
QAD v35,s[20:23],s13 offen nt lds
QAF m0,s52,0
QAF s13,s50,1048576
QAD v32,s[20:23],s13 offen nt lds
QAF m0,s52,1024
QAF s13,s50,1081344
QAD v33,s[20:23],s13 offen nt lds
QAF m0,s52,2048
QAF s13,s50,1114112
QAD v34,s[20:23],s13 offen nt lds
QAF m0,s52,3072
QAF s13,s50,1146880
QAD v35,s[20:23],s13 offen nt lds
QAF m0,s52,4096
QAF s13,s50,1179648
QAD v32,s[20:23],s13 offen nt lds
QAF m0,s52,5120
QAF s13,s50,1212416
QAD v33,s[20:23],s13 offen nt lds
QAF m0,s52,6144
QAF s13,s50,1245184
QAD v34,s[20:23],s13 offen nt lds
QAF m0,s52,7168
QAF s13,s50,1277952
QAD v35,s[20:23],s13 offen nt lds
QAF m0,s52,32768
QAF s13,s50,2097152
QAD v32,s[20:23],s13 offen nt lds
QAF m0,s52,33792
QAF s13,s50,2129920
QAD v33,s[20:23],s13 offen nt lds
QAF m0,s52,34816
QAF s13,s50,2162688
QAD v34,s[20:23],s13 offen nt lds
QAF m0,s52,35840
QAF s13,s50,2195456
QAD v35,s[20:23],s13 offen nt lds
QAF m0,s52,36864
QAF s13,s50,2228224
QAD v32,s[20:23],s13 offen nt lds
QAF m0,s52,37888
QAF s13,s50,2260992
QAD v33,s[20:23],s13 offen nt lds
QAF m0,s52,38912
QAF s13,s50,2293760
QAD v34,s[20:23],s13 offen nt lds
QAF m0,s52,39936
QAF s13,s50,2326528
QAD v35,s[20:23],s13 offen nt lds
QAF m0,s52,65536
QAF s13,s50,3145728
QAD v32,s[20:23],s13 offen nt lds
QAF m0,s52,66560
QAF s13,s50,3178496
QAD v33,s[20:23],s13 offen nt lds
QAF m0,s52,67584
QAF s13,s50,3211264
QAD v34,s[20:23],s13 offen nt lds
QAF m0,s52,68608
QAF s13,s50,3244032
QAD v35,s[20:23],s13 offen nt lds
QAF m0,s52,69632
QAF s13,s50,3276800
QAD v32,s[20:23],s13 offen nt lds
QAF m0,s52,70656
QAF s13,s50,3309568
QAD v33,s[20:23],s13 offen nt lds
QAF m0,s52,71680
QAF s13,s50,3342336
QAD v34,s[20:23],s13 offen nt lds
QAF m0,s52,72704
QAF s13,s50,3375104
QAD v35,s[20:23],s13 offen nt lds
QBO s13,s12,3
s_sub_u32 s13,s13,2
QBO s13,s13,3
QBS s13,3
s_cbranch_scc1 lay_nohelp
QAS s13,s13,2
QAF s13,s13,s9
QBO s14,s13,3
QBK s14,3
s_cbranch_scc1 lay_nohelp
QCB s13,s13,2
s_mul_i32 s13,s13,3
QAF s13,s13,s14
QAF s13,s13,0
QAS s13,s13,19
QBO s14,s12,28
s_or_b32 s14,s14,1
QAS s14,s14,8
QBK s13,4194304
QBL s24,s44,s40
QBL s25,s45,s41
QBL s15,2097152,0
QAT s26,4194304
QAT s27,0x20000
s_sub_u32 s13,s13,s15
QAF s13,s13,s14
QAI v48,13,v0
QBR v49,v48,s[24:27],s13 offen
QBR v50,v48,s[24:27],s13 offen offset:128
lay_nohelp:
QAI v1,4,v0
QBW v20,4,v0
QAM v21,15,v0
QAI v2,9,v20
QBC v2,v21,4,v2
QCC v22,v0,3,1
QAI v3,8,v22
QBC v3,v20,6,v3
QAM v22,7,v0
QBC v3,v22,3,v3
QAS s14,s9,10
QAF s14,s14,0
QBF v3,s14,v3
QAM v22,3,v0
QAI v4,6,v22
QCC v22,v0,5,1
QBC v4,v22,9,v4
QCC v22,v0,2,3
QBC v4,v22,3,v4
QBF v4,0,v4
QAI v5,7,v20
QCC v22,v0,2,2
QBC v5,v22,5,v5
QAM v22,1,v0
QBC v5,v22,4,v5
QAS s14,s9,9
QAF s14,s14,4096
QBF v5,s14,v5
QBF v22,2056,v5
QAS s15,s9,9
v_subrev_u32 v22,s15,v22
QAM v23,2,v0
v_cmp_ne_u32 vcc,0,v23
s_nop 1
QAX v5,v22,v5,vcc
QAQ v22,0x4444
QAQ v23,0xeeee
QAX v10,v22,v23,vcc
QAM v24,8,v0
v_cmp_ne_u32 vcc,0,v24
s_nop 1
QAX v11,v22,v23,vcc
QAI v6,7,v20
QAM v22,7,v0
QBC v6,v22,4,v6
QBF v6,4096,v6
QBW v7,5,v0
QAS s13,s9,1
QBF v7,s13,v7
QAI v7,13,v7
QCC v22,v0,3,2
QBC v7,v22,11,v7
QAM v22,7,v0
QBC v7,v22,3,v7
QAS s14,s12,6
QBF v7,s14,v7
QAI v8,4,v20
QAM v22,3,v0
QBC v8,v22,2,v8
QAS s14,s12,6
QAS s15,s9,11
QAF s14,s14,s15
QBF v8,s14,v8
QCC v24,v0,2,2
v_cmp_le_u32 vcc,1,v24
v_mul_u32_u24 v24,8192,v24
QBF v8,v8,v24
QAQ v24,0x80000000
QAX v8,v8,v24,vcc
QAT s36,0xcccccccc
QAT s37,0xcccccccc
QAT s33,0x42200000
QAS s14,s9,11
QAF s14,s14,0
QBF v19,s14,v1
QAI v30,8,v20
QCC v22,v0,3,1
QBC v30,v22,7,v30
QCC v22,v0,1,1
QBC v30,v22,6,v30
QCC v22,v0,2,1
QBC v30,v22,5,v30
QAM v22,1,v0
QBC v30,v22,4,v30
QBO s14,s12,0
s_mul_i32 s14,s14,8192
QBF v30,s14,v30
QBW v22,2,v21
QAM v23,3,v21
QBC v22,v23,2,v22
QAQ v24,0x3f80
QAQ v25,0x3f800000
QAQ v26,0x3f803f80
QAQ v12,0
QBP vcc,0,v22
s_nop 1
QAX v12,v12,v24,vcc
QBP vcc,1,v22
s_nop 1
QAX v12,v12,v25,vcc
v_cmp_le_u32 vcc,8,v22
s_nop 1
QAX v12,v12,v26,vcc
QAQ v13,0
QBP vcc,2,v22
s_nop 1
QAX v13,v13,v24,vcc
QBP vcc,3,v22
s_nop 1
QAX v13,v13,v25,vcc
v_cmp_le_u32 vcc,8,v22
s_nop 1
QAX v13,v13,v26,vcc
QAQ v14,0
QBP vcc,4,v22
s_nop 1
QAX v14,v14,v24,vcc
QBP vcc,5,v22
s_nop 1
QAX v14,v14,v25,vcc
v_cmp_le_u32 vcc,8,v22
s_nop 1
QAX v14,v14,v26,vcc
QAQ v15,0
QBP vcc,6,v22
s_nop 1
QAX v15,v15,v24,vcc
QBP vcc,7,v22
s_nop 1
QAX v15,v15,v25,vcc
v_cmp_le_u32 vcc,8,v22
s_nop 1
QAX v15,v15,v26,vcc
QBF v16,8192,v2
QAS s13,s9,14
QAF s13,s13,32768
QBF v17,s13,v1
QBF v18,0x10000,v17
QAT s34,0x3e0293ee
QCC v44,v0,5,1
QAI v44,4,v44
QCC v46,v0,4,1
QBC v44,v46,2,v44
QAI v45,2,v46
QCC v46,v0,2,1
QBF v44,v44,v46
QBC v45,v46,1,v45
QCC v46,v0,3,1
QBC v44,v46,3,v44
QBC v45,v46,3,v45
QAI v44,8,v44
QAM v46,1,v0
QBC v44,v46,3,v44
QCC v46,v0,1,1
QAS s13,s9,2
QBF v46,s13,v46
QBH v46,v46,v45
QBC v38,v46,4,v44
QBH v46,2,v46
QBC v39,v46,4,v44
QCC v44,v0,4,1
QAI v45,3,v44
QAI v44,4,v44
QCC v46,v0,5,1
QBC v44,v46,2,v44
QCC v46,v0,2,1
QBF v44,v44,v46
QBC v45,v46,2,v45
QAI v44,10,v44
QAM v46,1,v0
QBC v44,v46,3,v44
QCC v46,v0,1,1
QCC v47,v0,3,1
QBC v46,v47,1,v46
QBF v46,s13,v46
QBH v46,v46,v45
QBC v40,v46,4,v44
QAH vmcnt(24)
s_barrier
QAT s20,s44
QAT s21,s45
QAT s22,4194304
QAT s23,0x20000
QAF m0,s52,98304
QAF s13,s50,0
QAD v32,s[20:23],s13 offen nt lds
QAF m0,s52,99328
QAF s13,s50,32768
QAD v33,s[20:23],s13 offen nt lds
QAF m0,s52,100352
QAF s13,s50,65536
QAD v34,s[20:23],s13 offen nt lds
QAF m0,s52,101376
QAF s13,s50,98304
QAD v35,s[20:23],s13 offen nt lds
QAF m0,s52,102400
QAF s13,s50,131072
QAD v32,s[20:23],s13 offen nt lds
QAF m0,s52,103424
QAF s13,s50,163840
QAD v33,s[20:23],s13 offen nt lds
QAF m0,s52,104448
QAF s13,s50,196608
QAD v34,s[20:23],s13 offen nt lds
QAF m0,s52,105472
QAF s13,s50,229376
QAD v35,s[20:23],s13 offen nt lds
QBF v41,131072,v38
QBF v42,131072,v39
QAA a[0:1],v41 offset:0
QAA a[2:3],v41 offset:512
QAA a[4:5],v41 offset:8192
QAA a[6:7],v41 offset:8704
QAA a[8:9],v42 offset:0
QAA a[10:11],v42 offset:512
QAA a[12:13],v42 offset:8192
QAA a[14:15],v42 offset:8704
QAA a[16:17],v41 offset:16384
QAA a[18:19],v41 offset:16896
QAA a[20:21],v41 offset:24576
QAA a[22:23],v41 offset:25088
QAA a[24:25],v42 offset:16384
QAA a[26:27],v42 offset:16896
QAA a[28:29],v42 offset:24576
QAA a[30:31],v42 offset:25088
QAH lgkmcnt(0)
QAH vmcnt(24)
s_barrier
QAF m0,s52,131072
QAF s13,s50,1048576
QAD v32,s[20:23],s13 offen nt lds
QAF m0,s52,132096
QAF s13,s50,1081344
QAD v33,s[20:23],s13 offen nt lds
QAF m0,s52,133120
QAF s13,s50,1114112
QAD v34,s[20:23],s13 offen nt lds
QAF m0,s52,134144
QAF s13,s50,1146880
QAD v35,s[20:23],s13 offen nt lds
QAF m0,s52,135168
QAF s13,s50,1179648
QAD v32,s[20:23],s13 offen nt lds
QAF m0,s52,136192
QAF s13,s50,1212416
QAD v33,s[20:23],s13 offen nt lds
QAF m0,s52,137216
QAF s13,s50,1245184
QAD v34,s[20:23],s13 offen nt lds
QAF m0,s52,138240
QAF s13,s50,1277952
QAD v35,s[20:23],s13 offen nt lds
QBF v41,0,v38
QBF v42,0,v39
QAA a[32:33],v41 offset:0
QAA a[34:35],v41 offset:512
QAA a[36:37],v41 offset:8192
QAA a[38:39],v41 offset:8704
QAA a[40:41],v42 offset:0
QAA a[42:43],v42 offset:512
QAA a[44:45],v42 offset:8192
QAA a[46:47],v42 offset:8704
QAA a[48:49],v41 offset:16384
QAA a[50:51],v41 offset:16896
QAA a[52:53],v41 offset:24576
QAA a[54:55],v41 offset:25088
QAA a[56:57],v42 offset:16384
QAA a[58:59],v42 offset:16896
QAA a[60:61],v42 offset:24576
QAA a[62:63],v42 offset:25088
QAH lgkmcnt(0)
QAH vmcnt(24)
s_barrier
QAF m0,s52,0
QAF s13,s50,2097152
QAD v32,s[20:23],s13 offen nt lds
QAF m0,s52,1024
QAF s13,s50,2129920
QAD v33,s[20:23],s13 offen nt lds
QAF m0,s52,2048
QAF s13,s50,2162688
QAD v34,s[20:23],s13 offen nt lds
QAF m0,s52,3072
QAF s13,s50,2195456
QAD v35,s[20:23],s13 offen nt lds
QAF m0,s52,4096
QAF s13,s50,2228224
QAD v32,s[20:23],s13 offen nt lds
QAF m0,s52,5120
QAF s13,s50,2260992
QAD v33,s[20:23],s13 offen nt lds
QAF m0,s52,6144
QAF s13,s50,2293760
QAD v34,s[20:23],s13 offen nt lds
QAF m0,s52,7168
QAF s13,s50,2326528
QAD v35,s[20:23],s13 offen nt lds
QBF v41,32768,v38
QBF v42,32768,v39
QAA a[64:65],v41 offset:0
QAA a[66:67],v41 offset:512
QAA a[68:69],v41 offset:8192
QAA a[70:71],v41 offset:8704
QAA a[72:73],v42 offset:0
QAA a[74:75],v42 offset:512
QAA a[76:77],v42 offset:8192
QAA a[78:79],v42 offset:8704
QAA a[80:81],v41 offset:16384
QAA a[82:83],v41 offset:16896
QAA a[84:85],v41 offset:24576
QAA a[86:87],v41 offset:25088
QAA a[88:89],v42 offset:16384
QAA a[90:91],v42 offset:16896
QAA a[92:93],v42 offset:24576
QAA a[94:95],v42 offset:25088
QAH lgkmcnt(0)
QAH vmcnt(24)
s_barrier
QAF m0,s52,32768
QAF s13,s50,3145728
QAD v32,s[20:23],s13 offen nt lds
QAF m0,s52,33792
QAF s13,s50,3178496
QAD v33,s[20:23],s13 offen nt lds
QAF m0,s52,34816
QAF s13,s50,3211264
QAD v34,s[20:23],s13 offen nt lds
QAF m0,s52,35840
QAF s13,s50,3244032
QAD v35,s[20:23],s13 offen nt lds
QAF m0,s52,36864
QAF s13,s50,3276800
QAD v32,s[20:23],s13 offen nt lds
QAF m0,s52,37888
QAF s13,s50,3309568
QAD v33,s[20:23],s13 offen nt lds
QAF m0,s52,38912
QAF s13,s50,3342336
QAD v34,s[20:23],s13 offen nt lds
QAF m0,s52,39936
QAF s13,s50,3375104
QAD v35,s[20:23],s13 offen nt lds
QBF v41,65536,v38
QBF v42,65536,v39
QAA a[96:97],v41 offset:0
QAA a[98:99],v41 offset:512
QAA a[100:101],v41 offset:8192
QAA a[102:103],v41 offset:8704
QAA a[104:105],v42 offset:0
QAA a[106:107],v42 offset:512
QAA a[108:109],v42 offset:8192
QAA a[110:111],v42 offset:8704
QAA a[112:113],v41 offset:16384
QAA a[114:115],v41 offset:16896
QAA a[116:117],v41 offset:24576
QAA a[118:119],v41 offset:25088
QAA a[120:121],v42 offset:16384
QAA a[122:123],v42 offset:16896
QAA a[124:125],v42 offset:24576
QAA a[126:127],v42 offset:25088
QAH lgkmcnt(0)
QAH vmcnt(24)
s_barrier
QAT s20,s46
QAT s21,s47
QAT s22,4194304
QAT s23,0x20000
QAF m0,s52,65536
QAF s13,s51,0
QAD v36,s[20:23],s13 offen nt lds
QAF m0,s52,66560
QAF s13,s51,1024
QAD v37,s[20:23],s13 offen nt lds
QAF m0,s52,67584
QAF s13,s51,2048
QAD v36,s[20:23],s13 offen nt lds
QAF m0,s52,68608
QAF s13,s51,3072
QAD v37,s[20:23],s13 offen nt lds
QAF m0,s52,69632
QAF s13,s51,4096
QAD v36,s[20:23],s13 offen nt lds
QAF m0,s52,70656
QAF s13,s51,5120
QAD v37,s[20:23],s13 offen nt lds
QAF m0,s52,71680
QAF s13,s51,6144
QAD v36,s[20:23],s13 offen nt lds
QAF m0,s52,72704
QAF s13,s51,7168
QAD v37,s[20:23],s13 offen nt lds
QBF v41,98304,v38
QBF v42,98304,v39
QAA a[128:129],v41 offset:0
QAA a[130:131],v41 offset:512
QAA a[132:133],v41 offset:8192
QAA a[134:135],v41 offset:8704
QAA a[136:137],v42 offset:0
QAA a[138:139],v42 offset:512
QAA a[140:141],v42 offset:8192
QAA a[142:143],v42 offset:8704
QAA a[144:145],v41 offset:16384
QAA a[146:147],v41 offset:16896
QAA a[148:149],v41 offset:24576
QAA a[150:151],v41 offset:25088
QAA a[152:153],v42 offset:16384
QAA a[154:155],v42 offset:16896
QAA a[156:157],v42 offset:24576
QAA a[158:159],v42 offset:25088
QAH lgkmcnt(0)
QAH vmcnt(24)
s_barrier
QAF m0,s52,98304
QAF s13,s51,32768
QAD v36,s[20:23],s13 offen nt lds
QAF m0,s52,99328
QAF s13,s51,33792
QAD v37,s[20:23],s13 offen nt lds
QAF m0,s52,100352
QAF s13,s51,34816
QAD v36,s[20:23],s13 offen nt lds
QAF m0,s52,101376
QAF s13,s51,35840
QAD v37,s[20:23],s13 offen nt lds
QAF m0,s52,102400
QAF s13,s51,36864
QAD v36,s[20:23],s13 offen nt lds
QAF m0,s52,103424
QAF s13,s51,37888
QAD v37,s[20:23],s13 offen nt lds
QAF m0,s52,104448
QAF s13,s51,38912
QAD v36,s[20:23],s13 offen nt lds
QAF m0,s52,105472
QAF s13,s51,39936
QAD v37,s[20:23],s13 offen nt lds
QBF v41,131072,v38
QBF v42,131072,v39
QAA a[160:161],v41 offset:0
QAA a[162:163],v41 offset:512
QAA a[164:165],v41 offset:8192
QAA a[166:167],v41 offset:8704
QAA a[168:169],v42 offset:0
QAA a[170:171],v42 offset:512
QAA a[172:173],v42 offset:8192
QAA a[174:175],v42 offset:8704
QAA a[176:177],v41 offset:16384
QAA a[178:179],v41 offset:16896
QAA a[180:181],v41 offset:24576
QAA a[182:183],v41 offset:25088
QAA a[184:185],v42 offset:16384
QAA a[186:187],v42 offset:16896
QAA a[188:189],v42 offset:24576
QAA a[190:191],v42 offset:25088
QAH lgkmcnt(0)
QAH vmcnt(24)
s_barrier
QAF m0,s52,131072
QAF s13,s51,65536
QAD v36,s[20:23],s13 offen nt lds
QAF m0,s52,132096
QAF s13,s51,66560
QAD v37,s[20:23],s13 offen nt lds
QAF m0,s52,133120
QAF s13,s51,67584
QAD v36,s[20:23],s13 offen nt lds
QAF m0,s52,134144
QAF s13,s51,68608
QAD v37,s[20:23],s13 offen nt lds
QAF m0,s52,135168
QAF s13,s51,69632
QAD v36,s[20:23],s13 offen nt lds
QAF m0,s52,136192
QAF s13,s51,70656
QAD v37,s[20:23],s13 offen nt lds
QAF m0,s52,137216
QAF s13,s51,71680
QAD v36,s[20:23],s13 offen nt lds
QAF m0,s52,138240
QAF s13,s51,72704
QAD v37,s[20:23],s13 offen nt lds
QBF v41,0,v38
QBF v42,0,v39
QAA a[192:193],v41 offset:0
QAA a[194:195],v41 offset:512
QAA a[196:197],v41 offset:8192
QAA a[198:199],v41 offset:8704
QAA a[200:201],v42 offset:0
QAA a[202:203],v42 offset:512
QAA a[204:205],v42 offset:8192
QAA a[206:207],v42 offset:8704
QAA a[208:209],v41 offset:16384
QAA a[210:211],v41 offset:16896
QAA a[212:213],v41 offset:24576
QAA a[214:215],v41 offset:25088
QAA a[216:217],v42 offset:16384
QAA a[218:219],v42 offset:16896
QAA a[220:221],v42 offset:24576
QAA a[222:223],v42 offset:25088
QAH lgkmcnt(0)
QAH vmcnt(24)
s_barrier
QAF m0,s52,0
QAF s13,s51,98304
QAD v36,s[20:23],s13 offen nt lds
QAF m0,s52,1024
QAF s13,s51,99328
QAD v37,s[20:23],s13 offen nt lds
QAF m0,s52,2048
QAF s13,s51,100352
QAD v36,s[20:23],s13 offen nt lds
QAF m0,s52,3072
QAF s13,s51,101376
QAD v37,s[20:23],s13 offen nt lds
QAF m0,s52,4096
QAF s13,s51,102400
QAD v36,s[20:23],s13 offen nt lds
QAF m0,s52,5120
QAF s13,s51,103424
QAD v37,s[20:23],s13 offen nt lds
QAF m0,s52,6144
QAF s13,s51,104448
QAD v36,s[20:23],s13 offen nt lds
QAF m0,s52,7168
QAF s13,s51,105472
QAD v37,s[20:23],s13 offen nt lds
QBF v41,32768,v38
QBF v42,32768,v39
QAA a[224:225],v41 offset:0
QAA a[226:227],v41 offset:512
QAA a[228:229],v41 offset:8192
QAA a[230:231],v41 offset:8704
QAA a[232:233],v42 offset:0
QAA a[234:235],v42 offset:512
QAA a[236:237],v42 offset:8192
QAA a[238:239],v42 offset:8704
QAA a[240:241],v41 offset:16384
QAA a[242:243],v41 offset:16896
QAA a[244:245],v41 offset:24576
QAA a[246:247],v41 offset:25088
QAA a[248:249],v42 offset:16384
QAA a[250:251],v42 offset:16896
QAA a[252:253],v42 offset:24576
QAA a[254:255],v42 offset:25088
QAH lgkmcnt(0)
QAH vmcnt(24)
s_barrier
QAT s20,s40
QAT s21,s41
QAT s22,4194304
QAT s23,0x20000
QAF m0,s52,32768
QAF s13,s50,0
QAD v32,s[20:23],s13 offen nt lds
QAF m0,s52,33792
QAF s13,s50,32768
QAD v33,s[20:23],s13 offen nt lds
QAF m0,s52,34816
QAF s13,s50,65536
QAD v34,s[20:23],s13 offen nt lds
QAF m0,s52,35840
QAF s13,s50,98304
QAD v35,s[20:23],s13 offen nt lds
QAF m0,s52,36864
QAF s13,s50,131072
QAD v32,s[20:23],s13 offen nt lds
QAF m0,s52,37888
QAF s13,s50,163840
QAD v33,s[20:23],s13 offen nt lds
QAF m0,s52,38912
QAF s13,s50,196608
QAD v34,s[20:23],s13 offen nt lds
QAF m0,s52,39936
QAF s13,s50,229376
QAD v35,s[20:23],s13 offen nt lds
QBF v41,65536,v40
QAA v[128:129],v41 offset:0
QAA v[130:131],v41 offset:2048
QAA v[132:133],v41 offset:8192
QAA v[134:135],v41 offset:10240
QAA v[160:161],v41 offset:256
QAA v[162:163],v41 offset:2304
QAA v[164:165],v41 offset:8448
QAA v[166:167],v41 offset:10496
QAA v[192:193],v41 offset:512
QAA v[194:195],v41 offset:2560
QAA v[196:197],v41 offset:8704
QAA v[198:199],v41 offset:10752
QAA v[224:225],v41 offset:768
QAA v[226:227],v41 offset:2816
QAA v[228:229],v41 offset:8960
QAA v[230:231],v41 offset:11008
QAH lgkmcnt(0)
QAH vmcnt(24)
s_barrier
QAF m0,s52,65536
QAF s13,s50,1048576
QAD v32,s[20:23],s13 offen nt lds
QAF m0,s52,66560
QAF s13,s50,1081344
QAD v33,s[20:23],s13 offen nt lds
QAF m0,s52,67584
QAF s13,s50,1114112
QAD v34,s[20:23],s13 offen nt lds
QAF m0,s52,68608
QAF s13,s50,1146880
QAD v35,s[20:23],s13 offen nt lds
QAF m0,s52,69632
QAF s13,s50,1179648
QAD v32,s[20:23],s13 offen nt lds
QAF m0,s52,70656
QAF s13,s50,1212416
QAD v33,s[20:23],s13 offen nt lds
QAF m0,s52,71680
QAF s13,s50,1245184
QAD v34,s[20:23],s13 offen nt lds
QAF m0,s52,72704
QAF s13,s50,1277952
QAD v35,s[20:23],s13 offen nt lds
QBF v41,98304,v40
QAA v[136:137],v41 offset:0
QAA v[138:139],v41 offset:2048
QAA v[140:141],v41 offset:8192
QAA v[142:143],v41 offset:10240
QAA v[168:169],v41 offset:256
QAA v[170:171],v41 offset:2304
QAA v[172:173],v41 offset:8448
QAA v[174:175],v41 offset:10496
QAA v[200:201],v41 offset:512
QAA v[202:203],v41 offset:2560
QAA v[204:205],v41 offset:8704
QAA v[206:207],v41 offset:10752
QAA v[232:233],v41 offset:768
QAA v[234:235],v41 offset:2816
QAA v[236:237],v41 offset:8960
QAA v[238:239],v41 offset:11008
QAH lgkmcnt(0)
QAH vmcnt(24)
s_barrier
QAF m0,s52,98304
QAF s13,s50,2097152
QAD v32,s[20:23],s13 offen nt lds
QAF m0,s52,99328
QAF s13,s50,2129920
QAD v33,s[20:23],s13 offen nt lds
QAF m0,s52,100352
QAF s13,s50,2162688
QAD v34,s[20:23],s13 offen nt lds
QAF m0,s52,101376
QAF s13,s50,2195456
QAD v35,s[20:23],s13 offen nt lds
QAF m0,s52,102400
QAF s13,s50,2228224
QAD v32,s[20:23],s13 offen nt lds
QAF m0,s52,103424
QAF s13,s50,2260992
QAD v33,s[20:23],s13 offen nt lds
QAF m0,s52,104448
QAF s13,s50,2293760
QAD v34,s[20:23],s13 offen nt lds
QAF m0,s52,105472
QAF s13,s50,2326528
QAD v35,s[20:23],s13 offen nt lds
QBF v41,131072,v40
QAA v[144:145],v41 offset:0
QAA v[146:147],v41 offset:2048
QAA v[148:149],v41 offset:8192
QAA v[150:151],v41 offset:10240
QAA v[176:177],v41 offset:256
QAA v[178:179],v41 offset:2304
QAA v[180:181],v41 offset:8448
QAA v[182:183],v41 offset:10496
QAA v[208:209],v41 offset:512
QAA v[210:211],v41 offset:2560
QAA v[212:213],v41 offset:8704
QAA v[214:215],v41 offset:10752
QAA v[240:241],v41 offset:768
QAA v[242:243],v41 offset:2816
QAA v[244:245],v41 offset:8960
QAA v[246:247],v41 offset:11008
QAH lgkmcnt(0)
QAH vmcnt(24)
s_barrier
QBW v49,2,v1
QBR v48,v49,s[92:95],0 offen sc1
QAF m0,s52,131072
QAF s13,s50,3145728
QAD v32,s[20:23],s13 offen nt lds
QAF m0,s52,132096
QAF s13,s50,3178496
QAD v33,s[20:23],s13 offen nt lds
QAF m0,s52,133120
QAF s13,s50,3211264
QAD v34,s[20:23],s13 offen nt lds
QAF m0,s52,134144
QAF s13,s50,3244032
QAD v35,s[20:23],s13 offen nt lds
QAF m0,s52,135168
QAF s13,s50,3276800
QAD v32,s[20:23],s13 offen nt lds
QAF m0,s52,136192
QAF s13,s50,3309568
QAD v33,s[20:23],s13 offen nt lds
QAF m0,s52,137216
QAF s13,s50,3342336
QAD v34,s[20:23],s13 offen nt lds
QAF m0,s52,138240
QAF s13,s50,3375104
QAD v35,s[20:23],s13 offen nt lds
QBF v41,0,v40
QAA v[152:153],v41 offset:0
QAA v[154:155],v41 offset:2048
QAA v[156:157],v41 offset:8192
QAA v[158:159],v41 offset:10240
QAA v[184:185],v41 offset:256
QAA v[186:187],v41 offset:2304
QAA v[188:189],v41 offset:8448
QAA v[190:191],v41 offset:10496
QAA v[216:217],v41 offset:512
QAA v[218:219],v41 offset:2560
QAA v[220:221],v41 offset:8704
QAA v[222:223],v41 offset:10752
QAA v[248:249],v41 offset:768
QAA v[250:251],v41 offset:2816
QAA v[252:253],v41 offset:8960
QAA v[254:255],v41 offset:11008
QAH lgkmcnt(0)
QAH vmcnt(25)
s_barrier
QBF v41,32768,v38
QBF v42,32768,v39
QAA v[64:65],v41 offset:0
QAA v[66:67],v41 offset:512
QAA v[68:69],v41 offset:8192
QAA v[70:71],v41 offset:8704
QAA v[72:73],v42 offset:0
QAA v[74:75],v42 offset:512
QAA v[76:77],v42 offset:8192
QAA v[78:79],v42 offset:8704
QAA v[80:81],v41 offset:16384
QAA v[82:83],v41 offset:16896
QAA v[84:85],v41 offset:24576
QAA v[86:87],v41 offset:25088
QAA v[88:89],v42 offset:16384
QAA v[90:91],v42 offset:16896
QAA v[92:93],v42 offset:24576
QAA v[94:95],v42 offset:25088
QAH lgkmcnt(0)
QAH vmcnt(17)
s_barrier
QBF v41,65536,v38
QBF v42,65536,v39
QAA v[96:97],v41 offset:0
QAA v[98:99],v41 offset:512
QAA v[100:101],v41 offset:8192
QAA v[102:103],v41 offset:8704
QAA v[104:105],v42 offset:0
QAA v[106:107],v42 offset:512
QAA v[108:109],v42 offset:8192
QAA v[110:111],v42 offset:8704
QAA v[112:113],v41 offset:16384
QAA v[114:115],v41 offset:16896
QAA v[116:117],v41 offset:24576
QAA v[118:119],v41 offset:25088
QAA v[120:121],v42 offset:16384
QAA v[122:123],v42 offset:16896
QAA v[124:125],v42 offset:24576
QAA v[126:127],v42 offset:25088
QAH lgkmcnt(0)
QAH vmcnt(9)
s_barrier
QAY v17,v[64:67] offset:0
QAY v17,v[68:71] offset:1024
QAY v17,v[72:75] offset:2048
QAY v17,v[76:79] offset:3072
QAY v17,v[80:83] offset:4096
QAY v17,v[84:87] offset:5120
QAY v17,v[88:91] offset:6144
QAY v17,v[92:95] offset:7168
QAY v17,v[96:99] offset:8192
QAY v17,v[100:103] offset:9216
QAY v17,v[104:107] offset:10240
QAY v17,v[108:111] offset:11264
QAY v17,v[112:115] offset:12288
QAY v17,v[116:119] offset:13312
QAY v17,v[120:123] offset:14336
QAY v17,v[124:127] offset:15360
QAH lgkmcnt(0)
QBF v41,98304,v38
QBF v42,98304,v39
QAA v[64:65],v41 offset:0
QAA v[66:67],v41 offset:512
QAA v[68:69],v41 offset:8192
QAA v[70:71],v41 offset:8704
QAA v[72:73],v42 offset:0
QAA v[74:75],v42 offset:512
QAA v[76:77],v42 offset:8192
QAA v[78:79],v42 offset:8704
QAA v[80:81],v41 offset:16384
QAA v[82:83],v41 offset:16896
QAA v[84:85],v41 offset:24576
QAA v[86:87],v41 offset:25088
QAA v[88:89],v42 offset:16384
QAA v[90:91],v42 offset:16896
QAA v[92:93],v42 offset:24576
QAA v[94:95],v42 offset:25088
QAH lgkmcnt(0)
QAH vmcnt(0)
s_barrier
QBF v41,131072,v38
QBF v42,131072,v39
QAA v[96:97],v41 offset:0
QAA v[98:99],v41 offset:512
QAA v[100:101],v41 offset:8192
QAA v[102:103],v41 offset:8704
QAA v[104:105],v42 offset:0
QAA v[106:107],v42 offset:512
QAA v[108:109],v42 offset:8192
QAA v[110:111],v42 offset:8704
QAA v[112:113],v41 offset:16384
QAA v[114:115],v41 offset:16896
QAA v[116:117],v41 offset:24576
QAA v[118:119],v41 offset:25088
QAA v[120:121],v42 offset:16384
QAA v[122:123],v42 offset:16896
QAA v[124:125],v42 offset:24576
QAA v[126:127],v42 offset:25088
QAH lgkmcnt(0)
s_barrier
QAY v18,v[64:67] offset:0
QAY v18,v[68:71] offset:1024
QAY v18,v[72:75] offset:2048
QAY v18,v[76:79] offset:3072
QAY v18,v[80:83] offset:4096
QAY v18,v[84:87] offset:5120
QAY v18,v[88:91] offset:6144
QAY v18,v[92:95] offset:7168
QAY v18,v[96:99] offset:8192
QAY v18,v[100:103] offset:9216
QAY v18,v[104:107] offset:10240
QAY v18,v[108:111] offset:11264
QAY v18,v[112:115] offset:12288
QAY v18,v[116:119] offset:13312
QAY v18,v[120:123] offset:14336
QAY v18,v[124:127] offset:15360
QBE s14,v48,0
s_nop 1
QBK s14,32
QBL s44,1,0
QBE s13,v48,33
s_nop 1
QAF s14,s14,s13
QBE s13,v48,34
s_nop 1
QAF s14,s14,s13
QBE s13,v48,35
s_nop 1
QAF s14,s14,s13
QBE s13,v48,36
s_nop 1
QAF s14,s14,s13
QBE s13,v48,37
s_nop 1
QAF s14,s14,s13
QBE s13,v48,38
s_nop 1
QAF s14,s14,s13
QBE s13,v48,39
s_nop 1
QAF s14,s14,s13
QBE s13,v48,40
s_nop 1
QAF s14,s14,s13
QBE s13,v48,41
s_nop 1
QAF s14,s14,s13
QBE s13,v48,42
s_nop 1
QAF s14,s14,s13
QBE s13,v48,43
s_nop 1
QAF s14,s14,s13
QBE s13,v48,44
s_nop 1
QAF s14,s14,s13
QBE s13,v48,45
s_nop 1
QAF s14,s14,s13
QBE s13,v48,46
s_nop 1
QAF s14,s14,s13
QBE s13,v48,47
s_nop 1
QAF s14,s14,s13
QBE s13,v48,1
s_nop 1
QBK s13,32
QBL s14,s14,0
QBK s14,256
s_cbranch_scc1 lay_md_ok
QAT s15,0
lay_md:
QBW v49,2,v1
QBR v48,v49,s[92:95],0 offen sc1
QAH vmcnt(0)
QBE s14,v48,0
s_nop 1
QBK s14,32
QBL s44,1,0
QBE s13,v48,33
s_nop 1
QAF s14,s14,s13
QBE s13,v48,34
s_nop 1
QAF s14,s14,s13
QBE s13,v48,35
s_nop 1
QAF s14,s14,s13
QBE s13,v48,36
s_nop 1
QAF s14,s14,s13
QBE s13,v48,37
s_nop 1
QAF s14,s14,s13
QBE s13,v48,38
s_nop 1
QAF s14,s14,s13
QBE s13,v48,39
s_nop 1
QAF s14,s14,s13
QBE s13,v48,40
s_nop 1
QAF s14,s14,s13
QBE s13,v48,41
s_nop 1
QAF s14,s14,s13
QBE s13,v48,42
s_nop 1
QAF s14,s14,s13
QBE s13,v48,43
s_nop 1
QAF s14,s14,s13
QBE s13,v48,44
s_nop 1
QAF s14,s14,s13
QBE s13,v48,45
s_nop 1
QAF s14,s14,s13
QBE s13,v48,46
s_nop 1
QAF s14,s14,s13
QBE s13,v48,47
s_nop 1
QAF s14,s14,s13
QBE s13,v48,1
s_nop 1
QBK s13,32
QBL s14,s14,0
QBK s14,256
s_cbranch_scc1 lay_md_ok
s_sleep 10
QAF s15,s15,1
QBN s15,400000
s_cbranch_scc1 lay_md
lay_md_ok:
QAT s13,s44
QAT s44,s13
QAQ v0,v30
lay_restart:
QBF v16,8192,v2
QAS s54,s9,11
QAS s53,s12,13
QAF s53,s53,s54
QAS s39,s9,10
QAS s25,s12,19
QAF s25,s25,s54
QAF s25,s25,4194304
QAS s26,s12,18
QAF s26,s26,s39
QAF s26,s26,37748736
QAF s40,s53,56688640
QAQ v32,0
s_nop 0
QCA s24,v32
QAT s41,0
QAF s45,s53,56688640
QAS s43,s9,16
QAS s13,s12,11
QAF s43,s43,s13
QAF s57,s56,0
QAF s58,s56,524288
QAS s13,s12,8
QAF s13,s13,s56
QAF s55,s13,557056
QAF s59,s13,565248
QBO s13,s24,1
QAS s13,s13,18
QAF s27,s13,s57
QAF s28,s27,s43
QAF s13,s24,1
QBO s13,s13,3
QAS s13,s13,13
QAF s29,s13,s58
QBO s13,s24,3
QAS s13,s13,13
QAF s30,s13,s58
QCB s13,s24,1
QBO s13,s13,1
s_xor_b32 s32,s13,1
QAT s20,s48
QAT s21,s49
QAT s22,8192
QAT s23,0x20000
QBW v34,4,v1
QBW v32,2,v34
QAM v32,3,v32
QAI v32,1,v32
QAM v33,1,v34
QBF v32,v32,v33
QAI v32,10,v32
QBW v33,4,v34
QBC v32,v33,5,v32
QCC v33,v34,1,1
QBC v32,v33,4,v32
QAS s13,s9,7
QAF m0,s39,0
s_nop 0
QAD v32,s[20:23],s13 offen lds
QAF m0,s39,4096
QAF s13,s13,512
QAD v32,s[20:23],s13 offen lds
QAH lgkmcnt(0)
QAR v[64:65],0
QAR v[66:67],0
QAR v[68:69],0
QAR v[70:71],0
QAR v[72:73],0
QAR v[74:75],0
QAR v[76:77],0
QAR v[78:79],0
QAQ v24,0
QAQ v26,0
QAQ v25,0
QAQ v27,0
QAQ v29,0
QAG v[80:83],v17 offset:0
QAG v[84:87],v17 offset:1024
QAG v[88:91],v17 offset:2048
QAG v[92:95],v17 offset:3072
QAG v[96:99],v17 offset:4096
QAG v[100:103],v17 offset:5120
QAG v[104:107],v17 offset:6144
QAG v[108:111],v17 offset:7168
QAG v[112:115],v17 offset:8192
QAG v[116:119],v17 offset:9216
QAG v[120:123],v17 offset:10240
QAG v[124:127],v17 offset:11264
QAT s15,0
QAF s47,s54,16384
QAF s52,s39,4096
QAH vmcnt(0) lgkmcnt(0)
QBJ s9,0
s_cbranch_scc1 lay_k1
lay_k0:
QBR v33,off,s[16:19],s59 sc1
QAH vmcnt(0)
QCA s13,v33
s_nop 1
QBK s13,4
s_cbranch_scc1 lay_k1
QAF s15,s15,1
QBN s15,800000
s_cbranch_scc1 lay_k0
lay_k1:
s_barrier
QAF m0,s54,8192
QAF s13,s25,0
QAD v1,s[16:19],s13 offen sc1 lds
QAD v1,s[16:19],s13 offen offset:1024 sc1 lds
QAF m0,s54,24576
QAF s13,s25,16777216
QAD v1,s[16:19],s13 offen sc1 lds
QAD v1,s[16:19],s13 offen offset:1024 sc1 lds
QAF s25,s25,8192
QAT s14,0
QAT s15,0
QBS s44,0
s_cbranch_scc1 lay_fb
QBS s9,0
s_cbranch_scc1 lay_f0_entry
QBS s9,1
s_cbranch_scc1 lay_f1_entry
QBS s9,2
s_cbranch_scc1 lay_f2_entry
s_branch lay_f3_entry
lay_fb:
QBS s9,0
s_cbranch_scc1 lay_s0_entry
QBS s9,1
s_cbranch_scc1 lay_s1_entry
QBS s9,2
s_cbranch_scc1 lay_s2_entry
s_branch lay_s3_entry
.p2align 6
lay_f0_top:
QAH vmcnt(3)
QAV v30,v48,v49,v50
QAH vmcnt(2)
QAV v30,v30,v51,v52
QAV v30,v30,v53,v54
v_max_u32 v30,v30,v55
QBP vcc,-1,v30
s_cbranch_vccnz lay_f0_gr
QAY v19,v[48:51]
QAY v19,v[52:55] offset:1024
lay_f0_gok:
QAH lgkmcnt(0)
s_barrier
QAG v[32:35],v1 offset:0
QAG v[36:39],v1 offset:1024
QAG v[40:43],v1 offset:2048
QAD v0,s[16:19],s42 offen sc1 lds
lay_f0_entry2:
QAT m0,s47
QAH lgkmcnt(2)
QAC v[64:67],v[32:35],a[0:7],v10
QAG v[44:47],v1 offset:3072
QAC v[68:71],v[32:35],v[80:87],v10
QAC v[72:75],v[32:35],a[8:15],v10
QAD v1,s[16:19],s25 offen sc1 lds
QAC v[76:79],v[32:35],v[88:95],v10
QAH lgkmcnt(2)
QAG v[88:91],v17 offset:12288
QAQ v80,0
QAC v[64:67],v[36:39],a[16:23],v10
QAG v[92:95],v17 offset:13312
QAQ v81,0
QAC v[68:71],v[36:39],v[96:103],v10
QAG v[96:99],v17 offset:14336
QAQ v82,0
QAC v[72:75],v[36:39],a[24:31],v10
QAD v1,s[16:19],s25 offen offset:1024 sc1 lds
QAG v[100:103],v17 offset:15360
QAQ v83,0
QAC v[76:79],v[36:39],v[104:111],v10
QAH lgkmcnt(5)
QAG v[104:107],v18 offset:0
QAQ v84,0
QAC v[64:67],v[40:43],a[32:39],v10
QAG v[108:111],v18 offset:1024
QAQ v85,0
QAC v[68:71],v[40:43],v[112:119],v10
QAG v[112:115],v18 offset:4096
QAQ v86,0
QAC v[72:75],v[40:43],a[40:47],v10
QAG v[116:119],v18 offset:5120
QAQ v87,0
QAC v[76:79],v[40:43],v[120:127],v10
QAH vmcnt(2)
s_barrier
QAG v[48:51],v1 offset:4096
QAG v[52:55],v1 offset:5120
QAH lgkmcnt(10)
QAC v[64:67],v[44:47],a[48:55],v10
QAG v[56:59],v1 offset:6144
QAH lgkmcnt(9)
QAC v[68:71],v[44:47],v[88:95],v10
QAG v[60:63],v1 offset:7168
QAC v[72:75],v[44:47],a[56:63],v10
QAL v[20:23],v1,s[16:19],s40 offen sc1
QAG v[120:123],v18 offset:8192
QAH lgkmcnt(9)
QAC v[76:79],v[44:47],v[96:103],v10
QAG v[124:127],v18 offset:9216
QAH lgkmcnt(5)
QAC v[64:67],v[48:51],a[64:71],v10
QAG v[88:91],v18 offset:12288
v_max_u32 v30,v48,v49
QAC v[68:71],v[48:51],v[104:111],v10
QAH lgkmcnt(5)
QAG v[92:95],v18 offset:13312
QAV v30,v30,v50,v51
QAC v[64:67],v[52:55],a[80:87],v10
QAG v[96:99],v18 offset:2048
QAV v30,v30,v52,v53
QAC v[68:71],v[52:55],v[112:119],v10
QAH lgkmcnt(6)
QAG v[100:103],v18 offset:3072
QAV v30,v30,v54,v55
QAC v[64:67],v[56:59],a[96:103],v10
QAH lgkmcnt(4)
QAG v[104:107],v18 offset:6144
QAV v30,v30,v56,v57
QAC v[68:71],v[56:59],v[120:127],v10
QAG v[108:111],v18 offset:7168
QAV v30,v30,v58,v59
QAC v[64:67],v[60:63],a[112:119],v10
QAH lgkmcnt(4)
QAG v[112:115],v18 offset:10240
QAV v30,v30,v60,v61
QAC v[68:71],v[60:63],v[88:95],v10
QAG v[116:119],v18 offset:11264
QAV v30,v30,v62,v63
QAC v[72:75],v[48:51],a[72:79],v10
QAH lgkmcnt(4)
QAG v[120:123],v18 offset:14336
QBP vcc,-1,v30
QAC v[76:79],v[48:51],v[96:103],v10
QAG v[124:127],v18 offset:15360
QAU v64,v64,v66
QAC v[72:75],v[52:55],a[88:95],v10
QAH lgkmcnt(4)
QAF s31,s29,s54
QAG v[88:91],v2 offset:24576
QAU v65,v65,v67
QAC v[76:79],v[52:55],v[104:111],v10
QAG v[92:95],v2 offset:24832
QAU v68,v68,v70
QAC v[72:75],v[56:59],a[104:111],v10
QAH lgkmcnt(4)
QAF s42,s29,s52
QAG v[96:99],v16 offset:0
QAU v69,v69,v71
QAC v[76:79],v[56:59],v[112:119],v10
QAG v[100:103],v16 offset:2048
QAW v68,s34,v68
QAC v[72:75],v[60:63],a[120:127],v10
QAH lgkmcnt(4)
QAG v[104:107],v16 offset:4096
QAW v69,s34,v69
QAC v[76:79],v[60:63],v[120:127],v10
QAG v[108:111],v16 offset:6144
QAE v20,v64,v65
QAC v[80:83],v[32:35],a[128:135],v10
QAG v[112:115],v16 offset:256
QAE v21,v68,v69
QAC v[84:87],v[32:35],a[136:143],v10
QCG v3,v[20:21]
QAU v72,v72,v74
QAU v73,v73,v75
QAU v76,v76,v78
QAU v77,v77,v79
QAE v22,v72,v73
QAW v76,s34,v76
QAW v77,s34,v77
QAE v23,v76,v77
QCG v3,v[22:23] offset:512
QAC v[80:83],v[36:39],a[144:151],v10
QAC v[84:87],v[36:39],a[152:159],v10
QAG v[116:119],v16 offset:2304
QAC v[80:83],v[40:43],a[160:167],v10
QAG v[120:123],v16 offset:4352
QAC v[84:87],v[40:43],a[168:175],v10
QAG v[124:127],v16 offset:6400
QAC v[80:83],v[44:47],a[176:183],v10
s_cbranch_vccnz lay_f0_redo
QAH lgkmcnt(3)
s_barrier
QAA v[64:65],v4 offset:0
QAA v[66:67],v4 offset:256
QAF m0,s54,24576
QAF s13,s25,16777216
QAC v[84:87],v[44:47],a[184:191],v10
QAA v[68:69],v4 offset:1024
QAA v[70:71],v4 offset:1280
QAC v[80:83],v[48:51],a[192:199],v10
QAA v[72:73],v4 offset:2048
QAA v[74:75],v4 offset:2304
QAC v[84:87],v[48:51],a[200:207],v10
QAD v1,s[16:19],s13 offen sc1 lds
QAA v[76:77],v4 offset:3072
QAA v[78:79],v4 offset:3328
QAC v[80:83],v[52:55],a[208:215],v10
QAC v[84:87],v[52:55],a[216:223],v10
QAC v[80:83],v[56:59],a[224:231],v10
QAH lgkmcnt(0)
QAJ v[32:35],v[96:99],v[64:67],0
QAD v1,s[16:19],s13 offen offset:1024 sc1 lds
QAQ v20,v64
QAJ v[32:35],v[100:103],v[68:71],v[32:35]
QAQ v21,v65
QAJ v[32:35],v[104:107],v[72:75],v[32:35]
QAQ v22,v66
QAJ v[32:35],v[108:111],v[76:79],v[32:35]
QAQ v23,v67
QAJ v[36:39],v[112:115],v[64:67],0
QAJ v[36:39],v[116:119],v[68:71],v[36:39]
QAJ v[36:39],v[120:123],v[72:75],v[36:39]
QBA v44,v32
QAJ v[36:39],v[124:127],v[76:79],v[36:39]
QBA v45,v33
QAC v[84:87],v[56:59],a[232:239],v10
QBA v46,v34
QAC v[80:83],v[60:63],a[240:247],v10
QBA v47,v35
QAC v[84:87],v[60:63],a[248:255],v10
QBA v48,v36
QAJ v[40:43],v[64:67],v[64:67],0
QBA v49,v37
QAJ v[40:43],v[68:71],v[68:71],v[40:43]
QBA v50,v38
QAJ v[40:43],v[72:75],v[72:75],v[40:43]
QBA v51,v39
QAJ v[40:43],v[76:79],v[76:79],v[40:43]
QAE v54,v44,v45
QAE v55,v46,v47
QAE v56,v48,v49
QAE v57,v50,v51
QAU v80,v80,v82
QAU v81,v81,v83
QAJ v[58:61],v[12:15],v[54:57],0
QAE v24,v80,v81
QAU v84,v84,v86
QAJ v[96:99],v[88:91],v[54:57],0
QBA v52,v40
QAJ v[100:103],v[92:95],v[54:57],0
QBA v53,v41
QAU v85,v85,v87
QAE v28,v52,v53
QAE v26,v84,v85
QBQ v31,|v32|,|v33|,|v34|
QBD v[58:61],v[12:13],v[28:29],v[58:61]
QBQ v31,v31,|v35|,|v36|
QBQ v31,v31,|v37|,|v38|
QBD v[96:99],v[24:25],v[28:29],v[96:99]
QBQ v31,v31,|v39|,|v40|
v_max_f32 v31,v31,|v41|
QBD v[100:103],v[26:27],v[28:29],v[100:103]
v_rcp_f32 v30,v60
v_cmp_lt_f32 vcc,s33,v31
s_nop 1
QAW v96,v30,v96
QAW v97,v30,v97
QAW v98,v30,v98
QAW v99,v30,v99
QAE v44,v96,v97
QAE v45,v98,v99
QCG v5,v[44:45]
QBI v[100:101],v[100:101],v[30:31] op_sel_hi:[1,0]
QBI v[102:103],v[102:103],v[30:31] op_sel_hi:[1,0]
QAE v46,v100,v101
QAE v47,v102,v103
QCG v5,v[46:47] offset:8
s_and_b64 vcc,vcc,s[36:37]
s_cbranch_vccnz lay_f0_slow
lay_f0_norm:
QAR v[64:65],0
QAR v[66:67],0
QAR v[68:69],0
QAR v[70:71],0
QAH lgkmcnt(0)
s_barrier
QAG v[32:35],v6 offset:0
QAG v[36:39],v6 offset:512
QAG v[40:43],v6 offset:1024
QAG v[44:47],v6 offset:1536
QAF s13,s27,0
QAR v[72:73],0
QAR v[74:75],0
QAR v[76:77],0
QAR v[78:79],0
QAH lgkmcnt(2)
QAC v[64:67],v[32:35],v[128:135],v11
QAC v[64:67],v[36:39],v[136:143],v11
QAH lgkmcnt(0)
QAC v[64:67],v[40:43],v[144:151],v11
QAC v[64:67],v[44:47],v[152:159],v11
QAG v[88:91],v17 offset:2048
QAC v[68:71],v[32:35],v[160:167],v11
QAG v[92:95],v17 offset:3072
QAC v[68:71],v[36:39],v[168:175],v11
QAE v48,v64,v65
QAE v49,v66,v67
v_bfi_b32 v48,1,s32,v48
QBT v[48:49],v7,s[16:19],s13 offen
QAC v[68:71],v[40:43],v[176:183],v11
QAG v[96:99],v17 offset:4096
QAC v[68:71],v[44:47],v[184:191],v11
QAG v[100:103],v17 offset:5120
QAC v[72:75],v[32:35],v[192:199],v11
QAF s13,s27,65536
QAG v[104:107],v17 offset:6144
QAC v[72:75],v[36:39],v[200:207],v11
QAE v50,v68,v69
QAE v51,v70,v71
v_bfi_b32 v50,1,s32,v50
QBT v[50:51],v7,s[16:19],s13 offen
QAC v[72:75],v[40:43],v[208:215],v11
QAG v[108:111],v17 offset:7168
QAC v[72:75],v[44:47],v[216:223],v11
QAG v[112:115],v17 offset:8192
QAC v[76:79],v[32:35],v[224:231],v11
QAG v[116:119],v17 offset:9216
QAC v[76:79],v[36:39],v[232:239],v11
QAF s13,s27,131072
QAG v[120:123],v17 offset:10240
QAE v52,v72,v73
QAC v[76:79],v[40:43],v[240:247],v11
QAG v[124:127],v17 offset:11264
QAE v53,v74,v75
QAC v[76:79],v[44:47],v[248:255],v11
v_bfi_b32 v52,1,s32,v52
QBT v[52:53],v7,s[16:19],s13 offen
QAF s13,s27,196608
QAT s40,s26
QAF s26,s26,4096
QAT s14,0
QAT s15,0
s_nop 0
QAE v54,v76,v77
QAE v55,v78,v79
v_bfi_b32 v54,1,s32,v54
QAD v[56:59],v1,s[16:19],s28 offen sc1
QAD v[60:63],v1,s[16:19],s28 offen offset:1024 sc1
QBT v[54:55],v7,s[16:19],s13 offen
QAR v[64:65],0
QAR v[66:67],0
QAR v[68:69],0
QAR v[70:71],0
QAR v[72:73],0
QAR v[74:75],0
QAR v[76:77],0
QAR v[78:79],0
s_nop 15
s_nop 0
QAD v[80:83],v1,s[16:19],s28 offen sc1
QAD v[84:87],v1,s[16:19],s28 offen offset:1024 sc1
QAH vmcnt(4)
QAJ v[48:51],v[12:15],v[56:59],0
QBG v30,v56,v58,s32 bitop3:0x7e
QAH vmcnt(3)
QAJ v[48:51],v[12:15],v[60:63],v[48:51]
QBG v31,v60,v62,s32 bitop3:0x7e
QBG v30,v30,v31,1 bitop3:0xa8
v_cmp_ne_u32 vcc,0,v30
s_cbranch_vccnz lay_f0_rr
lay_f0_rok:
s_nop 0
QCE v52,v48,v48 row_ror:4 row_mask:0xf bank_mask:0xf
QCE v53,v49,v49 row_ror:4 row_mask:0xf bank_mask:0xf
s_nop 0
QCE v54,v52,v52 row_ror:8 row_mask:0xf bank_mask:0xf
QCE v55,v53,v53 row_ror:8 row_mask:0xf bank_mask:0xf
QAE v30,v54,v55
QCD v30,v8,s[16:19],s29 offen
QAQ v31,-1
QCD v31,v8,s[16:19],s30 offen
QAT s41,s24
QAF s24,s24,1
QBY vcc,s[36:37]
QCF v30,v24 quad_perm:[0,1,0,1] row_mask:0xf bank_mask:0xf
QCF v31,v26 quad_perm:[0,1,0,1] row_mask:0xf bank_mask:0xf
QAX v20,v20,v24,vcc
QAX v21,v21,v26,vcc
QAX v22,v22,v30,vcc
QAX v23,v23,v31,vcc
QBO s13,s24,1
QAS s13,s13,18
QAF s27,s13,s57
QAF s28,s27,s43
QAF s13,s24,1
QBO s13,s13,3
QAS s13,s13,13
QAF s29,s13,s58
QBO s13,s24,3
QAS s13,s13,13
QAF s30,s13,s58
QCB s13,s24,1
QBO s13,s13,1
s_xor_b32 s32,s13,1
QAF s25,s25,8192
s_xor_b32 s47,s47,0x6000
QBH v16,0x6000,v16
QAF m0,s39,4096
s_nop 2
QAD v[48:51],v0,s[16:19],s31 offen sc1
QAD v[52:55],v0,s[16:19],s31 offen offset:1024 sc1
QAH vmcnt(4)
QAG v[80:83],v17 offset:0
QAG v[84:87],v17 offset:1024
s_nop 15
s_nop 9
QAD v[56:59],v0,s[16:19],s31 offen sc1
QAD v[60:63],v0,s[16:19],s31 offen offset:1024 sc1
lay_f0_cutend:
QBN s24,63
s_cbranch_scc1 lay_f0_top
QAH vmcnt(3)
QAV v30,v48,v49,v50
QAH vmcnt(2)
QAV v30,v30,v51,v52
QAV v30,v30,v53,v54
v_max_u32 v30,v30,v55
QBP vcc,-1,v30
s_cbranch_vccnz lay_f0_gr_l
QAY v19,v[48:51]
QAY v19,v[52:55] offset:1024
lay_f0_gok_l:
QAH lgkmcnt(0)
s_barrier
QAG v[32:35],v1 offset:0
QAG v[36:39],v1 offset:1024
QAG v[40:43],v1 offset:2048
QAD v0,s[16:19],s42 offen sc1 lds
lay_f0_entry2_l:
QAT m0,s47
QAH lgkmcnt(2)
QAC v[64:67],v[32:35],a[0:7],v10
QAG v[44:47],v1 offset:3072
QAC v[68:71],v[32:35],v[80:87],v10
QAC v[72:75],v[32:35],a[8:15],v10
QAL v[20:23],v1,s[16:19],s40 offen sc1
QAC v[76:79],v[32:35],v[88:95],v10
QAH lgkmcnt(2)
QAG v[88:91],v17 offset:12288
QAQ v80,0
QAC v[64:67],v[36:39],a[16:23],v10
QAG v[92:95],v17 offset:13312
QAQ v81,0
QAC v[68:71],v[36:39],v[96:103],v10
QAG v[96:99],v17 offset:14336
QAQ v82,0
QAC v[72:75],v[36:39],a[24:31],v10
QAG v[100:103],v17 offset:15360
QAQ v83,0
QAC v[76:79],v[36:39],v[104:111],v10
QAH lgkmcnt(5)
QAG v[104:107],v18 offset:0
QAQ v84,0
QAC v[64:67],v[40:43],a[32:39],v10
QAG v[108:111],v18 offset:1024
QAQ v85,0
QAC v[68:71],v[40:43],v[112:119],v10
QAG v[112:115],v18 offset:4096
QAQ v86,0
QAC v[72:75],v[40:43],a[40:47],v10
QAG v[116:119],v18 offset:5120
QAQ v87,0
QAC v[76:79],v[40:43],v[120:127],v10
QAH vmcnt(1)
s_barrier
QAG v[48:51],v1 offset:4096
QAG v[52:55],v1 offset:5120
QAH lgkmcnt(10)
QAC v[64:67],v[44:47],a[48:55],v10
QAG v[56:59],v1 offset:6144
QAH lgkmcnt(9)
QAC v[68:71],v[44:47],v[88:95],v10
QAG v[60:63],v1 offset:7168
QAC v[72:75],v[44:47],a[56:63],v10
QAG v[120:123],v18 offset:8192
QAH lgkmcnt(9)
QAC v[76:79],v[44:47],v[96:103],v10
QAG v[124:127],v18 offset:9216
QAH lgkmcnt(5)
QAC v[64:67],v[48:51],a[64:71],v10
QAG v[88:91],v18 offset:12288
v_max_u32 v30,v48,v49
QAC v[68:71],v[48:51],v[104:111],v10
QAH lgkmcnt(5)
QAG v[92:95],v18 offset:13312
QAV v30,v30,v50,v51
QAC v[64:67],v[52:55],a[80:87],v10
QAG v[96:99],v18 offset:2048
QAV v30,v30,v52,v53
QAC v[68:71],v[52:55],v[112:119],v10
QAH lgkmcnt(6)
QAG v[100:103],v18 offset:3072
QAV v30,v30,v54,v55
QAC v[64:67],v[56:59],a[96:103],v10
QAH lgkmcnt(4)
QAG v[104:107],v18 offset:6144
QAV v30,v30,v56,v57
QAC v[68:71],v[56:59],v[120:127],v10
QAG v[108:111],v18 offset:7168
QAV v30,v30,v58,v59
QAC v[64:67],v[60:63],a[112:119],v10
QAH lgkmcnt(4)
QAG v[112:115],v18 offset:10240
QAV v30,v30,v60,v61
QAC v[68:71],v[60:63],v[88:95],v10
QAG v[116:119],v18 offset:11264
QAV v30,v30,v62,v63
QAC v[72:75],v[48:51],a[72:79],v10
QAH lgkmcnt(4)
QAG v[120:123],v18 offset:14336
QBP vcc,-1,v30
QAC v[76:79],v[48:51],v[96:103],v10
QAG v[124:127],v18 offset:15360
QAU v64,v64,v66
QAC v[72:75],v[52:55],a[88:95],v10
QAH lgkmcnt(4)
QAF s31,s29,s54
QAU v65,v65,v67
QAC v[76:79],v[52:55],v[104:111],v10
QAU v68,v68,v70
QAC v[72:75],v[56:59],a[104:111],v10
QAH lgkmcnt(2)
QAF s42,s29,s52
QAU v69,v69,v71
QAC v[76:79],v[56:59],v[112:119],v10
QAW v68,s34,v68
QAC v[72:75],v[60:63],a[120:127],v10
QAH lgkmcnt(0)
QAW v69,s34,v69
QAC v[76:79],v[60:63],v[120:127],v10
QAE v20,v64,v65
QAC v[80:83],v[32:35],a[128:135],v10
QAE v21,v68,v69
QAC v[84:87],v[32:35],a[136:143],v10
QAU v72,v72,v74
QAU v73,v73,v75
QAU v76,v76,v78
QAU v77,v77,v79
QAE v22,v72,v73
QAW v76,s34,v76
QAW v77,s34,v77
QAE v23,v76,v77
s_cbranch_vccnz lay_f0_redo_l
ds_write2_b64 v3,v[20:21],v[22:23] offset1:64
QAC v[80:83],v[36:39],a[144:151],v10
QAC v[84:87],v[36:39],a[152:159],v10
QAC v[80:83],v[40:43],a[160:167],v10
QAC v[84:87],v[40:43],a[168:175],v10
QAC v[80:83],v[44:47],a[176:183],v10
QAC v[84:87],v[44:47],a[184:191],v10
QAC v[80:83],v[48:51],a[192:199],v10
QAH lgkmcnt(0)
s_barrier
QAA v[20:21],v4 offset:0
QAA v[22:23],v4 offset:256
QAC v[84:87],v[48:51],a[200:207],v10
QAC v[80:83],v[52:55],a[208:215],v10
QAC v[84:87],v[52:55],a[216:223],v10
QAC v[80:83],v[56:59],a[224:231],v10
QAC v[84:87],v[56:59],a[232:239],v10
QAC v[80:83],v[60:63],a[240:247],v10
QAC v[84:87],v[60:63],a[248:255],v10
s_nop 3
QAU v80,v80,v82
QAU v81,v81,v83
QAE v24,v80,v81
s_nop 0
QAU v84,v84,v86
QAU v85,v85,v87
QAE v26,v84,v85
QAH lgkmcnt(0)
QBY vcc,s[36:37]
QCF v30,v24 quad_perm:[0,1,0,1] row_mask:0xf bank_mask:0xf
QCF v31,v26 quad_perm:[0,1,0,1] row_mask:0xf bank_mask:0xf
QAX v20,v20,v24,vcc
QAX v21,v21,v26,vcc
QAX v22,v22,v30,vcc
QAX v23,v23,v31,vcc
QAL v[20:23],v1,s[16:19],s26 offen sc1
QAH vmcnt(0)
s_barrier
QAQ v31,64
s_branch lay_fin
lay_f0_entry:
QAG v[32:35],v1 offset:0
QAG v[36:39],v1 offset:1024
QAG v[40:43],v1 offset:2048
s_branch lay_f0_entry2
lay_f0_entry_l:
QAG v[32:35],v1 offset:0
QAG v[36:39],v1 offset:1024
QAG v[40:43],v1 offset:2048
s_branch lay_f0_entry2_l
lay_f0_rr:
QAD v[56:59],v1,s[16:19],s28 offen sc1
QAD v[60:63],v1,s[16:19],s28 offen offset:1024 sc1
QAH vmcnt(3)
QAJ v[48:51],v[12:15],v[80:83],0
QBG v30,v80,v82,s32 bitop3:0x7e
QAH vmcnt(2)
QAJ v[48:51],v[12:15],v[84:87],v[48:51]
QBG v31,v84,v86,s32 bitop3:0x7e
QBG v30,v30,v31,1 bitop3:0xa8
v_cmp_ne_u32 vcc,0,v30
s_cbranch_vccz lay_f0_rok
lay_f0_rr_lp:
QAD v[80:83],v1,s[16:19],s28 offen sc1
QAD v[84:87],v1,s[16:19],s28 offen offset:1024 sc1
QAH vmcnt(3)
QAJ v[48:51],v[12:15],v[56:59],0
QBG v30,v56,v58,s32 bitop3:0x7e
QAH vmcnt(2)
QAJ v[48:51],v[12:15],v[60:63],v[48:51]
QBG v31,v60,v62,s32 bitop3:0x7e
QBG v30,v30,v31,1 bitop3:0xa8
v_cmp_ne_u32 vcc,0,v30
s_cbranch_vccz lay_f0_rok
QAD v[56:59],v1,s[16:19],s28 offen sc1
QAD v[60:63],v1,s[16:19],s28 offen offset:1024 sc1
QAH vmcnt(3)
QAJ v[48:51],v[12:15],v[80:83],0
QBG v30,v80,v82,s32 bitop3:0x7e
QAH vmcnt(2)
QAJ v[48:51],v[12:15],v[84:87],v[48:51]
QBG v31,v84,v86,s32 bitop3:0x7e
QBG v30,v30,v31,1 bitop3:0xa8
v_cmp_ne_u32 vcc,0,v30
s_cbranch_vccz lay_f0_rok
QAF s14,s14,s3
QBK s14,200000
s_cbranch_scc1 lay_f0_rr_to
s_branch lay_f0_rr_lp
lay_f0_rr_to:
QAT s3,200000
s_branch lay_f0_rok
lay_f0_gr:
QAD v[48:51],v0,s[16:19],s31 offen sc1
QAD v[52:55],v0,s[16:19],s31 offen offset:1024 sc1
QAH vmcnt(3)
QAY v19,v[56:59]
QAV v30,v56,v57,v58
QAH vmcnt(2)
QAY v19,v[60:63] offset:1024
QAV v30,v30,v59,v60
QAV v30,v30,v61,v62
v_max_u32 v30,v30,v63
QBP vcc,-1,v30
s_cbranch_vccz lay_f0_gok
lay_f0_gr_lp:
QAD v[56:59],v0,s[16:19],s31 offen sc1
QAD v[60:63],v0,s[16:19],s31 offen offset:1024 sc1
QAH vmcnt(3)
QAY v19,v[48:51]
QAV v30,v48,v49,v50
QAH vmcnt(2)
QAY v19,v[52:55] offset:1024
QAV v30,v30,v51,v52
QAV v30,v30,v53,v54
v_max_u32 v30,v30,v55
QBP vcc,-1,v30
s_cbranch_vccz lay_f0_gok
QAD v[48:51],v0,s[16:19],s31 offen sc1
QAD v[52:55],v0,s[16:19],s31 offen offset:1024 sc1
QAH vmcnt(3)
QAY v19,v[56:59]
QAV v30,v56,v57,v58
QAH vmcnt(2)
QAY v19,v[60:63] offset:1024
QAV v30,v30,v59,v60
QAV v30,v30,v61,v62
v_max_u32 v30,v30,v63
QBP vcc,-1,v30
s_cbranch_vccz lay_f0_gok
QAF s15,s15,s3
QBK s15,200000
s_cbranch_scc1 lay_f0_gr_to
s_branch lay_f0_gr_lp
lay_f0_gr_to:
QAT s3,200000
s_branch lay_f0_gok
lay_f0_redo:
QAF s15,s15,s3
QBK s15,200000
s_cbranch_scc1 lay_end
QAH vmcnt(0) lgkmcnt(0)
s_barrier
QAF s40,s53,56688640
QAF s42,s30,s39
QAF s31,s30,s39
QAF s42,s42,4096
QAF m0,s39,0
s_nop 0
QAD v0,s[16:19],s31 offen sc1 lds
QAF m0,s39,4096
QAR v[64:65],0
QAR v[66:67],0
QAR v[68:69],0
QAR v[70:71],0
QAR v[72:73],0
QAR v[74:75],0
QAR v[76:77],0
QAR v[78:79],0
QAD v0,s[16:19],s42 offen sc1 lds
QAG v[80:83],v17 offset:0
QAG v[84:87],v17 offset:1024
QAG v[88:91],v17 offset:2048
QAG v[92:95],v17 offset:3072
QAG v[96:99],v17 offset:4096
QAG v[100:103],v17 offset:5120
QAG v[104:107],v17 offset:6144
QAG v[108:111],v17 offset:7168
QAG v[112:115],v17 offset:8192
QAG v[116:119],v17 offset:9216
QAG v[120:123],v17 offset:10240
QAG v[124:127],v17 offset:11264
QAH vmcnt(0) lgkmcnt(0)
s_barrier
s_branch lay_f0_entry
lay_f0_gr_l:
QAD v[48:51],v0,s[16:19],s31 offen sc1
QAD v[52:55],v0,s[16:19],s31 offen offset:1024 sc1
QAH vmcnt(3)
QAY v19,v[56:59]
QAV v30,v56,v57,v58
QAH vmcnt(2)
QAY v19,v[60:63] offset:1024
QAV v30,v30,v59,v60
QAV v30,v30,v61,v62
v_max_u32 v30,v30,v63
QBP vcc,-1,v30
s_cbranch_vccz lay_f0_gok_l
lay_f0_gr_l_lp:
QAD v[56:59],v0,s[16:19],s31 offen sc1
QAD v[60:63],v0,s[16:19],s31 offen offset:1024 sc1
QAH vmcnt(3)
QAY v19,v[48:51]
QAV v30,v48,v49,v50
QAH vmcnt(2)
QAY v19,v[52:55] offset:1024
QAV v30,v30,v51,v52
QAV v30,v30,v53,v54
v_max_u32 v30,v30,v55
QBP vcc,-1,v30
s_cbranch_vccz lay_f0_gok_l
QAD v[48:51],v0,s[16:19],s31 offen sc1
QAD v[52:55],v0,s[16:19],s31 offen offset:1024 sc1
QAH vmcnt(3)
QAY v19,v[56:59]
QAV v30,v56,v57,v58
QAH vmcnt(2)
QAY v19,v[60:63] offset:1024
QAV v30,v30,v59,v60
QAV v30,v30,v61,v62
v_max_u32 v30,v30,v63
QBP vcc,-1,v30
s_cbranch_vccz lay_f0_gok_l
QAF s15,s15,s3
QBK s15,200000
s_cbranch_scc1 lay_f0_gr_l_to
s_branch lay_f0_gr_l_lp
lay_f0_gr_l_to:
QAT s3,200000
s_branch lay_f0_gok_l
lay_f0_redo_l:
QAF s15,s15,s3
QBK s15,200000
s_cbranch_scc1 lay_end
QAH vmcnt(0) lgkmcnt(0)
s_barrier
QAF s40,s53,56688640
QAF s42,s30,s39
QAF s31,s30,s39
QAF s42,s42,4096
QAF m0,s39,0
s_nop 0
QAD v0,s[16:19],s31 offen sc1 lds
QAF m0,s39,4096
QAR v[64:65],0
QAR v[66:67],0
QAR v[68:69],0
QAR v[70:71],0
QAR v[72:73],0
QAR v[74:75],0
QAR v[76:77],0
QAR v[78:79],0
QAD v0,s[16:19],s42 offen sc1 lds
QAG v[80:83],v17 offset:0
QAG v[84:87],v17 offset:1024
QAG v[88:91],v17 offset:2048
QAG v[92:95],v17 offset:3072
QAG v[96:99],v17 offset:4096
QAG v[100:103],v17 offset:5120
QAG v[104:107],v17 offset:6144
QAG v[108:111],v17 offset:7168
QAG v[112:115],v17 offset:8192
QAG v[116:119],v17 offset:9216
QAG v[120:123],v17 offset:10240
QAG v[124:127],v17 offset:11264
QAH vmcnt(0) lgkmcnt(0)
s_barrier
s_branch lay_f0_entry_l
lay_f0_slow:
QAH lgkmcnt(0)
s_nop 7
QBQ v30,v32,v33,v34
QBQ v31,v35,v36,v37
QBQ v30,v30,v38,v39
QBQ v31,v31,v40,v41
v_max_f32 v30,v30,v31
QAQ v31,v30
s_nop 1
QCH v30,v31
v_max_f32 v30,v30,v31
QAQ v31,v30
s_nop 1
v_permlane16_swap_b32 v30,v31
v_max_f32 v30,v30,v31
QBV v44,v32,v30
QBV v45,v33,v30
QBV v46,v34,v30
QBV v47,v35,v30
QBV v48,v36,v30
QBV v49,v37,v30
QBV v50,v38,v30
QBV v51,v39,v30
QBV v52,v40,v30
QBV v53,v41,v30
QBA v44,v44
QBA v45,v45
QBA v46,v46
QBA v47,v47
QBA v48,v48
QBA v49,v49
QBA v50,v50
QBA v51,v51
QBA v52,v52
QBA v53,v53
QAE v54,v44,v45
QAE v55,v46,v47
QAE v56,v48,v49
QAE v57,v50,v51
QAE v28,v52,v53
s_nop 0
QAJ v[96:99],v[88:91],v[54:57],0
QAJ v[100:103],v[92:95],v[54:57],0
QAJ v[58:61],v[12:15],v[54:57],0
QBD v[58:61],v[12:13],v[28:29],v[58:61]
QBD v[96:99],v[24:25],v[28:29],v[96:99]
QBD v[100:103],v[26:27],v[28:29],v[100:103]
s_nop 7
v_rcp_f32 v30,v60
s_nop 0
QAW v96,v30,v96
QAW v97,v30,v97
QAW v98,v30,v98
QAW v99,v30,v99
QAW v100,v30,v100
QAW v101,v30,v101
QAW v102,v30,v102
QAW v103,v30,v103
QAE v44,v96,v97
QAE v45,v98,v99
QAE v46,v100,v101
QAE v47,v102,v103
QAY v5,v[44:47]
QAH lgkmcnt(0)
s_branch lay_f0_norm
.p2align 6
lay_f1_top:
QAH vmcnt(3)
QAV v30,v48,v49,v50
QAH vmcnt(2)
QAV v30,v30,v51,v52
QAV v30,v30,v53,v54
v_max_u32 v30,v30,v55
QBP vcc,-1,v30
s_cbranch_vccnz lay_f1_gr
QAY v19,v[48:51]
QAY v19,v[52:55] offset:1024
lay_f1_gok:
QAH lgkmcnt(0)
s_barrier
QAG v[32:35],v1 offset:0
QAG v[36:39],v1 offset:1024
QAG v[40:43],v1 offset:2048
QAD v0,s[16:19],s42 offen sc1 lds
lay_f1_entry2:
QAT m0,s47
QAH lgkmcnt(2)
QAC v[64:67],v[32:35],a[0:7],v10
QAG v[44:47],v1 offset:3072
QAC v[68:71],v[32:35],v[80:87],v10
QAC v[72:75],v[32:35],a[8:15],v10
QAC v[76:79],v[32:35],v[88:95],v10
QAD v1,s[16:19],s25 offen sc1 lds
QAH lgkmcnt(2)
QAG v[88:91],v17 offset:12288
QAQ v80,0
QAC v[64:67],v[36:39],a[16:23],v10
QAG v[92:95],v17 offset:13312
QAQ v81,0
QAC v[68:71],v[36:39],v[96:103],v10
QAG v[96:99],v17 offset:14336
QAQ v82,0
QAC v[72:75],v[36:39],a[24:31],v10
QAG v[100:103],v17 offset:15360
QAQ v83,0
QAC v[76:79],v[36:39],v[104:111],v10
QAD v1,s[16:19],s25 offen offset:1024 sc1 lds
QAH lgkmcnt(5)
QAG v[104:107],v18 offset:0
QAQ v84,0
QAC v[64:67],v[40:43],a[32:39],v10
QAG v[108:111],v18 offset:1024
QAQ v85,0
QAC v[68:71],v[40:43],v[112:119],v10
QAG v[112:115],v18 offset:4096
QAQ v86,0
QAC v[72:75],v[40:43],a[40:47],v10
QAG v[116:119],v18 offset:5120
QAQ v87,0
QAC v[76:79],v[40:43],v[120:127],v10
QAH vmcnt(2)
s_barrier
QAG v[48:51],v1 offset:4096
QAG v[52:55],v1 offset:5120
QAH lgkmcnt(10)
QAC v[64:67],v[44:47],a[48:55],v10
QAG v[56:59],v1 offset:6144
QAH lgkmcnt(9)
QAC v[68:71],v[44:47],v[88:95],v10
QAG v[60:63],v1 offset:7168
QAC v[72:75],v[44:47],a[56:63],v10
QAG v[120:123],v18 offset:8192
QAH lgkmcnt(9)
QAC v[76:79],v[44:47],v[96:103],v10
QAL v[20:23],v1,s[16:19],s40 offen sc1
QAG v[124:127],v18 offset:9216
QAH lgkmcnt(5)
QAC v[64:67],v[48:51],a[64:71],v10
QAG v[88:91],v18 offset:12288
v_max_u32 v30,v48,v49
QAC v[68:71],v[48:51],v[104:111],v10
QAH lgkmcnt(5)
QAG v[92:95],v18 offset:13312
QAV v30,v30,v50,v51
QAC v[64:67],v[52:55],a[80:87],v10
QAG v[96:99],v18 offset:2048
QAV v30,v30,v52,v53
QAC v[68:71],v[52:55],v[112:119],v10
QAH lgkmcnt(6)
QAG v[100:103],v18 offset:3072
QAV v30,v30,v54,v55
QAC v[64:67],v[56:59],a[96:103],v10
QAH lgkmcnt(4)
QAG v[104:107],v18 offset:6144
QAV v30,v30,v56,v57
QAC v[68:71],v[56:59],v[120:127],v10
QAG v[108:111],v18 offset:7168
QAV v30,v30,v58,v59
QAC v[64:67],v[60:63],a[112:119],v10
QAH lgkmcnt(4)
QAG v[112:115],v18 offset:10240
QAV v30,v30,v60,v61
QAC v[68:71],v[60:63],v[88:95],v10
QAG v[116:119],v18 offset:11264
QAV v30,v30,v62,v63
QAC v[72:75],v[48:51],a[72:79],v10
QAH lgkmcnt(4)
QAG v[120:123],v18 offset:14336
QBP vcc,-1,v30
QAC v[76:79],v[48:51],v[96:103],v10
QAG v[124:127],v18 offset:15360
QAU v64,v64,v66
QAC v[72:75],v[52:55],a[88:95],v10
QAH lgkmcnt(4)
QAF s31,s29,s54
QAG v[88:91],v2 offset:26624
QAU v65,v65,v67
QAC v[76:79],v[52:55],v[104:111],v10
QAG v[92:95],v2 offset:26880
QAU v68,v68,v70
QAC v[72:75],v[56:59],a[104:111],v10
QAH lgkmcnt(4)
QAF s42,s29,s52
QAG v[96:99],v16 offset:0
QAU v69,v69,v71
QAC v[76:79],v[56:59],v[112:119],v10
QAG v[100:103],v16 offset:2048
QAW v68,s34,v68
QAC v[72:75],v[60:63],a[120:127],v10
QAH lgkmcnt(4)
QAG v[104:107],v16 offset:4096
QAW v69,s34,v69
QAC v[76:79],v[60:63],v[120:127],v10
QAG v[108:111],v16 offset:6144
QAE v20,v64,v65
QAC v[80:83],v[32:35],a[128:135],v10
QAG v[112:115],v16 offset:256
QAE v21,v68,v69
QAC v[84:87],v[32:35],a[136:143],v10
QCG v3,v[20:21]
QAU v72,v72,v74
QAU v73,v73,v75
QAU v76,v76,v78
QAU v77,v77,v79
QAE v22,v72,v73
QAW v76,s34,v76
QAW v77,s34,v77
QAE v23,v76,v77
QCG v3,v[22:23] offset:512
QAC v[80:83],v[36:39],a[144:151],v10
QAC v[84:87],v[36:39],a[152:159],v10
QAG v[116:119],v16 offset:2304
QAC v[80:83],v[40:43],a[160:167],v10
QAG v[120:123],v16 offset:4352
QAC v[84:87],v[40:43],a[168:175],v10
QAG v[124:127],v16 offset:6400
QAC v[80:83],v[44:47],a[176:183],v10
s_cbranch_vccnz lay_f1_redo
QAH lgkmcnt(3)
s_barrier
QAA v[64:65],v4 offset:0
QAA v[66:67],v4 offset:256
QAF m0,s54,24576
QAF s13,s25,16777216
QAC v[84:87],v[44:47],a[184:191],v10
QAA v[68:69],v4 offset:1024
QAA v[70:71],v4 offset:1280
QAC v[80:83],v[48:51],a[192:199],v10
QAA v[72:73],v4 offset:2048
QAA v[74:75],v4 offset:2304
QAC v[84:87],v[48:51],a[200:207],v10
QAA v[76:77],v4 offset:3072
QAA v[78:79],v4 offset:3328
QAC v[80:83],v[52:55],a[208:215],v10
QAD v1,s[16:19],s13 offen sc1 lds
QAC v[84:87],v[52:55],a[216:223],v10
QAC v[80:83],v[56:59],a[224:231],v10
QAH lgkmcnt(0)
QAJ v[32:35],v[96:99],v[64:67],0
QAQ v20,v68
QAJ v[32:35],v[100:103],v[68:71],v[32:35]
QAD v1,s[16:19],s13 offen offset:1024 sc1 lds
QAQ v21,v69
QAJ v[32:35],v[104:107],v[72:75],v[32:35]
QAQ v22,v70
QAJ v[32:35],v[108:111],v[76:79],v[32:35]
QAQ v23,v71
QAJ v[36:39],v[112:115],v[64:67],0
QAJ v[36:39],v[116:119],v[68:71],v[36:39]
QAJ v[36:39],v[120:123],v[72:75],v[36:39]
QBA v44,v32
QAJ v[36:39],v[124:127],v[76:79],v[36:39]
QBA v45,v33
QAC v[84:87],v[56:59],a[232:239],v10
QBA v46,v34
QAC v[80:83],v[60:63],a[240:247],v10
QBA v47,v35
QAC v[84:87],v[60:63],a[248:255],v10
QBA v48,v36
QAJ v[40:43],v[64:67],v[64:67],0
QBA v49,v37
QAJ v[40:43],v[68:71],v[68:71],v[40:43]
QBA v50,v38
QAJ v[40:43],v[72:75],v[72:75],v[40:43]
QBA v51,v39
QAJ v[40:43],v[76:79],v[76:79],v[40:43]
QAE v54,v44,v45
QAE v55,v46,v47
QAE v56,v48,v49
QAE v57,v50,v51
QAU v80,v80,v82
QAU v81,v81,v83
QAJ v[58:61],v[12:15],v[54:57],0
QAE v24,v80,v81
QAU v84,v84,v86
QAJ v[96:99],v[88:91],v[54:57],0
QBA v52,v40
QAJ v[100:103],v[92:95],v[54:57],0
QBA v53,v41
QAU v85,v85,v87
QAE v28,v52,v53
QAE v26,v84,v85
QBQ v31,|v32|,|v33|,|v34|
QBD v[58:61],v[12:13],v[28:29],v[58:61]
QBQ v31,v31,|v35|,|v36|
QBQ v31,v31,|v37|,|v38|
QBD v[96:99],v[24:25],v[28:29],v[96:99]
QBQ v31,v31,|v39|,|v40|
v_max_f32 v31,v31,|v41|
QBD v[100:103],v[26:27],v[28:29],v[100:103]
v_rcp_f32 v30,v60
v_cmp_lt_f32 vcc,s33,v31
s_nop 1
QAW v96,v30,v96
QAW v97,v30,v97
QAW v98,v30,v98
QAW v99,v30,v99
QAE v44,v96,v97
QAE v45,v98,v99
QCG v5,v[44:45]
QBI v[100:101],v[100:101],v[30:31] op_sel_hi:[1,0]
QBI v[102:103],v[102:103],v[30:31] op_sel_hi:[1,0]
QAE v46,v100,v101
QAE v47,v102,v103
QCG v5,v[46:47] offset:8
s_and_b64 vcc,vcc,s[36:37]
s_cbranch_vccnz lay_f1_slow
lay_f1_norm:
QAR v[64:65],0
QAR v[66:67],0
QAR v[68:69],0
QAR v[70:71],0
QAH lgkmcnt(0)
s_barrier
QAG v[32:35],v6 offset:0
QAG v[36:39],v6 offset:512
QAG v[40:43],v6 offset:1024
QAG v[44:47],v6 offset:1536
QAF s13,s27,0
QAR v[72:73],0
QAR v[74:75],0
QAR v[76:77],0
QAR v[78:79],0
QAH lgkmcnt(2)
QAC v[64:67],v[32:35],v[128:135],v11
QAC v[64:67],v[36:39],v[136:143],v11
QAH lgkmcnt(0)
QAC v[64:67],v[40:43],v[144:151],v11
QAC v[64:67],v[44:47],v[152:159],v11
QAG v[88:91],v17 offset:2048
QAC v[68:71],v[32:35],v[160:167],v11
QAG v[92:95],v17 offset:3072
QAC v[68:71],v[36:39],v[168:175],v11
QAE v48,v64,v65
QAE v49,v66,v67
v_bfi_b32 v48,1,s32,v48
QBT v[48:49],v7,s[16:19],s13 offen
QAC v[68:71],v[40:43],v[176:183],v11
QAG v[96:99],v17 offset:4096
QAC v[68:71],v[44:47],v[184:191],v11
QAG v[100:103],v17 offset:5120
QAC v[72:75],v[32:35],v[192:199],v11
QAF s13,s27,65536
QAG v[104:107],v17 offset:6144
QAC v[72:75],v[36:39],v[200:207],v11
QAE v50,v68,v69
QAE v51,v70,v71
v_bfi_b32 v50,1,s32,v50
QBT v[50:51],v7,s[16:19],s13 offen
QAC v[72:75],v[40:43],v[208:215],v11
QAG v[108:111],v17 offset:7168
QAC v[72:75],v[44:47],v[216:223],v11
QAG v[112:115],v17 offset:8192
QAC v[76:79],v[32:35],v[224:231],v11
QAG v[116:119],v17 offset:9216
QAC v[76:79],v[36:39],v[232:239],v11
QAF s13,s27,131072
QAG v[120:123],v17 offset:10240
QAE v52,v72,v73
QAC v[76:79],v[40:43],v[240:247],v11
QAG v[124:127],v17 offset:11264
QAE v53,v74,v75
QAC v[76:79],v[44:47],v[248:255],v11
v_bfi_b32 v52,1,s32,v52
QBT v[52:53],v7,s[16:19],s13 offen
QAF s13,s27,196608
QAT s40,s26
QAF s26,s26,4096
QAT s14,0
QAT s15,0
s_nop 0
QAE v54,v76,v77
QAE v55,v78,v79
v_bfi_b32 v54,1,s32,v54
QBT v[54:55],v7,s[16:19],s13 offen
QAR v[64:65],0
QAR v[66:67],0
QAR v[68:69],0
QAR v[70:71],0
QAR v[72:73],0
QAD v[56:59],v1,s[16:19],s28 offen sc1
QAD v[60:63],v1,s[16:19],s28 offen offset:1024 sc1
QAR v[74:75],0
QAR v[76:77],0
QAR v[78:79],0
s_nop 15
s_nop 9
QAD v[80:83],v1,s[16:19],s28 offen sc1
QAD v[84:87],v1,s[16:19],s28 offen offset:1024 sc1
QAH vmcnt(3)
QAJ v[48:51],v[12:15],v[56:59],0
QBG v30,v56,v58,s32 bitop3:0x7e
QAH vmcnt(2)
QAJ v[48:51],v[12:15],v[60:63],v[48:51]
QBG v31,v60,v62,s32 bitop3:0x7e
QBG v30,v30,v31,1 bitop3:0xa8
v_cmp_ne_u32 vcc,0,v30
s_cbranch_vccnz lay_f1_rr
lay_f1_rok:
s_nop 0
QCE v52,v48,v48 row_ror:4 row_mask:0xf bank_mask:0xf
QCE v53,v49,v49 row_ror:4 row_mask:0xf bank_mask:0xf
s_nop 0
QCE v54,v52,v52 row_ror:8 row_mask:0xf bank_mask:0xf
QCE v55,v53,v53 row_ror:8 row_mask:0xf bank_mask:0xf
QAE v30,v54,v55
QCD v30,v8,s[16:19],s29 offen
QAQ v31,-1
QCD v31,v8,s[16:19],s30 offen
QAT s41,s24
QAF s24,s24,1
QBY vcc,s[36:37]
QCF v30,v24 quad_perm:[0,1,0,1] row_mask:0xf bank_mask:0xf
QCF v31,v26 quad_perm:[0,1,0,1] row_mask:0xf bank_mask:0xf
QAX v20,v20,v24,vcc
QAX v21,v21,v26,vcc
QAX v22,v22,v30,vcc
QAX v23,v23,v31,vcc
QBO s13,s24,1
QAS s13,s13,18
QAF s27,s13,s57
QAF s28,s27,s43
QAF s13,s24,1
QBO s13,s13,3
QAD v[48:51],v0,s[16:19],s31 offen sc1
QAD v[52:55],v0,s[16:19],s31 offen offset:1024 sc1
QAH vmcnt(4)
QAG v[80:83],v17 offset:0
QAG v[84:87],v17 offset:1024
QAS s13,s13,13
QAF s29,s13,s58
QBO s13,s24,3
QAS s13,s13,13
QAF s30,s13,s58
QCB s13,s24,1
QBO s13,s13,1
s_xor_b32 s32,s13,1
QAF s25,s25,8192
s_xor_b32 s47,s47,0x6000
QBH v16,0x6000,v16
QAF m0,s39,4096
s_nop 13
QAD v[56:59],v0,s[16:19],s31 offen sc1
QAD v[60:63],v0,s[16:19],s31 offen offset:1024 sc1
lay_f1_cutend:
QBN s24,63
s_cbranch_scc1 lay_f1_top
QAH vmcnt(3)
QAV v30,v48,v49,v50
QAH vmcnt(2)
QAV v30,v30,v51,v52
QAV v30,v30,v53,v54
v_max_u32 v30,v30,v55
QBP vcc,-1,v30
s_cbranch_vccnz lay_f1_gr_l
QAY v19,v[48:51]
QAY v19,v[52:55] offset:1024
lay_f1_gok_l:
QAH lgkmcnt(0)
s_barrier
QAG v[32:35],v1 offset:0
QAG v[36:39],v1 offset:1024
QAG v[40:43],v1 offset:2048
QAD v0,s[16:19],s42 offen sc1 lds
lay_f1_entry2_l:
QAT m0,s47
QAH lgkmcnt(2)
QAC v[64:67],v[32:35],a[0:7],v10
QAG v[44:47],v1 offset:3072
QAC v[68:71],v[32:35],v[80:87],v10
QAC v[72:75],v[32:35],a[8:15],v10
QAC v[76:79],v[32:35],v[88:95],v10
QAL v[20:23],v1,s[16:19],s40 offen sc1
QAH lgkmcnt(2)
QAG v[88:91],v17 offset:12288
QAQ v80,0
QAC v[64:67],v[36:39],a[16:23],v10
QAG v[92:95],v17 offset:13312
QAQ v81,0
QAC v[68:71],v[36:39],v[96:103],v10
QAG v[96:99],v17 offset:14336
QAQ v82,0
QAC v[72:75],v[36:39],a[24:31],v10
QAG v[100:103],v17 offset:15360
QAQ v83,0
QAC v[76:79],v[36:39],v[104:111],v10
QAH lgkmcnt(5)
QAG v[104:107],v18 offset:0
QAQ v84,0
QAC v[64:67],v[40:43],a[32:39],v10
QAG v[108:111],v18 offset:1024
QAQ v85,0
QAC v[68:71],v[40:43],v[112:119],v10
QAG v[112:115],v18 offset:4096
QAQ v86,0
QAC v[72:75],v[40:43],a[40:47],v10
QAG v[116:119],v18 offset:5120
QAQ v87,0
QAC v[76:79],v[40:43],v[120:127],v10
QAH vmcnt(1)
s_barrier
QAG v[48:51],v1 offset:4096
QAG v[52:55],v1 offset:5120
QAH lgkmcnt(10)
QAC v[64:67],v[44:47],a[48:55],v10
QAG v[56:59],v1 offset:6144
QAH lgkmcnt(9)
QAC v[68:71],v[44:47],v[88:95],v10
QAG v[60:63],v1 offset:7168
QAC v[72:75],v[44:47],a[56:63],v10
QAG v[120:123],v18 offset:8192
QAH lgkmcnt(9)
QAC v[76:79],v[44:47],v[96:103],v10
QAG v[124:127],v18 offset:9216
QAH lgkmcnt(5)
QAC v[64:67],v[48:51],a[64:71],v10
QAG v[88:91],v18 offset:12288
v_max_u32 v30,v48,v49
QAC v[68:71],v[48:51],v[104:111],v10
QAH lgkmcnt(5)
QAG v[92:95],v18 offset:13312
QAV v30,v30,v50,v51
QAC v[64:67],v[52:55],a[80:87],v10
QAG v[96:99],v18 offset:2048
QAV v30,v30,v52,v53
QAC v[68:71],v[52:55],v[112:119],v10
QAH lgkmcnt(6)
QAG v[100:103],v18 offset:3072
QAV v30,v30,v54,v55
QAC v[64:67],v[56:59],a[96:103],v10
QAH lgkmcnt(4)
QAG v[104:107],v18 offset:6144
QAV v30,v30,v56,v57
QAC v[68:71],v[56:59],v[120:127],v10
QAG v[108:111],v18 offset:7168
QAV v30,v30,v58,v59
QAC v[64:67],v[60:63],a[112:119],v10
QAH lgkmcnt(4)
QAG v[112:115],v18 offset:10240
QAV v30,v30,v60,v61
QAC v[68:71],v[60:63],v[88:95],v10
QAG v[116:119],v18 offset:11264
QAV v30,v30,v62,v63
QAC v[72:75],v[48:51],a[72:79],v10
QAH lgkmcnt(4)
QAG v[120:123],v18 offset:14336
QBP vcc,-1,v30
QAC v[76:79],v[48:51],v[96:103],v10
QAG v[124:127],v18 offset:15360
QAU v64,v64,v66
QAC v[72:75],v[52:55],a[88:95],v10
QAH lgkmcnt(4)
QAF s31,s29,s54
QAU v65,v65,v67
QAC v[76:79],v[52:55],v[104:111],v10
QAU v68,v68,v70
QAC v[72:75],v[56:59],a[104:111],v10
QAH lgkmcnt(2)
QAF s42,s29,s52
QAU v69,v69,v71
QAC v[76:79],v[56:59],v[112:119],v10
QAW v68,s34,v68
QAC v[72:75],v[60:63],a[120:127],v10
QAH lgkmcnt(0)
QAW v69,s34,v69
QAC v[76:79],v[60:63],v[120:127],v10
QAE v20,v64,v65
QAC v[80:83],v[32:35],a[128:135],v10
QAE v21,v68,v69
QAC v[84:87],v[32:35],a[136:143],v10
QAU v72,v72,v74
QAU v73,v73,v75
QAU v76,v76,v78
QAU v77,v77,v79
QAE v22,v72,v73
QAW v76,s34,v76
QAW v77,s34,v77
QAE v23,v76,v77
s_cbranch_vccnz lay_f1_redo_l
ds_write2_b64 v3,v[20:21],v[22:23] offset1:64
QAC v[80:83],v[36:39],a[144:151],v10
QAC v[84:87],v[36:39],a[152:159],v10
QAC v[80:83],v[40:43],a[160:167],v10
QAC v[84:87],v[40:43],a[168:175],v10
QAC v[80:83],v[44:47],a[176:183],v10
QAC v[84:87],v[44:47],a[184:191],v10
QAC v[80:83],v[48:51],a[192:199],v10
QAH lgkmcnt(0)
s_barrier
QAA v[20:21],v4 offset:1024
QAA v[22:23],v4 offset:1280
QAC v[84:87],v[48:51],a[200:207],v10
QAC v[80:83],v[52:55],a[208:215],v10
QAC v[84:87],v[52:55],a[216:223],v10
QAC v[80:83],v[56:59],a[224:231],v10
QAC v[84:87],v[56:59],a[232:239],v10
QAC v[80:83],v[60:63],a[240:247],v10
QAC v[84:87],v[60:63],a[248:255],v10
s_nop 3
QAU v80,v80,v82
QAU v81,v81,v83
QAE v24,v80,v81
s_nop 0
QAU v84,v84,v86
QAU v85,v85,v87
QAE v26,v84,v85
QAH lgkmcnt(0)
QBY vcc,s[36:37]
QCF v30,v24 quad_perm:[0,1,0,1] row_mask:0xf bank_mask:0xf
QCF v31,v26 quad_perm:[0,1,0,1] row_mask:0xf bank_mask:0xf
QAX v20,v20,v24,vcc
QAX v21,v21,v26,vcc
QAX v22,v22,v30,vcc
QAX v23,v23,v31,vcc
QAL v[20:23],v1,s[16:19],s26 offen sc1
QAH vmcnt(0)
s_barrier
QAQ v31,64
s_branch lay_fin
lay_f1_entry:
QAG v[32:35],v1 offset:0
QAG v[36:39],v1 offset:1024
QAG v[40:43],v1 offset:2048
s_branch lay_f1_entry2
lay_f1_entry_l:
QAG v[32:35],v1 offset:0
QAG v[36:39],v1 offset:1024
QAG v[40:43],v1 offset:2048
s_branch lay_f1_entry2_l
lay_f1_rr:
QAD v[56:59],v1,s[16:19],s28 offen sc1
QAD v[60:63],v1,s[16:19],s28 offen offset:1024 sc1
QAH vmcnt(3)
QAJ v[48:51],v[12:15],v[80:83],0
QBG v30,v80,v82,s32 bitop3:0x7e
QAH vmcnt(2)
QAJ v[48:51],v[12:15],v[84:87],v[48:51]
QBG v31,v84,v86,s32 bitop3:0x7e
QBG v30,v30,v31,1 bitop3:0xa8
v_cmp_ne_u32 vcc,0,v30
s_cbranch_vccz lay_f1_rok
lay_f1_rr_lp:
QAD v[80:83],v1,s[16:19],s28 offen sc1
QAD v[84:87],v1,s[16:19],s28 offen offset:1024 sc1
QAH vmcnt(3)
QAJ v[48:51],v[12:15],v[56:59],0
QBG v30,v56,v58,s32 bitop3:0x7e
QAH vmcnt(2)
QAJ v[48:51],v[12:15],v[60:63],v[48:51]
QBG v31,v60,v62,s32 bitop3:0x7e
QBG v30,v30,v31,1 bitop3:0xa8
v_cmp_ne_u32 vcc,0,v30
s_cbranch_vccz lay_f1_rok
QAD v[56:59],v1,s[16:19],s28 offen sc1
QAD v[60:63],v1,s[16:19],s28 offen offset:1024 sc1
QAH vmcnt(3)
QAJ v[48:51],v[12:15],v[80:83],0
QBG v30,v80,v82,s32 bitop3:0x7e
QAH vmcnt(2)
QAJ v[48:51],v[12:15],v[84:87],v[48:51]
QBG v31,v84,v86,s32 bitop3:0x7e
QBG v30,v30,v31,1 bitop3:0xa8
v_cmp_ne_u32 vcc,0,v30
s_cbranch_vccz lay_f1_rok
QAF s14,s14,s3
QBK s14,200000
s_cbranch_scc1 lay_f1_rr_to
s_branch lay_f1_rr_lp
lay_f1_rr_to:
QAT s3,200000
s_branch lay_f1_rok
lay_f1_gr:
QAD v[48:51],v0,s[16:19],s31 offen sc1
QAD v[52:55],v0,s[16:19],s31 offen offset:1024 sc1
QAH vmcnt(3)
QAY v19,v[56:59]
QAV v30,v56,v57,v58
QAH vmcnt(2)
QAY v19,v[60:63] offset:1024
QAV v30,v30,v59,v60
QAV v30,v30,v61,v62
v_max_u32 v30,v30,v63
QBP vcc,-1,v30
s_cbranch_vccz lay_f1_gok
lay_f1_gr_lp:
QAD v[56:59],v0,s[16:19],s31 offen sc1
QAD v[60:63],v0,s[16:19],s31 offen offset:1024 sc1
QAH vmcnt(3)
QAY v19,v[48:51]
QAV v30,v48,v49,v50
QAH vmcnt(2)
QAY v19,v[52:55] offset:1024
QAV v30,v30,v51,v52
QAV v30,v30,v53,v54
v_max_u32 v30,v30,v55
QBP vcc,-1,v30
s_cbranch_vccz lay_f1_gok
QAD v[48:51],v0,s[16:19],s31 offen sc1
QAD v[52:55],v0,s[16:19],s31 offen offset:1024 sc1
QAH vmcnt(3)
QAY v19,v[56:59]
QAV v30,v56,v57,v58
QAH vmcnt(2)
QAY v19,v[60:63] offset:1024
QAV v30,v30,v59,v60
QAV v30,v30,v61,v62
v_max_u32 v30,v30,v63
QBP vcc,-1,v30
s_cbranch_vccz lay_f1_gok
QAF s15,s15,s3
QBK s15,200000
s_cbranch_scc1 lay_f1_gr_to
s_branch lay_f1_gr_lp
lay_f1_gr_to:
QAT s3,200000
s_branch lay_f1_gok
lay_f1_redo:
QAF s15,s15,s3
QBK s15,200000
s_cbranch_scc1 lay_end
QAH vmcnt(0) lgkmcnt(0)
s_barrier
QAF s40,s53,56688640
QAF s42,s30,s39
QAF s31,s30,s39
QAF s42,s42,4096
QAF m0,s39,0
s_nop 0
QAD v0,s[16:19],s31 offen sc1 lds
QAF m0,s39,4096
QAR v[64:65],0
QAR v[66:67],0
QAR v[68:69],0
QAR v[70:71],0
QAR v[72:73],0
QAR v[74:75],0
QAR v[76:77],0
QAR v[78:79],0
QAD v0,s[16:19],s42 offen sc1 lds
QAG v[80:83],v17 offset:0
QAG v[84:87],v17 offset:1024
QAG v[88:91],v17 offset:2048
QAG v[92:95],v17 offset:3072
QAG v[96:99],v17 offset:4096
QAG v[100:103],v17 offset:5120
QAG v[104:107],v17 offset:6144
QAG v[108:111],v17 offset:7168
QAG v[112:115],v17 offset:8192
QAG v[116:119],v17 offset:9216
QAG v[120:123],v17 offset:10240
QAG v[124:127],v17 offset:11264
QAH vmcnt(0) lgkmcnt(0)
s_barrier
s_branch lay_f1_entry
lay_f1_gr_l:
QAD v[48:51],v0,s[16:19],s31 offen sc1
QAD v[52:55],v0,s[16:19],s31 offen offset:1024 sc1
QAH vmcnt(3)
QAY v19,v[56:59]
QAV v30,v56,v57,v58
QAH vmcnt(2)
QAY v19,v[60:63] offset:1024
QAV v30,v30,v59,v60
QAV v30,v30,v61,v62
v_max_u32 v30,v30,v63
QBP vcc,-1,v30
s_cbranch_vccz lay_f1_gok_l
lay_f1_gr_l_lp:
QAD v[56:59],v0,s[16:19],s31 offen sc1
QAD v[60:63],v0,s[16:19],s31 offen offset:1024 sc1
QAH vmcnt(3)
QAY v19,v[48:51]
QAV v30,v48,v49,v50
QAH vmcnt(2)
QAY v19,v[52:55] offset:1024
QAV v30,v30,v51,v52
QAV v30,v30,v53,v54
v_max_u32 v30,v30,v55
QBP vcc,-1,v30
s_cbranch_vccz lay_f1_gok_l
QAD v[48:51],v0,s[16:19],s31 offen sc1
QAD v[52:55],v0,s[16:19],s31 offen offset:1024 sc1
QAH vmcnt(3)
QAY v19,v[56:59]
QAV v30,v56,v57,v58
QAH vmcnt(2)
QAY v19,v[60:63] offset:1024
QAV v30,v30,v59,v60
QAV v30,v30,v61,v62
v_max_u32 v30,v30,v63
QBP vcc,-1,v30
s_cbranch_vccz lay_f1_gok_l
QAF s15,s15,s3
QBK s15,200000
s_cbranch_scc1 lay_f1_gr_l_to
s_branch lay_f1_gr_l_lp
lay_f1_gr_l_to:
QAT s3,200000
s_branch lay_f1_gok_l
lay_f1_redo_l:
QAF s15,s15,s3
QBK s15,200000
s_cbranch_scc1 lay_end
QAH vmcnt(0) lgkmcnt(0)
s_barrier
QAF s40,s53,56688640
QAF s42,s30,s39
QAF s31,s30,s39
QAF s42,s42,4096
QAF m0,s39,0
s_nop 0
QAD v0,s[16:19],s31 offen sc1 lds
QAF m0,s39,4096
QAR v[64:65],0
QAR v[66:67],0
QAR v[68:69],0
QAR v[70:71],0
QAR v[72:73],0
QAR v[74:75],0
QAR v[76:77],0
QAR v[78:79],0
QAD v0,s[16:19],s42 offen sc1 lds
QAG v[80:83],v17 offset:0
QAG v[84:87],v17 offset:1024
QAG v[88:91],v17 offset:2048
QAG v[92:95],v17 offset:3072
QAG v[96:99],v17 offset:4096
QAG v[100:103],v17 offset:5120
QAG v[104:107],v17 offset:6144
QAG v[108:111],v17 offset:7168
QAG v[112:115],v17 offset:8192
QAG v[116:119],v17 offset:9216
QAG v[120:123],v17 offset:10240
QAG v[124:127],v17 offset:11264
QAH vmcnt(0) lgkmcnt(0)
s_barrier
s_branch lay_f1_entry_l
lay_f1_slow:
QAH lgkmcnt(0)
s_nop 7
QBQ v30,v32,v33,v34
QBQ v31,v35,v36,v37
QBQ v30,v30,v38,v39
QBQ v31,v31,v40,v41
v_max_f32 v30,v30,v31
QAQ v31,v30
s_nop 1
QCH v30,v31
v_max_f32 v30,v30,v31
QAQ v31,v30
s_nop 1
v_permlane16_swap_b32 v30,v31
v_max_f32 v30,v30,v31
QBV v44,v32,v30
QBV v45,v33,v30
QBV v46,v34,v30
QBV v47,v35,v30
QBV v48,v36,v30
QBV v49,v37,v30
QBV v50,v38,v30
QBV v51,v39,v30
QBV v52,v40,v30
QBV v53,v41,v30
QBA v44,v44
QBA v45,v45
QBA v46,v46
QBA v47,v47
QBA v48,v48
QBA v49,v49
QBA v50,v50
QBA v51,v51
QBA v52,v52
QBA v53,v53
QAE v54,v44,v45
QAE v55,v46,v47
QAE v56,v48,v49
QAE v57,v50,v51
QAE v28,v52,v53
s_nop 0
QAJ v[96:99],v[88:91],v[54:57],0
QAJ v[100:103],v[92:95],v[54:57],0
QAJ v[58:61],v[12:15],v[54:57],0
QBD v[58:61],v[12:13],v[28:29],v[58:61]
QBD v[96:99],v[24:25],v[28:29],v[96:99]
QBD v[100:103],v[26:27],v[28:29],v[100:103]
s_nop 7
v_rcp_f32 v30,v60
s_nop 0
QAW v96,v30,v96
QAW v97,v30,v97
QAW v98,v30,v98
QAW v99,v30,v99
QAW v100,v30,v100
QAW v101,v30,v101
QAW v102,v30,v102
QAW v103,v30,v103
QAE v44,v96,v97
QAE v45,v98,v99
QAE v46,v100,v101
QAE v47,v102,v103
QAY v5,v[44:47]
QAH lgkmcnt(0)
s_branch lay_f1_norm
.p2align 6
lay_f2_top:
s_barrier
QAG v[32:35],v1 offset:0
QAG v[36:39],v1 offset:1024
QAG v[40:43],v1 offset:2048
QAD v0,s[16:19],s42 offen sc1 lds
lay_f2_entry2:
QAT m0,s47
QAH lgkmcnt(2)
QAC v[64:67],v[32:35],a[0:7],v10
QAG v[44:47],v1 offset:3072
QAC v[68:71],v[32:35],v[80:87],v10
QAC v[72:75],v[32:35],a[8:15],v10
QAC v[76:79],v[32:35],v[88:95],v10
QAH lgkmcnt(2)
QAG v[88:91],v17 offset:12288
QAQ v80,0
QAC v[64:67],v[36:39],a[16:23],v10
QAD v1,s[16:19],s25 offen sc1 lds
QAG v[92:95],v17 offset:13312
QAQ v81,0
QAC v[68:71],v[36:39],v[96:103],v10
QAG v[96:99],v17 offset:14336
QAQ v82,0
QAC v[72:75],v[36:39],a[24:31],v10
QAG v[100:103],v17 offset:15360
QAQ v83,0
QAC v[76:79],v[36:39],v[104:111],v10
QAH lgkmcnt(5)
QAG v[104:107],v18 offset:0
QAQ v84,0
QAC v[64:67],v[40:43],a[32:39],v10
QAD v1,s[16:19],s25 offen offset:1024 sc1 lds
QAG v[108:111],v18 offset:1024
QAQ v85,0
QAC v[68:71],v[40:43],v[112:119],v10
QAG v[112:115],v18 offset:4096
QAQ v86,0
QAC v[72:75],v[40:43],a[40:47],v10
QAG v[116:119],v18 offset:5120
QAQ v87,0
QAC v[76:79],v[40:43],v[120:127],v10
QAH vmcnt(2)
s_barrier
QAG v[48:51],v1 offset:4096
QAG v[52:55],v1 offset:5120
QAH lgkmcnt(10)
QAC v[64:67],v[44:47],a[48:55],v10
QAG v[56:59],v1 offset:6144
QAH lgkmcnt(9)
QAC v[68:71],v[44:47],v[88:95],v10
QAG v[60:63],v1 offset:7168
QAC v[72:75],v[44:47],a[56:63],v10
QAG v[120:123],v18 offset:8192
QAH lgkmcnt(9)
QAC v[76:79],v[44:47],v[96:103],v10
QAG v[124:127],v18 offset:9216
QAH lgkmcnt(5)
QAC v[64:67],v[48:51],a[64:71],v10
QAL v[20:23],v1,s[16:19],s40 offen sc1
QAG v[88:91],v18 offset:12288
v_max_u32 v30,v48,v49
QAC v[68:71],v[48:51],v[104:111],v10
QAH lgkmcnt(5)
QAG v[92:95],v18 offset:13312
QAV v30,v30,v50,v51
QAC v[64:67],v[52:55],a[80:87],v10
QAG v[96:99],v18 offset:2048
QAV v30,v30,v52,v53
QAC v[68:71],v[52:55],v[112:119],v10
QAH lgkmcnt(6)
QAG v[100:103],v18 offset:3072
QAV v30,v30,v54,v55
QAC v[64:67],v[56:59],a[96:103],v10
QAQ v31,s41
QBY exec,1
QCD v31,off,s[16:19],s55 sc1
QBY exec,-1
QAH lgkmcnt(4)
QAG v[104:107],v18 offset:6144
QAV v30,v30,v56,v57
QAC v[68:71],v[56:59],v[120:127],v10
QAG v[108:111],v18 offset:7168
QAV v30,v30,v58,v59
QAC v[64:67],v[60:63],a[112:119],v10
QAH lgkmcnt(4)
QAG v[112:115],v18 offset:10240
QAV v30,v30,v60,v61
QAC v[68:71],v[60:63],v[88:95],v10
QAG v[116:119],v18 offset:11264
QAV v30,v30,v62,v63
QAC v[72:75],v[48:51],a[72:79],v10
QAH lgkmcnt(4)
QAG v[120:123],v18 offset:14336
QBP vcc,-1,v30
QAC v[76:79],v[48:51],v[96:103],v10
QAG v[124:127],v18 offset:15360
QAU v64,v64,v66
QAC v[72:75],v[52:55],a[88:95],v10
QAH lgkmcnt(4)
QAF s31,s29,s54
QAG v[88:91],v2 offset:28672
QAU v65,v65,v67
QAC v[76:79],v[52:55],v[104:111],v10
QAG v[92:95],v2 offset:28928
QAU v68,v68,v70
QAC v[72:75],v[56:59],a[104:111],v10
QAH lgkmcnt(4)
QAF s42,s29,s52
QAG v[96:99],v16 offset:0
QAU v69,v69,v71
QAC v[76:79],v[56:59],v[112:119],v10
QAG v[100:103],v16 offset:2048
QAW v68,s34,v68
QAC v[72:75],v[60:63],a[120:127],v10
QAH lgkmcnt(4)
QAG v[104:107],v16 offset:4096
QAW v69,s34,v69
QAC v[76:79],v[60:63],v[120:127],v10
QAG v[108:111],v16 offset:6144
QAE v20,v64,v65
QAC v[80:83],v[32:35],a[128:135],v10
QAG v[112:115],v16 offset:256
QAE v21,v68,v69
QAC v[84:87],v[32:35],a[136:143],v10
QCG v3,v[20:21]
QAU v72,v72,v74
QAU v73,v73,v75
QAU v76,v76,v78
QAU v77,v77,v79
QAE v22,v72,v73
QAW v76,s34,v76
QAW v77,s34,v77
QAE v23,v76,v77
QCG v3,v[22:23] offset:512
QAC v[80:83],v[36:39],a[144:151],v10
QAC v[84:87],v[36:39],a[152:159],v10
QAG v[116:119],v16 offset:2304
QAC v[80:83],v[40:43],a[160:167],v10
QAG v[120:123],v16 offset:4352
QAC v[84:87],v[40:43],a[168:175],v10
QAG v[124:127],v16 offset:6400
QAC v[80:83],v[44:47],a[176:183],v10
s_cbranch_vccnz lay_f2_redo
QAH lgkmcnt(3)
s_barrier
QAA v[64:65],v4 offset:0
QAA v[66:67],v4 offset:256
QAF m0,s54,24576
QAF s13,s25,16777216
QAC v[84:87],v[44:47],a[184:191],v10
QAA v[68:69],v4 offset:1024
QAA v[70:71],v4 offset:1280
QAC v[80:83],v[48:51],a[192:199],v10
QAA v[72:73],v4 offset:2048
QAA v[74:75],v4 offset:2304
QAC v[84:87],v[48:51],a[200:207],v10
QAA v[76:77],v4 offset:3072
QAA v[78:79],v4 offset:3328
QAC v[80:83],v[52:55],a[208:215],v10
QAC v[84:87],v[52:55],a[216:223],v10
QAD v1,s[16:19],s13 offen sc1 lds
QAC v[80:83],v[56:59],a[224:231],v10
QAH lgkmcnt(0)
QAJ v[32:35],v[96:99],v[64:67],0
QAQ v20,v72
QAJ v[32:35],v[100:103],v[68:71],v[32:35]
QAQ v21,v73
QAJ v[32:35],v[104:107],v[72:75],v[32:35]
QAD v1,s[16:19],s13 offen offset:1024 sc1 lds
QAQ v22,v74
QAJ v[32:35],v[108:111],v[76:79],v[32:35]
QAQ v23,v75
QAJ v[36:39],v[112:115],v[64:67],0
QAJ v[36:39],v[116:119],v[68:71],v[36:39]
QAJ v[36:39],v[120:123],v[72:75],v[36:39]
QBA v44,v32
QAJ v[36:39],v[124:127],v[76:79],v[36:39]
QBA v45,v33
QAC v[84:87],v[56:59],a[232:239],v10
QBA v46,v34
QAC v[80:83],v[60:63],a[240:247],v10
QBA v47,v35
QAC v[84:87],v[60:63],a[248:255],v10
QBA v48,v36
QAJ v[40:43],v[64:67],v[64:67],0
QBA v49,v37
QAJ v[40:43],v[68:71],v[68:71],v[40:43]
QBA v50,v38
QAJ v[40:43],v[72:75],v[72:75],v[40:43]
QBA v51,v39
QAJ v[40:43],v[76:79],v[76:79],v[40:43]
QAE v54,v44,v45
QAE v55,v46,v47
QAE v56,v48,v49
QAE v57,v50,v51
QAU v80,v80,v82
QAU v81,v81,v83
QAJ v[58:61],v[12:15],v[54:57],0
QAE v24,v80,v81
QAU v84,v84,v86
QAJ v[96:99],v[88:91],v[54:57],0
QBA v52,v40
QAJ v[100:103],v[92:95],v[54:57],0
QBA v53,v41
QAU v85,v85,v87
QAE v28,v52,v53
QAE v26,v84,v85
QBQ v31,|v32|,|v33|,|v34|
QBD v[58:61],v[12:13],v[28:29],v[58:61]
QBQ v31,v31,|v35|,|v36|
QBQ v31,v31,|v37|,|v38|
QBD v[96:99],v[24:25],v[28:29],v[96:99]
QBQ v31,v31,|v39|,|v40|
v_max_f32 v31,v31,|v41|
QBD v[100:103],v[26:27],v[28:29],v[100:103]
v_rcp_f32 v30,v60
v_cmp_lt_f32 vcc,s33,v31
s_nop 1
QAW v96,v30,v96
QAW v97,v30,v97
QAW v98,v30,v98
QAW v99,v30,v99
QAE v44,v96,v97
QAE v45,v98,v99
QCG v5,v[44:45]
QBI v[100:101],v[100:101],v[30:31] op_sel_hi:[1,0]
QBI v[102:103],v[102:103],v[30:31] op_sel_hi:[1,0]
QAE v46,v100,v101
QAE v47,v102,v103
QCG v5,v[46:47] offset:8
s_and_b64 vcc,vcc,s[36:37]
s_cbranch_vccnz lay_f2_slow
lay_f2_norm:
QAR v[64:65],0
QAR v[66:67],0
QAR v[68:69],0
QAR v[70:71],0
QAH lgkmcnt(0)
s_barrier
QAG v[32:35],v6 offset:0
QAG v[36:39],v6 offset:512
QAG v[40:43],v6 offset:1024
QAG v[44:47],v6 offset:1536
QAF s13,s27,0
QAR v[72:73],0
QAR v[74:75],0
QAR v[76:77],0
QAR v[78:79],0
QAH lgkmcnt(2)
QAC v[64:67],v[32:35],v[128:135],v11
QAC v[64:67],v[36:39],v[136:143],v11
QAH lgkmcnt(0)
QAC v[64:67],v[40:43],v[144:151],v11
QAC v[64:67],v[44:47],v[152:159],v11
QAG v[88:91],v17 offset:2048
QAC v[68:71],v[32:35],v[160:167],v11
QAG v[92:95],v17 offset:3072
QAC v[68:71],v[36:39],v[168:175],v11
QAE v48,v64,v65
QAE v49,v66,v67
v_bfi_b32 v48,1,s32,v48
QBT v[48:49],v7,s[16:19],s13 offen
QAC v[68:71],v[40:43],v[176:183],v11
QAG v[96:99],v17 offset:4096
QAC v[68:71],v[44:47],v[184:191],v11
QAG v[100:103],v17 offset:5120
QAC v[72:75],v[32:35],v[192:199],v11
QAF s13,s27,65536
QAG v[104:107],v17 offset:6144
QAC v[72:75],v[36:39],v[200:207],v11
QAE v50,v68,v69
QAE v51,v70,v71
v_bfi_b32 v50,1,s32,v50
QBT v[50:51],v7,s[16:19],s13 offen
QAC v[72:75],v[40:43],v[208:215],v11
QAG v[108:111],v17 offset:7168
QAC v[72:75],v[44:47],v[216:223],v11
QAG v[112:115],v17 offset:8192
QAC v[76:79],v[32:35],v[224:231],v11
QAG v[116:119],v17 offset:9216
QAC v[76:79],v[36:39],v[232:239],v11
QAF s13,s27,131072
QAG v[120:123],v17 offset:10240
QAE v52,v72,v73
QAC v[76:79],v[40:43],v[240:247],v11
QAG v[124:127],v17 offset:11264
QAE v53,v74,v75
QAC v[76:79],v[44:47],v[248:255],v11
v_bfi_b32 v52,1,s32,v52
QBT v[52:53],v7,s[16:19],s13 offen
QAF s13,s27,196608
QAT s40,s26
QAF s26,s26,4096
QAT s14,0
QAT s15,0
s_nop 0
QAE v54,v76,v77
QAE v55,v78,v79
v_bfi_b32 v54,1,s32,v54
QBT v[54:55],v7,s[16:19],s13 offen
QAR v[64:65],0
QAR v[66:67],0
QAR v[68:69],0
QAR v[70:71],0
QAR v[72:73],0
QAR v[74:75],0
QAR v[76:77],0
QAR v[78:79],0
s_nop 15
s_nop 15
s_nop 6
QAD v[56:59],v1,s[16:19],s28 offen sc1
QAD v[60:63],v1,s[16:19],s28 offen offset:1024 sc1
s_nop 15
s_nop 12
QAD v[80:83],v1,s[16:19],s28 offen sc1
QAD v[84:87],v1,s[16:19],s28 offen offset:1024 sc1
QAH vmcnt(3)
QAJ v[48:51],v[12:15],v[56:59],0
QBG v30,v56,v58,s32 bitop3:0x7e
QAH vmcnt(2)
QAJ v[48:51],v[12:15],v[60:63],v[48:51]
QBG v31,v60,v62,s32 bitop3:0x7e
QBG v30,v30,v31,1 bitop3:0xa8
v_cmp_ne_u32 vcc,0,v30
s_cbranch_vccnz lay_f2_rr
lay_f2_rok:
s_nop 0
QCE v52,v48,v48 row_ror:4 row_mask:0xf bank_mask:0xf
QCE v53,v49,v49 row_ror:4 row_mask:0xf bank_mask:0xf
s_nop 0
QCE v54,v52,v52 row_ror:8 row_mask:0xf bank_mask:0xf
QCE v55,v53,v53 row_ror:8 row_mask:0xf bank_mask:0xf
QAE v30,v54,v55
QCD v30,v8,s[16:19],s29 offen
QAQ v31,-1
QCD v31,v8,s[16:19],s30 offen
QAT s41,s24
QAF s24,s24,1
QBY vcc,s[36:37]
QCF v30,v24 quad_perm:[0,1,0,1] row_mask:0xf bank_mask:0xf
QCF v31,v26 quad_perm:[0,1,0,1] row_mask:0xf bank_mask:0xf
QAX v20,v20,v24,vcc
QAX v21,v21,v26,vcc
QAX v22,v22,v30,vcc
QAX v23,v23,v31,vcc
QBO s13,s24,1
QAS s13,s13,18
QAF s27,s13,s57
QAF s28,s27,s43
QAF s13,s24,1
QBO s13,s13,3
QAS s13,s13,13
QAF s29,s13,s58
QBO s13,s24,3
QAS s13,s13,13
QAF s30,s13,s58
QCB s13,s24,1
QBO s13,s13,1
s_xor_b32 s32,s13,1
QAF s25,s25,8192
s_xor_b32 s47,s47,0x6000
QBH v16,0x6000,v16
QAF m0,s39,4096
QAH vmcnt(2)
QAG v[80:83],v17 offset:0
QAG v[84:87],v17 offset:1024
lay_f2_cutend:
QBN s24,63
s_cbranch_scc1 lay_f2_top
s_barrier
QAG v[32:35],v1 offset:0
QAG v[36:39],v1 offset:1024
QAG v[40:43],v1 offset:2048
QAD v0,s[16:19],s42 offen sc1 lds
lay_f2_entry2_l:
QAT m0,s47
QAH lgkmcnt(2)
QAC v[64:67],v[32:35],a[0:7],v10
QAG v[44:47],v1 offset:3072
QAC v[68:71],v[32:35],v[80:87],v10
QAC v[72:75],v[32:35],a[8:15],v10
QAC v[76:79],v[32:35],v[88:95],v10
QAH lgkmcnt(2)
QAG v[88:91],v17 offset:12288
QAQ v80,0
QAC v[64:67],v[36:39],a[16:23],v10
QAL v[20:23],v1,s[16:19],s40 offen sc1
QAG v[92:95],v17 offset:13312
QAQ v81,0
QAC v[68:71],v[36:39],v[96:103],v10
QAG v[96:99],v17 offset:14336
QAQ v82,0
QAC v[72:75],v[36:39],a[24:31],v10
QAG v[100:103],v17 offset:15360
QAQ v83,0
QAC v[76:79],v[36:39],v[104:111],v10
QAH lgkmcnt(5)
QAG v[104:107],v18 offset:0
QAQ v84,0
QAC v[64:67],v[40:43],a[32:39],v10
QAQ v31,s41
QBY exec,1
QCD v31,off,s[16:19],s55 sc1
QBY exec,-1
QAG v[108:111],v18 offset:1024
QAQ v85,0
QAC v[68:71],v[40:43],v[112:119],v10
QAG v[112:115],v18 offset:4096
QAQ v86,0
QAC v[72:75],v[40:43],a[40:47],v10
QAG v[116:119],v18 offset:5120
QAQ v87,0
QAC v[76:79],v[40:43],v[120:127],v10
QAH vmcnt(2)
s_barrier
QAG v[48:51],v1 offset:4096
QAG v[52:55],v1 offset:5120
QAH lgkmcnt(10)
QAC v[64:67],v[44:47],a[48:55],v10
QAG v[56:59],v1 offset:6144
QAH lgkmcnt(9)
QAC v[68:71],v[44:47],v[88:95],v10
QAG v[60:63],v1 offset:7168
QAC v[72:75],v[44:47],a[56:63],v10
QAG v[120:123],v18 offset:8192
QAH lgkmcnt(9)
QAC v[76:79],v[44:47],v[96:103],v10
QAG v[124:127],v18 offset:9216
QAH lgkmcnt(5)
QAC v[64:67],v[48:51],a[64:71],v10
QAG v[88:91],v18 offset:12288
v_max_u32 v30,v48,v49
QAC v[68:71],v[48:51],v[104:111],v10
QAH lgkmcnt(5)
QAG v[92:95],v18 offset:13312
QAV v30,v30,v50,v51
QAC v[64:67],v[52:55],a[80:87],v10
QAG v[96:99],v18 offset:2048
QAV v30,v30,v52,v53
QAC v[68:71],v[52:55],v[112:119],v10
QAH lgkmcnt(6)
QAG v[100:103],v18 offset:3072
QAV v30,v30,v54,v55
QAC v[64:67],v[56:59],a[96:103],v10
QAH lgkmcnt(4)
QAG v[104:107],v18 offset:6144
QAV v30,v30,v56,v57
QAC v[68:71],v[56:59],v[120:127],v10
QAG v[108:111],v18 offset:7168
QAV v30,v30,v58,v59
QAC v[64:67],v[60:63],a[112:119],v10
QAH lgkmcnt(4)
QAG v[112:115],v18 offset:10240
QAV v30,v30,v60,v61
QAC v[68:71],v[60:63],v[88:95],v10
QAG v[116:119],v18 offset:11264
QAV v30,v30,v62,v63
QAC v[72:75],v[48:51],a[72:79],v10
QAH lgkmcnt(4)
QAG v[120:123],v18 offset:14336
QBP vcc,-1,v30
QAC v[76:79],v[48:51],v[96:103],v10
QAG v[124:127],v18 offset:15360
QAU v64,v64,v66
QAC v[72:75],v[52:55],a[88:95],v10
QAH lgkmcnt(4)
QAF s31,s29,s54
QAU v65,v65,v67
QAC v[76:79],v[52:55],v[104:111],v10
QAU v68,v68,v70
QAC v[72:75],v[56:59],a[104:111],v10
QAH lgkmcnt(2)
QAF s42,s29,s52
QAU v69,v69,v71
QAC v[76:79],v[56:59],v[112:119],v10
QAW v68,s34,v68
QAC v[72:75],v[60:63],a[120:127],v10
QAH lgkmcnt(0)
QAW v69,s34,v69
QAC v[76:79],v[60:63],v[120:127],v10
QAE v20,v64,v65
QAC v[80:83],v[32:35],a[128:135],v10
QAE v21,v68,v69
QAC v[84:87],v[32:35],a[136:143],v10
QAU v72,v72,v74
QAU v73,v73,v75
QAU v76,v76,v78
QAU v77,v77,v79
QAE v22,v72,v73
QAW v76,s34,v76
QAW v77,s34,v77
QAE v23,v76,v77
s_cbranch_vccnz lay_f2_redo_l
ds_write2_b64 v3,v[20:21],v[22:23] offset1:64
QAC v[80:83],v[36:39],a[144:151],v10
QAC v[84:87],v[36:39],a[152:159],v10
QAC v[80:83],v[40:43],a[160:167],v10
QAC v[84:87],v[40:43],a[168:175],v10
QAC v[80:83],v[44:47],a[176:183],v10
QAC v[84:87],v[44:47],a[184:191],v10
QAC v[80:83],v[48:51],a[192:199],v10
QAH lgkmcnt(0)
s_barrier
QAA v[20:21],v4 offset:2048
QAA v[22:23],v4 offset:2304
QAC v[84:87],v[48:51],a[200:207],v10
QAC v[80:83],v[52:55],a[208:215],v10
QAC v[84:87],v[52:55],a[216:223],v10
QAC v[80:83],v[56:59],a[224:231],v10
QAC v[84:87],v[56:59],a[232:239],v10
QAC v[80:83],v[60:63],a[240:247],v10
QAC v[84:87],v[60:63],a[248:255],v10
s_nop 3
QAU v80,v80,v82
QAU v81,v81,v83
QAE v24,v80,v81
s_nop 0
QAU v84,v84,v86
QAU v85,v85,v87
QAE v26,v84,v85
QAH lgkmcnt(0)
QBY vcc,s[36:37]
QCF v30,v24 quad_perm:[0,1,0,1] row_mask:0xf bank_mask:0xf
QCF v31,v26 quad_perm:[0,1,0,1] row_mask:0xf bank_mask:0xf
QAX v20,v20,v24,vcc
QAX v21,v21,v26,vcc
QAX v22,v22,v30,vcc
QAX v23,v23,v31,vcc
QAL v[20:23],v1,s[16:19],s26 offen sc1
QAH vmcnt(0)
s_barrier
QAQ v31,64
s_branch lay_fin
lay_f2_entry:
QAG v[32:35],v1 offset:0
QAG v[36:39],v1 offset:1024
QAG v[40:43],v1 offset:2048
s_branch lay_f2_entry2
lay_f2_entry_l:
QAG v[32:35],v1 offset:0
QAG v[36:39],v1 offset:1024
QAG v[40:43],v1 offset:2048
s_branch lay_f2_entry2_l
lay_f2_rr:
QAD v[56:59],v1,s[16:19],s28 offen sc1
QAD v[60:63],v1,s[16:19],s28 offen offset:1024 sc1
QAH vmcnt(3)
QAJ v[48:51],v[12:15],v[80:83],0
QBG v30,v80,v82,s32 bitop3:0x7e
QAH vmcnt(2)
QAJ v[48:51],v[12:15],v[84:87],v[48:51]
QBG v31,v84,v86,s32 bitop3:0x7e
QBG v30,v30,v31,1 bitop3:0xa8
v_cmp_ne_u32 vcc,0,v30
s_cbranch_vccz lay_f2_rok
lay_f2_rr_lp:
QAD v[80:83],v1,s[16:19],s28 offen sc1
QAD v[84:87],v1,s[16:19],s28 offen offset:1024 sc1
QAH vmcnt(3)
QAJ v[48:51],v[12:15],v[56:59],0
QBG v30,v56,v58,s32 bitop3:0x7e
QAH vmcnt(2)
QAJ v[48:51],v[12:15],v[60:63],v[48:51]
QBG v31,v60,v62,s32 bitop3:0x7e
QBG v30,v30,v31,1 bitop3:0xa8
v_cmp_ne_u32 vcc,0,v30
s_cbranch_vccz lay_f2_rok
QAD v[56:59],v1,s[16:19],s28 offen sc1
QAD v[60:63],v1,s[16:19],s28 offen offset:1024 sc1
QAH vmcnt(3)
QAJ v[48:51],v[12:15],v[80:83],0
QBG v30,v80,v82,s32 bitop3:0x7e
QAH vmcnt(2)
QAJ v[48:51],v[12:15],v[84:87],v[48:51]
QBG v31,v84,v86,s32 bitop3:0x7e
QBG v30,v30,v31,1 bitop3:0xa8
v_cmp_ne_u32 vcc,0,v30
s_cbranch_vccz lay_f2_rok
QAF s14,s14,s3
QBK s14,200000
s_cbranch_scc1 lay_f2_rr_to
s_branch lay_f2_rr_lp
lay_f2_rr_to:
QAT s3,200000
s_branch lay_f2_rok
lay_f2_redo:
QAF s15,s15,s3
QBK s15,200000
s_cbranch_scc1 lay_end
QAH vmcnt(0) lgkmcnt(0)
s_barrier
QAF s40,s53,56688640
QAF s42,s30,s39
QAF s31,s30,s39
QAF s42,s42,4096
QAF m0,s39,0
s_nop 0
QAD v0,s[16:19],s31 offen sc1 lds
QAF m0,s39,4096
QAR v[64:65],0
QAR v[66:67],0
QAR v[68:69],0
QAR v[70:71],0
QAR v[72:73],0
QAR v[74:75],0
QAR v[76:77],0
QAR v[78:79],0
QAD v0,s[16:19],s42 offen sc1 lds
QAG v[80:83],v17 offset:0
QAG v[84:87],v17 offset:1024
QAG v[88:91],v17 offset:2048
QAG v[92:95],v17 offset:3072
QAG v[96:99],v17 offset:4096
QAG v[100:103],v17 offset:5120
QAG v[104:107],v17 offset:6144
QAG v[108:111],v17 offset:7168
QAG v[112:115],v17 offset:8192
QAG v[116:119],v17 offset:9216
QAG v[120:123],v17 offset:10240
QAG v[124:127],v17 offset:11264
QAH vmcnt(0) lgkmcnt(0)
s_barrier
s_branch lay_f2_entry
lay_f2_redo_l:
QAF s15,s15,s3
QBK s15,200000
s_cbranch_scc1 lay_end
QAH vmcnt(0) lgkmcnt(0)
s_barrier
QAF s40,s53,56688640
QAF s42,s30,s39
QAF s31,s30,s39
QAF s42,s42,4096
QAF m0,s39,0
s_nop 0
QAD v0,s[16:19],s31 offen sc1 lds
QAF m0,s39,4096
QAR v[64:65],0
QAR v[66:67],0
QAR v[68:69],0
QAR v[70:71],0
QAR v[72:73],0
QAR v[74:75],0
QAR v[76:77],0
QAR v[78:79],0
QAD v0,s[16:19],s42 offen sc1 lds
QAG v[80:83],v17 offset:0
QAG v[84:87],v17 offset:1024
QAG v[88:91],v17 offset:2048
QAG v[92:95],v17 offset:3072
QAG v[96:99],v17 offset:4096
QAG v[100:103],v17 offset:5120
QAG v[104:107],v17 offset:6144
QAG v[108:111],v17 offset:7168
QAG v[112:115],v17 offset:8192
QAG v[116:119],v17 offset:9216
QAG v[120:123],v17 offset:10240
QAG v[124:127],v17 offset:11264
QAH vmcnt(0) lgkmcnt(0)
s_barrier
s_branch lay_f2_entry_l
lay_f2_slow:
QAH lgkmcnt(0)
s_nop 7
QBQ v30,v32,v33,v34
QBQ v31,v35,v36,v37
QBQ v30,v30,v38,v39
QBQ v31,v31,v40,v41
v_max_f32 v30,v30,v31
QAQ v31,v30
s_nop 1
QCH v30,v31
v_max_f32 v30,v30,v31
QAQ v31,v30
s_nop 1
v_permlane16_swap_b32 v30,v31
v_max_f32 v30,v30,v31
QBV v44,v32,v30
QBV v45,v33,v30
QBV v46,v34,v30
QBV v47,v35,v30
QBV v48,v36,v30
QBV v49,v37,v30
QBV v50,v38,v30
QBV v51,v39,v30
QBV v52,v40,v30
QBV v53,v41,v30
QBA v44,v44
QBA v45,v45
QBA v46,v46
QBA v47,v47
QBA v48,v48
QBA v49,v49
QBA v50,v50
QBA v51,v51
QBA v52,v52
QBA v53,v53
QAE v54,v44,v45
QAE v55,v46,v47
QAE v56,v48,v49
QAE v57,v50,v51
QAE v28,v52,v53
s_nop 0
QAJ v[96:99],v[88:91],v[54:57],0
QAJ v[100:103],v[92:95],v[54:57],0
QAJ v[58:61],v[12:15],v[54:57],0
QBD v[58:61],v[12:13],v[28:29],v[58:61]
QBD v[96:99],v[24:25],v[28:29],v[96:99]
QBD v[100:103],v[26:27],v[28:29],v[100:103]
s_nop 7
v_rcp_f32 v30,v60
s_nop 0
QAW v96,v30,v96
QAW v97,v30,v97
QAW v98,v30,v98
QAW v99,v30,v99
QAW v100,v30,v100
QAW v101,v30,v101
QAW v102,v30,v102
QAW v103,v30,v103
QAE v44,v96,v97
QAE v45,v98,v99
QAE v46,v100,v101
QAE v47,v102,v103
QAY v5,v[44:47]
QAH lgkmcnt(0)
s_branch lay_f2_norm
.p2align 6
lay_f3_top:
s_barrier
QAG v[32:35],v1 offset:0
QAG v[36:39],v1 offset:1024
QAG v[40:43],v1 offset:2048
QAD v0,s[16:19],s42 offen sc1 lds
lay_f3_entry2:
QAT m0,s47
QAH lgkmcnt(2)
QAC v[64:67],v[32:35],a[0:7],v10
QAG v[44:47],v1 offset:3072
QAC v[68:71],v[32:35],v[80:87],v10
QAC v[72:75],v[32:35],a[8:15],v10
QAC v[76:79],v[32:35],v[88:95],v10
QAH lgkmcnt(2)
QAG v[88:91],v17 offset:12288
QAQ v80,0
QAC v[64:67],v[36:39],a[16:23],v10
QAG v[92:95],v17 offset:13312
QAQ v81,0
QAC v[68:71],v[36:39],v[96:103],v10
QAD v1,s[16:19],s25 offen sc1 lds
QAG v[96:99],v17 offset:14336
QAQ v82,0
QAC v[72:75],v[36:39],a[24:31],v10
QAG v[100:103],v17 offset:15360
QAQ v83,0
QAC v[76:79],v[36:39],v[104:111],v10
QAH lgkmcnt(5)
QAG v[104:107],v18 offset:0
QAQ v84,0
QAC v[64:67],v[40:43],a[32:39],v10
QAG v[108:111],v18 offset:1024
QAQ v85,0
QAC v[68:71],v[40:43],v[112:119],v10
QAD v1,s[16:19],s25 offen offset:1024 sc1 lds
QAG v[112:115],v18 offset:4096
QAQ v86,0
QAC v[72:75],v[40:43],a[40:47],v10
QAG v[116:119],v18 offset:5120
QAQ v87,0
QAC v[76:79],v[40:43],v[120:127],v10
QAH vmcnt(2)
s_barrier
QAG v[48:51],v1 offset:4096
QAG v[52:55],v1 offset:5120
QAH lgkmcnt(10)
QAC v[64:67],v[44:47],a[48:55],v10
QAG v[56:59],v1 offset:6144
QAH lgkmcnt(9)
QAC v[68:71],v[44:47],v[88:95],v10
QAG v[60:63],v1 offset:7168
QAC v[72:75],v[44:47],a[56:63],v10
QAG v[120:123],v18 offset:8192
QAH lgkmcnt(9)
QAC v[76:79],v[44:47],v[96:103],v10
QAG v[124:127],v18 offset:9216
QAH lgkmcnt(5)
QAC v[64:67],v[48:51],a[64:71],v10
QAG v[88:91],v18 offset:12288
v_max_u32 v30,v48,v49
QAC v[68:71],v[48:51],v[104:111],v10
QAL v[20:23],v1,s[16:19],s40 offen sc1
QAH lgkmcnt(5)
QAG v[92:95],v18 offset:13312
QAV v30,v30,v50,v51
QAC v[64:67],v[52:55],a[80:87],v10
QAG v[96:99],v18 offset:2048
QAV v30,v30,v52,v53
QAC v[68:71],v[52:55],v[112:119],v10
QAH lgkmcnt(6)
QAG v[100:103],v18 offset:3072
QAV v30,v30,v54,v55
QAC v[64:67],v[56:59],a[96:103],v10
QAH lgkmcnt(4)
QAG v[104:107],v18 offset:6144
QAV v30,v30,v56,v57
QAC v[68:71],v[56:59],v[120:127],v10
QAG v[108:111],v18 offset:7168
QAV v30,v30,v58,v59
QAC v[64:67],v[60:63],a[112:119],v10
QAH lgkmcnt(4)
QAG v[112:115],v18 offset:10240
QAV v30,v30,v60,v61
QAC v[68:71],v[60:63],v[88:95],v10
QAG v[116:119],v18 offset:11264
QAV v30,v30,v62,v63
QAC v[72:75],v[48:51],a[72:79],v10
QAH lgkmcnt(4)
QAG v[120:123],v18 offset:14336
QBP vcc,-1,v30
QAC v[76:79],v[48:51],v[96:103],v10
QAG v[124:127],v18 offset:15360
QAU v64,v64,v66
QAC v[72:75],v[52:55],a[88:95],v10
QAH lgkmcnt(4)
QAF s31,s29,s54
QAG v[88:91],v2 offset:30720
QAU v65,v65,v67
QAC v[76:79],v[52:55],v[104:111],v10
QAG v[92:95],v2 offset:30976
QAU v68,v68,v70
QAC v[72:75],v[56:59],a[104:111],v10
QAH lgkmcnt(4)
QAF s42,s29,s52
QAG v[96:99],v16 offset:0
QAU v69,v69,v71
QAC v[76:79],v[56:59],v[112:119],v10
QAG v[100:103],v16 offset:2048
QAW v68,s34,v68
QAC v[72:75],v[60:63],a[120:127],v10
QAH lgkmcnt(4)
QAG v[104:107],v16 offset:4096
QAW v69,s34,v69
QAC v[76:79],v[60:63],v[120:127],v10
QAG v[108:111],v16 offset:6144
QAE v20,v64,v65
QAC v[80:83],v[32:35],a[128:135],v10
QAG v[112:115],v16 offset:256
QAE v21,v68,v69
QAC v[84:87],v[32:35],a[136:143],v10
QCG v3,v[20:21]
QAU v72,v72,v74
QAU v73,v73,v75
QAU v76,v76,v78
QAU v77,v77,v79
QAE v22,v72,v73
QAW v76,s34,v76
QAW v77,s34,v77
QAE v23,v76,v77
QCG v3,v[22:23] offset:512
QAC v[80:83],v[36:39],a[144:151],v10
QAC v[84:87],v[36:39],a[152:159],v10
QAG v[116:119],v16 offset:2304
QAC v[80:83],v[40:43],a[160:167],v10
QAG v[120:123],v16 offset:4352
QAC v[84:87],v[40:43],a[168:175],v10
QAG v[124:127],v16 offset:6400
QAC v[80:83],v[44:47],a[176:183],v10
s_cbranch_vccnz lay_f3_redo
QAH lgkmcnt(3)
s_barrier
QAA v[64:65],v4 offset:0
QAA v[66:67],v4 offset:256
QAF m0,s54,24576
QAF s13,s25,16777216
QAC v[84:87],v[44:47],a[184:191],v10
QAA v[68:69],v4 offset:1024
QAA v[70:71],v4 offset:1280
QAC v[80:83],v[48:51],a[192:199],v10
QAA v[72:73],v4 offset:2048
QAA v[74:75],v4 offset:2304
QAC v[84:87],v[48:51],a[200:207],v10
QAA v[76:77],v4 offset:3072
QAA v[78:79],v4 offset:3328
QAC v[80:83],v[52:55],a[208:215],v10
QAC v[84:87],v[52:55],a[216:223],v10
QAC v[80:83],v[56:59],a[224:231],v10
QAD v1,s[16:19],s13 offen sc1 lds
QAH lgkmcnt(0)
QAJ v[32:35],v[96:99],v[64:67],0
QAQ v20,v76
QAJ v[32:35],v[100:103],v[68:71],v[32:35]
QAQ v21,v77
QAJ v[32:35],v[104:107],v[72:75],v[32:35]
QAQ v22,v78
QAJ v[32:35],v[108:111],v[76:79],v[32:35]
QAD v1,s[16:19],s13 offen offset:1024 sc1 lds
QAQ v23,v79
QAJ v[36:39],v[112:115],v[64:67],0
QAJ v[36:39],v[116:119],v[68:71],v[36:39]
QAJ v[36:39],v[120:123],v[72:75],v[36:39]
QBA v44,v32
QAJ v[36:39],v[124:127],v[76:79],v[36:39]
QBW v9,2,v1
QBR v9,v9,s[16:19],s59 offen sc1
QBA v45,v33
QAC v[84:87],v[56:59],a[232:239],v10
QBA v46,v34
QAC v[80:83],v[60:63],a[240:247],v10
QBA v47,v35
QAC v[84:87],v[60:63],a[248:255],v10
QBA v48,v36
QAJ v[40:43],v[64:67],v[64:67],0
QBA v49,v37
QAJ v[40:43],v[68:71],v[68:71],v[40:43]
QBA v50,v38
QAJ v[40:43],v[72:75],v[72:75],v[40:43]
QBA v51,v39
QAJ v[40:43],v[76:79],v[76:79],v[40:43]
QAE v54,v44,v45
QAE v55,v46,v47
QAE v56,v48,v49
QAE v57,v50,v51
QAU v80,v80,v82
QAU v81,v81,v83
QAJ v[58:61],v[12:15],v[54:57],0
QAE v24,v80,v81
QAU v84,v84,v86
QAJ v[96:99],v[88:91],v[54:57],0
QBA v52,v40
QAJ v[100:103],v[92:95],v[54:57],0
QBA v53,v41
QAU v85,v85,v87
QAE v28,v52,v53
QAE v26,v84,v85
QBQ v31,|v32|,|v33|,|v34|
QBD v[58:61],v[12:13],v[28:29],v[58:61]
QBQ v31,v31,|v35|,|v36|
QBQ v31,v31,|v37|,|v38|
QBD v[96:99],v[24:25],v[28:29],v[96:99]
QBQ v31,v31,|v39|,|v40|
v_max_f32 v31,v31,|v41|
QBD v[100:103],v[26:27],v[28:29],v[100:103]
v_rcp_f32 v30,v60
v_cmp_lt_f32 vcc,s33,v31
s_nop 1
QAW v96,v30,v96
QAW v97,v30,v97
QAW v98,v30,v98
QAW v99,v30,v99
QAE v44,v96,v97
QAE v45,v98,v99
QCG v5,v[44:45]
QBI v[100:101],v[100:101],v[30:31] op_sel_hi:[1,0]
QBI v[102:103],v[102:103],v[30:31] op_sel_hi:[1,0]
QAE v46,v100,v101
QAE v47,v102,v103
QCG v5,v[46:47] offset:8
s_and_b64 vcc,vcc,s[36:37]
s_cbranch_vccnz lay_f3_slow
lay_f3_norm:
QAR v[64:65],0
QAR v[66:67],0
QAR v[68:69],0
QAR v[70:71],0
QAH lgkmcnt(0)
s_barrier
QAG v[32:35],v6 offset:0
QAG v[36:39],v6 offset:512
QAG v[40:43],v6 offset:1024
QAG v[44:47],v6 offset:1536
QAF s13,s27,0
QAR v[72:73],0
QAR v[74:75],0
QAR v[76:77],0
QAR v[78:79],0
QAH lgkmcnt(2)
QAC v[64:67],v[32:35],v[128:135],v11
QAC v[64:67],v[36:39],v[136:143],v11
QAH lgkmcnt(0)
QAC v[64:67],v[40:43],v[144:151],v11
QAC v[64:67],v[44:47],v[152:159],v11
QAG v[88:91],v17 offset:2048
QAC v[68:71],v[32:35],v[160:167],v11
QAG v[92:95],v17 offset:3072
QAC v[68:71],v[36:39],v[168:175],v11
QAE v48,v64,v65
QAE v49,v66,v67
v_bfi_b32 v48,1,s32,v48
QBT v[48:49],v7,s[16:19],s13 offen
QAC v[68:71],v[40:43],v[176:183],v11
QAG v[96:99],v17 offset:4096
QAC v[68:71],v[44:47],v[184:191],v11
QAG v[100:103],v17 offset:5120
QAC v[72:75],v[32:35],v[192:199],v11
QAF s13,s27,65536
QAG v[104:107],v17 offset:6144
QAC v[72:75],v[36:39],v[200:207],v11
QAE v50,v68,v69
QAE v51,v70,v71
v_bfi_b32 v50,1,s32,v50
QBT v[50:51],v7,s[16:19],s13 offen
QAC v[72:75],v[40:43],v[208:215],v11
QAG v[108:111],v17 offset:7168
QAC v[72:75],v[44:47],v[216:223],v11
QAG v[112:115],v17 offset:8192
QAC v[76:79],v[32:35],v[224:231],v11
QAG v[116:119],v17 offset:9216
QAC v[76:79],v[36:39],v[232:239],v11
QAF s13,s27,131072
QAG v[120:123],v17 offset:10240
QAE v52,v72,v73
QAC v[76:79],v[40:43],v[240:247],v11
QAG v[124:127],v17 offset:11264
QAE v53,v74,v75
QAC v[76:79],v[44:47],v[248:255],v11
v_bfi_b32 v52,1,s32,v52
QBT v[52:53],v7,s[16:19],s13 offen
QAF s13,s27,196608
QAT s40,s26
QAF s26,s26,4096
QAT s14,0
QAT s15,0
s_nop 0
QAE v54,v76,v77
QAE v55,v78,v79
v_bfi_b32 v54,1,s32,v54
QBT v[54:55],v7,s[16:19],s13 offen
QAR v[64:65],0
QAR v[66:67],0
QAR v[68:69],0
QAR v[70:71],0
QAR v[72:73],0
QAR v[74:75],0
QAR v[76:77],0
QAR v[78:79],0
s_nop 15
s_nop 15
s_nop 15
s_nop 5
QAD v[56:59],v1,s[16:19],s28 offen sc1
QAD v[60:63],v1,s[16:19],s28 offen offset:1024 sc1
s_nop 15
s_nop 12
QAD v[80:83],v1,s[16:19],s28 offen sc1
QAD v[84:87],v1,s[16:19],s28 offen offset:1024 sc1
QAH vmcnt(3)
QAJ v[48:51],v[12:15],v[56:59],0
QBG v30,v56,v58,s32 bitop3:0x7e
QAH vmcnt(2)
QAJ v[48:51],v[12:15],v[60:63],v[48:51]
QBG v31,v60,v62,s32 bitop3:0x7e
QBG v30,v30,v31,1 bitop3:0xa8
v_cmp_ne_u32 vcc,0,v30
s_cbranch_vccnz lay_f3_rr
lay_f3_rok:
s_nop 0
QCE v52,v48,v48 row_ror:4 row_mask:0xf bank_mask:0xf
QCE v53,v49,v49 row_ror:4 row_mask:0xf bank_mask:0xf
s_nop 0
QCE v54,v52,v52 row_ror:8 row_mask:0xf bank_mask:0xf
QCE v55,v53,v53 row_ror:8 row_mask:0xf bank_mask:0xf
QAE v30,v54,v55
QCD v30,v8,s[16:19],s29 offen
QAQ v31,-1
QCD v31,v8,s[16:19],s30 offen
QAT s41,s24
QAF s24,s24,1
QBY vcc,s[36:37]
QCF v30,v24 quad_perm:[0,1,0,1] row_mask:0xf bank_mask:0xf
QCF v31,v26 quad_perm:[0,1,0,1] row_mask:0xf bank_mask:0xf
QAX v20,v20,v24,vcc
QAX v21,v21,v26,vcc
QAX v22,v22,v30,vcc
QAX v23,v23,v31,vcc
QBO s13,s24,1
QAS s13,s13,18
QAF s27,s13,s57
QAF s28,s27,s43
QAF s13,s24,1
QBO s13,s13,3
QAS s13,s13,13
QAF s29,s13,s58
QBO s13,s24,3
QAS s13,s13,13
QAF s30,s13,s58
QCB s13,s24,1
QBO s13,s13,1
s_xor_b32 s32,s13,1
QAF s25,s25,8192
s_xor_b32 s47,s47,0x6000
QBH v16,0x6000,v16
QAF m0,s39,4096
QAF s13,s24,1
s_min_u32 s13,s13,63
QCB s38,s13,2
QAF s38,s38,2
QCB s13,s13,1
s_min_u32 s13,s13,s38
QAS s13,2,s13
s_sub_u32 s13,s13,1
lay_f3_kc:
v_cmp_le_u32 vcc,4,v9
s_nop 1
QBO s38,vcc_lo,s13
QBJ s38,s13
s_cbranch_scc1 lay_f3_kw
lay_f3_kok:
QAH vmcnt(2)
QAG v[80:83],v17 offset:0
QAG v[84:87],v17 offset:1024
lay_f3_cutend:
QBN s24,63
s_cbranch_scc1 lay_f3_top
s_barrier
QAG v[32:35],v1 offset:0
QAG v[36:39],v1 offset:1024
QAG v[40:43],v1 offset:2048
QAD v0,s[16:19],s42 offen sc1 lds
lay_f3_entry2_l:
QAT m0,s47
QAH lgkmcnt(2)
QAC v[64:67],v[32:35],a[0:7],v10
QAG v[44:47],v1 offset:3072
QAC v[68:71],v[32:35],v[80:87],v10
QAC v[72:75],v[32:35],a[8:15],v10
QAC v[76:79],v[32:35],v[88:95],v10
QAH lgkmcnt(2)
QAG v[88:91],v17 offset:12288
QAQ v80,0
QAC v[64:67],v[36:39],a[16:23],v10
QAG v[92:95],v17 offset:13312
QAQ v81,0
QAC v[68:71],v[36:39],v[96:103],v10
QAL v[20:23],v1,s[16:19],s40 offen sc1
QAG v[96:99],v17 offset:14336
QAQ v82,0
QAC v[72:75],v[36:39],a[24:31],v10
QAG v[100:103],v17 offset:15360
QAQ v83,0
QAC v[76:79],v[36:39],v[104:111],v10
QAH lgkmcnt(5)
QAG v[104:107],v18 offset:0
QAQ v84,0
QAC v[64:67],v[40:43],a[32:39],v10
QAG v[108:111],v18 offset:1024
QAQ v85,0
QAC v[68:71],v[40:43],v[112:119],v10
QAG v[112:115],v18 offset:4096
QAQ v86,0
QAC v[72:75],v[40:43],a[40:47],v10
QAG v[116:119],v18 offset:5120
QAQ v87,0
QAC v[76:79],v[40:43],v[120:127],v10
QAH vmcnt(1)
s_barrier
QAG v[48:51],v1 offset:4096
QAG v[52:55],v1 offset:5120
QAH lgkmcnt(10)
QAC v[64:67],v[44:47],a[48:55],v10
QAG v[56:59],v1 offset:6144
QAH lgkmcnt(9)
QAC v[68:71],v[44:47],v[88:95],v10
QAG v[60:63],v1 offset:7168
QAC v[72:75],v[44:47],a[56:63],v10
QAG v[120:123],v18 offset:8192
QAH lgkmcnt(9)
QAC v[76:79],v[44:47],v[96:103],v10
QAG v[124:127],v18 offset:9216
QAH lgkmcnt(5)
QAC v[64:67],v[48:51],a[64:71],v10
QAG v[88:91],v18 offset:12288
v_max_u32 v30,v48,v49
QAC v[68:71],v[48:51],v[104:111],v10
QAH lgkmcnt(5)
QAG v[92:95],v18 offset:13312
QAV v30,v30,v50,v51
QAC v[64:67],v[52:55],a[80:87],v10
QAG v[96:99],v18 offset:2048
QAV v30,v30,v52,v53
QAC v[68:71],v[52:55],v[112:119],v10
QAH lgkmcnt(6)
QAG v[100:103],v18 offset:3072
QAV v30,v30,v54,v55
QAC v[64:67],v[56:59],a[96:103],v10
QAH lgkmcnt(4)
QAG v[104:107],v18 offset:6144
QAV v30,v30,v56,v57
QAC v[68:71],v[56:59],v[120:127],v10
QAG v[108:111],v18 offset:7168
QAV v30,v30,v58,v59
QAC v[64:67],v[60:63],a[112:119],v10
QAH lgkmcnt(4)
QAG v[112:115],v18 offset:10240
QAV v30,v30,v60,v61
QAC v[68:71],v[60:63],v[88:95],v10
QAG v[116:119],v18 offset:11264
QAV v30,v30,v62,v63
QAC v[72:75],v[48:51],a[72:79],v10
QAH lgkmcnt(4)
QAG v[120:123],v18 offset:14336
QBP vcc,-1,v30
QAC v[76:79],v[48:51],v[96:103],v10
QAG v[124:127],v18 offset:15360
QAU v64,v64,v66
QAC v[72:75],v[52:55],a[88:95],v10
QAH lgkmcnt(4)
QAF s31,s29,s54
QAU v65,v65,v67
QAC v[76:79],v[52:55],v[104:111],v10
QAU v68,v68,v70
QAC v[72:75],v[56:59],a[104:111],v10
QAH lgkmcnt(2)
QAF s42,s29,s52
QAU v69,v69,v71
QAC v[76:79],v[56:59],v[112:119],v10
QAW v68,s34,v68
QAC v[72:75],v[60:63],a[120:127],v10
QAH lgkmcnt(0)
QAW v69,s34,v69
QAC v[76:79],v[60:63],v[120:127],v10
QAE v20,v64,v65
QAC v[80:83],v[32:35],a[128:135],v10
QAE v21,v68,v69
QAC v[84:87],v[32:35],a[136:143],v10
QAU v72,v72,v74
QAU v73,v73,v75
QAU v76,v76,v78
QAU v77,v77,v79
QAE v22,v72,v73
QAW v76,s34,v76
QAW v77,s34,v77
QAE v23,v76,v77
s_cbranch_vccnz lay_f3_redo_l
ds_write2_b64 v3,v[20:21],v[22:23] offset1:64
QAC v[80:83],v[36:39],a[144:151],v10
QAC v[84:87],v[36:39],a[152:159],v10
QAC v[80:83],v[40:43],a[160:167],v10
QAC v[84:87],v[40:43],a[168:175],v10
QAC v[80:83],v[44:47],a[176:183],v10
QAC v[84:87],v[44:47],a[184:191],v10
QAC v[80:83],v[48:51],a[192:199],v10
QAH lgkmcnt(0)
s_barrier
QAA v[20:21],v4 offset:3072
QAA v[22:23],v4 offset:3328
QAC v[84:87],v[48:51],a[200:207],v10
QAC v[80:83],v[52:55],a[208:215],v10
QAC v[84:87],v[52:55],a[216:223],v10
QAC v[80:83],v[56:59],a[224:231],v10
QAC v[84:87],v[56:59],a[232:239],v10
QAC v[80:83],v[60:63],a[240:247],v10
QAC v[84:87],v[60:63],a[248:255],v10
s_nop 3
QAU v80,v80,v82
QAU v81,v81,v83
QAE v24,v80,v81
s_nop 0
QAU v84,v84,v86
QAU v85,v85,v87
QAE v26,v84,v85
QAH lgkmcnt(0)
QBY vcc,s[36:37]
QCF v30,v24 quad_perm:[0,1,0,1] row_mask:0xf bank_mask:0xf
QCF v31,v26 quad_perm:[0,1,0,1] row_mask:0xf bank_mask:0xf
QAX v20,v20,v24,vcc
QAX v21,v21,v26,vcc
QAX v22,v22,v30,vcc
QAX v23,v23,v31,vcc
QAL v[20:23],v1,s[16:19],s26 offen sc1
QAH vmcnt(0)
s_barrier
QAQ v31,64
s_branch lay_fin
lay_f3_entry:
QAG v[32:35],v1 offset:0
QAG v[36:39],v1 offset:1024
QAG v[40:43],v1 offset:2048
s_branch lay_f3_entry2
lay_f3_entry_l:
QAG v[32:35],v1 offset:0
QAG v[36:39],v1 offset:1024
QAG v[40:43],v1 offset:2048
s_branch lay_f3_entry2_l
lay_f3_rr:
QAD v[56:59],v1,s[16:19],s28 offen sc1
QAD v[60:63],v1,s[16:19],s28 offen offset:1024 sc1
QAH vmcnt(3)
QAJ v[48:51],v[12:15],v[80:83],0
QBG v30,v80,v82,s32 bitop3:0x7e
QAH vmcnt(2)
QAJ v[48:51],v[12:15],v[84:87],v[48:51]
QBG v31,v84,v86,s32 bitop3:0x7e
QBG v30,v30,v31,1 bitop3:0xa8
v_cmp_ne_u32 vcc,0,v30
s_cbranch_vccz lay_f3_rok
lay_f3_rr_lp:
QAD v[80:83],v1,s[16:19],s28 offen sc1
QAD v[84:87],v1,s[16:19],s28 offen offset:1024 sc1
QAH vmcnt(3)
QAJ v[48:51],v[12:15],v[56:59],0
QBG v30,v56,v58,s32 bitop3:0x7e
QAH vmcnt(2)
QAJ v[48:51],v[12:15],v[60:63],v[48:51]
QBG v31,v60,v62,s32 bitop3:0x7e
QBG v30,v30,v31,1 bitop3:0xa8
v_cmp_ne_u32 vcc,0,v30
s_cbranch_vccz lay_f3_rok
QAD v[56:59],v1,s[16:19],s28 offen sc1
QAD v[60:63],v1,s[16:19],s28 offen offset:1024 sc1
QAH vmcnt(3)
QAJ v[48:51],v[12:15],v[80:83],0
QBG v30,v80,v82,s32 bitop3:0x7e
QAH vmcnt(2)
QAJ v[48:51],v[12:15],v[84:87],v[48:51]
QBG v31,v84,v86,s32 bitop3:0x7e
QBG v30,v30,v31,1 bitop3:0xa8
v_cmp_ne_u32 vcc,0,v30
s_cbranch_vccz lay_f3_rok
QAF s14,s14,s3
QBK s14,200000
s_cbranch_scc1 lay_f3_rr_to
s_branch lay_f3_rr_lp
lay_f3_rr_to:
QAT s3,200000
s_branch lay_f3_rok
lay_f3_redo:
QAF s15,s15,s3
QBK s15,200000
s_cbranch_scc1 lay_end
QAH vmcnt(0) lgkmcnt(0)
s_barrier
QAF s40,s53,56688640
QAF s42,s30,s39
QAF s31,s30,s39
QAF s42,s42,4096
QAF m0,s39,0
s_nop 0
QAD v0,s[16:19],s31 offen sc1 lds
QAF m0,s39,4096
QAR v[64:65],0
QAR v[66:67],0
QAR v[68:69],0
QAR v[70:71],0
QAR v[72:73],0
QAR v[74:75],0
QAR v[76:77],0
QAR v[78:79],0
QAD v0,s[16:19],s42 offen sc1 lds
QAG v[80:83],v17 offset:0
QAG v[84:87],v17 offset:1024
QAG v[88:91],v17 offset:2048
QAG v[92:95],v17 offset:3072
QAG v[96:99],v17 offset:4096
QAG v[100:103],v17 offset:5120
QAG v[104:107],v17 offset:6144
QAG v[108:111],v17 offset:7168
QAG v[112:115],v17 offset:8192
QAG v[116:119],v17 offset:9216
QAG v[120:123],v17 offset:10240
QAG v[124:127],v17 offset:11264
QAH vmcnt(0) lgkmcnt(0)
s_barrier
s_branch lay_f3_entry
lay_f3_redo_l:
QAF s15,s15,s3
QBK s15,200000
s_cbranch_scc1 lay_end
QAH vmcnt(0) lgkmcnt(0)
s_barrier
QAF s40,s53,56688640
QAF s42,s30,s39
QAF s31,s30,s39
QAF s42,s42,4096
QAF m0,s39,0
s_nop 0
QAD v0,s[16:19],s31 offen sc1 lds
QAF m0,s39,4096
QAR v[64:65],0
QAR v[66:67],0
QAR v[68:69],0
QAR v[70:71],0
QAR v[72:73],0
QAR v[74:75],0
QAR v[76:77],0
QAR v[78:79],0
QAD v0,s[16:19],s42 offen sc1 lds
QAG v[80:83],v17 offset:0
QAG v[84:87],v17 offset:1024
QAG v[88:91],v17 offset:2048
QAG v[92:95],v17 offset:3072
QAG v[96:99],v17 offset:4096
QAG v[100:103],v17 offset:5120
QAG v[104:107],v17 offset:6144
QAG v[108:111],v17 offset:7168
QAG v[112:115],v17 offset:8192
QAG v[116:119],v17 offset:9216
QAG v[120:123],v17 offset:10240
QAG v[124:127],v17 offset:11264
QAH vmcnt(0) lgkmcnt(0)
s_barrier
s_branch lay_f3_entry_l
lay_f3_kw:
QAF s15,s15,s3
QBK s15,200000
s_cbranch_scc1 lay_f3_kto
s_sleep 2
QBW v9,2,v1
QBR v9,v9,s[16:19],s59 offen sc1
QAH vmcnt(0)
s_branch lay_f3_kc
lay_f3_kto:
QAT s3,200000
s_branch lay_f3_kok
lay_f3_slow:
QAH lgkmcnt(0)
s_nop 7
QBQ v30,v32,v33,v34
QBQ v31,v35,v36,v37
QBQ v30,v30,v38,v39
QBQ v31,v31,v40,v41
v_max_f32 v30,v30,v31
QAQ v31,v30
s_nop 1
QCH v30,v31
v_max_f32 v30,v30,v31
QAQ v31,v30
s_nop 1
v_permlane16_swap_b32 v30,v31
v_max_f32 v30,v30,v31
QBV v44,v32,v30
QBV v45,v33,v30
QBV v46,v34,v30
QBV v47,v35,v30
QBV v48,v36,v30
QBV v49,v37,v30
QBV v50,v38,v30
QBV v51,v39,v30
QBV v52,v40,v30
QBV v53,v41,v30
QBA v44,v44
QBA v45,v45
QBA v46,v46
QBA v47,v47
QBA v48,v48
QBA v49,v49
QBA v50,v50
QBA v51,v51
QBA v52,v52
QBA v53,v53
QAE v54,v44,v45
QAE v55,v46,v47
QAE v56,v48,v49
QAE v57,v50,v51
QAE v28,v52,v53
s_nop 0
QAJ v[96:99],v[88:91],v[54:57],0
QAJ v[100:103],v[92:95],v[54:57],0
QAJ v[58:61],v[12:15],v[54:57],0
QBD v[58:61],v[12:13],v[28:29],v[58:61]
QBD v[96:99],v[24:25],v[28:29],v[96:99]
QBD v[100:103],v[26:27],v[28:29],v[100:103]
s_nop 7
v_rcp_f32 v30,v60
s_nop 0
QAW v96,v30,v96
QAW v97,v30,v97
QAW v98,v30,v98
QAW v99,v30,v99
QAW v100,v30,v100
QAW v101,v30,v101
QAW v102,v30,v102
QAW v103,v30,v103
QAE v44,v96,v97
QAE v45,v98,v99
QAE v46,v100,v101
QAE v47,v102,v103
QAY v5,v[44:47]
QAH lgkmcnt(0)
s_branch lay_f3_norm
.p2align 6
lay_s0_top:
QAH vmcnt(3)
QAV v30,v48,v49,v50
QAH vmcnt(2)
QAV v30,v30,v51,v52
QAV v30,v30,v53,v54
v_max_u32 v30,v30,v55
QBP vcc,-1,v30
s_cbranch_vccnz lay_s0_gr
QAY v19,v[48:51]
QAY v19,v[52:55] offset:1024
lay_s0_gok:
QAH lgkmcnt(0)
s_barrier
QAG v[32:35],v1 offset:0
QAG v[36:39],v1 offset:1024
QAG v[40:43],v1 offset:2048
QAD v0,s[16:19],s42 offen sc1 lds
lay_s0_entry2:
QAT m0,s47
QAH lgkmcnt(2)
QAC v[64:67],v[32:35],a[0:7],v10
QAG v[44:47],v1 offset:3072
QAC v[68:71],v[32:35],v[80:87],v10
QAC v[72:75],v[32:35],a[8:15],v10
QAD v1,s[16:19],s25 offen sc1 lds
QAC v[76:79],v[32:35],v[88:95],v10
QAH lgkmcnt(2)
QAG v[88:91],v17 offset:12288
QAQ v80,0
QAC v[64:67],v[36:39],a[16:23],v10
QAG v[92:95],v17 offset:13312
QAQ v81,0
QAC v[68:71],v[36:39],v[96:103],v10
QAG v[96:99],v17 offset:14336
QAQ v82,0
QAC v[72:75],v[36:39],a[24:31],v10
QAD v1,s[16:19],s25 offen offset:1024 sc1 lds
QAG v[100:103],v17 offset:15360
QAQ v83,0
QAC v[76:79],v[36:39],v[104:111],v10
QAH lgkmcnt(5)
QAG v[104:107],v18 offset:0
QAQ v84,0
QAC v[64:67],v[40:43],a[32:39],v10
QAG v[108:111],v18 offset:1024
QAQ v85,0
QAC v[68:71],v[40:43],v[112:119],v10
QAG v[112:115],v18 offset:4096
QAQ v86,0
QAC v[72:75],v[40:43],a[40:47],v10
QAG v[116:119],v18 offset:5120
QAQ v87,0
QAC v[76:79],v[40:43],v[120:127],v10
QAH vmcnt(2)
s_barrier
QAG v[48:51],v1 offset:4096
QAG v[52:55],v1 offset:5120
QAH lgkmcnt(10)
QAC v[64:67],v[44:47],a[48:55],v10
QAG v[56:59],v1 offset:6144
QAH lgkmcnt(9)
QAC v[68:71],v[44:47],v[88:95],v10
QAG v[60:63],v1 offset:7168
QAC v[72:75],v[44:47],a[56:63],v10
QAL v[20:23],v1,s[16:19],s40 offen sc1
QAG v[120:123],v18 offset:8192
QAH lgkmcnt(9)
QAC v[76:79],v[44:47],v[96:103],v10
QAG v[124:127],v18 offset:9216
QAH lgkmcnt(5)
QAC v[64:67],v[48:51],a[64:71],v10
QAG v[88:91],v18 offset:12288
v_max_u32 v30,v48,v49
QAC v[68:71],v[48:51],v[104:111],v10
QAH lgkmcnt(5)
QAG v[92:95],v18 offset:13312
QAV v30,v30,v50,v51
QAC v[64:67],v[52:55],a[80:87],v10
QAG v[96:99],v18 offset:2048
QAV v30,v30,v52,v53
QAC v[68:71],v[52:55],v[112:119],v10
QAH lgkmcnt(6)
QAG v[100:103],v18 offset:3072
QAV v30,v30,v54,v55
QAC v[64:67],v[56:59],a[96:103],v10
QAH lgkmcnt(4)
QAG v[104:107],v18 offset:6144
QAV v30,v30,v56,v57
QAC v[68:71],v[56:59],v[120:127],v10
QAG v[108:111],v18 offset:7168
QAV v30,v30,v58,v59
QAC v[64:67],v[60:63],a[112:119],v10
QAH lgkmcnt(4)
QAG v[112:115],v18 offset:10240
QAV v30,v30,v60,v61
QAC v[68:71],v[60:63],v[88:95],v10
QAG v[116:119],v18 offset:11264
QAV v30,v30,v62,v63
QAC v[72:75],v[48:51],a[72:79],v10
QAH lgkmcnt(4)
QAG v[120:123],v18 offset:14336
QBP vcc,-1,v30
QAC v[76:79],v[48:51],v[96:103],v10
QAG v[124:127],v18 offset:15360
QAU v64,v64,v66
QAC v[72:75],v[52:55],a[88:95],v10
QAH lgkmcnt(4)
QAF s31,s29,s54
QAG v[88:91],v2 offset:24576
QAU v65,v65,v67
QAC v[76:79],v[52:55],v[104:111],v10
QAG v[92:95],v2 offset:24832
QAU v68,v68,v70
QAC v[72:75],v[56:59],a[104:111],v10
QAH lgkmcnt(4)
QAF s42,s29,s52
QAG v[96:99],v16 offset:0
QAU v69,v69,v71
QAC v[76:79],v[56:59],v[112:119],v10
QAG v[100:103],v16 offset:2048
QAW v68,s34,v68
QAC v[72:75],v[60:63],a[120:127],v10
QAH lgkmcnt(4)
QAG v[104:107],v16 offset:4096
QAW v69,s34,v69
QAC v[76:79],v[60:63],v[120:127],v10
QAG v[108:111],v16 offset:6144
QAE v20,v64,v65
QAC v[80:83],v[32:35],a[128:135],v10
QAG v[112:115],v16 offset:256
QAE v21,v68,v69
QAC v[84:87],v[32:35],a[136:143],v10
QCG v3,v[20:21]
QAU v72,v72,v74
QAU v73,v73,v75
QAU v76,v76,v78
QAU v77,v77,v79
QAE v22,v72,v73
QAW v76,s34,v76
QAW v77,s34,v77
QAE v23,v76,v77
QCG v3,v[22:23] offset:512
QAC v[80:83],v[36:39],a[144:151],v10
QAC v[84:87],v[36:39],a[152:159],v10
QAG v[116:119],v16 offset:2304
QAC v[80:83],v[40:43],a[160:167],v10
QAG v[120:123],v16 offset:4352
QAC v[84:87],v[40:43],a[168:175],v10
QAG v[124:127],v16 offset:6400
QAC v[80:83],v[44:47],a[176:183],v10
s_cbranch_vccnz lay_s0_redo
QAH lgkmcnt(3)
s_barrier
QAA v[64:65],v4 offset:0
QAA v[66:67],v4 offset:256
QAF m0,s54,24576
QAF s13,s25,16777216
QAC v[84:87],v[44:47],a[184:191],v10
QAA v[68:69],v4 offset:1024
QAA v[70:71],v4 offset:1280
QAC v[80:83],v[48:51],a[192:199],v10
QAA v[72:73],v4 offset:2048
QAA v[74:75],v4 offset:2304
QAC v[84:87],v[48:51],a[200:207],v10
QAD v1,s[16:19],s13 offen sc1 lds
QAA v[76:77],v4 offset:3072
QAA v[78:79],v4 offset:3328
QAC v[80:83],v[52:55],a[208:215],v10
QAC v[84:87],v[52:55],a[216:223],v10
QAC v[80:83],v[56:59],a[224:231],v10
QAH lgkmcnt(0)
QAJ v[32:35],v[96:99],v[64:67],0
QAD v1,s[16:19],s13 offen offset:1024 sc1 lds
QAQ v20,v64
QAJ v[32:35],v[100:103],v[68:71],v[32:35]
QAQ v21,v65
QAJ v[32:35],v[104:107],v[72:75],v[32:35]
QAQ v22,v66
QAJ v[32:35],v[108:111],v[76:79],v[32:35]
QAQ v23,v67
QAJ v[36:39],v[112:115],v[64:67],0
QAJ v[36:39],v[116:119],v[68:71],v[36:39]
QAJ v[36:39],v[120:123],v[72:75],v[36:39]
QBA v44,v32
QAJ v[36:39],v[124:127],v[76:79],v[36:39]
QBA v45,v33
QAC v[84:87],v[56:59],a[232:239],v10
QBA v46,v34
QAC v[80:83],v[60:63],a[240:247],v10
QBA v47,v35
QAC v[84:87],v[60:63],a[248:255],v10
QBA v48,v36
QAJ v[40:43],v[64:67],v[64:67],0
QBA v49,v37
QAJ v[40:43],v[68:71],v[68:71],v[40:43]
QBA v50,v38
QAJ v[40:43],v[72:75],v[72:75],v[40:43]
QBA v51,v39
QAJ v[40:43],v[76:79],v[76:79],v[40:43]
QAE v54,v44,v45
QAE v55,v46,v47
QAE v56,v48,v49
QAE v57,v50,v51
QAU v80,v80,v82
QAU v81,v81,v83
QAJ v[58:61],v[12:15],v[54:57],0
QAE v24,v80,v81
QAU v84,v84,v86
QAJ v[96:99],v[88:91],v[54:57],0
QBA v52,v40
QAJ v[100:103],v[92:95],v[54:57],0
QBA v53,v41
QAU v85,v85,v87
QAE v28,v52,v53
QAE v26,v84,v85
QBQ v31,|v32|,|v33|,|v34|
QBD v[58:61],v[12:13],v[28:29],v[58:61]
QBQ v31,v31,|v35|,|v36|
QBQ v31,v31,|v37|,|v38|
QBD v[96:99],v[24:25],v[28:29],v[96:99]
QBQ v31,v31,|v39|,|v40|
v_max_f32 v31,v31,|v41|
QBD v[100:103],v[26:27],v[28:29],v[100:103]
v_rcp_f32 v30,v60
v_cmp_lt_f32 vcc,s33,v31
s_nop 1
QAW v96,v30,v96
QAW v97,v30,v97
QAW v98,v30,v98
QAW v99,v30,v99
QAE v44,v96,v97
QAE v45,v98,v99
QCG v5,v[44:45]
QBI v[100:101],v[100:101],v[30:31] op_sel_hi:[1,0]
QBI v[102:103],v[102:103],v[30:31] op_sel_hi:[1,0]
QAE v46,v100,v101
QAE v47,v102,v103
QCG v5,v[46:47] offset:8
s_and_b64 vcc,vcc,s[36:37]
s_cbranch_vccnz lay_s0_slow
lay_s0_norm:
QAR v[64:65],0
QAR v[66:67],0
QAR v[68:69],0
QAR v[70:71],0
QAH lgkmcnt(0)
s_barrier
QAG v[32:35],v6 offset:0
QAG v[36:39],v6 offset:512
QAG v[40:43],v6 offset:1024
QAG v[44:47],v6 offset:1536
QAF s13,s27,0
QAR v[72:73],0
QAR v[74:75],0
QAR v[76:77],0
QAR v[78:79],0
QAH lgkmcnt(2)
QAC v[64:67],v[32:35],v[128:135],v11
QAC v[64:67],v[36:39],v[136:143],v11
QAH lgkmcnt(0)
QAC v[64:67],v[40:43],v[144:151],v11
QAC v[64:67],v[44:47],v[152:159],v11
QAG v[88:91],v17 offset:2048
QAC v[68:71],v[32:35],v[160:167],v11
QAG v[92:95],v17 offset:3072
QAC v[68:71],v[36:39],v[168:175],v11
QAE v48,v64,v65
QAE v49,v66,v67
v_bfi_b32 v48,1,s32,v48
QBT v[48:49],v7,s[16:19],s13 offen sc1
QAC v[68:71],v[40:43],v[176:183],v11
QAG v[96:99],v17 offset:4096
QAC v[68:71],v[44:47],v[184:191],v11
QAG v[100:103],v17 offset:5120
QAC v[72:75],v[32:35],v[192:199],v11
QAF s13,s27,65536
QAG v[104:107],v17 offset:6144
QAC v[72:75],v[36:39],v[200:207],v11
QAE v50,v68,v69
QAE v51,v70,v71
v_bfi_b32 v50,1,s32,v50
QBT v[50:51],v7,s[16:19],s13 offen sc1
QAC v[72:75],v[40:43],v[208:215],v11
QAG v[108:111],v17 offset:7168
QAC v[72:75],v[44:47],v[216:223],v11
QAG v[112:115],v17 offset:8192
QAC v[76:79],v[32:35],v[224:231],v11
QAG v[116:119],v17 offset:9216
QAC v[76:79],v[36:39],v[232:239],v11
QAF s13,s27,131072
QAG v[120:123],v17 offset:10240
QAE v52,v72,v73
QAC v[76:79],v[40:43],v[240:247],v11
QAG v[124:127],v17 offset:11264
QAE v53,v74,v75
QAC v[76:79],v[44:47],v[248:255],v11
v_bfi_b32 v52,1,s32,v52
QBT v[52:53],v7,s[16:19],s13 offen sc1
QAF s13,s27,196608
QAT s40,s26
QAF s26,s26,4096
QAT s14,0
QAT s15,0
s_nop 0
QAE v54,v76,v77
QAE v55,v78,v79
v_bfi_b32 v54,1,s32,v54
QAD v[56:59],v1,s[16:19],s28 offen sc1
QAD v[60:63],v1,s[16:19],s28 offen offset:1024 sc1
QBT v[54:55],v7,s[16:19],s13 offen sc1
QAR v[64:65],0
QAR v[66:67],0
QAR v[68:69],0
QAR v[70:71],0
QAR v[72:73],0
QAR v[74:75],0
QAR v[76:77],0
QAR v[78:79],0
s_nop 15
s_nop 0
QAD v[80:83],v1,s[16:19],s28 offen sc1
QAD v[84:87],v1,s[16:19],s28 offen offset:1024 sc1
QAH vmcnt(4)
QAJ v[48:51],v[12:15],v[56:59],0
QBG v30,v56,v58,s32 bitop3:0x7e
QAH vmcnt(3)
QAJ v[48:51],v[12:15],v[60:63],v[48:51]
QBG v31,v60,v62,s32 bitop3:0x7e
QBG v30,v30,v31,1 bitop3:0xa8
v_cmp_ne_u32 vcc,0,v30
s_cbranch_vccnz lay_s0_rr
lay_s0_rok:
s_nop 0
QCE v52,v48,v48 row_ror:4 row_mask:0xf bank_mask:0xf
QCE v53,v49,v49 row_ror:4 row_mask:0xf bank_mask:0xf
s_nop 0
QCE v54,v52,v52 row_ror:8 row_mask:0xf bank_mask:0xf
QCE v55,v53,v53 row_ror:8 row_mask:0xf bank_mask:0xf
QAE v30,v54,v55
QCD v30,v8,s[16:19],s29 offen sc1
QAQ v31,-1
QCD v31,v8,s[16:19],s30 offen sc1
QAD v[48:51],v0,s[16:19],s31 offen sc1
QAD v[52:55],v0,s[16:19],s31 offen offset:1024 sc1
QAH vmcnt(4)
QAG v[80:83],v17 offset:0
QAG v[84:87],v17 offset:1024
QAT s41,s24
QAF s24,s24,1
QBY vcc,s[36:37]
QCF v30,v24 quad_perm:[0,1,0,1] row_mask:0xf bank_mask:0xf
QCF v31,v26 quad_perm:[0,1,0,1] row_mask:0xf bank_mask:0xf
QAX v20,v20,v24,vcc
QAX v21,v21,v26,vcc
QAX v22,v22,v30,vcc
QAX v23,v23,v31,vcc
QBO s13,s24,1
QAS s13,s13,18
QAF s27,s13,s57
QAF s28,s27,s43
QAF s13,s24,1
QBO s13,s13,3
QAS s13,s13,13
QAF s29,s13,s58
QBO s13,s24,3
QAS s13,s13,13
QAF s30,s13,s58
QCB s13,s24,1
QBO s13,s13,1
s_xor_b32 s32,s13,1
QAF s25,s25,8192
s_xor_b32 s47,s47,0x6000
QBH v16,0x6000,v16
QAD v[56:59],v0,s[16:19],s31 offen sc1
QAD v[60:63],v0,s[16:19],s31 offen offset:1024 sc1
QAF m0,s39,4096
lay_s0_cutend:
QBN s24,63
s_cbranch_scc1 lay_s0_top
QAH vmcnt(3)
QAV v30,v48,v49,v50
QAH vmcnt(2)
QAV v30,v30,v51,v52
QAV v30,v30,v53,v54
v_max_u32 v30,v30,v55
QBP vcc,-1,v30
s_cbranch_vccnz lay_s0_gr_l
QAY v19,v[48:51]
QAY v19,v[52:55] offset:1024
lay_s0_gok_l:
QAH lgkmcnt(0)
s_barrier
QAG v[32:35],v1 offset:0
QAG v[36:39],v1 offset:1024
QAG v[40:43],v1 offset:2048
QAD v0,s[16:19],s42 offen sc1 lds
lay_s0_entry2_l:
QAT m0,s47
QAH lgkmcnt(2)
QAC v[64:67],v[32:35],a[0:7],v10
QAG v[44:47],v1 offset:3072
QAC v[68:71],v[32:35],v[80:87],v10
QAC v[72:75],v[32:35],a[8:15],v10
QAL v[20:23],v1,s[16:19],s40 offen sc1
QAC v[76:79],v[32:35],v[88:95],v10
QAH lgkmcnt(2)
QAG v[88:91],v17 offset:12288
QAQ v80,0
QAC v[64:67],v[36:39],a[16:23],v10
QAG v[92:95],v17 offset:13312
QAQ v81,0
QAC v[68:71],v[36:39],v[96:103],v10
QAG v[96:99],v17 offset:14336
QAQ v82,0
QAC v[72:75],v[36:39],a[24:31],v10
QAG v[100:103],v17 offset:15360
QAQ v83,0
QAC v[76:79],v[36:39],v[104:111],v10
QAH lgkmcnt(5)
QAG v[104:107],v18 offset:0
QAQ v84,0
QAC v[64:67],v[40:43],a[32:39],v10
QAG v[108:111],v18 offset:1024
QAQ v85,0
QAC v[68:71],v[40:43],v[112:119],v10
QAG v[112:115],v18 offset:4096
QAQ v86,0
QAC v[72:75],v[40:43],a[40:47],v10
QAG v[116:119],v18 offset:5120
QAQ v87,0
QAC v[76:79],v[40:43],v[120:127],v10
QAH vmcnt(1)
s_barrier
QAG v[48:51],v1 offset:4096
QAG v[52:55],v1 offset:5120
QAH lgkmcnt(10)
QAC v[64:67],v[44:47],a[48:55],v10
QAG v[56:59],v1 offset:6144
QAH lgkmcnt(9)
QAC v[68:71],v[44:47],v[88:95],v10
QAG v[60:63],v1 offset:7168
QAC v[72:75],v[44:47],a[56:63],v10
QAG v[120:123],v18 offset:8192
QAH lgkmcnt(9)
QAC v[76:79],v[44:47],v[96:103],v10
QAG v[124:127],v18 offset:9216
QAH lgkmcnt(5)
QAC v[64:67],v[48:51],a[64:71],v10
QAG v[88:91],v18 offset:12288
v_max_u32 v30,v48,v49
QAC v[68:71],v[48:51],v[104:111],v10
QAH lgkmcnt(5)
QAG v[92:95],v18 offset:13312
QAV v30,v30,v50,v51
QAC v[64:67],v[52:55],a[80:87],v10
QAG v[96:99],v18 offset:2048
QAV v30,v30,v52,v53
QAC v[68:71],v[52:55],v[112:119],v10
QAH lgkmcnt(6)
QAG v[100:103],v18 offset:3072
QAV v30,v30,v54,v55
QAC v[64:67],v[56:59],a[96:103],v10
QAH lgkmcnt(4)
QAG v[104:107],v18 offset:6144
QAV v30,v30,v56,v57
QAC v[68:71],v[56:59],v[120:127],v10
QAG v[108:111],v18 offset:7168
QAV v30,v30,v58,v59
QAC v[64:67],v[60:63],a[112:119],v10
QAH lgkmcnt(4)
QAG v[112:115],v18 offset:10240
QAV v30,v30,v60,v61
QAC v[68:71],v[60:63],v[88:95],v10
QAG v[116:119],v18 offset:11264
QAV v30,v30,v62,v63
QAC v[72:75],v[48:51],a[72:79],v10
QAH lgkmcnt(4)
QAG v[120:123],v18 offset:14336
QBP vcc,-1,v30
QAC v[76:79],v[48:51],v[96:103],v10
QAG v[124:127],v18 offset:15360
QAU v64,v64,v66
QAC v[72:75],v[52:55],a[88:95],v10
QAH lgkmcnt(4)
QAF s31,s29,s54
QAU v65,v65,v67
QAC v[76:79],v[52:55],v[104:111],v10
QAU v68,v68,v70
QAC v[72:75],v[56:59],a[104:111],v10
QAH lgkmcnt(2)
QAF s42,s29,s52
QAU v69,v69,v71
QAC v[76:79],v[56:59],v[112:119],v10
QAW v68,s34,v68
QAC v[72:75],v[60:63],a[120:127],v10
QAH lgkmcnt(0)
QAW v69,s34,v69
QAC v[76:79],v[60:63],v[120:127],v10
QAE v20,v64,v65
QAC v[80:83],v[32:35],a[128:135],v10
QAE v21,v68,v69
QAC v[84:87],v[32:35],a[136:143],v10
QAU v72,v72,v74
QAU v73,v73,v75
QAU v76,v76,v78
QAU v77,v77,v79
QAE v22,v72,v73
QAW v76,s34,v76
QAW v77,s34,v77
QAE v23,v76,v77
s_cbranch_vccnz lay_s0_redo_l
ds_write2_b64 v3,v[20:21],v[22:23] offset1:64
QAC v[80:83],v[36:39],a[144:151],v10
QAC v[84:87],v[36:39],a[152:159],v10
QAC v[80:83],v[40:43],a[160:167],v10
QAC v[84:87],v[40:43],a[168:175],v10
QAC v[80:83],v[44:47],a[176:183],v10
QAC v[84:87],v[44:47],a[184:191],v10
QAC v[80:83],v[48:51],a[192:199],v10
QAH lgkmcnt(0)
s_barrier
QAA v[20:21],v4 offset:0
QAA v[22:23],v4 offset:256
QAC v[84:87],v[48:51],a[200:207],v10
QAC v[80:83],v[52:55],a[208:215],v10
QAC v[84:87],v[52:55],a[216:223],v10
QAC v[80:83],v[56:59],a[224:231],v10
QAC v[84:87],v[56:59],a[232:239],v10
QAC v[80:83],v[60:63],a[240:247],v10
QAC v[84:87],v[60:63],a[248:255],v10
s_nop 3
QAU v80,v80,v82
QAU v81,v81,v83
QAE v24,v80,v81
s_nop 0
QAU v84,v84,v86
QAU v85,v85,v87
QAE v26,v84,v85
QAH lgkmcnt(0)
QBY vcc,s[36:37]
QCF v30,v24 quad_perm:[0,1,0,1] row_mask:0xf bank_mask:0xf
QCF v31,v26 quad_perm:[0,1,0,1] row_mask:0xf bank_mask:0xf
QAX v20,v20,v24,vcc
QAX v21,v21,v26,vcc
QAX v22,v22,v30,vcc
QAX v23,v23,v31,vcc
QAL v[20:23],v1,s[16:19],s26 offen sc1
QAH vmcnt(0)
s_barrier
QAQ v31,64
s_branch lay_fin
lay_s0_entry:
QAG v[32:35],v1 offset:0
QAG v[36:39],v1 offset:1024
QAG v[40:43],v1 offset:2048
s_branch lay_s0_entry2
lay_s0_entry_l:
QAG v[32:35],v1 offset:0
QAG v[36:39],v1 offset:1024
QAG v[40:43],v1 offset:2048
s_branch lay_s0_entry2_l
lay_s0_rr:
QAD v[56:59],v1,s[16:19],s28 offen sc1
QAD v[60:63],v1,s[16:19],s28 offen offset:1024 sc1
QAH vmcnt(3)
QAJ v[48:51],v[12:15],v[80:83],0
QBG v30,v80,v82,s32 bitop3:0x7e
QAH vmcnt(2)
QAJ v[48:51],v[12:15],v[84:87],v[48:51]
QBG v31,v84,v86,s32 bitop3:0x7e
QBG v30,v30,v31,1 bitop3:0xa8
v_cmp_ne_u32 vcc,0,v30
s_cbranch_vccz lay_s0_rok
lay_s0_rr_lp:
QAD v[80:83],v1,s[16:19],s28 offen sc1
QAD v[84:87],v1,s[16:19],s28 offen offset:1024 sc1
QAH vmcnt(3)
QAJ v[48:51],v[12:15],v[56:59],0
QBG v30,v56,v58,s32 bitop3:0x7e
QAH vmcnt(2)
QAJ v[48:51],v[12:15],v[60:63],v[48:51]
QBG v31,v60,v62,s32 bitop3:0x7e
QBG v30,v30,v31,1 bitop3:0xa8
v_cmp_ne_u32 vcc,0,v30
s_cbranch_vccz lay_s0_rok
QAD v[56:59],v1,s[16:19],s28 offen sc1
QAD v[60:63],v1,s[16:19],s28 offen offset:1024 sc1
QAH vmcnt(3)
QAJ v[48:51],v[12:15],v[80:83],0
QBG v30,v80,v82,s32 bitop3:0x7e
QAH vmcnt(2)
QAJ v[48:51],v[12:15],v[84:87],v[48:51]
QBG v31,v84,v86,s32 bitop3:0x7e
QBG v30,v30,v31,1 bitop3:0xa8
v_cmp_ne_u32 vcc,0,v30
s_cbranch_vccz lay_s0_rok
QAF s14,s14,s3
QBK s14,200000
s_cbranch_scc1 lay_s0_rr_to
s_branch lay_s0_rr_lp
lay_s0_rr_to:
QAT s3,200000
s_branch lay_s0_rok
lay_s0_gr:
QAD v[48:51],v0,s[16:19],s31 offen sc1
QAD v[52:55],v0,s[16:19],s31 offen offset:1024 sc1
QAH vmcnt(3)
QAY v19,v[56:59]
QAV v30,v56,v57,v58
QAH vmcnt(2)
QAY v19,v[60:63] offset:1024
QAV v30,v30,v59,v60
QAV v30,v30,v61,v62
v_max_u32 v30,v30,v63
QBP vcc,-1,v30
s_cbranch_vccz lay_s0_gok
lay_s0_gr_lp:
QAD v[56:59],v0,s[16:19],s31 offen sc1
QAD v[60:63],v0,s[16:19],s31 offen offset:1024 sc1
QAH vmcnt(3)
QAY v19,v[48:51]
QAV v30,v48,v49,v50
QAH vmcnt(2)
QAY v19,v[52:55] offset:1024
QAV v30,v30,v51,v52
QAV v30,v30,v53,v54
v_max_u32 v30,v30,v55
QBP vcc,-1,v30
s_cbranch_vccz lay_s0_gok
QAD v[48:51],v0,s[16:19],s31 offen sc1
QAD v[52:55],v0,s[16:19],s31 offen offset:1024 sc1
QAH vmcnt(3)
QAY v19,v[56:59]
QAV v30,v56,v57,v58
QAH vmcnt(2)
QAY v19,v[60:63] offset:1024
QAV v30,v30,v59,v60
QAV v30,v30,v61,v62
v_max_u32 v30,v30,v63
QBP vcc,-1,v30
s_cbranch_vccz lay_s0_gok
QAF s15,s15,s3
QBK s15,200000
s_cbranch_scc1 lay_s0_gr_to
s_branch lay_s0_gr_lp
lay_s0_gr_to:
QAT s3,200000
s_branch lay_s0_gok
lay_s0_redo:
QAF s15,s15,s3
QBK s15,200000
s_cbranch_scc1 lay_end
QAH vmcnt(0) lgkmcnt(0)
s_barrier
QAF s40,s53,56688640
QAF s42,s30,s39
QAF s31,s30,s39
QAF s42,s42,4096
QAF m0,s39,0
s_nop 0
QAD v0,s[16:19],s31 offen sc1 lds
QAF m0,s39,4096
QAR v[64:65],0
QAR v[66:67],0
QAR v[68:69],0
QAR v[70:71],0
QAR v[72:73],0
QAR v[74:75],0
QAR v[76:77],0
QAR v[78:79],0
QAD v0,s[16:19],s42 offen sc1 lds
QAG v[80:83],v17 offset:0
QAG v[84:87],v17 offset:1024
QAG v[88:91],v17 offset:2048
QAG v[92:95],v17 offset:3072
QAG v[96:99],v17 offset:4096
QAG v[100:103],v17 offset:5120
QAG v[104:107],v17 offset:6144
QAG v[108:111],v17 offset:7168
QAG v[112:115],v17 offset:8192
QAG v[116:119],v17 offset:9216
QAG v[120:123],v17 offset:10240
QAG v[124:127],v17 offset:11264
QAH vmcnt(0) lgkmcnt(0)
s_barrier
s_branch lay_s0_entry
lay_s0_gr_l:
QAD v[48:51],v0,s[16:19],s31 offen sc1
QAD v[52:55],v0,s[16:19],s31 offen offset:1024 sc1
QAH vmcnt(3)
QAY v19,v[56:59]
QAV v30,v56,v57,v58
QAH vmcnt(2)
QAY v19,v[60:63] offset:1024
QAV v30,v30,v59,v60
QAV v30,v30,v61,v62
v_max_u32 v30,v30,v63
QBP vcc,-1,v30
s_cbranch_vccz lay_s0_gok_l
lay_s0_gr_l_lp:
QAD v[56:59],v0,s[16:19],s31 offen sc1
QAD v[60:63],v0,s[16:19],s31 offen offset:1024 sc1
QAH vmcnt(3)
QAY v19,v[48:51]
QAV v30,v48,v49,v50
QAH vmcnt(2)
QAY v19,v[52:55] offset:1024
QAV v30,v30,v51,v52
QAV v30,v30,v53,v54
v_max_u32 v30,v30,v55
QBP vcc,-1,v30
s_cbranch_vccz lay_s0_gok_l
QAD v[48:51],v0,s[16:19],s31 offen sc1
QAD v[52:55],v0,s[16:19],s31 offen offset:1024 sc1
QAH vmcnt(3)
QAY v19,v[56:59]
QAV v30,v56,v57,v58
QAH vmcnt(2)
QAY v19,v[60:63] offset:1024
QAV v30,v30,v59,v60
QAV v30,v30,v61,v62
v_max_u32 v30,v30,v63
QBP vcc,-1,v30
s_cbranch_vccz lay_s0_gok_l
QAF s15,s15,s3
QBK s15,200000
s_cbranch_scc1 lay_s0_gr_l_to
s_branch lay_s0_gr_l_lp
lay_s0_gr_l_to:
QAT s3,200000
s_branch lay_s0_gok_l
lay_s0_redo_l:
QAF s15,s15,s3
QBK s15,200000
s_cbranch_scc1 lay_end
QAH vmcnt(0) lgkmcnt(0)
s_barrier
QAF s40,s53,56688640
QAF s42,s30,s39
QAF s31,s30,s39
QAF s42,s42,4096
QAF m0,s39,0
s_nop 0
QAD v0,s[16:19],s31 offen sc1 lds
QAF m0,s39,4096
QAR v[64:65],0
QAR v[66:67],0
QAR v[68:69],0
QAR v[70:71],0
QAR v[72:73],0
QAR v[74:75],0
QAR v[76:77],0
QAR v[78:79],0
QAD v0,s[16:19],s42 offen sc1 lds
QAG v[80:83],v17 offset:0
QAG v[84:87],v17 offset:1024
QAG v[88:91],v17 offset:2048
QAG v[92:95],v17 offset:3072
QAG v[96:99],v17 offset:4096
QAG v[100:103],v17 offset:5120
QAG v[104:107],v17 offset:6144
QAG v[108:111],v17 offset:7168
QAG v[112:115],v17 offset:8192
QAG v[116:119],v17 offset:9216
QAG v[120:123],v17 offset:10240
QAG v[124:127],v17 offset:11264
QAH vmcnt(0) lgkmcnt(0)
s_barrier
s_branch lay_s0_entry_l
lay_s0_slow:
QAH lgkmcnt(0)
s_nop 7
QBQ v30,v32,v33,v34
QBQ v31,v35,v36,v37
QBQ v30,v30,v38,v39
QBQ v31,v31,v40,v41
v_max_f32 v30,v30,v31
QAQ v31,v30
s_nop 1
QCH v30,v31
v_max_f32 v30,v30,v31
QAQ v31,v30
s_nop 1
v_permlane16_swap_b32 v30,v31
v_max_f32 v30,v30,v31
QBV v44,v32,v30
QBV v45,v33,v30
QBV v46,v34,v30
QBV v47,v35,v30
QBV v48,v36,v30
QBV v49,v37,v30
QBV v50,v38,v30
QBV v51,v39,v30
QBV v52,v40,v30
QBV v53,v41,v30
QBA v44,v44
QBA v45,v45
QBA v46,v46
QBA v47,v47
QBA v48,v48
QBA v49,v49
QBA v50,v50
QBA v51,v51
QBA v52,v52
QBA v53,v53
QAE v54,v44,v45
QAE v55,v46,v47
QAE v56,v48,v49
QAE v57,v50,v51
QAE v28,v52,v53
s_nop 0
QAJ v[96:99],v[88:91],v[54:57],0
QAJ v[100:103],v[92:95],v[54:57],0
QAJ v[58:61],v[12:15],v[54:57],0
QBD v[58:61],v[12:13],v[28:29],v[58:61]
QBD v[96:99],v[24:25],v[28:29],v[96:99]
QBD v[100:103],v[26:27],v[28:29],v[100:103]
s_nop 7
v_rcp_f32 v30,v60
s_nop 0
QAW v96,v30,v96
QAW v97,v30,v97
QAW v98,v30,v98
QAW v99,v30,v99
QAW v100,v30,v100
QAW v101,v30,v101
QAW v102,v30,v102
QAW v103,v30,v103
QAE v44,v96,v97
QAE v45,v98,v99
QAE v46,v100,v101
QAE v47,v102,v103
QAY v5,v[44:47]
QAH lgkmcnt(0)
s_branch lay_s0_norm
.p2align 6
lay_s1_top:
QAH vmcnt(3)
QAV v30,v48,v49,v50
QAH vmcnt(2)
QAV v30,v30,v51,v52
QAV v30,v30,v53,v54
v_max_u32 v30,v30,v55
QBP vcc,-1,v30
s_cbranch_vccnz lay_s1_gr
QAY v19,v[48:51]
QAY v19,v[52:55] offset:1024
lay_s1_gok:
QAH lgkmcnt(0)
s_barrier
QAG v[32:35],v1 offset:0
QAG v[36:39],v1 offset:1024
QAG v[40:43],v1 offset:2048
QAD v0,s[16:19],s42 offen sc1 lds
lay_s1_entry2:
QAT m0,s47
QAH lgkmcnt(2)
QAC v[64:67],v[32:35],a[0:7],v10
QAG v[44:47],v1 offset:3072
QAC v[68:71],v[32:35],v[80:87],v10
QAC v[72:75],v[32:35],a[8:15],v10
QAC v[76:79],v[32:35],v[88:95],v10
QAD v1,s[16:19],s25 offen sc1 lds
QAH lgkmcnt(2)
QAG v[88:91],v17 offset:12288
QAQ v80,0
QAC v[64:67],v[36:39],a[16:23],v10
QAG v[92:95],v17 offset:13312
QAQ v81,0
QAC v[68:71],v[36:39],v[96:103],v10
QAG v[96:99],v17 offset:14336
QAQ v82,0
QAC v[72:75],v[36:39],a[24:31],v10
QAG v[100:103],v17 offset:15360
QAQ v83,0
QAC v[76:79],v[36:39],v[104:111],v10
QAD v1,s[16:19],s25 offen offset:1024 sc1 lds
QAH lgkmcnt(5)
QAG v[104:107],v18 offset:0
QAQ v84,0
QAC v[64:67],v[40:43],a[32:39],v10
QAG v[108:111],v18 offset:1024
QAQ v85,0
QAC v[68:71],v[40:43],v[112:119],v10
QAG v[112:115],v18 offset:4096
QAQ v86,0
QAC v[72:75],v[40:43],a[40:47],v10
QAG v[116:119],v18 offset:5120
QAQ v87,0
QAC v[76:79],v[40:43],v[120:127],v10
QAH vmcnt(2)
s_barrier
QAG v[48:51],v1 offset:4096
QAG v[52:55],v1 offset:5120
QAH lgkmcnt(10)
QAC v[64:67],v[44:47],a[48:55],v10
QAG v[56:59],v1 offset:6144
QAH lgkmcnt(9)
QAC v[68:71],v[44:47],v[88:95],v10
QAG v[60:63],v1 offset:7168
QAC v[72:75],v[44:47],a[56:63],v10
QAG v[120:123],v18 offset:8192
QAH lgkmcnt(9)
QAC v[76:79],v[44:47],v[96:103],v10
QAL v[20:23],v1,s[16:19],s40 offen sc1
QAG v[124:127],v18 offset:9216
QAH lgkmcnt(5)
QAC v[64:67],v[48:51],a[64:71],v10
QAG v[88:91],v18 offset:12288
v_max_u32 v30,v48,v49
QAC v[68:71],v[48:51],v[104:111],v10
QAH lgkmcnt(5)
QAG v[92:95],v18 offset:13312
QAV v30,v30,v50,v51
QAC v[64:67],v[52:55],a[80:87],v10
QAG v[96:99],v18 offset:2048
QAV v30,v30,v52,v53
QAC v[68:71],v[52:55],v[112:119],v10
QAH lgkmcnt(6)
QAG v[100:103],v18 offset:3072
QAV v30,v30,v54,v55
QAC v[64:67],v[56:59],a[96:103],v10
QAH lgkmcnt(4)
QAG v[104:107],v18 offset:6144
QAV v30,v30,v56,v57
QAC v[68:71],v[56:59],v[120:127],v10
QAG v[108:111],v18 offset:7168
QAV v30,v30,v58,v59
QAC v[64:67],v[60:63],a[112:119],v10
QAH lgkmcnt(4)
QAG v[112:115],v18 offset:10240
QAV v30,v30,v60,v61
QAC v[68:71],v[60:63],v[88:95],v10
QAG v[116:119],v18 offset:11264
QAV v30,v30,v62,v63
QAC v[72:75],v[48:51],a[72:79],v10
QAH lgkmcnt(4)
QAG v[120:123],v18 offset:14336
QBP vcc,-1,v30
QAC v[76:79],v[48:51],v[96:103],v10
QAG v[124:127],v18 offset:15360
QAU v64,v64,v66
QAC v[72:75],v[52:55],a[88:95],v10
QAH lgkmcnt(4)
QAF s31,s29,s54
QAG v[88:91],v2 offset:26624
QAU v65,v65,v67
QAC v[76:79],v[52:55],v[104:111],v10
QAG v[92:95],v2 offset:26880
QAU v68,v68,v70
QAC v[72:75],v[56:59],a[104:111],v10
QAH lgkmcnt(4)
QAF s42,s29,s52
QAG v[96:99],v16 offset:0
QAU v69,v69,v71
QAC v[76:79],v[56:59],v[112:119],v10
QAG v[100:103],v16 offset:2048
QAW v68,s34,v68
QAC v[72:75],v[60:63],a[120:127],v10
QAH lgkmcnt(4)
QAG v[104:107],v16 offset:4096
QAW v69,s34,v69
QAC v[76:79],v[60:63],v[120:127],v10
QAG v[108:111],v16 offset:6144
QAE v20,v64,v65
QAC v[80:83],v[32:35],a[128:135],v10
QAG v[112:115],v16 offset:256
QAE v21,v68,v69
QAC v[84:87],v[32:35],a[136:143],v10
QCG v3,v[20:21]
QAU v72,v72,v74
QAU v73,v73,v75
QAU v76,v76,v78
QAU v77,v77,v79
QAE v22,v72,v73
QAW v76,s34,v76
QAW v77,s34,v77
QAE v23,v76,v77
QCG v3,v[22:23] offset:512
QAC v[80:83],v[36:39],a[144:151],v10
QAC v[84:87],v[36:39],a[152:159],v10
QAG v[116:119],v16 offset:2304
QAC v[80:83],v[40:43],a[160:167],v10
QAG v[120:123],v16 offset:4352
QAC v[84:87],v[40:43],a[168:175],v10
QAG v[124:127],v16 offset:6400
QAC v[80:83],v[44:47],a[176:183],v10
s_cbranch_vccnz lay_s1_redo
QAH lgkmcnt(3)
s_barrier
QAA v[64:65],v4 offset:0
QAA v[66:67],v4 offset:256
QAF m0,s54,24576
QAF s13,s25,16777216
QAC v[84:87],v[44:47],a[184:191],v10
QAA v[68:69],v4 offset:1024
QAA v[70:71],v4 offset:1280
QAC v[80:83],v[48:51],a[192:199],v10
QAA v[72:73],v4 offset:2048
QAA v[74:75],v4 offset:2304
QAC v[84:87],v[48:51],a[200:207],v10
QAA v[76:77],v4 offset:3072
QAA v[78:79],v4 offset:3328
QAC v[80:83],v[52:55],a[208:215],v10
QAD v1,s[16:19],s13 offen sc1 lds
QAC v[84:87],v[52:55],a[216:223],v10
QAC v[80:83],v[56:59],a[224:231],v10
QAH lgkmcnt(0)
QAJ v[32:35],v[96:99],v[64:67],0
QAQ v20,v68
QAJ v[32:35],v[100:103],v[68:71],v[32:35]
QAD v1,s[16:19],s13 offen offset:1024 sc1 lds
QAQ v21,v69
QAJ v[32:35],v[104:107],v[72:75],v[32:35]
QAQ v22,v70
QAJ v[32:35],v[108:111],v[76:79],v[32:35]
QAQ v23,v71
QAJ v[36:39],v[112:115],v[64:67],0
QAJ v[36:39],v[116:119],v[68:71],v[36:39]
QAJ v[36:39],v[120:123],v[72:75],v[36:39]
QBA v44,v32
QAJ v[36:39],v[124:127],v[76:79],v[36:39]
QBA v45,v33
QAC v[84:87],v[56:59],a[232:239],v10
QBA v46,v34
QAC v[80:83],v[60:63],a[240:247],v10
QBA v47,v35
QAC v[84:87],v[60:63],a[248:255],v10
QBA v48,v36
QAJ v[40:43],v[64:67],v[64:67],0
QBA v49,v37
QAJ v[40:43],v[68:71],v[68:71],v[40:43]
QBA v50,v38
QAJ v[40:43],v[72:75],v[72:75],v[40:43]
QBA v51,v39
QAJ v[40:43],v[76:79],v[76:79],v[40:43]
QAE v54,v44,v45
QAE v55,v46,v47
QAE v56,v48,v49
QAE v57,v50,v51
QAU v80,v80,v82
QAU v81,v81,v83
QAJ v[58:61],v[12:15],v[54:57],0
QAE v24,v80,v81
QAU v84,v84,v86
QAJ v[96:99],v[88:91],v[54:57],0
QBA v52,v40
QAJ v[100:103],v[92:95],v[54:57],0
QBA v53,v41
QAU v85,v85,v87
QAE v28,v52,v53
QAE v26,v84,v85
QBQ v31,|v32|,|v33|,|v34|
QBD v[58:61],v[12:13],v[28:29],v[58:61]
QBQ v31,v31,|v35|,|v36|
QBQ v31,v31,|v37|,|v38|
QBD v[96:99],v[24:25],v[28:29],v[96:99]
QBQ v31,v31,|v39|,|v40|
v_max_f32 v31,v31,|v41|
QBD v[100:103],v[26:27],v[28:29],v[100:103]
v_rcp_f32 v30,v60
v_cmp_lt_f32 vcc,s33,v31
s_nop 1
QAW v96,v30,v96
QAW v97,v30,v97
QAW v98,v30,v98
QAW v99,v30,v99
QAE v44,v96,v97
QAE v45,v98,v99
QCG v5,v[44:45]
QBI v[100:101],v[100:101],v[30:31] op_sel_hi:[1,0]
QBI v[102:103],v[102:103],v[30:31] op_sel_hi:[1,0]
QAE v46,v100,v101
QAE v47,v102,v103
QCG v5,v[46:47] offset:8
s_and_b64 vcc,vcc,s[36:37]
s_cbranch_vccnz lay_s1_slow
lay_s1_norm:
QAR v[64:65],0
QAR v[66:67],0
QAR v[68:69],0
QAR v[70:71],0
QAH lgkmcnt(0)
s_barrier
QAG v[32:35],v6 offset:0
QAG v[36:39],v6 offset:512
QAG v[40:43],v6 offset:1024
QAG v[44:47],v6 offset:1536
QAF s13,s27,0
QAR v[72:73],0
QAR v[74:75],0
QAR v[76:77],0
QAR v[78:79],0
QAH lgkmcnt(2)
QAC v[64:67],v[32:35],v[128:135],v11
QAC v[64:67],v[36:39],v[136:143],v11
QAH lgkmcnt(0)
QAC v[64:67],v[40:43],v[144:151],v11
QAC v[64:67],v[44:47],v[152:159],v11
QAG v[88:91],v17 offset:2048
QAC v[68:71],v[32:35],v[160:167],v11
QAG v[92:95],v17 offset:3072
QAC v[68:71],v[36:39],v[168:175],v11
QAE v48,v64,v65
QAE v49,v66,v67
v_bfi_b32 v48,1,s32,v48
QBT v[48:49],v7,s[16:19],s13 offen sc1
QAC v[68:71],v[40:43],v[176:183],v11
QAG v[96:99],v17 offset:4096
QAC v[68:71],v[44:47],v[184:191],v11
QAG v[100:103],v17 offset:5120
QAC v[72:75],v[32:35],v[192:199],v11
QAF s13,s27,65536
QAG v[104:107],v17 offset:6144
QAC v[72:75],v[36:39],v[200:207],v11
QAE v50,v68,v69
QAE v51,v70,v71
v_bfi_b32 v50,1,s32,v50
QBT v[50:51],v7,s[16:19],s13 offen sc1
QAC v[72:75],v[40:43],v[208:215],v11
QAG v[108:111],v17 offset:7168
QAC v[72:75],v[44:47],v[216:223],v11
QAG v[112:115],v17 offset:8192
QAC v[76:79],v[32:35],v[224:231],v11
QAG v[116:119],v17 offset:9216
QAC v[76:79],v[36:39],v[232:239],v11
QAF s13,s27,131072
QAG v[120:123],v17 offset:10240
QAE v52,v72,v73
QAC v[76:79],v[40:43],v[240:247],v11
QAG v[124:127],v17 offset:11264
QAE v53,v74,v75
QAC v[76:79],v[44:47],v[248:255],v11
v_bfi_b32 v52,1,s32,v52
QBT v[52:53],v7,s[16:19],s13 offen sc1
QAF s13,s27,196608
QAT s40,s26
QAF s26,s26,4096
QAT s14,0
QAT s15,0
s_nop 0
QAE v54,v76,v77
QAE v55,v78,v79
v_bfi_b32 v54,1,s32,v54
QBT v[54:55],v7,s[16:19],s13 offen sc1
QAR v[64:65],0
QAR v[66:67],0
QAR v[68:69],0
QAR v[70:71],0
QAR v[72:73],0
QAD v[56:59],v1,s[16:19],s28 offen sc1
QAD v[60:63],v1,s[16:19],s28 offen offset:1024 sc1
QAR v[74:75],0
QAR v[76:77],0
QAR v[78:79],0
s_nop 15
s_nop 9
QAD v[80:83],v1,s[16:19],s28 offen sc1
QAD v[84:87],v1,s[16:19],s28 offen offset:1024 sc1
QAH vmcnt(3)
QAJ v[48:51],v[12:15],v[56:59],0
QBG v30,v56,v58,s32 bitop3:0x7e
QAH vmcnt(2)
QAJ v[48:51],v[12:15],v[60:63],v[48:51]
QBG v31,v60,v62,s32 bitop3:0x7e
QBG v30,v30,v31,1 bitop3:0xa8
v_cmp_ne_u32 vcc,0,v30
s_cbranch_vccnz lay_s1_rr
lay_s1_rok:
s_nop 0
QCE v52,v48,v48 row_ror:4 row_mask:0xf bank_mask:0xf
QCE v53,v49,v49 row_ror:4 row_mask:0xf bank_mask:0xf
s_nop 0
QCE v54,v52,v52 row_ror:8 row_mask:0xf bank_mask:0xf
QCE v55,v53,v53 row_ror:8 row_mask:0xf bank_mask:0xf
QAE v30,v54,v55
QCD v30,v8,s[16:19],s29 offen sc1
QAQ v31,-1
QCD v31,v8,s[16:19],s30 offen sc1
QAD v[48:51],v0,s[16:19],s31 offen sc1
QAD v[52:55],v0,s[16:19],s31 offen offset:1024 sc1
QAH vmcnt(4)
QAG v[80:83],v17 offset:0
QAG v[84:87],v17 offset:1024
QAT s41,s24
QAF s24,s24,1
QBY vcc,s[36:37]
QCF v30,v24 quad_perm:[0,1,0,1] row_mask:0xf bank_mask:0xf
QCF v31,v26 quad_perm:[0,1,0,1] row_mask:0xf bank_mask:0xf
QAX v20,v20,v24,vcc
QAX v21,v21,v26,vcc
QAX v22,v22,v30,vcc
QAX v23,v23,v31,vcc
QBO s13,s24,1
QAS s13,s13,18
QAF s27,s13,s57
QAF s28,s27,s43
QAF s13,s24,1
QBO s13,s13,3
QAS s13,s13,13
QAF s29,s13,s58
QBO s13,s24,3
QAS s13,s13,13
QAF s30,s13,s58
QCB s13,s24,1
QBO s13,s13,1
s_xor_b32 s32,s13,1
QAF s25,s25,8192
s_xor_b32 s47,s47,0x6000
QBH v16,0x6000,v16
QAD v[56:59],v0,s[16:19],s31 offen sc1
QAD v[60:63],v0,s[16:19],s31 offen offset:1024 sc1
QAF m0,s39,4096
lay_s1_cutend:
QBN s24,63
s_cbranch_scc1 lay_s1_top
QAH vmcnt(3)
QAV v30,v48,v49,v50
QAH vmcnt(2)
QAV v30,v30,v51,v52
QAV v30,v30,v53,v54
v_max_u32 v30,v30,v55
QBP vcc,-1,v30
s_cbranch_vccnz lay_s1_gr_l
QAY v19,v[48:51]
QAY v19,v[52:55] offset:1024
lay_s1_gok_l:
QAH lgkmcnt(0)
s_barrier
QAG v[32:35],v1 offset:0
QAG v[36:39],v1 offset:1024
QAG v[40:43],v1 offset:2048
QAD v0,s[16:19],s42 offen sc1 lds
lay_s1_entry2_l:
QAT m0,s47
QAH lgkmcnt(2)
QAC v[64:67],v[32:35],a[0:7],v10
QAG v[44:47],v1 offset:3072
QAC v[68:71],v[32:35],v[80:87],v10
QAC v[72:75],v[32:35],a[8:15],v10
QAC v[76:79],v[32:35],v[88:95],v10
QAL v[20:23],v1,s[16:19],s40 offen sc1
QAH lgkmcnt(2)
QAG v[88:91],v17 offset:12288
QAQ v80,0
QAC v[64:67],v[36:39],a[16:23],v10
QAG v[92:95],v17 offset:13312
QAQ v81,0
QAC v[68:71],v[36:39],v[96:103],v10
QAG v[96:99],v17 offset:14336
QAQ v82,0
QAC v[72:75],v[36:39],a[24:31],v10
QAG v[100:103],v17 offset:15360
QAQ v83,0
QAC v[76:79],v[36:39],v[104:111],v10
QAH lgkmcnt(5)
QAG v[104:107],v18 offset:0
QAQ v84,0
QAC v[64:67],v[40:43],a[32:39],v10
QAG v[108:111],v18 offset:1024
QAQ v85,0
QAC v[68:71],v[40:43],v[112:119],v10
QAG v[112:115],v18 offset:4096
QAQ v86,0
QAC v[72:75],v[40:43],a[40:47],v10
QAG v[116:119],v18 offset:5120
QAQ v87,0
QAC v[76:79],v[40:43],v[120:127],v10
QAH vmcnt(1)
s_barrier
QAG v[48:51],v1 offset:4096
QAG v[52:55],v1 offset:5120
QAH lgkmcnt(10)
QAC v[64:67],v[44:47],a[48:55],v10
QAG v[56:59],v1 offset:6144
QAH lgkmcnt(9)
QAC v[68:71],v[44:47],v[88:95],v10
QAG v[60:63],v1 offset:7168
QAC v[72:75],v[44:47],a[56:63],v10
QAG v[120:123],v18 offset:8192
QAH lgkmcnt(9)
QAC v[76:79],v[44:47],v[96:103],v10
QAG v[124:127],v18 offset:9216
QAH lgkmcnt(5)
QAC v[64:67],v[48:51],a[64:71],v10
QAG v[88:91],v18 offset:12288
v_max_u32 v30,v48,v49
QAC v[68:71],v[48:51],v[104:111],v10
QAH lgkmcnt(5)
QAG v[92:95],v18 offset:13312
QAV v30,v30,v50,v51
QAC v[64:67],v[52:55],a[80:87],v10
QAG v[96:99],v18 offset:2048
QAV v30,v30,v52,v53
QAC v[68:71],v[52:55],v[112:119],v10
QAH lgkmcnt(6)
QAG v[100:103],v18 offset:3072
QAV v30,v30,v54,v55
QAC v[64:67],v[56:59],a[96:103],v10
QAH lgkmcnt(4)
QAG v[104:107],v18 offset:6144
QAV v30,v30,v56,v57
QAC v[68:71],v[56:59],v[120:127],v10
QAG v[108:111],v18 offset:7168
QAV v30,v30,v58,v59
QAC v[64:67],v[60:63],a[112:119],v10
QAH lgkmcnt(4)
QAG v[112:115],v18 offset:10240
QAV v30,v30,v60,v61
QAC v[68:71],v[60:63],v[88:95],v10
QAG v[116:119],v18 offset:11264
QAV v30,v30,v62,v63
QAC v[72:75],v[48:51],a[72:79],v10
QAH lgkmcnt(4)
QAG v[120:123],v18 offset:14336
QBP vcc,-1,v30
QAC v[76:79],v[48:51],v[96:103],v10
QAG v[124:127],v18 offset:15360
QAU v64,v64,v66
QAC v[72:75],v[52:55],a[88:95],v10
QAH lgkmcnt(4)
QAF s31,s29,s54
QAU v65,v65,v67
QAC v[76:79],v[52:55],v[104:111],v10
QAU v68,v68,v70
QAC v[72:75],v[56:59],a[104:111],v10
QAH lgkmcnt(2)
QAF s42,s29,s52
QAU v69,v69,v71
QAC v[76:79],v[56:59],v[112:119],v10
QAW v68,s34,v68
QAC v[72:75],v[60:63],a[120:127],v10
QAH lgkmcnt(0)
QAW v69,s34,v69
QAC v[76:79],v[60:63],v[120:127],v10
QAE v20,v64,v65
QAC v[80:83],v[32:35],a[128:135],v10
QAE v21,v68,v69
QAC v[84:87],v[32:35],a[136:143],v10
QAU v72,v72,v74
QAU v73,v73,v75
QAU v76,v76,v78
QAU v77,v77,v79
QAE v22,v72,v73
QAW v76,s34,v76
QAW v77,s34,v77
QAE v23,v76,v77
s_cbranch_vccnz lay_s1_redo_l
ds_write2_b64 v3,v[20:21],v[22:23] offset1:64
QAC v[80:83],v[36:39],a[144:151],v10
QAC v[84:87],v[36:39],a[152:159],v10
QAC v[80:83],v[40:43],a[160:167],v10
QAC v[84:87],v[40:43],a[168:175],v10
QAC v[80:83],v[44:47],a[176:183],v10
QAC v[84:87],v[44:47],a[184:191],v10
QAC v[80:83],v[48:51],a[192:199],v10
QAH lgkmcnt(0)
s_barrier
QAA v[20:21],v4 offset:1024
QAA v[22:23],v4 offset:1280
QAC v[84:87],v[48:51],a[200:207],v10
QAC v[80:83],v[52:55],a[208:215],v10
QAC v[84:87],v[52:55],a[216:223],v10
QAC v[80:83],v[56:59],a[224:231],v10
QAC v[84:87],v[56:59],a[232:239],v10
QAC v[80:83],v[60:63],a[240:247],v10
QAC v[84:87],v[60:63],a[248:255],v10
s_nop 3
QAU v80,v80,v82
QAU v81,v81,v83
QAE v24,v80,v81
s_nop 0
QAU v84,v84,v86
QAU v85,v85,v87
QAE v26,v84,v85
QAH lgkmcnt(0)
QBY vcc,s[36:37]
QCF v30,v24 quad_perm:[0,1,0,1] row_mask:0xf bank_mask:0xf
QCF v31,v26 quad_perm:[0,1,0,1] row_mask:0xf bank_mask:0xf
QAX v20,v20,v24,vcc
QAX v21,v21,v26,vcc
QAX v22,v22,v30,vcc
QAX v23,v23,v31,vcc
QAL v[20:23],v1,s[16:19],s26 offen sc1
QAH vmcnt(0)
s_barrier
QAQ v31,64
s_branch lay_fin
lay_s1_entry:
QAG v[32:35],v1 offset:0
QAG v[36:39],v1 offset:1024
QAG v[40:43],v1 offset:2048
s_branch lay_s1_entry2
lay_s1_entry_l:
QAG v[32:35],v1 offset:0
QAG v[36:39],v1 offset:1024
QAG v[40:43],v1 offset:2048
s_branch lay_s1_entry2_l
lay_s1_rr:
QAD v[56:59],v1,s[16:19],s28 offen sc1
QAD v[60:63],v1,s[16:19],s28 offen offset:1024 sc1
QAH vmcnt(3)
QAJ v[48:51],v[12:15],v[80:83],0
QBG v30,v80,v82,s32 bitop3:0x7e
QAH vmcnt(2)
QAJ v[48:51],v[12:15],v[84:87],v[48:51]
QBG v31,v84,v86,s32 bitop3:0x7e
QBG v30,v30,v31,1 bitop3:0xa8
v_cmp_ne_u32 vcc,0,v30
s_cbranch_vccz lay_s1_rok
lay_s1_rr_lp:
QAD v[80:83],v1,s[16:19],s28 offen sc1
QAD v[84:87],v1,s[16:19],s28 offen offset:1024 sc1
QAH vmcnt(3)
QAJ v[48:51],v[12:15],v[56:59],0
QBG v30,v56,v58,s32 bitop3:0x7e
QAH vmcnt(2)
QAJ v[48:51],v[12:15],v[60:63],v[48:51]
QBG v31,v60,v62,s32 bitop3:0x7e
QBG v30,v30,v31,1 bitop3:0xa8
v_cmp_ne_u32 vcc,0,v30
s_cbranch_vccz lay_s1_rok
QAD v[56:59],v1,s[16:19],s28 offen sc1
QAD v[60:63],v1,s[16:19],s28 offen offset:1024 sc1
QAH vmcnt(3)
QAJ v[48:51],v[12:15],v[80:83],0
QBG v30,v80,v82,s32 bitop3:0x7e
QAH vmcnt(2)
QAJ v[48:51],v[12:15],v[84:87],v[48:51]
QBG v31,v84,v86,s32 bitop3:0x7e
QBG v30,v30,v31,1 bitop3:0xa8
v_cmp_ne_u32 vcc,0,v30
s_cbranch_vccz lay_s1_rok
QAF s14,s14,s3
QBK s14,200000
s_cbranch_scc1 lay_s1_rr_to
s_branch lay_s1_rr_lp
lay_s1_rr_to:
QAT s3,200000
s_branch lay_s1_rok
lay_s1_gr:
QAD v[48:51],v0,s[16:19],s31 offen sc1
QAD v[52:55],v0,s[16:19],s31 offen offset:1024 sc1
QAH vmcnt(3)
QAY v19,v[56:59]
QAV v30,v56,v57,v58
QAH vmcnt(2)
QAY v19,v[60:63] offset:1024
QAV v30,v30,v59,v60
QAV v30,v30,v61,v62
v_max_u32 v30,v30,v63
QBP vcc,-1,v30
s_cbranch_vccz lay_s1_gok
lay_s1_gr_lp:
QAD v[56:59],v0,s[16:19],s31 offen sc1
QAD v[60:63],v0,s[16:19],s31 offen offset:1024 sc1
QAH vmcnt(3)
QAY v19,v[48:51]
QAV v30,v48,v49,v50
QAH vmcnt(2)
QAY v19,v[52:55] offset:1024
QAV v30,v30,v51,v52
QAV v30,v30,v53,v54
v_max_u32 v30,v30,v55
QBP vcc,-1,v30
s_cbranch_vccz lay_s1_gok
QAD v[48:51],v0,s[16:19],s31 offen sc1
QAD v[52:55],v0,s[16:19],s31 offen offset:1024 sc1
QAH vmcnt(3)
QAY v19,v[56:59]
QAV v30,v56,v57,v58
QAH vmcnt(2)
QAY v19,v[60:63] offset:1024
QAV v30,v30,v59,v60
QAV v30,v30,v61,v62
v_max_u32 v30,v30,v63
QBP vcc,-1,v30
s_cbranch_vccz lay_s1_gok
QAF s15,s15,s3
QBK s15,200000
s_cbranch_scc1 lay_s1_gr_to
s_branch lay_s1_gr_lp
lay_s1_gr_to:
QAT s3,200000
s_branch lay_s1_gok
lay_s1_redo:
QAF s15,s15,s3
QBK s15,200000
s_cbranch_scc1 lay_end
QAH vmcnt(0) lgkmcnt(0)
s_barrier
QAF s40,s53,56688640
QAF s42,s30,s39
QAF s31,s30,s39
QAF s42,s42,4096
QAF m0,s39,0
s_nop 0
QAD v0,s[16:19],s31 offen sc1 lds
QAF m0,s39,4096
QAR v[64:65],0
QAR v[66:67],0
QAR v[68:69],0
QAR v[70:71],0
QAR v[72:73],0
QAR v[74:75],0
QAR v[76:77],0
QAR v[78:79],0
QAD v0,s[16:19],s42 offen sc1 lds
QAG v[80:83],v17 offset:0
QAG v[84:87],v17 offset:1024
QAG v[88:91],v17 offset:2048
QAG v[92:95],v17 offset:3072
QAG v[96:99],v17 offset:4096
QAG v[100:103],v17 offset:5120
QAG v[104:107],v17 offset:6144
QAG v[108:111],v17 offset:7168
QAG v[112:115],v17 offset:8192
QAG v[116:119],v17 offset:9216
QAG v[120:123],v17 offset:10240
QAG v[124:127],v17 offset:11264
QAH vmcnt(0) lgkmcnt(0)
s_barrier
s_branch lay_s1_entry
lay_s1_gr_l:
QAD v[48:51],v0,s[16:19],s31 offen sc1
QAD v[52:55],v0,s[16:19],s31 offen offset:1024 sc1
QAH vmcnt(3)
QAY v19,v[56:59]
QAV v30,v56,v57,v58
QAH vmcnt(2)
QAY v19,v[60:63] offset:1024
QAV v30,v30,v59,v60
QAV v30,v30,v61,v62
v_max_u32 v30,v30,v63
QBP vcc,-1,v30
s_cbranch_vccz lay_s1_gok_l
lay_s1_gr_l_lp:
QAD v[56:59],v0,s[16:19],s31 offen sc1
QAD v[60:63],v0,s[16:19],s31 offen offset:1024 sc1
QAH vmcnt(3)
QAY v19,v[48:51]
QAV v30,v48,v49,v50
QAH vmcnt(2)
QAY v19,v[52:55] offset:1024
QAV v30,v30,v51,v52
QAV v30,v30,v53,v54
v_max_u32 v30,v30,v55
QBP vcc,-1,v30
s_cbranch_vccz lay_s1_gok_l
QAD v[48:51],v0,s[16:19],s31 offen sc1
QAD v[52:55],v0,s[16:19],s31 offen offset:1024 sc1
QAH vmcnt(3)
QAY v19,v[56:59]
QAV v30,v56,v57,v58
QAH vmcnt(2)
QAY v19,v[60:63] offset:1024
QAV v30,v30,v59,v60
QAV v30,v30,v61,v62
v_max_u32 v30,v30,v63
QBP vcc,-1,v30
s_cbranch_vccz lay_s1_gok_l
QAF s15,s15,s3
QBK s15,200000
s_cbranch_scc1 lay_s1_gr_l_to
s_branch lay_s1_gr_l_lp
lay_s1_gr_l_to:
QAT s3,200000
s_branch lay_s1_gok_l
lay_s1_redo_l:
QAF s15,s15,s3
QBK s15,200000
s_cbranch_scc1 lay_end
QAH vmcnt(0) lgkmcnt(0)
s_barrier
QAF s40,s53,56688640
QAF s42,s30,s39
QAF s31,s30,s39
QAF s42,s42,4096
QAF m0,s39,0
s_nop 0
QAD v0,s[16:19],s31 offen sc1 lds
QAF m0,s39,4096
QAR v[64:65],0
QAR v[66:67],0
QAR v[68:69],0
QAR v[70:71],0
QAR v[72:73],0
QAR v[74:75],0
QAR v[76:77],0
QAR v[78:79],0
QAD v0,s[16:19],s42 offen sc1 lds
QAG v[80:83],v17 offset:0
QAG v[84:87],v17 offset:1024
QAG v[88:91],v17 offset:2048
QAG v[92:95],v17 offset:3072
QAG v[96:99],v17 offset:4096
QAG v[100:103],v17 offset:5120
QAG v[104:107],v17 offset:6144
QAG v[108:111],v17 offset:7168
QAG v[112:115],v17 offset:8192
QAG v[116:119],v17 offset:9216
QAG v[120:123],v17 offset:10240
QAG v[124:127],v17 offset:11264
QAH vmcnt(0) lgkmcnt(0)
s_barrier
s_branch lay_s1_entry_l
lay_s1_slow:
QAH lgkmcnt(0)
s_nop 7
QBQ v30,v32,v33,v34
QBQ v31,v35,v36,v37
QBQ v30,v30,v38,v39
QBQ v31,v31,v40,v41
v_max_f32 v30,v30,v31
QAQ v31,v30
s_nop 1
QCH v30,v31
v_max_f32 v30,v30,v31
QAQ v31,v30
s_nop 1
v_permlane16_swap_b32 v30,v31
v_max_f32 v30,v30,v31
QBV v44,v32,v30
QBV v45,v33,v30
QBV v46,v34,v30
QBV v47,v35,v30
QBV v48,v36,v30
QBV v49,v37,v30
QBV v50,v38,v30
QBV v51,v39,v30
QBV v52,v40,v30
QBV v53,v41,v30
QBA v44,v44
QBA v45,v45
QBA v46,v46
QBA v47,v47
QBA v48,v48
QBA v49,v49
QBA v50,v50
QBA v51,v51
QBA v52,v52
QBA v53,v53
QAE v54,v44,v45
QAE v55,v46,v47
QAE v56,v48,v49
QAE v57,v50,v51
QAE v28,v52,v53
s_nop 0
QAJ v[96:99],v[88:91],v[54:57],0
QAJ v[100:103],v[92:95],v[54:57],0
QAJ v[58:61],v[12:15],v[54:57],0
QBD v[58:61],v[12:13],v[28:29],v[58:61]
QBD v[96:99],v[24:25],v[28:29],v[96:99]
QBD v[100:103],v[26:27],v[28:29],v[100:103]
s_nop 7
v_rcp_f32 v30,v60
s_nop 0
QAW v96,v30,v96
QAW v97,v30,v97
QAW v98,v30,v98
QAW v99,v30,v99
QAW v100,v30,v100
QAW v101,v30,v101
QAW v102,v30,v102
QAW v103,v30,v103
QAE v44,v96,v97
QAE v45,v98,v99
QAE v46,v100,v101
QAE v47,v102,v103
QAY v5,v[44:47]
QAH lgkmcnt(0)
s_branch lay_s1_norm
.p2align 6
lay_s2_top:
s_barrier
QAG v[32:35],v1 offset:0
QAG v[36:39],v1 offset:1024
QAG v[40:43],v1 offset:2048
QAD v0,s[16:19],s42 offen sc1 lds
lay_s2_entry2:
QAT m0,s47
QAH lgkmcnt(2)
QAC v[64:67],v[32:35],a[0:7],v10
QAG v[44:47],v1 offset:3072
QAC v[68:71],v[32:35],v[80:87],v10
QAC v[72:75],v[32:35],a[8:15],v10
QAC v[76:79],v[32:35],v[88:95],v10
QAH lgkmcnt(2)
QAG v[88:91],v17 offset:12288
QAQ v80,0
QAC v[64:67],v[36:39],a[16:23],v10
QAD v1,s[16:19],s25 offen sc1 lds
QAG v[92:95],v17 offset:13312
QAQ v81,0
QAC v[68:71],v[36:39],v[96:103],v10
QAG v[96:99],v17 offset:14336
QAQ v82,0
QAC v[72:75],v[36:39],a[24:31],v10
QAG v[100:103],v17 offset:15360
QAQ v83,0
QAC v[76:79],v[36:39],v[104:111],v10
QAH lgkmcnt(5)
QAG v[104:107],v18 offset:0
QAQ v84,0
QAC v[64:67],v[40:43],a[32:39],v10
QAD v1,s[16:19],s25 offen offset:1024 sc1 lds
QAG v[108:111],v18 offset:1024
QAQ v85,0
QAC v[68:71],v[40:43],v[112:119],v10
QAG v[112:115],v18 offset:4096
QAQ v86,0
QAC v[72:75],v[40:43],a[40:47],v10
QAG v[116:119],v18 offset:5120
QAQ v87,0
QAC v[76:79],v[40:43],v[120:127],v10
QAH vmcnt(2)
s_barrier
QAG v[48:51],v1 offset:4096
QAG v[52:55],v1 offset:5120
QAH lgkmcnt(10)
QAC v[64:67],v[44:47],a[48:55],v10
QAG v[56:59],v1 offset:6144
QAH lgkmcnt(9)
QAC v[68:71],v[44:47],v[88:95],v10
QAG v[60:63],v1 offset:7168
QAC v[72:75],v[44:47],a[56:63],v10
QAG v[120:123],v18 offset:8192
QAH lgkmcnt(9)
QAC v[76:79],v[44:47],v[96:103],v10
QAG v[124:127],v18 offset:9216
QAH lgkmcnt(5)
QAC v[64:67],v[48:51],a[64:71],v10
QAL v[20:23],v1,s[16:19],s40 offen sc1
QAG v[88:91],v18 offset:12288
v_max_u32 v30,v48,v49
QAC v[68:71],v[48:51],v[104:111],v10
QAH lgkmcnt(5)
QAG v[92:95],v18 offset:13312
QAV v30,v30,v50,v51
QAC v[64:67],v[52:55],a[80:87],v10
QAG v[96:99],v18 offset:2048
QAV v30,v30,v52,v53
QAC v[68:71],v[52:55],v[112:119],v10
QAH lgkmcnt(6)
QAG v[100:103],v18 offset:3072
QAV v30,v30,v54,v55
QAC v[64:67],v[56:59],a[96:103],v10
QAQ v31,s41
QBY exec,1
QCD v31,off,s[16:19],s55 sc1
QBY exec,-1
QAH lgkmcnt(4)
QAG v[104:107],v18 offset:6144
QAV v30,v30,v56,v57
QAC v[68:71],v[56:59],v[120:127],v10
QAG v[108:111],v18 offset:7168
QAV v30,v30,v58,v59
QAC v[64:67],v[60:63],a[112:119],v10
QAH lgkmcnt(4)
QAG v[112:115],v18 offset:10240
QAV v30,v30,v60,v61
QAC v[68:71],v[60:63],v[88:95],v10
QAG v[116:119],v18 offset:11264
QAV v30,v30,v62,v63
QAC v[72:75],v[48:51],a[72:79],v10
QAH lgkmcnt(4)
QAG v[120:123],v18 offset:14336
QBP vcc,-1,v30
QAC v[76:79],v[48:51],v[96:103],v10
QAG v[124:127],v18 offset:15360
QAU v64,v64,v66
QAC v[72:75],v[52:55],a[88:95],v10
QAH lgkmcnt(4)
QAF s31,s29,s54
QAG v[88:91],v2 offset:28672
QAU v65,v65,v67
QAC v[76:79],v[52:55],v[104:111],v10
QAG v[92:95],v2 offset:28928
QAU v68,v68,v70
QAC v[72:75],v[56:59],a[104:111],v10
QAH lgkmcnt(4)
QAF s42,s29,s52
QAG v[96:99],v16 offset:0
QAU v69,v69,v71
QAC v[76:79],v[56:59],v[112:119],v10
QAG v[100:103],v16 offset:2048
QAW v68,s34,v68
QAC v[72:75],v[60:63],a[120:127],v10
QAH lgkmcnt(4)
QAG v[104:107],v16 offset:4096
QAW v69,s34,v69
QAC v[76:79],v[60:63],v[120:127],v10
QAG v[108:111],v16 offset:6144
QAE v20,v64,v65
QAC v[80:83],v[32:35],a[128:135],v10
QAG v[112:115],v16 offset:256
QAE v21,v68,v69
QAC v[84:87],v[32:35],a[136:143],v10
QCG v3,v[20:21]
QAU v72,v72,v74
QAU v73,v73,v75
QAU v76,v76,v78
QAU v77,v77,v79
QAE v22,v72,v73
QAW v76,s34,v76
QAW v77,s34,v77
QAE v23,v76,v77
QCG v3,v[22:23] offset:512
QAC v[80:83],v[36:39],a[144:151],v10
QAC v[84:87],v[36:39],a[152:159],v10
QAG v[116:119],v16 offset:2304
QAC v[80:83],v[40:43],a[160:167],v10
QAG v[120:123],v16 offset:4352
QAC v[84:87],v[40:43],a[168:175],v10
QAG v[124:127],v16 offset:6400
QAC v[80:83],v[44:47],a[176:183],v10
s_cbranch_vccnz lay_s2_redo
QAH lgkmcnt(3)
s_barrier
QAA v[64:65],v4 offset:0
QAA v[66:67],v4 offset:256
QAF m0,s54,24576
QAF s13,s25,16777216
QAC v[84:87],v[44:47],a[184:191],v10
QAA v[68:69],v4 offset:1024
QAA v[70:71],v4 offset:1280
QAC v[80:83],v[48:51],a[192:199],v10
QAA v[72:73],v4 offset:2048
QAA v[74:75],v4 offset:2304
QAC v[84:87],v[48:51],a[200:207],v10
QAA v[76:77],v4 offset:3072
QAA v[78:79],v4 offset:3328
QAC v[80:83],v[52:55],a[208:215],v10
QAC v[84:87],v[52:55],a[216:223],v10
QAD v1,s[16:19],s13 offen sc1 lds
QAC v[80:83],v[56:59],a[224:231],v10
QAH lgkmcnt(0)
QAJ v[32:35],v[96:99],v[64:67],0
QAQ v20,v72
QAJ v[32:35],v[100:103],v[68:71],v[32:35]
QAQ v21,v73
QAJ v[32:35],v[104:107],v[72:75],v[32:35]
QAD v1,s[16:19],s13 offen offset:1024 sc1 lds
QAQ v22,v74
QAJ v[32:35],v[108:111],v[76:79],v[32:35]
QAQ v23,v75
QAJ v[36:39],v[112:115],v[64:67],0
QAJ v[36:39],v[116:119],v[68:71],v[36:39]
QAJ v[36:39],v[120:123],v[72:75],v[36:39]
QBA v44,v32
QAJ v[36:39],v[124:127],v[76:79],v[36:39]
QBA v45,v33
QAC v[84:87],v[56:59],a[232:239],v10
QBA v46,v34
QAC v[80:83],v[60:63],a[240:247],v10
QBA v47,v35
QAC v[84:87],v[60:63],a[248:255],v10
QBA v48,v36
QAJ v[40:43],v[64:67],v[64:67],0
QBA v49,v37
QAJ v[40:43],v[68:71],v[68:71],v[40:43]
QBA v50,v38
QAJ v[40:43],v[72:75],v[72:75],v[40:43]
QBA v51,v39
QAJ v[40:43],v[76:79],v[76:79],v[40:43]
QAE v54,v44,v45
QAE v55,v46,v47
QAE v56,v48,v49
QAE v57,v50,v51
QAU v80,v80,v82
QAU v81,v81,v83
QAJ v[58:61],v[12:15],v[54:57],0
QAE v24,v80,v81
QAU v84,v84,v86
QAJ v[96:99],v[88:91],v[54:57],0
QBA v52,v40
QAJ v[100:103],v[92:95],v[54:57],0
QBA v53,v41
QAU v85,v85,v87
QAE v28,v52,v53
QAE v26,v84,v85
QBQ v31,|v32|,|v33|,|v34|
QBD v[58:61],v[12:13],v[28:29],v[58:61]
QBQ v31,v31,|v35|,|v36|
QBQ v31,v31,|v37|,|v38|
QBD v[96:99],v[24:25],v[28:29],v[96:99]
QBQ v31,v31,|v39|,|v40|
v_max_f32 v31,v31,|v41|
QBD v[100:103],v[26:27],v[28:29],v[100:103]
v_rcp_f32 v30,v60
v_cmp_lt_f32 vcc,s33,v31
s_nop 1
QAW v96,v30,v96
QAW v97,v30,v97
QAW v98,v30,v98
QAW v99,v30,v99
QAE v44,v96,v97
QAE v45,v98,v99
QCG v5,v[44:45]
QBI v[100:101],v[100:101],v[30:31] op_sel_hi:[1,0]
QBI v[102:103],v[102:103],v[30:31] op_sel_hi:[1,0]
QAE v46,v100,v101
QAE v47,v102,v103
QCG v5,v[46:47] offset:8
s_and_b64 vcc,vcc,s[36:37]
s_cbranch_vccnz lay_s2_slow
lay_s2_norm:
QAR v[64:65],0
QAR v[66:67],0
QAR v[68:69],0
QAR v[70:71],0
QAH lgkmcnt(0)
s_barrier
QAG v[32:35],v6 offset:0
QAG v[36:39],v6 offset:512
QAG v[40:43],v6 offset:1024
QAG v[44:47],v6 offset:1536
QAF s13,s27,0
QAR v[72:73],0
QAR v[74:75],0
QAR v[76:77],0
QAR v[78:79],0
QAH lgkmcnt(2)
QAC v[64:67],v[32:35],v[128:135],v11
QAC v[64:67],v[36:39],v[136:143],v11
QAH lgkmcnt(0)
QAC v[64:67],v[40:43],v[144:151],v11
QAC v[64:67],v[44:47],v[152:159],v11
QAG v[88:91],v17 offset:2048
QAC v[68:71],v[32:35],v[160:167],v11
QAG v[92:95],v17 offset:3072
QAC v[68:71],v[36:39],v[168:175],v11
QAE v48,v64,v65
QAE v49,v66,v67
v_bfi_b32 v48,1,s32,v48
QBT v[48:49],v7,s[16:19],s13 offen sc1
QAC v[68:71],v[40:43],v[176:183],v11
QAG v[96:99],v17 offset:4096
QAC v[68:71],v[44:47],v[184:191],v11
QAG v[100:103],v17 offset:5120
QAC v[72:75],v[32:35],v[192:199],v11
QAF s13,s27,65536
QAG v[104:107],v17 offset:6144
QAC v[72:75],v[36:39],v[200:207],v11
QAE v50,v68,v69
QAE v51,v70,v71
v_bfi_b32 v50,1,s32,v50
QBT v[50:51],v7,s[16:19],s13 offen sc1
QAC v[72:75],v[40:43],v[208:215],v11
QAG v[108:111],v17 offset:7168
QAC v[72:75],v[44:47],v[216:223],v11
QAG v[112:115],v17 offset:8192
QAC v[76:79],v[32:35],v[224:231],v11
QAG v[116:119],v17 offset:9216
QAC v[76:79],v[36:39],v[232:239],v11
QAF s13,s27,131072
QAG v[120:123],v17 offset:10240
QAE v52,v72,v73
QAC v[76:79],v[40:43],v[240:247],v11
QAG v[124:127],v17 offset:11264
QAE v53,v74,v75
QAC v[76:79],v[44:47],v[248:255],v11
v_bfi_b32 v52,1,s32,v52
QBT v[52:53],v7,s[16:19],s13 offen sc1
QAF s13,s27,196608
QAT s40,s26
QAF s26,s26,4096
QAT s14,0
QAT s15,0
s_nop 0
QAE v54,v76,v77
QAE v55,v78,v79
v_bfi_b32 v54,1,s32,v54
QBT v[54:55],v7,s[16:19],s13 offen sc1
QAR v[64:65],0
QAR v[66:67],0
QAR v[68:69],0
QAR v[70:71],0
QAR v[72:73],0
QAR v[74:75],0
QAR v[76:77],0
QAR v[78:79],0
s_nop 15
s_nop 15
s_nop 6
QAD v[56:59],v1,s[16:19],s28 offen sc1
QAD v[60:63],v1,s[16:19],s28 offen offset:1024 sc1
s_nop 15
s_nop 12
QAD v[80:83],v1,s[16:19],s28 offen sc1
QAD v[84:87],v1,s[16:19],s28 offen offset:1024 sc1
QAH vmcnt(3)
QAJ v[48:51],v[12:15],v[56:59],0
QBG v30,v56,v58,s32 bitop3:0x7e
QAH vmcnt(2)
QAJ v[48:51],v[12:15],v[60:63],v[48:51]
QBG v31,v60,v62,s32 bitop3:0x7e
QBG v30,v30,v31,1 bitop3:0xa8
v_cmp_ne_u32 vcc,0,v30
s_cbranch_vccnz lay_s2_rr
lay_s2_rok:
s_nop 0
QCE v52,v48,v48 row_ror:4 row_mask:0xf bank_mask:0xf
QCE v53,v49,v49 row_ror:4 row_mask:0xf bank_mask:0xf
s_nop 0
QCE v54,v52,v52 row_ror:8 row_mask:0xf bank_mask:0xf
QCE v55,v53,v53 row_ror:8 row_mask:0xf bank_mask:0xf
QAE v30,v54,v55
QCD v30,v8,s[16:19],s29 offen sc1
QAQ v31,-1
QCD v31,v8,s[16:19],s30 offen sc1
QAT s41,s24
QAF s24,s24,1
QBY vcc,s[36:37]
QCF v30,v24 quad_perm:[0,1,0,1] row_mask:0xf bank_mask:0xf
QCF v31,v26 quad_perm:[0,1,0,1] row_mask:0xf bank_mask:0xf
QAX v20,v20,v24,vcc
QAX v21,v21,v26,vcc
QAX v22,v22,v30,vcc
QAX v23,v23,v31,vcc
QBO s13,s24,1
QAS s13,s13,18
QAF s27,s13,s57
QAF s28,s27,s43
QAF s13,s24,1
QBO s13,s13,3
QAS s13,s13,13
QAF s29,s13,s58
QBO s13,s24,3
QAS s13,s13,13
QAF s30,s13,s58
QCB s13,s24,1
QBO s13,s13,1
s_xor_b32 s32,s13,1
QAF s25,s25,8192
s_xor_b32 s47,s47,0x6000
QBH v16,0x6000,v16
QAF m0,s39,4096
QAH vmcnt(2)
QAG v[80:83],v17 offset:0
QAG v[84:87],v17 offset:1024
lay_s2_cutend:
QBN s24,63
s_cbranch_scc1 lay_s2_top
s_barrier
QAG v[32:35],v1 offset:0
QAG v[36:39],v1 offset:1024
QAG v[40:43],v1 offset:2048
QAD v0,s[16:19],s42 offen sc1 lds
lay_s2_entry2_l:
QAT m0,s47
QAH lgkmcnt(2)
QAC v[64:67],v[32:35],a[0:7],v10
QAG v[44:47],v1 offset:3072
QAC v[68:71],v[32:35],v[80:87],v10
QAC v[72:75],v[32:35],a[8:15],v10
QAC v[76:79],v[32:35],v[88:95],v10
QAH lgkmcnt(2)
QAG v[88:91],v17 offset:12288
QAQ v80,0
QAC v[64:67],v[36:39],a[16:23],v10
QAL v[20:23],v1,s[16:19],s40 offen sc1
QAG v[92:95],v17 offset:13312
QAQ v81,0
QAC v[68:71],v[36:39],v[96:103],v10
QAG v[96:99],v17 offset:14336
QAQ v82,0
QAC v[72:75],v[36:39],a[24:31],v10
QAG v[100:103],v17 offset:15360
QAQ v83,0
QAC v[76:79],v[36:39],v[104:111],v10
QAH lgkmcnt(5)
QAG v[104:107],v18 offset:0
QAQ v84,0
QAC v[64:67],v[40:43],a[32:39],v10
QAQ v31,s41
QBY exec,1
QCD v31,off,s[16:19],s55 sc1
QBY exec,-1
QAG v[108:111],v18 offset:1024
QAQ v85,0
QAC v[68:71],v[40:43],v[112:119],v10
QAG v[112:115],v18 offset:4096
QAQ v86,0
QAC v[72:75],v[40:43],a[40:47],v10
QAG v[116:119],v18 offset:5120
QAQ v87,0
QAC v[76:79],v[40:43],v[120:127],v10
QAH vmcnt(2)
s_barrier
QAG v[48:51],v1 offset:4096
QAG v[52:55],v1 offset:5120
QAH lgkmcnt(10)
QAC v[64:67],v[44:47],a[48:55],v10
QAG v[56:59],v1 offset:6144
QAH lgkmcnt(9)
QAC v[68:71],v[44:47],v[88:95],v10
QAG v[60:63],v1 offset:7168
QAC v[72:75],v[44:47],a[56:63],v10
QAG v[120:123],v18 offset:8192
QAH lgkmcnt(9)
QAC v[76:79],v[44:47],v[96:103],v10
QAG v[124:127],v18 offset:9216
QAH lgkmcnt(5)
QAC v[64:67],v[48:51],a[64:71],v10
QAG v[88:91],v18 offset:12288
v_max_u32 v30,v48,v49
QAC v[68:71],v[48:51],v[104:111],v10
QAH lgkmcnt(5)
QAG v[92:95],v18 offset:13312
QAV v30,v30,v50,v51
QAC v[64:67],v[52:55],a[80:87],v10
QAG v[96:99],v18 offset:2048
QAV v30,v30,v52,v53
QAC v[68:71],v[52:55],v[112:119],v10
QAH lgkmcnt(6)
QAG v[100:103],v18 offset:3072
QAV v30,v30,v54,v55
QAC v[64:67],v[56:59],a[96:103],v10
QAH lgkmcnt(4)
QAG v[104:107],v18 offset:6144
QAV v30,v30,v56,v57
QAC v[68:71],v[56:59],v[120:127],v10
QAG v[108:111],v18 offset:7168
QAV v30,v30,v58,v59
QAC v[64:67],v[60:63],a[112:119],v10
QAH lgkmcnt(4)
QAG v[112:115],v18 offset:10240
QAV v30,v30,v60,v61
QAC v[68:71],v[60:63],v[88:95],v10
QAG v[116:119],v18 offset:11264
QAV v30,v30,v62,v63
QAC v[72:75],v[48:51],a[72:79],v10
QAH lgkmcnt(4)
QAG v[120:123],v18 offset:14336
QBP vcc,-1,v30
QAC v[76:79],v[48:51],v[96:103],v10
QAG v[124:127],v18 offset:15360
QAU v64,v64,v66
QAC v[72:75],v[52:55],a[88:95],v10
QAH lgkmcnt(4)
QAF s31,s29,s54
QAU v65,v65,v67
QAC v[76:79],v[52:55],v[104:111],v10
QAU v68,v68,v70
QAC v[72:75],v[56:59],a[104:111],v10
QAH lgkmcnt(2)
QAF s42,s29,s52
QAU v69,v69,v71
QAC v[76:79],v[56:59],v[112:119],v10
QAW v68,s34,v68
QAC v[72:75],v[60:63],a[120:127],v10
QAH lgkmcnt(0)
QAW v69,s34,v69
QAC v[76:79],v[60:63],v[120:127],v10
QAE v20,v64,v65
QAC v[80:83],v[32:35],a[128:135],v10
QAE v21,v68,v69
QAC v[84:87],v[32:35],a[136:143],v10
QAU v72,v72,v74
QAU v73,v73,v75
QAU v76,v76,v78
QAU v77,v77,v79
QAE v22,v72,v73
QAW v76,s34,v76
QAW v77,s34,v77
QAE v23,v76,v77
s_cbranch_vccnz lay_s2_redo_l
ds_write2_b64 v3,v[20:21],v[22:23] offset1:64
QAC v[80:83],v[36:39],a[144:151],v10
QAC v[84:87],v[36:39],a[152:159],v10
QAC v[80:83],v[40:43],a[160:167],v10
QAC v[84:87],v[40:43],a[168:175],v10
QAC v[80:83],v[44:47],a[176:183],v10
QAC v[84:87],v[44:47],a[184:191],v10
QAC v[80:83],v[48:51],a[192:199],v10
QAH lgkmcnt(0)
s_barrier
QAA v[20:21],v4 offset:2048
QAA v[22:23],v4 offset:2304
QAC v[84:87],v[48:51],a[200:207],v10
QAC v[80:83],v[52:55],a[208:215],v10
QAC v[84:87],v[52:55],a[216:223],v10
QAC v[80:83],v[56:59],a[224:231],v10
QAC v[84:87],v[56:59],a[232:239],v10
QAC v[80:83],v[60:63],a[240:247],v10
QAC v[84:87],v[60:63],a[248:255],v10
s_nop 3
QAU v80,v80,v82
QAU v81,v81,v83
QAE v24,v80,v81
s_nop 0
QAU v84,v84,v86
QAU v85,v85,v87
QAE v26,v84,v85
QAH lgkmcnt(0)
QBY vcc,s[36:37]
QCF v30,v24 quad_perm:[0,1,0,1] row_mask:0xf bank_mask:0xf
QCF v31,v26 quad_perm:[0,1,0,1] row_mask:0xf bank_mask:0xf
QAX v20,v20,v24,vcc
QAX v21,v21,v26,vcc
QAX v22,v22,v30,vcc
QAX v23,v23,v31,vcc
QAL v[20:23],v1,s[16:19],s26 offen sc1
QAH vmcnt(0)
s_barrier
QAQ v31,64
s_branch lay_fin
lay_s2_entry:
QAG v[32:35],v1 offset:0
QAG v[36:39],v1 offset:1024
QAG v[40:43],v1 offset:2048
s_branch lay_s2_entry2
lay_s2_entry_l:
QAG v[32:35],v1 offset:0
QAG v[36:39],v1 offset:1024
QAG v[40:43],v1 offset:2048
s_branch lay_s2_entry2_l
lay_s2_rr:
QAD v[56:59],v1,s[16:19],s28 offen sc1
QAD v[60:63],v1,s[16:19],s28 offen offset:1024 sc1
QAH vmcnt(3)
QAJ v[48:51],v[12:15],v[80:83],0
QBG v30,v80,v82,s32 bitop3:0x7e
QAH vmcnt(2)
QAJ v[48:51],v[12:15],v[84:87],v[48:51]
QBG v31,v84,v86,s32 bitop3:0x7e
QBG v30,v30,v31,1 bitop3:0xa8
v_cmp_ne_u32 vcc,0,v30
s_cbranch_vccz lay_s2_rok
lay_s2_rr_lp:
QAD v[80:83],v1,s[16:19],s28 offen sc1
QAD v[84:87],v1,s[16:19],s28 offen offset:1024 sc1
QAH vmcnt(3)
QAJ v[48:51],v[12:15],v[56:59],0
QBG v30,v56,v58,s32 bitop3:0x7e
QAH vmcnt(2)
QAJ v[48:51],v[12:15],v[60:63],v[48:51]
QBG v31,v60,v62,s32 bitop3:0x7e
QBG v30,v30,v31,1 bitop3:0xa8
v_cmp_ne_u32 vcc,0,v30
s_cbranch_vccz lay_s2_rok
QAD v[56:59],v1,s[16:19],s28 offen sc1
QAD v[60:63],v1,s[16:19],s28 offen offset:1024 sc1
QAH vmcnt(3)
QAJ v[48:51],v[12:15],v[80:83],0
QBG v30,v80,v82,s32 bitop3:0x7e
QAH vmcnt(2)
QAJ v[48:51],v[12:15],v[84:87],v[48:51]
QBG v31,v84,v86,s32 bitop3:0x7e
QBG v30,v30,v31,1 bitop3:0xa8
v_cmp_ne_u32 vcc,0,v30
s_cbranch_vccz lay_s2_rok
QAF s14,s14,s3
QBK s14,200000
s_cbranch_scc1 lay_s2_rr_to
s_branch lay_s2_rr_lp
lay_s2_rr_to:
QAT s3,200000
s_branch lay_s2_rok
lay_s2_redo:
QAF s15,s15,s3
QBK s15,200000
s_cbranch_scc1 lay_end
QAH vmcnt(0) lgkmcnt(0)
s_barrier
QAF s40,s53,56688640
QAF s42,s30,s39
QAF s31,s30,s39
QAF s42,s42,4096
QAF m0,s39,0
s_nop 0
QAD v0,s[16:19],s31 offen sc1 lds
QAF m0,s39,4096
QAR v[64:65],0
QAR v[66:67],0
QAR v[68:69],0
QAR v[70:71],0
QAR v[72:73],0
QAR v[74:75],0
QAR v[76:77],0
QAR v[78:79],0
QAD v0,s[16:19],s42 offen sc1 lds
QAG v[80:83],v17 offset:0
QAG v[84:87],v17 offset:1024
QAG v[88:91],v17 offset:2048
QAG v[92:95],v17 offset:3072
QAG v[96:99],v17 offset:4096
QAG v[100:103],v17 offset:5120
QAG v[104:107],v17 offset:6144
QAG v[108:111],v17 offset:7168
QAG v[112:115],v17 offset:8192
QAG v[116:119],v17 offset:9216
QAG v[120:123],v17 offset:10240
QAG v[124:127],v17 offset:11264
QAH vmcnt(0) lgkmcnt(0)
s_barrier
s_branch lay_s2_entry
lay_s2_redo_l:
QAF s15,s15,s3
QBK s15,200000
s_cbranch_scc1 lay_end
QAH vmcnt(0) lgkmcnt(0)
s_barrier
QAF s40,s53,56688640
QAF s42,s30,s39
QAF s31,s30,s39
QAF s42,s42,4096
QAF m0,s39,0
s_nop 0
QAD v0,s[16:19],s31 offen sc1 lds
QAF m0,s39,4096
QAR v[64:65],0
QAR v[66:67],0
QAR v[68:69],0
QAR v[70:71],0
QAR v[72:73],0
QAR v[74:75],0
QAR v[76:77],0
QAR v[78:79],0
QAD v0,s[16:19],s42 offen sc1 lds
QAG v[80:83],v17 offset:0
QAG v[84:87],v17 offset:1024
QAG v[88:91],v17 offset:2048
QAG v[92:95],v17 offset:3072
QAG v[96:99],v17 offset:4096
QAG v[100:103],v17 offset:5120
QAG v[104:107],v17 offset:6144
QAG v[108:111],v17 offset:7168
QAG v[112:115],v17 offset:8192
QAG v[116:119],v17 offset:9216
QAG v[120:123],v17 offset:10240
QAG v[124:127],v17 offset:11264
QAH vmcnt(0) lgkmcnt(0)
s_barrier
s_branch lay_s2_entry_l
lay_s2_slow:
QAH lgkmcnt(0)
s_nop 7
QBQ v30,v32,v33,v34
QBQ v31,v35,v36,v37
QBQ v30,v30,v38,v39
QBQ v31,v31,v40,v41
v_max_f32 v30,v30,v31
QAQ v31,v30
s_nop 1
QCH v30,v31
v_max_f32 v30,v30,v31
QAQ v31,v30
s_nop 1
v_permlane16_swap_b32 v30,v31
v_max_f32 v30,v30,v31
QBV v44,v32,v30
QBV v45,v33,v30
QBV v46,v34,v30
QBV v47,v35,v30
QBV v48,v36,v30
QBV v49,v37,v30
QBV v50,v38,v30
QBV v51,v39,v30
QBV v52,v40,v30
QBV v53,v41,v30
QBA v44,v44
QBA v45,v45
QBA v46,v46
QBA v47,v47
QBA v48,v48
QBA v49,v49
QBA v50,v50
QBA v51,v51
QBA v52,v52
QBA v53,v53
QAE v54,v44,v45
QAE v55,v46,v47
QAE v56,v48,v49
QAE v57,v50,v51
QAE v28,v52,v53
s_nop 0
QAJ v[96:99],v[88:91],v[54:57],0
QAJ v[100:103],v[92:95],v[54:57],0
QAJ v[58:61],v[12:15],v[54:57],0
QBD v[58:61],v[12:13],v[28:29],v[58:61]
QBD v[96:99],v[24:25],v[28:29],v[96:99]
QBD v[100:103],v[26:27],v[28:29],v[100:103]
s_nop 7
v_rcp_f32 v30,v60
s_nop 0
QAW v96,v30,v96
QAW v97,v30,v97
QAW v98,v30,v98
QAW v99,v30,v99
QAW v100,v30,v100
QAW v101,v30,v101
QAW v102,v30,v102
QAW v103,v30,v103
QAE v44,v96,v97
QAE v45,v98,v99
QAE v46,v100,v101
QAE v47,v102,v103
QAY v5,v[44:47]
QAH lgkmcnt(0)
s_branch lay_s2_norm
.p2align 6
lay_s3_top:
s_barrier
QAG v[32:35],v1 offset:0
QAG v[36:39],v1 offset:1024
QAG v[40:43],v1 offset:2048
QAD v0,s[16:19],s42 offen sc1 lds
lay_s3_entry2:
QAT m0,s47
QAH lgkmcnt(2)
QAC v[64:67],v[32:35],a[0:7],v10
QAG v[44:47],v1 offset:3072
QAC v[68:71],v[32:35],v[80:87],v10
QAC v[72:75],v[32:35],a[8:15],v10
QAC v[76:79],v[32:35],v[88:95],v10
QAH lgkmcnt(2)
QAG v[88:91],v17 offset:12288
QAQ v80,0
QAC v[64:67],v[36:39],a[16:23],v10
QAG v[92:95],v17 offset:13312
QAQ v81,0
QAC v[68:71],v[36:39],v[96:103],v10
QAD v1,s[16:19],s25 offen sc1 lds
QAG v[96:99],v17 offset:14336
QAQ v82,0
QAC v[72:75],v[36:39],a[24:31],v10
QAG v[100:103],v17 offset:15360
QAQ v83,0
QAC v[76:79],v[36:39],v[104:111],v10
QAH lgkmcnt(5)
QAG v[104:107],v18 offset:0
QAQ v84,0
QAC v[64:67],v[40:43],a[32:39],v10
QAG v[108:111],v18 offset:1024
QAQ v85,0
QAC v[68:71],v[40:43],v[112:119],v10
QAD v1,s[16:19],s25 offen offset:1024 sc1 lds
QAG v[112:115],v18 offset:4096
QAQ v86,0
QAC v[72:75],v[40:43],a[40:47],v10
QAG v[116:119],v18 offset:5120
QAQ v87,0
QAC v[76:79],v[40:43],v[120:127],v10
QAH vmcnt(2)
s_barrier
QAG v[48:51],v1 offset:4096
QAG v[52:55],v1 offset:5120
QAH lgkmcnt(10)
QAC v[64:67],v[44:47],a[48:55],v10
QAG v[56:59],v1 offset:6144
QAH lgkmcnt(9)
QAC v[68:71],v[44:47],v[88:95],v10
QAG v[60:63],v1 offset:7168
QAC v[72:75],v[44:47],a[56:63],v10
QAG v[120:123],v18 offset:8192
QAH lgkmcnt(9)
QAC v[76:79],v[44:47],v[96:103],v10
QAG v[124:127],v18 offset:9216
QAH lgkmcnt(5)
QAC v[64:67],v[48:51],a[64:71],v10
QAG v[88:91],v18 offset:12288
v_max_u32 v30,v48,v49
QAC v[68:71],v[48:51],v[104:111],v10
QAL v[20:23],v1,s[16:19],s40 offen sc1
QAH lgkmcnt(5)
QAG v[92:95],v18 offset:13312
QAV v30,v30,v50,v51
QAC v[64:67],v[52:55],a[80:87],v10
QAG v[96:99],v18 offset:2048
QAV v30,v30,v52,v53
QAC v[68:71],v[52:55],v[112:119],v10
QAH lgkmcnt(6)
QAG v[100:103],v18 offset:3072
QAV v30,v30,v54,v55
QAC v[64:67],v[56:59],a[96:103],v10
QAH lgkmcnt(4)
QAG v[104:107],v18 offset:6144
QAV v30,v30,v56,v57
QAC v[68:71],v[56:59],v[120:127],v10
QAG v[108:111],v18 offset:7168
QAV v30,v30,v58,v59
QAC v[64:67],v[60:63],a[112:119],v10
QAH lgkmcnt(4)
QAG v[112:115],v18 offset:10240
QAV v30,v30,v60,v61
QAC v[68:71],v[60:63],v[88:95],v10
QAG v[116:119],v18 offset:11264
QAV v30,v30,v62,v63
QAC v[72:75],v[48:51],a[72:79],v10
QAH lgkmcnt(4)
QAG v[120:123],v18 offset:14336
QBP vcc,-1,v30
QAC v[76:79],v[48:51],v[96:103],v10
QAG v[124:127],v18 offset:15360
QAU v64,v64,v66
QAC v[72:75],v[52:55],a[88:95],v10
QAH lgkmcnt(4)
QAF s31,s29,s54
QAG v[88:91],v2 offset:30720
QAU v65,v65,v67
QAC v[76:79],v[52:55],v[104:111],v10
QAG v[92:95],v2 offset:30976
QAU v68,v68,v70
QAC v[72:75],v[56:59],a[104:111],v10
QAH lgkmcnt(4)
QAF s42,s29,s52
QAG v[96:99],v16 offset:0
QAU v69,v69,v71
QAC v[76:79],v[56:59],v[112:119],v10
QAG v[100:103],v16 offset:2048
QAW v68,s34,v68
QAC v[72:75],v[60:63],a[120:127],v10
QAH lgkmcnt(4)
QAG v[104:107],v16 offset:4096
QAW v69,s34,v69
QAC v[76:79],v[60:63],v[120:127],v10
QAG v[108:111],v16 offset:6144
QAE v20,v64,v65
QAC v[80:83],v[32:35],a[128:135],v10
QAG v[112:115],v16 offset:256
QAE v21,v68,v69
QAC v[84:87],v[32:35],a[136:143],v10
QCG v3,v[20:21]
QAU v72,v72,v74
QAU v73,v73,v75
QAU v76,v76,v78
QAU v77,v77,v79
QAE v22,v72,v73
QAW v76,s34,v76
QAW v77,s34,v77
QAE v23,v76,v77
QCG v3,v[22:23] offset:512
QAC v[80:83],v[36:39],a[144:151],v10
QAC v[84:87],v[36:39],a[152:159],v10
QAG v[116:119],v16 offset:2304
QAC v[80:83],v[40:43],a[160:167],v10
QAG v[120:123],v16 offset:4352
QAC v[84:87],v[40:43],a[168:175],v10
QAG v[124:127],v16 offset:6400
QAC v[80:83],v[44:47],a[176:183],v10
s_cbranch_vccnz lay_s3_redo
QAH lgkmcnt(3)
s_barrier
QAA v[64:65],v4 offset:0
QAA v[66:67],v4 offset:256
QAF m0,s54,24576
QAF s13,s25,16777216
QAC v[84:87],v[44:47],a[184:191],v10
QAA v[68:69],v4 offset:1024
QAA v[70:71],v4 offset:1280
QAC v[80:83],v[48:51],a[192:199],v10
QAA v[72:73],v4 offset:2048
QAA v[74:75],v4 offset:2304
QAC v[84:87],v[48:51],a[200:207],v10
QAA v[76:77],v4 offset:3072
QAA v[78:79],v4 offset:3328
QAC v[80:83],v[52:55],a[208:215],v10
QAC v[84:87],v[52:55],a[216:223],v10
QAC v[80:83],v[56:59],a[224:231],v10
QAD v1,s[16:19],s13 offen sc1 lds
QAH lgkmcnt(0)
QAJ v[32:35],v[96:99],v[64:67],0
QAQ v20,v76
QAJ v[32:35],v[100:103],v[68:71],v[32:35]
QAQ v21,v77
QAJ v[32:35],v[104:107],v[72:75],v[32:35]
QAQ v22,v78
QAJ v[32:35],v[108:111],v[76:79],v[32:35]
QAD v1,s[16:19],s13 offen offset:1024 sc1 lds
QAQ v23,v79
QAJ v[36:39],v[112:115],v[64:67],0
QAJ v[36:39],v[116:119],v[68:71],v[36:39]
QAJ v[36:39],v[120:123],v[72:75],v[36:39]
QBA v44,v32
QAJ v[36:39],v[124:127],v[76:79],v[36:39]
QBW v9,2,v1
QBR v9,v9,s[16:19],s59 offen sc1
QBA v45,v33
QAC v[84:87],v[56:59],a[232:239],v10
QBA v46,v34
QAC v[80:83],v[60:63],a[240:247],v10
QBA v47,v35
QAC v[84:87],v[60:63],a[248:255],v10
QBA v48,v36
QAJ v[40:43],v[64:67],v[64:67],0
QBA v49,v37
QAJ v[40:43],v[68:71],v[68:71],v[40:43]
QBA v50,v38
QAJ v[40:43],v[72:75],v[72:75],v[40:43]
QBA v51,v39
QAJ v[40:43],v[76:79],v[76:79],v[40:43]
QAE v54,v44,v45
QAE v55,v46,v47
QAE v56,v48,v49
QAE v57,v50,v51
QAU v80,v80,v82
QAU v81,v81,v83
QAJ v[58:61],v[12:15],v[54:57],0
QAE v24,v80,v81
QAU v84,v84,v86
QAJ v[96:99],v[88:91],v[54:57],0
QBA v52,v40
QAJ v[100:103],v[92:95],v[54:57],0
QBA v53,v41
QAU v85,v85,v87
QAE v28,v52,v53
QAE v26,v84,v85
QBQ v31,|v32|,|v33|,|v34|
QBD v[58:61],v[12:13],v[28:29],v[58:61]
QBQ v31,v31,|v35|,|v36|
QBQ v31,v31,|v37|,|v38|
QBD v[96:99],v[24:25],v[28:29],v[96:99]
QBQ v31,v31,|v39|,|v40|
v_max_f32 v31,v31,|v41|
QBD v[100:103],v[26:27],v[28:29],v[100:103]
v_rcp_f32 v30,v60
v_cmp_lt_f32 vcc,s33,v31
s_nop 1
QAW v96,v30,v96
QAW v97,v30,v97
QAW v98,v30,v98
QAW v99,v30,v99
QAE v44,v96,v97
QAE v45,v98,v99
QCG v5,v[44:45]
QBI v[100:101],v[100:101],v[30:31] op_sel_hi:[1,0]
QBI v[102:103],v[102:103],v[30:31] op_sel_hi:[1,0]
QAE v46,v100,v101
QAE v47,v102,v103
QCG v5,v[46:47] offset:8
s_and_b64 vcc,vcc,s[36:37]
s_cbranch_vccnz lay_s3_slow
lay_s3_norm:
QAR v[64:65],0
QAR v[66:67],0
QAR v[68:69],0
QAR v[70:71],0
QAH lgkmcnt(0)
s_barrier
QAG v[32:35],v6 offset:0
QAG v[36:39],v6 offset:512
QAG v[40:43],v6 offset:1024
QAG v[44:47],v6 offset:1536
QAF s13,s27,0
QAR v[72:73],0
QAR v[74:75],0
QAR v[76:77],0
QAR v[78:79],0
QAH lgkmcnt(2)
QAC v[64:67],v[32:35],v[128:135],v11
QAC v[64:67],v[36:39],v[136:143],v11
QAH lgkmcnt(0)
QAC v[64:67],v[40:43],v[144:151],v11
QAC v[64:67],v[44:47],v[152:159],v11
QAG v[88:91],v17 offset:2048
QAC v[68:71],v[32:35],v[160:167],v11
QAG v[92:95],v17 offset:3072
QAC v[68:71],v[36:39],v[168:175],v11
QAE v48,v64,v65
QAE v49,v66,v67
v_bfi_b32 v48,1,s32,v48
QBT v[48:49],v7,s[16:19],s13 offen sc1
QAC v[68:71],v[40:43],v[176:183],v11
QAG v[96:99],v17 offset:4096
QAC v[68:71],v[44:47],v[184:191],v11
QAG v[100:103],v17 offset:5120
QAC v[72:75],v[32:35],v[192:199],v11
QAF s13,s27,65536
QAG v[104:107],v17 offset:6144
QAC v[72:75],v[36:39],v[200:207],v11
QAE v50,v68,v69
QAE v51,v70,v71
v_bfi_b32 v50,1,s32,v50
QBT v[50:51],v7,s[16:19],s13 offen sc1
QAC v[72:75],v[40:43],v[208:215],v11
QAG v[108:111],v17 offset:7168
QAC v[72:75],v[44:47],v[216:223],v11
QAG v[112:115],v17 offset:8192
QAC v[76:79],v[32:35],v[224:231],v11
QAG v[116:119],v17 offset:9216
QAC v[76:79],v[36:39],v[232:239],v11
QAF s13,s27,131072
QAG v[120:123],v17 offset:10240
QAE v52,v72,v73
QAC v[76:79],v[40:43],v[240:247],v11
QAG v[124:127],v17 offset:11264
QAE v53,v74,v75
QAC v[76:79],v[44:47],v[248:255],v11
v_bfi_b32 v52,1,s32,v52
QBT v[52:53],v7,s[16:19],s13 offen sc1
QAF s13,s27,196608
QAT s40,s26
QAF s26,s26,4096
QAT s14,0
QAT s15,0
s_nop 0
QAE v54,v76,v77
QAE v55,v78,v79
v_bfi_b32 v54,1,s32,v54
QBT v[54:55],v7,s[16:19],s13 offen sc1
QAR v[64:65],0
QAR v[66:67],0
QAR v[68:69],0
QAR v[70:71],0
QAR v[72:73],0
QAR v[74:75],0
QAR v[76:77],0
QAR v[78:79],0
s_nop 15
s_nop 15
s_nop 15
s_nop 5
QAD v[56:59],v1,s[16:19],s28 offen sc1
QAD v[60:63],v1,s[16:19],s28 offen offset:1024 sc1
s_nop 15
s_nop 12
QAD v[80:83],v1,s[16:19],s28 offen sc1
QAD v[84:87],v1,s[16:19],s28 offen offset:1024 sc1
QAH vmcnt(3)
QAJ v[48:51],v[12:15],v[56:59],0
QBG v30,v56,v58,s32 bitop3:0x7e
QAH vmcnt(2)
QAJ v[48:51],v[12:15],v[60:63],v[48:51]
QBG v31,v60,v62,s32 bitop3:0x7e
QBG v30,v30,v31,1 bitop3:0xa8
v_cmp_ne_u32 vcc,0,v30
s_cbranch_vccnz lay_s3_rr
lay_s3_rok:
s_nop 0
QCE v52,v48,v48 row_ror:4 row_mask:0xf bank_mask:0xf
QCE v53,v49,v49 row_ror:4 row_mask:0xf bank_mask:0xf
s_nop 0
QCE v54,v52,v52 row_ror:8 row_mask:0xf bank_mask:0xf
QCE v55,v53,v53 row_ror:8 row_mask:0xf bank_mask:0xf
QAE v30,v54,v55
QCD v30,v8,s[16:19],s29 offen sc1
QAQ v31,-1
QCD v31,v8,s[16:19],s30 offen sc1
QAT s41,s24
QAF s24,s24,1
QBY vcc,s[36:37]
QCF v30,v24 quad_perm:[0,1,0,1] row_mask:0xf bank_mask:0xf
QCF v31,v26 quad_perm:[0,1,0,1] row_mask:0xf bank_mask:0xf
QAX v20,v20,v24,vcc
QAX v21,v21,v26,vcc
QAX v22,v22,v30,vcc
QAX v23,v23,v31,vcc
QBO s13,s24,1
QAS s13,s13,18
QAF s27,s13,s57
QAF s28,s27,s43
QAF s13,s24,1
QBO s13,s13,3
QAS s13,s13,13
QAF s29,s13,s58
QBO s13,s24,3
QAS s13,s13,13
QAF s30,s13,s58
QCB s13,s24,1
QBO s13,s13,1
s_xor_b32 s32,s13,1
QAF s25,s25,8192
s_xor_b32 s47,s47,0x6000
QBH v16,0x6000,v16
QAF m0,s39,4096
QAF s13,s24,1
s_min_u32 s13,s13,63
QCB s38,s13,2
QAF s38,s38,2
QCB s13,s13,1
s_min_u32 s13,s13,s38
QAS s13,2,s13
s_sub_u32 s13,s13,1
lay_s3_kc:
v_cmp_le_u32 vcc,4,v9
s_nop 1
QBO s38,vcc_lo,s13
QBJ s38,s13
s_cbranch_scc1 lay_s3_kw
lay_s3_kok:
QAH vmcnt(2)
QAG v[80:83],v17 offset:0
QAG v[84:87],v17 offset:1024
lay_s3_cutend:
QBN s24,63
s_cbranch_scc1 lay_s3_top
s_barrier
QAG v[32:35],v1 offset:0
QAG v[36:39],v1 offset:1024
QAG v[40:43],v1 offset:2048
QAD v0,s[16:19],s42 offen sc1 lds
lay_s3_entry2_l:
QAT m0,s47
QAH lgkmcnt(2)
QAC v[64:67],v[32:35],a[0:7],v10
QAG v[44:47],v1 offset:3072
QAC v[68:71],v[32:35],v[80:87],v10
QAC v[72:75],v[32:35],a[8:15],v10
QAC v[76:79],v[32:35],v[88:95],v10
QAH lgkmcnt(2)
QAG v[88:91],v17 offset:12288
QAQ v80,0
QAC v[64:67],v[36:39],a[16:23],v10
QAG v[92:95],v17 offset:13312
QAQ v81,0
QAC v[68:71],v[36:39],v[96:103],v10
QAL v[20:23],v1,s[16:19],s40 offen sc1
QAG v[96:99],v17 offset:14336
QAQ v82,0
QAC v[72:75],v[36:39],a[24:31],v10
QAG v[100:103],v17 offset:15360
QAQ v83,0
QAC v[76:79],v[36:39],v[104:111],v10
QAH lgkmcnt(5)
QAG v[104:107],v18 offset:0
QAQ v84,0
QAC v[64:67],v[40:43],a[32:39],v10
QAG v[108:111],v18 offset:1024
QAQ v85,0
QAC v[68:71],v[40:43],v[112:119],v10
QAG v[112:115],v18 offset:4096
QAQ v86,0
QAC v[72:75],v[40:43],a[40:47],v10
QAG v[116:119],v18 offset:5120
QAQ v87,0
QAC v[76:79],v[40:43],v[120:127],v10
QAH vmcnt(1)
s_barrier
QAG v[48:51],v1 offset:4096
QAG v[52:55],v1 offset:5120
QAH lgkmcnt(10)
QAC v[64:67],v[44:47],a[48:55],v10
QAG v[56:59],v1 offset:6144
QAH lgkmcnt(9)
QAC v[68:71],v[44:47],v[88:95],v10
QAG v[60:63],v1 offset:7168
QAC v[72:75],v[44:47],a[56:63],v10
QAG v[120:123],v18 offset:8192
QAH lgkmcnt(9)
QAC v[76:79],v[44:47],v[96:103],v10
QAG v[124:127],v18 offset:9216
QAH lgkmcnt(5)
QAC v[64:67],v[48:51],a[64:71],v10
QAG v[88:91],v18 offset:12288
v_max_u32 v30,v48,v49
QAC v[68:71],v[48:51],v[104:111],v10
QAH lgkmcnt(5)
QAG v[92:95],v18 offset:13312
QAV v30,v30,v50,v51
QAC v[64:67],v[52:55],a[80:87],v10
QAG v[96:99],v18 offset:2048
QAV v30,v30,v52,v53
QAC v[68:71],v[52:55],v[112:119],v10
QAH lgkmcnt(6)
QAG v[100:103],v18 offset:3072
QAV v30,v30,v54,v55
QAC v[64:67],v[56:59],a[96:103],v10
QAH lgkmcnt(4)
QAG v[104:107],v18 offset:6144
QAV v30,v30,v56,v57
QAC v[68:71],v[56:59],v[120:127],v10
QAG v[108:111],v18 offset:7168
QAV v30,v30,v58,v59
QAC v[64:67],v[60:63],a[112:119],v10
QAH lgkmcnt(4)
QAG v[112:115],v18 offset:10240
QAV v30,v30,v60,v61
QAC v[68:71],v[60:63],v[88:95],v10
QAG v[116:119],v18 offset:11264
QAV v30,v30,v62,v63
QAC v[72:75],v[48:51],a[72:79],v10
QAH lgkmcnt(4)
QAG v[120:123],v18 offset:14336
QBP vcc,-1,v30
QAC v[76:79],v[48:51],v[96:103],v10
QAG v[124:127],v18 offset:15360
QAU v64,v64,v66
QAC v[72:75],v[52:55],a[88:95],v10
QAH lgkmcnt(4)
QAF s31,s29,s54
QAU v65,v65,v67
QAC v[76:79],v[52:55],v[104:111],v10
QAU v68,v68,v70
QAC v[72:75],v[56:59],a[104:111],v10
QAH lgkmcnt(2)
QAF s42,s29,s52
QAU v69,v69,v71
QAC v[76:79],v[56:59],v[112:119],v10
QAW v68,s34,v68
QAC v[72:75],v[60:63],a[120:127],v10
QAH lgkmcnt(0)
QAW v69,s34,v69
QAC v[76:79],v[60:63],v[120:127],v10
QAE v20,v64,v65
QAC v[80:83],v[32:35],a[128:135],v10
QAE v21,v68,v69
QAC v[84:87],v[32:35],a[136:143],v10
QAU v72,v72,v74
QAU v73,v73,v75
QAU v76,v76,v78
QAU v77,v77,v79
QAE v22,v72,v73
QAW v76,s34,v76
QAW v77,s34,v77
QAE v23,v76,v77
s_cbranch_vccnz lay_s3_redo_l
ds_write2_b64 v3,v[20:21],v[22:23] offset1:64
QAC v[80:83],v[36:39],a[144:151],v10
QAC v[84:87],v[36:39],a[152:159],v10
QAC v[80:83],v[40:43],a[160:167],v10
QAC v[84:87],v[40:43],a[168:175],v10
QAC v[80:83],v[44:47],a[176:183],v10
QAC v[84:87],v[44:47],a[184:191],v10
QAC v[80:83],v[48:51],a[192:199],v10
QAH lgkmcnt(0)
s_barrier
QAA v[20:21],v4 offset:3072
QAA v[22:23],v4 offset:3328
QAC v[84:87],v[48:51],a[200:207],v10
QAC v[80:83],v[52:55],a[208:215],v10
QAC v[84:87],v[52:55],a[216:223],v10
QAC v[80:83],v[56:59],a[224:231],v10
QAC v[84:87],v[56:59],a[232:239],v10
QAC v[80:83],v[60:63],a[240:247],v10
QAC v[84:87],v[60:63],a[248:255],v10
s_nop 3
QAU v80,v80,v82
QAU v81,v81,v83
QAE v24,v80,v81
s_nop 0
QAU v84,v84,v86
QAU v85,v85,v87
QAE v26,v84,v85
QAH lgkmcnt(0)
QBY vcc,s[36:37]
QCF v30,v24 quad_perm:[0,1,0,1] row_mask:0xf bank_mask:0xf
QCF v31,v26 quad_perm:[0,1,0,1] row_mask:0xf bank_mask:0xf
QAX v20,v20,v24,vcc
QAX v21,v21,v26,vcc
QAX v22,v22,v30,vcc
QAX v23,v23,v31,vcc
QAL v[20:23],v1,s[16:19],s26 offen sc1
QAH vmcnt(0)
s_barrier
QAQ v31,64
s_branch lay_fin
lay_s3_entry:
QAG v[32:35],v1 offset:0
QAG v[36:39],v1 offset:1024
QAG v[40:43],v1 offset:2048
s_branch lay_s3_entry2
lay_s3_entry_l:
QAG v[32:35],v1 offset:0
QAG v[36:39],v1 offset:1024
QAG v[40:43],v1 offset:2048
s_branch lay_s3_entry2_l
lay_s3_rr:
QAD v[56:59],v1,s[16:19],s28 offen sc1
QAD v[60:63],v1,s[16:19],s28 offen offset:1024 sc1
QAH vmcnt(3)
QAJ v[48:51],v[12:15],v[80:83],0
QBG v30,v80,v82,s32 bitop3:0x7e
QAH vmcnt(2)
QAJ v[48:51],v[12:15],v[84:87],v[48:51]
QBG v31,v84,v86,s32 bitop3:0x7e
QBG v30,v30,v31,1 bitop3:0xa8
v_cmp_ne_u32 vcc,0,v30
s_cbranch_vccz lay_s3_rok
lay_s3_rr_lp:
QAD v[80:83],v1,s[16:19],s28 offen sc1
QAD v[84:87],v1,s[16:19],s28 offen offset:1024 sc1
QAH vmcnt(3)
QAJ v[48:51],v[12:15],v[56:59],0
QBG v30,v56,v58,s32 bitop3:0x7e
QAH vmcnt(2)
QAJ v[48:51],v[12:15],v[60:63],v[48:51]
QBG v31,v60,v62,s32 bitop3:0x7e
QBG v30,v30,v31,1 bitop3:0xa8
v_cmp_ne_u32 vcc,0,v30
s_cbranch_vccz lay_s3_rok
QAD v[56:59],v1,s[16:19],s28 offen sc1
QAD v[60:63],v1,s[16:19],s28 offen offset:1024 sc1
QAH vmcnt(3)
QAJ v[48:51],v[12:15],v[80:83],0
QBG v30,v80,v82,s32 bitop3:0x7e
QAH vmcnt(2)
QAJ v[48:51],v[12:15],v[84:87],v[48:51]
QBG v31,v84,v86,s32 bitop3:0x7e
QBG v30,v30,v31,1 bitop3:0xa8
v_cmp_ne_u32 vcc,0,v30
s_cbranch_vccz lay_s3_rok
QAF s14,s14,s3
QBK s14,200000
s_cbranch_scc1 lay_s3_rr_to
s_branch lay_s3_rr_lp
lay_s3_rr_to:
QAT s3,200000
s_branch lay_s3_rok
lay_s3_redo:
QAF s15,s15,s3
QBK s15,200000
s_cbranch_scc1 lay_end
QAH vmcnt(0) lgkmcnt(0)
s_barrier
QAF s40,s53,56688640
QAF s42,s30,s39
QAF s31,s30,s39
QAF s42,s42,4096
QAF m0,s39,0
s_nop 0
QAD v0,s[16:19],s31 offen sc1 lds
QAF m0,s39,4096
QAR v[64:65],0
QAR v[66:67],0
QAR v[68:69],0
QAR v[70:71],0
QAR v[72:73],0
QAR v[74:75],0
QAR v[76:77],0
QAR v[78:79],0
QAD v0,s[16:19],s42 offen sc1 lds
QAG v[80:83],v17 offset:0
QAG v[84:87],v17 offset:1024
QAG v[88:91],v17 offset:2048
QAG v[92:95],v17 offset:3072
QAG v[96:99],v17 offset:4096
QAG v[100:103],v17 offset:5120
QAG v[104:107],v17 offset:6144
QAG v[108:111],v17 offset:7168
QAG v[112:115],v17 offset:8192
QAG v[116:119],v17 offset:9216
QAG v[120:123],v17 offset:10240
QAG v[124:127],v17 offset:11264
QAH vmcnt(0) lgkmcnt(0)
s_barrier
s_branch lay_s3_entry
lay_s3_redo_l:
QAF s15,s15,s3
QBK s15,200000
s_cbranch_scc1 lay_end
QAH vmcnt(0) lgkmcnt(0)
s_barrier
QAF s40,s53,56688640
QAF s42,s30,s39
QAF s31,s30,s39
QAF s42,s42,4096
QAF m0,s39,0
s_nop 0
QAD v0,s[16:19],s31 offen sc1 lds
QAF m0,s39,4096
QAR v[64:65],0
QAR v[66:67],0
QAR v[68:69],0
QAR v[70:71],0
QAR v[72:73],0
QAR v[74:75],0
QAR v[76:77],0
QAR v[78:79],0
QAD v0,s[16:19],s42 offen sc1 lds
QAG v[80:83],v17 offset:0
QAG v[84:87],v17 offset:1024
QAG v[88:91],v17 offset:2048
QAG v[92:95],v17 offset:3072
QAG v[96:99],v17 offset:4096
QAG v[100:103],v17 offset:5120
QAG v[104:107],v17 offset:6144
QAG v[108:111],v17 offset:7168
QAG v[112:115],v17 offset:8192
QAG v[116:119],v17 offset:9216
QAG v[120:123],v17 offset:10240
QAG v[124:127],v17 offset:11264
QAH vmcnt(0) lgkmcnt(0)
s_barrier
s_branch lay_s3_entry_l
lay_s3_kw:
QAF s15,s15,s3
QBK s15,200000
s_cbranch_scc1 lay_s3_kto
s_sleep 2
QBW v9,2,v1
QBR v9,v9,s[16:19],s59 offen sc1
QAH vmcnt(0)
s_branch lay_s3_kc
lay_s3_kto:
QAT s3,200000
s_branch lay_s3_kok
lay_s3_slow:
QAH lgkmcnt(0)
s_nop 7
QBQ v30,v32,v33,v34
QBQ v31,v35,v36,v37
QBQ v30,v30,v38,v39
QBQ v31,v31,v40,v41
v_max_f32 v30,v30,v31
QAQ v31,v30
s_nop 1
QCH v30,v31
v_max_f32 v30,v30,v31
QAQ v31,v30
s_nop 1
v_permlane16_swap_b32 v30,v31
v_max_f32 v30,v30,v31
QBV v44,v32,v30
QBV v45,v33,v30
QBV v46,v34,v30
QBV v47,v35,v30
QBV v48,v36,v30
QBV v49,v37,v30
QBV v50,v38,v30
QBV v51,v39,v30
QBV v52,v40,v30
QBV v53,v41,v30
QBA v44,v44
QBA v45,v45
QBA v46,v46
QBA v47,v47
QBA v48,v48
QBA v49,v49
QBA v50,v50
QBA v51,v51
QBA v52,v52
QBA v53,v53
QAE v54,v44,v45
QAE v55,v46,v47
QAE v56,v48,v49
QAE v57,v50,v51
QAE v28,v52,v53
s_nop 0
QAJ v[96:99],v[88:91],v[54:57],0
QAJ v[100:103],v[92:95],v[54:57],0
QAJ v[58:61],v[12:15],v[54:57],0
QBD v[58:61],v[12:13],v[28:29],v[58:61]
QBD v[96:99],v[24:25],v[28:29],v[96:99]
QBD v[100:103],v[26:27],v[28:29],v[100:103]
s_nop 7
v_rcp_f32 v30,v60
s_nop 0
QAW v96,v30,v96
QAW v97,v30,v97
QAW v98,v30,v98
QAW v99,v30,v99
QAW v100,v30,v100
QAW v101,v30,v101
QAW v102,v30,v102
QAW v103,v30,v103
QAE v44,v96,v97
QAE v45,v98,v99
QAE v46,v100,v101
QAE v47,v102,v103
QAY v5,v[44:47]
QAH lgkmcnt(0)
s_branch lay_s3_norm
lay_fin:
QBJ s9,2
s_cbranch_scc1 lay_fin2
QBY exec,1
QCD v31,off,s[16:19],s55 sc1
QBY exec,-1
lay_fin2:
QBJ s56,60817408
s_cbranch_scc1 lay_done
QAF s56,s56,1048576
QAH vmcnt(0)
s_barrier
s_branch lay_restart
lay_done:
QAH vmcnt(0)
lay_end:
s_endpgm
.section .rodata,"a"
.p2align 6
.amdhsa_kernel interleave_layers__memory_aug_recurrent_mem_tr__spectral_gfnet__prompt_kernel
  .amdhsa_next_free_vgpr 512
  .amdhsa_next_free_sgpr 102
  .amdhsa_accum_offset 256
  .amdhsa_group_segment_fixed_size 0
  .amdhsa_kernarg_size 104
  .amdhsa_user_sgpr_count 2
  .amdhsa_user_sgpr_kernarg_segment_ptr 1
  .amdhsa_system_sgpr_workgroup_id_x 1
  .amdhsa_float_denorm_mode_32 3
  .amdhsa_float_denorm_mode_16_64 3
.end_amdhsa_kernel
```
